```python
import torch

def _softmax(x, axis=-1):
    return torch.softmax(x, dim=axis)
def _gelu(x):
    return torch.nn.functional.gelu(x, approximate="tanh")
def _silu(x):
    return torch.nn.functional.silu(x)
def _sigmoid(x):
    return torch.sigmoid(x)
def _layernorm(x, axis=-1, eps=1e-5):
    m = x.mean(dim=axis, keepdim=True)
    v = x.var(dim=axis, keepdim=True, unbiased=False)
    return (x - m) / torch.sqrt(v + eps)
def _scatter_add(tgt, idx, src, axis=0):
    return tgt.clone().index_add_(axis, idx, src)
def _segment_sum(src, seg, n):
    out = torch.zeros((n,) + src.shape[1:], dtype=src.dtype)
    return out.index_add_(0, seg, src)
def _pad(x, pw):
    flat = tuple(v for pair in reversed(pw) for v in pair)
    return torch.nn.functional.pad(x, flat)

kernel_name = 'parallel_sum__compressed_kv_cla__swiglu_ffn__prompt'

def setup_inputs():

    _w = (lambda a: (lambda t: t.to(torch.bfloat16) if t.is_floating_point() else t)(torch.as_tensor(a)))
    def _A_setup():
        B, H, Sq, Sk, D, M = 1, 32, 2048, 2048, 128, 512
        Dc = 4 * D
        return {
            "x": _w((lambda *s: torch.randn(*s, dtype=torch.bfloat16) * 0.05)(B, Sq, M)),
            "c_kv": _w((lambda *s: torch.randn(*s, dtype=torch.bfloat16) * 1.6)(B, Sk, Dc)),
            "w_q": _w((lambda *s: torch.randn(*s, dtype=torch.bfloat16) * 0.8)(M, H, D) * (M ** -0.5)),
            "w_uk": _w((lambda *s: torch.randn(*s, dtype=torch.bfloat16) * 0.8)(Dc, H, D) * (Dc ** -0.5)),
            "w_uv": _w((lambda *s: torch.randn(*s, dtype=torch.bfloat16) * 1.6)(Dc, H, D) * (Dc ** -0.5)),
            "w_o": _w((lambda *s: torch.randn(*s, dtype=torch.bfloat16) * 1.6)(H, D, M) * ((H * D) ** -0.5)),
        }
    _A_in = _A_setup()

    def _B_setup():
        B, S, D, F = 1, 2048, 512, 1376
        return {
            "x": _w((lambda *s: torch.randn(*s, dtype=torch.bfloat16) * 0.05)(B, S, D)),
            "w_gate": _w((lambda *s: torch.randn(*s, dtype=torch.bfloat16) * 0.05)(D, F)),
            "w_up": _w((lambda *s: torch.randn(*s, dtype=torch.bfloat16) * 0.05)(D, F)),
            "w_down": _w((lambda *s: torch.randn(*s, dtype=torch.bfloat16) * 0.05)(F, D)),
        }
    _B_in = _B_setup()

    return {
        "A_x": _A_in["x"],
        "A_c_kv": _A_in["c_kv"],
        "A_w_q": _A_in["w_q"],
        "A_w_uk": _A_in["w_uk"],
        "A_w_uv": _A_in["w_uv"],
        "A_w_o": _A_in["w_o"],
        "B_x": _B_in["x"],
        "B_w_gate": _B_in["w_gate"],
        "B_w_up": _B_in["w_up"],
        "B_w_down": _B_in["w_down"],
    }

def reference(A_x, A_c_kv, A_w_q, A_w_uk, A_w_uv, A_w_o, B_x, B_w_gate, B_w_up, B_w_down):
    def _A_ref(x, c_kv, w_q, w_uk, w_uv, w_o):
        B, Sq, M = x.shape[0], x.shape[1], x.shape[2]
        Sk = c_kv.shape[1]
        H, D = w_q.shape[1], w_q.shape[2]
        q = torch.einsum("bqm,mhd->bhqd", x, w_q)
        k = torch.einsum("bkc,chd->bhkd", c_kv, w_uk)
        v = torch.einsum("bkc,chd->bhkd", c_kv, w_uv)
        scores = torch.einsum("bhqd,bhkd->bhqk", q, k) * (D ** -0.5)
        off = Sk - Sq
        qi = torch.arange(Sq)[:, None]
        kj = torch.arange(Sk)[None, :]
        cmask = kj <= (qi + off)
        scores = torch.where(cmask[None, None], scores, -1e9)
        p = _softmax(scores, axis=-1)
        ctx = torch.einsum("bhqk,bhkd->bhqd", p, v)
        return torch.einsum("bhqd,hdm->bqm", ctx, w_o)

    def _B_ref(x, w_gate, w_up, w_down):
        g = _silu(x @ w_gate)
        u = x @ w_up
        return (g * u) @ w_down

    x = A_x
    xn = _layernorm(x, axis=-1)
    return x + _A_ref(xn, A_c_kv, A_w_q, A_w_uk, A_w_uv, A_w_o) + _B_ref(xn, B_w_gate, B_w_up, B_w_down)
```

```asm
; @launch grid=(256,1,1) block=(512,1,1) lds=163840
.amdgcn_target "amdgcn-amd-amdhsa--gfx950"
.text
.globl parallel_sum__compressed_kv_cla__swiglu_ffn__prompt_kernel
.p2align 8
.type parallel_sum__compressed_kv_cla__swiglu_ffn__prompt_kernel,@function
parallel_sum__compressed_kv_cla__swiglu_ffn__prompt_kernel:
    s_cmp_ge_u32 s2, 256
    s_cbranch_scc1 K_end
    s_getpc_b64 s[100:101]
K_pc:
    s_sub_u32 s100, s100, K_pc-parallel_sum__compressed_kv_cla__swiglu_ffn__prompt_kernel
    s_subb_u32 s101, s101, 0
    s_lshr_b32 s38, s2, 3
    s_lshl_b32 s38, s38, 5
    v_and_b32 v4, 31, v0
    v_add_u32 v4, s38, v4
    v_lshlrev_b32 v4, 7, v4
    s_mov_b32 s38, K_code_end-parallel_sum__compressed_kv_cla__swiglu_ffn__prompt_kernel-128
    v_min_u32 v4, s38, v4
    v_and_b32 v6, 63, v0
    v_lshlrev_b32 v6, 7, v6
    v_lshrrev_b32 v7, 6, v0
    v_mul_u32_u24 v7, 0x2000, v7
    v_add_u32 v6, v6, v7
    v_subrev_u32 v6, 0x2000, v6
    v_cmp_gt_u32 vcc, 192, v0
    s_nop 1
    v_cndmask_b32 v6, 0, v6, vcc
    v_cmp_gt_u32 vcc, 64, v0
    s_nop 1
    v_cndmask_b32 v4, v6, v4, vcc
    v_mov_b32 v5, s101
    v_add_co_u32 v4, vcc, s100, v4
    s_nop 1
    v_addc_co_u32 v5, vcc, 0, v5, vcc
    global_load_dword v3, v[4:5], off
    s_load_dwordx16 s[4:19], s[0:1], 0
    s_load_dwordx8 s[20:27], s[0:1], 64
    s_load_dwordx2 s[92:93], s[0:1], 96
    v_lshrrev_b32 v18, 6, v0
    s_nop 0
    v_readfirstlane_b32 s3, v18
    v_and_b32 v1, 63, v0
    v_lshlrev_b32 v2, 4, v1
    s_and_b32 s38, s2, 7
    s_lshl_b32 s38, s38, 2
    s_lshr_b32 s39, s2, 3
    s_and_b32 s39, s39, 3
    s_add_u32 s36, s38, s39
    s_lshr_b32 s37, s2, 5
    v_lshrrev_b32 v18, 5, v1
    v_lshlrev_b32 v18, 3, v18
    v_bfe_u32 v19, v1, 2, 2
    v_add_u32 v18, v18, v19
    v_lshlrev_b32 v18, 8, v18
    v_bfe_u32 v4, v1, 4, 1
    v_lshlrev_b32 v4, 5, v4
    v_add_u32 v18, v18, v4
    v_and_b32 v4, 3, v1
    v_lshlrev_b32 v4, 3, v4
    v_add_u32 v18, v18, v4
    v_xor_b32 v4, 0, v19
    v_lshlrev_b32 v4, 6, v4
    v_add_u32 v4, v4, v18
    v_xor_b32 v5, 1, v19
    v_lshlrev_b32 v5, 6, v5
    v_add_u32 v5, v5, v18
    v_xor_b32 v6, 2, v19
    v_lshlrev_b32 v6, 6, v6
    v_add_u32 v6, v6, v18
    v_xor_b32 v7, 3, v19
    v_lshlrev_b32 v7, 6, v7
    v_add_u32 v7, v7, v18
    v_lshrrev_b32 v18, 4, v1
    v_bfe_u32 v19, v1, 2, 2
    v_xor_b32 v19, v19, v18
    v_lshlrev_b32 v19, 6, v19
    v_and_b32 v8, 3, v1
    v_lshlrev_b32 v8, 4, v8
    v_add_u32 v19, v19, v8
    v_mul_u32_u24 v18, 8192, v18
    v_add_u32 v8, v18, v19
    v_add_u32 v9, 31744, v8
    v_bfe_u32 v18, v1, 4, 2
    v_and_b32 v19, 3, v1
    v_xor_b32 v18, v18, v19
    v_lshlrev_b32 v18, 4, v18
    v_lshrrev_b32 v19, 2, v1
    v_lshl_add_u32 v10, v19, 10, v18
    v_add_u32 v11, 15360, v10
    s_lshl_b32 s57, s3, 11
    v_and_b32 v18, 31, v1
    v_bfe_u32 v19, v1, 2, 2
    v_lshrrev_b32 v20, 5, v1
    s_add_u32 s38, s57, 131072
    v_add_u32 v21, 0, v20
    v_xor_b32 v21, v21, v19
    v_lshlrev_b32 v21, 4, v21
    v_lshl_add_u32 v21, v18, 6, v21
    v_add_u32 v12, s38, v21
    v_add_u32 v21, 2, v20
    v_xor_b32 v21, v21, v19
    v_lshlrev_b32 v21, 4, v21
    v_lshl_add_u32 v21, v18, 6, v21
    v_add_u32 v13, s38, v21
    v_add_u32 v14, 147456, v4
    v_add_u32 v15, 147456, v5
    v_add_u32 v16, 147456, v6
    v_add_u32 v17, 147456, v7
    s_waitcnt lgkmcnt(0)
    s_mov_b32 s28, s92
    s_and_b32 s29, s93, 0xffff
    s_mov_b32 s30, 104857600
    s_mov_b32 s31, 0x20000
    s_mov_b32 s32, s26
    s_and_b32 s33, s27, 0xffff
    s_mov_b32 s34, 256
    s_mov_b32 s35, 0x20000
    s_mov_b32 s48, s4
    s_and_b32 s49, s5, 0xffff
    s_mov_b32 s50, 2097152
    s_mov_b32 s51, 0x20000
    s_mov_b32 s52, s6
    s_and_b32 s53, s7, 0xffff
    s_mov_b32 s54, 2097152
    s_mov_b32 s55, 0x20000
    s_mov_b32 s68, s10
    s_and_b32 s69, s11, 0xffff
    s_mov_b32 s70, 4194304
    s_mov_b32 s71, 0x20000
    s_mov_b32 s72, s12
    s_and_b32 s73, s13, 0xffff
    s_mov_b32 s74, 4194304
    s_mov_b32 s75, 0x20000
    s_mov_b32 s76, s18
    s_and_b32 s77, s19, 0xffff
    s_mov_b32 s78, 1409024
    s_mov_b32 s79, 0x20000
    s_mov_b32 s80, s20
    s_and_b32 s81, s21, 0xffff
    s_mov_b32 s82, 1409024
    s_mov_b32 s83, 0x20000
    s_lshl_b32 s38, s36, 8
    s_lshl_b32 s39, s3, 16
    s_add_u32 s65, s38, s39
    s_lshl_b32 s38, s37, 18
    s_lshl_b32 s39, s3, 15
    s_add_u32 s67, s38, s39
    s_lshl_b32 s47, s3, 11
    s_lshl_b32 s38, s36, 8
    s_lshl_b32 s39, s3, 15
    s_add_u32 s99, s38, s39
    s_getreg_b32 s97, hwreg(HW_REG_XCC_ID, 0, 4)
    v_mov_b32 v22, 0
    v_mov_b32 v23, 0
    s_lshl_b32 s40, s2, 3
    s_add_u32 s40, s40, s3
    s_lshl_b32 s41, s40, 10
    buffer_load_dwordx4 v[64:67], v2, s[48:51], s41 offen
    s_add_u32 m0, s57, 131072
    s_add_u32 s38, s67, 0
    buffer_load_dwordx4 v10, s[52:55], s38 offen offset:0 lds
    s_add_u32 m0, s57, 131072
    s_add_u32 s38, s67, 0
    buffer_load_dwordx4 v11, s[52:55], s38 offen offset:1024 lds
    s_lshr_b32 s39, s57, 1
    s_add_u32 m0, s39, 147456
    s_add_u32 s38, s99, 0
    buffer_load_dwordx4 v8, s[68:71], s38 offen lds
    s_lshr_b32 s39, s57, 1
    s_add_u32 m0, s39, 155648
    s_add_u32 s38, s99, 0
    buffer_load_dwordx4 v8, s[72:75], s38 offen lds
    s_lshr_b32 s42, s2, 3
    s_and_b32 s43, s2, 7
    s_lshl_b32 s43, s43, 6
    s_mul_i32 s44, s42, 3
    s_lshl_b32 s45, s42, 1
    s_add_u32 s45, s45, 22
    s_cmp_lt_u32 s42, 22
    s_cselect_b32 s44, s44, s45
    s_lshl_b32 s45, s42, 9
    s_add_u32 s45, s45, s43
    s_mul_i32 s45, s45, 192
    s_add_u32 s45, s45, 37748736
    s_mov_b32 s46, 43691
    s_lshl_b32 s38, s3, 6
    s_add_u32 s38, s38, 0
    v_add_u32 v96, s38, v1
    v_mul_lo_u32 v97, v96, s46
    v_lshrrev_b32 v97, 19, v97
    v_mul_u32_u24 v98, 12, v97
    v_sub_u32 v98, v96, v98
    v_add_u32 v97, s43, v97
    v_mul_u32_u24 v97, 2752, v97
    v_lshrrev_b32 v99, 2, v98
    v_add_u32 v99, s44, v99
    v_lshlrev_b32 v99, 5, v99
    v_and_b32 v100, 1, v98
    v_lshlrev_b32 v100, 4, v100
    v_add3_u32 v97, v97, v99, v100
    v_mov_b32 v101, 0x7fffff00
    v_cmp_gt_u32 vcc, 768, v96
    s_nop 1
    v_cndmask_b32 v97, v101, v97, vcc
    v_lshlrev_b32 v96, 4, v96
    v_cndmask_b32 v96, v101, v96, vcc
    v_and_b32 v98, 2, v98
    v_cmp_eq_u32 vcc, 0, v98
    s_nop 1
    v_cndmask_b32 v99, v101, v97, vcc
    v_cndmask_b32 v100, v97, v101, vcc
    s_lshl_b32 s38, s3, 6
    s_add_u32 s38, s38, 512
    v_add_u32 v112, s38, v1
    v_mul_lo_u32 v113, v112, s46
    v_lshrrev_b32 v113, 19, v113
    v_mul_u32_u24 v114, 12, v113
    v_sub_u32 v114, v112, v114
    v_add_u32 v113, s43, v113
    v_mul_u32_u24 v113, 2752, v113
    v_lshrrev_b32 v115, 2, v114
    v_add_u32 v115, s44, v115
    v_lshlrev_b32 v115, 5, v115
    v_and_b32 v116, 1, v114
    v_lshlrev_b32 v116, 4, v116
    v_add3_u32 v113, v113, v115, v116
    v_mov_b32 v117, 0x7fffff00
    v_cmp_gt_u32 vcc, 768, v112
    s_nop 1
    v_cndmask_b32 v113, v117, v113, vcc
    v_lshlrev_b32 v112, 4, v112
    v_cndmask_b32 v112, v117, v112, vcc
    v_and_b32 v114, 2, v114
    v_cmp_eq_u32 vcc, 0, v114
    s_nop 1
    v_cndmask_b32 v115, v117, v113, vcc
    v_cndmask_b32 v116, v113, v117, vcc
    s_waitcnt vmcnt(4)
    v_lshlrev_b32 v72, 16, v64
    v_and_b32 v73, 0xffff0000, v64
    v_lshlrev_b32 v74, 16, v65
    v_and_b32 v75, 0xffff0000, v65
    v_lshlrev_b32 v76, 16, v66
    v_and_b32 v77, 0xffff0000, v66
    v_lshlrev_b32 v78, 16, v67
    v_and_b32 v79, 0xffff0000, v67
    v_add_f32 v18, v72, v73
    v_add_f32 v18, v18, v74
    v_add_f32 v18, v18, v75
    v_add_f32 v18, v18, v76
    v_add_f32 v18, v18, v77
    v_add_f32 v18, v18, v78
    v_add_f32 v18, v18, v79
    s_nop 1
    v_add_f32_dpp v18, v18, v18 row_ror:8 row_mask:0xf bank_mask:0xf
    s_nop 1
    v_add_f32_dpp v18, v18, v18 row_ror:4 row_mask:0xf bank_mask:0xf
    s_nop 1
    v_add_f32_dpp v18, v18, v18 row_ror:2 row_mask:0xf bank_mask:0xf
    s_nop 1
    v_add_f32_dpp v18, v18, v18 row_ror:1 row_mask:0xf bank_mask:0xf
    v_mov_b32 v19, v18
    s_nop 1
    v_permlane16_swap_b32 v18, v19
    v_add_f32 v18, v18, v19
    v_mov_b32 v19, v18
    s_nop 1
    v_permlane32_swap_b32 v18, v19
    v_add_f32 v18, v18, v19
    v_mul_f32 v18, 0x3b000000, v18
    v_sub_f32 v72, v72, v18
    v_sub_f32 v73, v73, v18
    v_sub_f32 v74, v74, v18
    v_sub_f32 v75, v75, v18
    v_sub_f32 v76, v76, v18
    v_sub_f32 v77, v77, v18
    v_sub_f32 v78, v78, v18
    v_sub_f32 v79, v79, v18
    v_mul_f32 v20, v72, v72
    v_fmac_f32 v20, v73, v73
    v_fmac_f32 v20, v74, v74
    v_fmac_f32 v20, v75, v75
    v_fmac_f32 v20, v76, v76
    v_fmac_f32 v20, v77, v77
    v_fmac_f32 v20, v78, v78
    v_fmac_f32 v20, v79, v79
    s_nop 1
    v_add_f32_dpp v20, v20, v20 row_ror:8 row_mask:0xf bank_mask:0xf
    s_nop 1
    v_add_f32_dpp v20, v20, v20 row_ror:4 row_mask:0xf bank_mask:0xf
    s_nop 1
    v_add_f32_dpp v20, v20, v20 row_ror:2 row_mask:0xf bank_mask:0xf
    s_nop 1
    v_add_f32_dpp v20, v20, v20 row_ror:1 row_mask:0xf bank_mask:0xf
    v_mov_b32 v19, v20
    s_nop 1
    v_permlane16_swap_b32 v20, v19
    v_add_f32 v20, v20, v19
    v_mov_b32 v19, v20
    s_nop 1
    v_permlane32_swap_b32 v20, v19
    v_add_f32 v20, v20, v19
    v_mov_b32 v21, 0x3727c5ac
    v_fmac_f32 v21, 0x3b000000, v20
    v_rsq_f32 v21, v21
    s_nop 0
    v_mul_f32 v72, v72, v21
    v_mul_f32 v73, v73, v21
    v_mul_f32 v74, v74, v21
    v_mul_f32 v75, v75, v21
    v_mul_f32 v76, v76, v21
    v_mul_f32 v77, v77, v21
    v_mul_f32 v78, v78, v21
    v_mul_f32 v79, v79, v21
    v_cvt_pk_bf16_f32 v64, v72, v73
    v_cvt_pk_bf16_f32 v65, v74, v75
    v_cvt_pk_bf16_f32 v66, v76, v77
    v_cvt_pk_bf16_f32 v67, v78, v79
    v_lshlrev_b32 v18, 7, v1
    s_lshl_b32 s38, s3, 4
    s_add_u32 s38, s38, 98304
    v_add_u32 v18, s38, v18
    ds_write_b128 v18, v[64:67]
    s_add_u32 m0, s57, 0
    s_add_u32 s38, s67, 64
    buffer_load_dwordx4 v10, s[52:55], s38 offen offset:0 lds
    s_add_u32 m0, s57, 0
    s_add_u32 s38, s67, 64
    buffer_load_dwordx4 v11, s[52:55], s38 offen offset:1024 lds
    s_lshr_b32 s39, s57, 1
    s_add_u32 m0, s39, 16384
    s_add_u32 s38, s99, 262144
    buffer_load_dwordx4 v8, s[68:71], s38 offen lds
    s_lshr_b32 s39, s57, 1
    s_add_u32 m0, s39, 24576
    s_add_u32 s38, s99, 262144
    buffer_load_dwordx4 v8, s[72:75], s38 offen lds
    s_mov_b32 s58, s45
    v_mov_b32 v19, 0x7fffff00
    s_lshl_b32 s40, s2, 7
    s_add_u32 s40, s40, 83886080
    v_mov_b32 v20, s40
    s_cmp_lt_u32 s2, 192
    s_cselect_b32 s41, 1, 0
    v_cmp_gt_u32 vcc, s41, v0
    s_nop 1
    v_cndmask_b32 v20, v19, v20, vcc
    v_mov_b32 v21, 0
    buffer_store_dword v21, v20, s[28:31], 0 offen sc1
    s_mov_b32 s48, s8
    s_and_b32 s49, s9, 0xffff
    s_mov_b32 s50, 4194304
    s_mov_b32 s51, 0x20000
    v_lshlrev_b32 v26, 6, v1
    v_lshrrev_b32 v27, 4, v1
    v_lshlrev_b32 v27, 13, v27
    v_and_b32 v30, 15, v1
    v_lshlrev_b32 v30, 6, v30
    v_add_u32 v27, v27, v30
    s_mov_b32 s62, 0x80000000
    s_sub_u32 s44, 15, s37
    s_cmp_lt_u32 s3, 4
    s_cselect_b32 s45, s37, s44
    s_and_b32 s46, s3, 3
    s_lshl_b32 s38, s45, 2
    s_add_u32 s64, s38, s46
    s_lshl_b32 s38, s45, 1
    s_add_u32 s63, s38, 2
    s_cmp_lt_u32 s46, 2
    s_cselect_b32 s39, 1, 0
    s_cmp_eq_u32 s45, 0
    s_cselect_b32 s39, 0, s39
    s_sub_u32 s63, s63, s39
    s_lshl_b32 s38, s44, 1
    s_add_u32 s59, s38, 2
    s_mul_i32 s38, s36, 98304
    s_mul_i32 s39, s3, 3072
    s_add_u32 s41, s38, s39
    s_add_u32 s41, s41, 37748736
    s_add_u32 s42, s39, 65536
    s_mul_i32 s38, s36, 3
    s_lshl_b32 s39, s36, 1
    s_add_u32 s39, s39, 22
    s_cmp_lt_u32 s36, 22
    s_cselect_b32 s40, s38, s39
    s_mul_i32 s38, s64, 342
    s_lshl_b32 s39, s36, 3
    s_add_u32 s39, s38, s39
    s_lshl_b32 s66, s39, 10
    s_add_u32 s66, s66, 41943040
    s_add_u32 s38, s38, s40
    s_add_u32 s38, s38, 256
    s_lshl_b32 s43, s38, 10
    s_add_u32 s43, s43, 41943040
    s_lshl_b32 s38, s36, 19
    s_lshl_b32 s39, s46, 12
    s_add_u32 s38, s38, s39
    s_add_u32 s60, s38, 0
    s_add_u32 s61, s38, 16777216
    s_mov_b32 s45, s39
    s_mov_b32 s44, s39
    s_lshl_b32 s38, s36, 6
    s_lshl_b32 s39, s37, 3
    s_add_u32 s38, s38, s39
    s_add_u32 s38, s38, s3
    s_lshl_b32 s56, s38, 13
    s_lshl_b32 s45, s36, 7
    s_add_u32 s45, s45, 83886080
    s_cmp_ge_u32 s3, 4
    s_cbranch_scc1 K2_B
    s_waitcnt lgkmcnt(0)
    s_waitcnt vmcnt(5)
    s_barrier
    s_lshl_b32 s38, s3, 10
    s_add_u32 s38, s38, 98304
    v_add_u32 v18, s38, v2
    ds_read_b128 v[28:31], v18
    v_lshrrev_b32 v18, 3, v1
    v_lshlrev_b32 v18, 9, v18
    v_and_b32 v19, 7, v1
    v_lshl_add_u32 v18, v19, 4, v18
    s_lshr_b32 s38, s2, 2
    s_lshl_b32 s38, s38, 15
    s_and_b32 s39, s2, 3
    s_lshl_b32 s39, s39, 7
    s_add_u32 s38, s38, s39
    s_lshl_b32 s39, s3, 12
    s_add_u32 s38, s38, s39
    s_add_u32 s38, s38, 33554432
    s_waitcnt lgkmcnt(0)
    buffer_store_dwordx4 v[28:31], v18, s[28:31], s38 offen sc1
    ds_read_b128 v[32:35], v12
    ds_read_b128 v[36:39], v13
    ds_read_b64_tr_b16 v[48:49], v14 offset:0
    ds_read_b64_tr_b16 v[50:51], v14 offset:1024
    ds_read_b64_tr_b16 v[52:53], v15 offset:0
    ds_read_b64_tr_b16 v[54:55], v15 offset:1024
    ds_read_b64_tr_b16 v[56:57], v16 offset:0
    ds_read_b64_tr_b16 v[58:59], v16 offset:1024
    ds_read_b64_tr_b16 v[60:61], v17 offset:0
    ds_read_b64_tr_b16 v[62:63], v17 offset:1024
    v_lshrrev_b32 v18, 5, v1
    v_lshlrev_b32 v18, 3, v18
    v_bfe_u32 v19, v1, 2, 2
    v_add_u32 v18, v18, v19
    v_mul_u32_u24 v18, 192, v18
    v_bfe_u32 v19, v1, 4, 1
    v_lshlrev_b32 v19, 5, v19
    v_add_u32 v18, v18, v19
    v_and_b32 v19, 3, v1
    v_lshlrev_b32 v19, 3, v19
    v_add_u32 v18, v18, v19
    v_add_u32 v24, 65536, v18
    v_add_u32 v25, 114688, v18
    s_waitcnt lgkmcnt(6)
    v_mfma_f32_32x32x16_bf16 a[0:15], v[48:51], v[32:35], 0
    ds_read_b64_tr_b16 v[64:65], v14 offset:8192
    ds_read_b64_tr_b16 v[66:67], v14 offset:9216
    s_add_u32 m0, s57, 32768
    s_add_u32 s38, s67, 128
    buffer_load_dwordx4 v10, s[52:55], s38 offen offset:0 lds
    s_waitcnt lgkmcnt(6)
    v_mfma_f32_32x32x16_bf16 a[16:31], v[52:55], v[32:35], 0
    ds_read_b64_tr_b16 v[68:69], v15 offset:8192
    ds_read_b64_tr_b16 v[70:71], v15 offset:9216
    s_waitcnt lgkmcnt(6)
    v_mfma_f32_32x32x16_bf16 a[32:47], v[56:59], v[32:35], 0
    ds_read_b64_tr_b16 v[72:73], v16 offset:8192
    ds_read_b64_tr_b16 v[74:75], v16 offset:9216
    s_add_u32 m0, s57, 32768
    s_add_u32 s38, s67, 128
    buffer_load_dwordx4 v11, s[52:55], s38 offen offset:1024 lds
    s_waitcnt lgkmcnt(6)
    v_mfma_f32_32x32x16_bf16 a[48:63], v[60:63], v[32:35], 0
    ds_read_b64_tr_b16 v[76:77], v17 offset:8192
    ds_read_b64_tr_b16 v[78:79], v17 offset:9216
    s_waitcnt lgkmcnt(6)
    v_mfma_f32_32x32x16_bf16 a[64:79], v[32:35], v[64:67], 0
    ds_read_b64_tr_b16 v[48:49], v14 offset:4096
    ds_read_b64_tr_b16 v[50:51], v14 offset:5120
    s_lshr_b32 s39, s57, 1
    s_add_u32 m0, s39, 49152
    s_add_u32 s38, s99, 524288
    buffer_load_dwordx4 v8, s[68:71], s38 offen lds
    s_waitcnt lgkmcnt(6)
    v_mfma_f32_32x32x16_bf16 a[80:95], v[32:35], v[68:71], 0
    ds_read_b64_tr_b16 v[52:53], v15 offset:4096
    ds_read_b64_tr_b16 v[54:55], v15 offset:5120
    s_waitcnt lgkmcnt(6)
    v_mfma_f32_32x32x16_bf16 a[96:111], v[32:35], v[72:75], 0
    ds_read_b64_tr_b16 v[56:57], v16 offset:4096
    ds_read_b64_tr_b16 v[58:59], v16 offset:5120
    s_lshr_b32 s39, s57, 1
    s_add_u32 m0, s39, 57344
    s_add_u32 s38, s99, 524288
    buffer_load_dwordx4 v8, s[72:75], s38 offen lds
    s_waitcnt lgkmcnt(6)
    v_mfma_f32_32x32x16_bf16 a[112:127], v[32:35], v[76:79], 0
    ds_read_b64_tr_b16 v[60:61], v17 offset:4096
    ds_read_b64_tr_b16 v[62:63], v17 offset:5120
    s_waitcnt lgkmcnt(6)
    v_mfma_f32_32x32x16_bf16 a[0:15], v[48:51], v[36:39], a[0:15]
    ds_read_b64_tr_b16 v[64:65], v14 offset:12288
    ds_read_b64_tr_b16 v[66:67], v14 offset:13312
    buffer_load_dwordx4 v[104:107], v99, s[76:79], 0 offen
    s_waitcnt lgkmcnt(6)
    v_mfma_f32_32x32x16_bf16 a[16:31], v[52:55], v[36:39], a[16:31]
    ds_read_b64_tr_b16 v[68:69], v15 offset:12288
    ds_read_b64_tr_b16 v[70:71], v15 offset:13312
    s_waitcnt lgkmcnt(6)
    v_mfma_f32_32x32x16_bf16 a[32:47], v[56:59], v[36:39], a[32:47]
    ds_read_b64_tr_b16 v[72:73], v16 offset:12288
    ds_read_b64_tr_b16 v[74:75], v16 offset:13312
    buffer_load_dwordx4 v[108:111], v100, s[80:83], 0 offen
    s_waitcnt lgkmcnt(6)
    v_mfma_f32_32x32x16_bf16 a[48:63], v[60:63], v[36:39], a[48:63]
    s_waitcnt vmcnt(8)
    s_barrier
    v_add_u32 v12, 0xfffe0000, v12
    v_add_u32 v13, 0xfffe0000, v13
    ds_read_b128 v[40:43], v12
    ds_read_b128 v[44:47], v13
    ds_read_b64_tr_b16 v[76:77], v17 offset:12288
    ds_read_b64_tr_b16 v[78:79], v17 offset:13312
    s_waitcnt lgkmcnt(8)
    v_mfma_f32_32x32x16_bf16 a[64:79], v[36:39], v[64:67], a[64:79]
    v_add_u32 v14, 0xfffe0000, v14
    v_add_u32 v15, 0xfffe0000, v15
    v_add_u32 v16, 0xfffe0000, v16
    v_add_u32 v17, 0xfffe0000, v17
    ds_read_b64_tr_b16 v[48:49], v14 offset:0
    ds_read_b64_tr_b16 v[50:51], v14 offset:1024
    buffer_load_dwordx4 v[120:123], v115, s[76:79], 0 offen
    s_waitcnt lgkmcnt(8)
    v_mfma_f32_32x32x16_bf16 a[80:95], v[36:39], v[68:71], a[80:95]
    ds_read_b64_tr_b16 v[52:53], v15 offset:0
    ds_read_b64_tr_b16 v[54:55], v15 offset:1024
    s_waitcnt lgkmcnt(8)
    v_mfma_f32_32x32x16_bf16 a[96:111], v[36:39], v[72:75], a[96:111]
    ds_read_b64_tr_b16 v[56:57], v16 offset:0
    ds_read_b64_tr_b16 v[58:59], v16 offset:1024
    buffer_load_dwordx4 v[124:127], v116, s[80:83], 0 offen
    s_waitcnt lgkmcnt(6)
    v_mfma_f32_32x32x16_bf16 a[112:127], v[36:39], v[76:79], a[112:127]
    ds_read_b64_tr_b16 v[60:61], v17 offset:0
    ds_read_b64_tr_b16 v[62:63], v17 offset:1024
    s_waitcnt lgkmcnt(6)
    v_mfma_f32_32x32x16_bf16 a[0:15], v[48:51], v[40:43], a[0:15]
    ds_read_b64_tr_b16 v[64:65], v14 offset:8192
    ds_read_b64_tr_b16 v[66:67], v14 offset:9216
    s_add_u32 m0, s57, 65536
    s_add_u32 s38, s67, 192
    buffer_load_dwordx4 v10, s[52:55], s38 offen offset:0 lds
    s_waitcnt lgkmcnt(6)
    v_mfma_f32_32x32x16_bf16 a[16:31], v[52:55], v[40:43], a[16:31]
    ds_read_b64_tr_b16 v[68:69], v15 offset:8192
    ds_read_b64_tr_b16 v[70:71], v15 offset:9216
    s_waitcnt lgkmcnt(6)
    v_mfma_f32_32x32x16_bf16 a[32:47], v[56:59], v[40:43], a[32:47]
    ds_read_b64_tr_b16 v[72:73], v16 offset:8192
    ds_read_b64_tr_b16 v[74:75], v16 offset:9216
    s_add_u32 m0, s57, 65536
    s_add_u32 s38, s67, 192
    buffer_load_dwordx4 v11, s[52:55], s38 offen offset:1024 lds
    s_waitcnt lgkmcnt(6)
    v_mfma_f32_32x32x16_bf16 a[48:63], v[60:63], v[40:43], a[48:63]
    ds_read_b64_tr_b16 v[76:77], v17 offset:8192
    ds_read_b64_tr_b16 v[78:79], v17 offset:9216
    s_waitcnt lgkmcnt(6)
    v_mfma_f32_32x32x16_bf16 a[64:79], v[40:43], v[64:67], a[64:79]
    ds_read_b64_tr_b16 v[48:49], v14 offset:4096
    ds_read_b64_tr_b16 v[50:51], v14 offset:5120
    s_lshr_b32 s39, s57, 1
    s_add_u32 m0, s39, 81920
    s_add_u32 s38, s99, 786432
    buffer_load_dwordx4 v8, s[68:71], s38 offen lds
    s_waitcnt lgkmcnt(6)
    v_mfma_f32_32x32x16_bf16 a[80:95], v[40:43], v[68:71], a[80:95]
    ds_read_b64_tr_b16 v[52:53], v15 offset:4096
    ds_read_b64_tr_b16 v[54:55], v15 offset:5120
    s_waitcnt lgkmcnt(6)
    v_mfma_f32_32x32x16_bf16 a[96:111], v[40:43], v[72:75], a[96:111]
    ds_read_b64_tr_b16 v[56:57], v16 offset:4096
    ds_read_b64_tr_b16 v[58:59], v16 offset:5120
    s_lshr_b32 s39, s57, 1
    s_add_u32 m0, s39, 90112
    s_add_u32 s38, s99, 786432
    buffer_load_dwordx4 v8, s[72:75], s38 offen lds
    s_waitcnt lgkmcnt(6)
    v_mfma_f32_32x32x16_bf16 a[112:127], v[40:43], v[76:79], a[112:127]
    ds_read_b64_tr_b16 v[60:61], v17 offset:4096
    ds_read_b64_tr_b16 v[62:63], v17 offset:5120
    s_waitcnt lgkmcnt(6)
    v_mfma_f32_32x32x16_bf16 a[0:15], v[48:51], v[44:47], a[0:15]
    ds_read_b64_tr_b16 v[64:65], v14 offset:12288
    ds_read_b64_tr_b16 v[66:67], v14 offset:13312
    s_add_u32 m0, s57, 98304
    s_add_u32 s38, s67, 256
    buffer_load_dwordx4 v10, s[52:55], s38 offen offset:0 lds
    s_waitcnt lgkmcnt(6)
    v_mfma_f32_32x32x16_bf16 a[16:31], v[52:55], v[44:47], a[16:31]
    ds_read_b64_tr_b16 v[68:69], v15 offset:12288
    ds_read_b64_tr_b16 v[70:71], v15 offset:13312
    s_waitcnt lgkmcnt(6)
    v_mfma_f32_32x32x16_bf16 a[32:47], v[56:59], v[44:47], a[32:47]
    ds_read_b64_tr_b16 v[72:73], v16 offset:12288
    ds_read_b64_tr_b16 v[74:75], v16 offset:13312
    s_add_u32 m0, s57, 98304
    s_add_u32 s38, s67, 256
    buffer_load_dwordx4 v11, s[52:55], s38 offen offset:1024 lds
    s_waitcnt lgkmcnt(6)
    v_mfma_f32_32x32x16_bf16 a[48:63], v[60:63], v[44:47], a[48:63]
    s_waitcnt vmcnt(10)
    s_barrier
    v_add_u32 v12, 0x8000, v12
    v_add_u32 v13, 0x8000, v13
    ds_read_b128 v[32:35], v12
    ds_read_b128 v[36:39], v13
    ds_read_b64_tr_b16 v[76:77], v17 offset:12288
    ds_read_b64_tr_b16 v[78:79], v17 offset:13312
    s_waitcnt lgkmcnt(8)
    v_mfma_f32_32x32x16_bf16 a[64:79], v[44:47], v[64:67], a[64:79]
    v_add_u32 v14, 0x8000, v14
    v_add_u32 v15, 0x8000, v15
    v_add_u32 v16, 0x8000, v16
    v_add_u32 v17, 0x8000, v17
    ds_read_b64_tr_b16 v[48:49], v14 offset:0
    ds_read_b64_tr_b16 v[50:51], v14 offset:1024
    s_lshr_b32 s39, s57, 1
    s_add_u32 m0, s39, 114688
    s_add_u32 s38, s99, 1048576
    buffer_load_dwordx4 v8, s[68:71], s38 offen lds
    s_waitcnt lgkmcnt(8)
    v_mfma_f32_32x32x16_bf16 a[80:95], v[44:47], v[68:71], a[80:95]
    ds_read_b64_tr_b16 v[52:53], v15 offset:0
    ds_read_b64_tr_b16 v[54:55], v15 offset:1024
    s_waitcnt lgkmcnt(8)
    v_mfma_f32_32x32x16_bf16 a[96:111], v[44:47], v[72:75], a[96:111]
    ds_read_b64_tr_b16 v[56:57], v16 offset:0
    ds_read_b64_tr_b16 v[58:59], v16 offset:1024
    s_lshr_b32 s39, s57, 1
    s_add_u32 m0, s39, 122880
    s_add_u32 s38, s99, 1048576
    buffer_load_dwordx4 v8, s[72:75], s38 offen lds
    s_waitcnt lgkmcnt(6)
    v_mfma_f32_32x32x16_bf16 a[112:127], v[44:47], v[76:79], a[112:127]
    ds_read_b64_tr_b16 v[60:61], v17 offset:0
    ds_read_b64_tr_b16 v[62:63], v17 offset:1024
    s_waitcnt lgkmcnt(6)
    v_mfma_f32_32x32x16_bf16 a[0:15], v[48:51], v[32:35], a[0:15]
    ds_read_b64_tr_b16 v[64:65], v14 offset:8192
    ds_read_b64_tr_b16 v[66:67], v14 offset:9216
    s_lshr_b32 s38, s2, 3
    s_lshl_b32 s38, s38, 4
    s_and_b32 s39, s3, 3
    s_lshl_b32 s39, s39, 2
    s_add_u32 s38, s38, s39
    s_lshl_b32 s38, s38, 13
    s_and_b32 s39, s2, 7
    s_lshl_b32 s39, s39, 10
    s_add_u32 s38, s38, s39
    buffer_load_dword v3, v27, s[68:71], s38 offen
    s_waitcnt lgkmcnt(6)
    v_mfma_f32_32x32x16_bf16 a[16:31], v[52:55], v[32:35], a[16:31]
    ds_read_b64_tr_b16 v[68:69], v15 offset:8192
    ds_read_b64_tr_b16 v[70:71], v15 offset:9216
    s_waitcnt lgkmcnt(6)
    v_mfma_f32_32x32x16_bf16 a[32:47], v[56:59], v[32:35], a[32:47]
    ds_read_b64_tr_b16 v[72:73], v16 offset:8192
    ds_read_b64_tr_b16 v[74:75], v16 offset:9216
    s_waitcnt vmcnt(11)
    v_or_b32 v104, v104, v108
    s_add_u32 m0, s57, 131072
    s_add_u32 s38, s67, 320
    buffer_load_dwordx4 v10, s[52:55], s38 offen offset:0 lds
    s_waitcnt lgkmcnt(6)
    v_mfma_f32_32x32x16_bf16 a[48:63], v[60:63], v[32:35], a[48:63]
    ds_read_b64_tr_b16 v[76:77], v17 offset:8192
    ds_read_b64_tr_b16 v[78:79], v17 offset:9216
    v_or_b32 v105, v105, v109
    s_waitcnt lgkmcnt(6)
    v_mfma_f32_32x32x16_bf16 a[64:79], v[32:35], v[64:67], a[64:79]
    ds_read_b64_tr_b16 v[48:49], v14 offset:4096
    ds_read_b64_tr_b16 v[50:51], v14 offset:5120
    v_or_b32 v106, v106, v110
    s_add_u32 m0, s57, 131072
    s_add_u32 s38, s67, 320
    buffer_load_dwordx4 v11, s[52:55], s38 offen offset:1024 lds
    s_waitcnt lgkmcnt(6)
    v_mfma_f32_32x32x16_bf16 a[80:95], v[32:35], v[68:71], a[80:95]
    ds_read_b64_tr_b16 v[52:53], v15 offset:4096
    ds_read_b64_tr_b16 v[54:55], v15 offset:5120
    v_or_b32 v107, v107, v111
    s_waitcnt lgkmcnt(6)
    v_mfma_f32_32x32x16_bf16 a[96:111], v[32:35], v[72:75], a[96:111]
    ds_read_b64_tr_b16 v[56:57], v16 offset:4096
    ds_read_b64_tr_b16 v[58:59], v16 offset:5120
    buffer_store_dwordx4 v[104:107], v96, s[28:31], s58 offen sc1
    s_lshr_b32 s39, s57, 1
    s_add_u32 m0, s39, 147456
    s_add_u32 s38, s99, 1310720
    buffer_load_dwordx4 v8, s[68:71], s38 offen lds
    s_waitcnt lgkmcnt(6)
    v_mfma_f32_32x32x16_bf16 a[112:127], v[32:35], v[76:79], a[112:127]
    ds_read_b64_tr_b16 v[60:61], v17 offset:4096
    ds_read_b64_tr_b16 v[62:63], v17 offset:5120
    s_waitcnt vmcnt(13)
    v_or_b32 v120, v120, v124
    s_waitcnt lgkmcnt(6)
    v_mfma_f32_32x32x16_bf16 a[0:15], v[48:51], v[36:39], a[0:15]
    ds_read_b64_tr_b16 v[64:65], v14 offset:12288
    ds_read_b64_tr_b16 v[66:67], v14 offset:13312
    v_or_b32 v121, v121, v125
    s_lshr_b32 s39, s57, 1
    s_add_u32 m0, s39, 155648
    s_add_u32 s38, s99, 1310720
    buffer_load_dwordx4 v8, s[72:75], s38 offen lds
    s_waitcnt lgkmcnt(6)
    v_mfma_f32_32x32x16_bf16 a[16:31], v[52:55], v[36:39], a[16:31]
    ds_read_b64_tr_b16 v[68:69], v15 offset:12288
    ds_read_b64_tr_b16 v[70:71], v15 offset:13312
    v_or_b32 v122, v122, v126
    s_waitcnt lgkmcnt(6)
    v_mfma_f32_32x32x16_bf16 a[32:47], v[56:59], v[36:39], a[32:47]
    ds_read_b64_tr_b16 v[72:73], v16 offset:12288
    ds_read_b64_tr_b16 v[74:75], v16 offset:13312
    v_or_b32 v123, v123, v127
    s_waitcnt lgkmcnt(6)
    v_mfma_f32_32x32x16_bf16 a[48:63], v[60:63], v[36:39], a[48:63]
    s_waitcnt vmcnt(10)
    s_barrier
    v_add_u32 v12, 0x8000, v12
    v_add_u32 v13, 0x8000, v13
    ds_read_b128 v[40:43], v12
    ds_read_b128 v[44:47], v13
    ds_read_b64_tr_b16 v[76:77], v17 offset:12288
    ds_read_b64_tr_b16 v[78:79], v17 offset:13312
    buffer_store_dwordx4 v[120:123], v112, s[28:31], s58 offen sc1
    s_waitcnt lgkmcnt(8)
    v_mfma_f32_32x32x16_bf16 a[64:79], v[36:39], v[64:67], a[64:79]
    v_add_u32 v14, 0x8000, v14
    v_add_u32 v15, 0x8000, v15
    v_add_u32 v16, 0x8000, v16
    v_add_u32 v17, 0x8000, v17
    ds_read_b64_tr_b16 v[48:49], v14 offset:0
    ds_read_b64_tr_b16 v[50:51], v14 offset:1024
    s_add_u32 m0, s57, 0
    s_add_u32 s38, s67, 384
    buffer_load_dwordx4 v10, s[52:55], s38 offen offset:0 lds
    s_waitcnt lgkmcnt(8)
    v_mfma_f32_32x32x16_bf16 a[80:95], v[36:39], v[68:71], a[80:95]
    ds_read_b64_tr_b16 v[52:53], v15 offset:0
    ds_read_b64_tr_b16 v[54:55], v15 offset:1024
    s_waitcnt lgkmcnt(8)
    v_mfma_f32_32x32x16_bf16 a[96:111], v[36:39], v[72:75], a[96:111]
    ds_read_b64_tr_b16 v[56:57], v16 offset:0
    ds_read_b64_tr_b16 v[58:59], v16 offset:1024
    s_add_u32 m0, s57, 0
    s_add_u32 s38, s67, 384
    buffer_load_dwordx4 v11, s[52:55], s38 offen offset:1024 lds
    s_waitcnt lgkmcnt(6)
    v_mfma_f32_32x32x16_bf16 a[112:127], v[36:39], v[76:79], a[112:127]
    ds_read_b64_tr_b16 v[60:61], v17 offset:0
    ds_read_b64_tr_b16 v[62:63], v17 offset:1024
    s_waitcnt lgkmcnt(6)
    v_mfma_f32_32x32x16_bf16 a[0:15], v[48:51], v[40:43], a[0:15]
    ds_read_b64_tr_b16 v[64:65], v14 offset:8192
    ds_read_b64_tr_b16 v[66:67], v14 offset:9216
    s_lshr_b32 s39, s57, 1
    s_add_u32 m0, s39, 16384
    s_add_u32 s38, s99, 1572864
    buffer_load_dwordx4 v8, s[68:71], s38 offen lds
    s_waitcnt lgkmcnt(6)
    v_mfma_f32_32x32x16_bf16 a[16:31], v[52:55], v[40:43], a[16:31]
    ds_read_b64_tr_b16 v[68:69], v15 offset:8192
    ds_read_b64_tr_b16 v[70:71], v15 offset:9216
    s_waitcnt lgkmcnt(6)
    v_mfma_f32_32x32x16_bf16 a[32:47], v[56:59], v[40:43], a[32:47]
    ds_read_b64_tr_b16 v[72:73], v16 offset:8192
    ds_read_b64_tr_b16 v[74:75], v16 offset:9216
    s_lshr_b32 s39, s57, 1
    s_add_u32 m0, s39, 24576
    s_add_u32 s38, s99, 1572864
    buffer_load_dwordx4 v8, s[72:75], s38 offen lds
    s_waitcnt lgkmcnt(6)
    v_mfma_f32_32x32x16_bf16 a[48:63], v[60:63], v[40:43], a[48:63]
    ds_read_b64_tr_b16 v[76:77], v17 offset:8192
    ds_read_b64_tr_b16 v[78:79], v17 offset:9216
    s_waitcnt lgkmcnt(6)
    v_mfma_f32_32x32x16_bf16 a[64:79], v[40:43], v[64:67], a[64:79]
    ds_read_b64_tr_b16 v[48:49], v14 offset:4096
    ds_read_b64_tr_b16 v[50:51], v14 offset:5120
    s_waitcnt lgkmcnt(6)
    v_mfma_f32_32x32x16_bf16 a[80:95], v[40:43], v[68:71], a[80:95]
    ds_read_b64_tr_b16 v[52:53], v15 offset:4096
    ds_read_b64_tr_b16 v[54:55], v15 offset:5120
    s_waitcnt lgkmcnt(6)
    v_mfma_f32_32x32x16_bf16 a[96:111], v[40:43], v[72:75], a[96:111]
    ds_read_b64_tr_b16 v[56:57], v16 offset:4096
    ds_read_b64_tr_b16 v[58:59], v16 offset:5120
    s_waitcnt lgkmcnt(6)
    v_mfma_f32_32x32x16_bf16 a[112:127], v[40:43], v[76:79], a[112:127]
    ds_read_b64_tr_b16 v[60:61], v17 offset:4096
    ds_read_b64_tr_b16 v[62:63], v17 offset:5120
    s_waitcnt lgkmcnt(6)
    v_mfma_f32_32x32x16_bf16 a[0:15], v[48:51], v[44:47], a[0:15]
    ds_read_b64_tr_b16 v[64:65], v14 offset:12288
    ds_read_b64_tr_b16 v[66:67], v14 offset:13312
    s_waitcnt lgkmcnt(6)
    v_mfma_f32_32x32x16_bf16 a[16:31], v[52:55], v[44:47], a[16:31]
    ds_read_b64_tr_b16 v[68:69], v15 offset:12288
    ds_read_b64_tr_b16 v[70:71], v15 offset:13312
    s_waitcnt lgkmcnt(6)
    v_mfma_f32_32x32x16_bf16 a[32:47], v[56:59], v[44:47], a[32:47]
    ds_read_b64_tr_b16 v[72:73], v16 offset:12288
    ds_read_b64_tr_b16 v[74:75], v16 offset:13312
    s_waitcnt lgkmcnt(6)
    v_mfma_f32_32x32x16_bf16 a[48:63], v[60:63], v[44:47], a[48:63]
    s_waitcnt vmcnt(4)
    s_barrier
    v_add_u32 v12, 0x8000, v12
    v_add_u32 v13, 0x8000, v13
    ds_read_b128 v[32:35], v12
    ds_read_b128 v[36:39], v13
    s_cmp_lg_u32 s3, 0
    s_cbranch_scc1 ON1
    v_mbcnt_lo_u32_b32 v18, -1, 0
    v_mbcnt_hi_u32_b32 v18, -1, v18
    v_cmp_eq_u32 vcc, 0, v18
    v_mov_b32 v19, 0x7fffff00
    s_nop 0
    v_cndmask_b32 v18, v19, v18, vcc
    s_or_b32 s38, s97, 0x80
    v_mov_b32 v19, s38
    buffer_store_byte v19, v18, s[32:35], s2 offen sc1
ON1:
    ds_read_b64_tr_b16 v[76:77], v17 offset:12288
    ds_read_b64_tr_b16 v[78:79], v17 offset:13312
    s_waitcnt lgkmcnt(8)
    v_mfma_f32_32x32x16_bf16 a[64:79], v[44:47], v[64:67], a[64:79]
    v_add_u32 v14, 0x8000, v14
    v_add_u32 v15, 0x8000, v15
    v_add_u32 v16, 0x8000, v16
    v_add_u32 v17, 0x8000, v17
    ds_read_b64_tr_b16 v[48:49], v14 offset:0
    ds_read_b64_tr_b16 v[50:51], v14 offset:1024
    s_add_u32 m0, s57, 32768
    s_add_u32 s38, s67, 448
    buffer_load_dwordx4 v10, s[52:55], s38 offen offset:0 lds
    s_waitcnt lgkmcnt(8)
    v_mfma_f32_32x32x16_bf16 a[80:95], v[44:47], v[68:71], a[80:95]
    ds_read_b64_tr_b16 v[52:53], v15 offset:0
    ds_read_b64_tr_b16 v[54:55], v15 offset:1024
    s_waitcnt lgkmcnt(8)
    v_mfma_f32_32x32x16_bf16 a[96:111], v[44:47], v[72:75], a[96:111]
    ds_read_b64_tr_b16 v[56:57], v16 offset:0
    ds_read_b64_tr_b16 v[58:59], v16 offset:1024
    s_add_u32 m0, s57, 32768
    s_add_u32 s38, s67, 448
    buffer_load_dwordx4 v11, s[52:55], s38 offen offset:1024 lds
    s_waitcnt lgkmcnt(6)
    v_mfma_f32_32x32x16_bf16 a[112:127], v[44:47], v[76:79], a[112:127]
    ds_read_b64_tr_b16 v[60:61], v17 offset:0
    ds_read_b64_tr_b16 v[62:63], v17 offset:1024
    s_waitcnt lgkmcnt(6)
    v_mfma_f32_32x32x16_bf16 a[0:15], v[48:51], v[32:35], a[0:15]
    ds_read_b64_tr_b16 v[64:65], v14 offset:8192
    ds_read_b64_tr_b16 v[66:67], v14 offset:9216
    s_lshr_b32 s39, s57, 1
    s_add_u32 m0, s39, 49152
    s_add_u32 s38, s99, 1835008
    buffer_load_dwordx4 v8, s[68:71], s38 offen lds
    s_waitcnt lgkmcnt(6)
    v_mfma_f32_32x32x16_bf16 a[16:31], v[52:55], v[32:35], a[16:31]
    ds_read_b64_tr_b16 v[68:69], v15 offset:8192
    ds_read_b64_tr_b16 v[70:71], v15 offset:9216
    s_waitcnt lgkmcnt(6)
    v_mfma_f32_32x32x16_bf16 a[32:47], v[56:59], v[32:35], a[32:47]
    ds_read_b64_tr_b16 v[72:73], v16 offset:8192
    ds_read_b64_tr_b16 v[74:75], v16 offset:9216
    s_lshr_b32 s39, s57, 1
    s_add_u32 m0, s39, 57344
    s_add_u32 s38, s99, 1835008
    buffer_load_dwordx4 v8, s[72:75], s38 offen lds
    s_waitcnt lgkmcnt(6)
    v_mfma_f32_32x32x16_bf16 a[48:63], v[60:63], v[32:35], a[48:63]
    ds_read_b64_tr_b16 v[76:77], v17 offset:8192
    ds_read_b64_tr_b16 v[78:79], v17 offset:9216
    s_waitcnt lgkmcnt(6)
    v_mfma_f32_32x32x16_bf16 a[64:79], v[32:35], v[64:67], a[64:79]
    ds_read_b64_tr_b16 v[48:49], v14 offset:4096
    ds_read_b64_tr_b16 v[50:51], v14 offset:5120
    s_waitcnt lgkmcnt(6)
    v_mfma_f32_32x32x16_bf16 a[80:95], v[32:35], v[68:71], a[80:95]
    ds_read_b64_tr_b16 v[52:53], v15 offset:4096
    ds_read_b64_tr_b16 v[54:55], v15 offset:5120
    s_waitcnt lgkmcnt(6)
    v_mfma_f32_32x32x16_bf16 a[96:111], v[32:35], v[72:75], a[96:111]
    ds_read_b64_tr_b16 v[56:57], v16 offset:4096
    ds_read_b64_tr_b16 v[58:59], v16 offset:5120
    s_waitcnt lgkmcnt(6)
    v_mfma_f32_32x32x16_bf16 a[112:127], v[32:35], v[76:79], a[112:127]
    ds_read_b64_tr_b16 v[60:61], v17 offset:4096
    ds_read_b64_tr_b16 v[62:63], v17 offset:5120
    s_waitcnt lgkmcnt(6)
    v_mfma_f32_32x32x16_bf16 a[0:15], v[48:51], v[36:39], a[0:15]
    ds_read_b64_tr_b16 v[64:65], v14 offset:12288
    ds_read_b64_tr_b16 v[66:67], v14 offset:13312
    s_waitcnt lgkmcnt(6)
    v_mfma_f32_32x32x16_bf16 a[16:31], v[52:55], v[36:39], a[16:31]
    ds_read_b64_tr_b16 v[68:69], v15 offset:12288
    ds_read_b64_tr_b16 v[70:71], v15 offset:13312
    s_waitcnt lgkmcnt(6)
    v_mfma_f32_32x32x16_bf16 a[32:47], v[56:59], v[36:39], a[32:47]
    ds_read_b64_tr_b16 v[72:73], v16 offset:12288
    ds_read_b64_tr_b16 v[74:75], v16 offset:13312
    s_waitcnt lgkmcnt(6)
    v_mfma_f32_32x32x16_bf16 a[48:63], v[60:63], v[36:39], a[48:63]
    s_barrier
    v_add_u32 v12, 0x8000, v12
    v_add_u32 v13, 0x8000, v13
    ds_read_b128 v[40:43], v12
    ds_read_b128 v[44:47], v13
    ds_read_b64_tr_b16 v[76:77], v17 offset:12288
    ds_read_b64_tr_b16 v[78:79], v17 offset:13312
    s_waitcnt lgkmcnt(8)
    v_mfma_f32_32x32x16_bf16 a[64:79], v[36:39], v[64:67], a[64:79]
    v_add_u32 v14, 0x8000, v14
    v_add_u32 v15, 0x8000, v15
    v_add_u32 v16, 0x8000, v16
    v_add_u32 v17, 0x8000, v17
    ds_read_b64_tr_b16 v[48:49], v14 offset:0
    ds_read_b64_tr_b16 v[50:51], v14 offset:1024
    s_add_u32 m0, s57, 65536
    s_add_u32 s38, s67, 512
    buffer_load_dwordx4 v10, s[52:55], s38 offen offset:0 lds
    s_waitcnt lgkmcnt(8)
    v_mfma_f32_32x32x16_bf16 a[80:95], v[36:39], v[68:71], a[80:95]
    ds_read_b64_tr_b16 v[52:53], v15 offset:0
    ds_read_b64_tr_b16 v[54:55], v15 offset:1024
    s_waitcnt lgkmcnt(8)
    v_mfma_f32_32x32x16_bf16 a[96:111], v[36:39], v[72:75], a[96:111]
    ds_read_b64_tr_b16 v[56:57], v16 offset:0
    ds_read_b64_tr_b16 v[58:59], v16 offset:1024
    s_add_u32 m0, s57, 65536
    s_add_u32 s38, s67, 512
    buffer_load_dwordx4 v11, s[52:55], s38 offen offset:1024 lds
    s_waitcnt lgkmcnt(6)
    v_mfma_f32_32x32x16_bf16 a[112:127], v[36:39], v[76:79], a[112:127]
    ds_read_b64_tr_b16 v[60:61], v17 offset:0
    ds_read_b64_tr_b16 v[62:63], v17 offset:1024
    s_waitcnt lgkmcnt(6)
    v_mfma_f32_32x32x16_bf16 a[0:15], v[48:51], v[40:43], a[0:15]
    ds_read_b64_tr_b16 v[64:65], v14 offset:8192
    ds_read_b64_tr_b16 v[66:67], v14 offset:9216
    s_lshr_b32 s39, s57, 1
    s_add_u32 m0, s39, 81920
    s_add_u32 s38, s99, 2097152
    buffer_load_dwordx4 v8, s[68:71], s38 offen lds
    s_waitcnt lgkmcnt(6)
    v_mfma_f32_32x32x16_bf16 a[16:31], v[52:55], v[40:43], a[16:31]
    ds_read_b64_tr_b16 v[68:69], v15 offset:8192
    ds_read_b64_tr_b16 v[70:71], v15 offset:9216
    s_waitcnt lgkmcnt(6)
    v_mfma_f32_32x32x16_bf16 a[32:47], v[56:59], v[40:43], a[32:47]
    ds_read_b64_tr_b16 v[72:73], v16 offset:8192
    ds_read_b64_tr_b16 v[74:75], v16 offset:9216
    s_lshr_b32 s39, s57, 1
    s_add_u32 m0, s39, 90112
    s_add_u32 s38, s99, 2097152
    buffer_load_dwordx4 v8, s[72:75], s38 offen lds
    s_waitcnt lgkmcnt(6)
    v_mfma_f32_32x32x16_bf16 a[48:63], v[60:63], v[40:43], a[48:63]
    ds_read_b64_tr_b16 v[76:77], v17 offset:8192
    ds_read_b64_tr_b16 v[78:79], v17 offset:9216
    s_waitcnt lgkmcnt(6)
    v_mfma_f32_32x32x16_bf16 a[64:79], v[40:43], v[64:67], a[64:79]
    ds_read_b64_tr_b16 v[48:49], v14 offset:4096
    ds_read_b64_tr_b16 v[50:51], v14 offset:5120
    s_waitcnt lgkmcnt(6)
    v_mfma_f32_32x32x16_bf16 a[80:95], v[40:43], v[68:71], a[80:95]
    ds_read_b64_tr_b16 v[52:53], v15 offset:4096
    ds_read_b64_tr_b16 v[54:55], v15 offset:5120
    s_waitcnt lgkmcnt(6)
    v_mfma_f32_32x32x16_bf16 a[96:111], v[40:43], v[72:75], a[96:111]
    ds_read_b64_tr_b16 v[56:57], v16 offset:4096
    ds_read_b64_tr_b16 v[58:59], v16 offset:5120
    s_waitcnt lgkmcnt(6)
    v_mfma_f32_32x32x16_bf16 a[112:127], v[40:43], v[76:79], a[112:127]
    ds_read_b64_tr_b16 v[60:61], v17 offset:4096
    ds_read_b64_tr_b16 v[62:63], v17 offset:5120
    s_waitcnt lgkmcnt(6)
    v_mfma_f32_32x32x16_bf16 a[0:15], v[48:51], v[44:47], a[0:15]
    ds_read_b64_tr_b16 v[64:65], v14 offset:12288
    ds_read_b64_tr_b16 v[66:67], v14 offset:13312
    s_waitcnt lgkmcnt(6)
    v_mfma_f32_32x32x16_bf16 a[16:31], v[52:55], v[44:47], a[16:31]
    ds_read_b64_tr_b16 v[68:69], v15 offset:12288
    ds_read_b64_tr_b16 v[70:71], v15 offset:13312
    s_waitcnt lgkmcnt(6)
    v_mfma_f32_32x32x16_bf16 a[32:47], v[56:59], v[44:47], a[32:47]
    ds_read_b64_tr_b16 v[72:73], v16 offset:12288
    ds_read_b64_tr_b16 v[74:75], v16 offset:13312
    s_waitcnt lgkmcnt(6)
    v_mfma_f32_32x32x16_bf16 a[48:63], v[60:63], v[44:47], a[48:63]
    s_waitcnt vmcnt(8)
    s_barrier
    v_add_u32 v12, 0xfffe0000, v12
    v_add_u32 v13, 0xfffe0000, v13
    ds_read_b128 v[32:35], v12
    ds_read_b128 v[36:39], v13
    ds_read_b64_tr_b16 v[76:77], v17 offset:12288
    ds_read_b64_tr_b16 v[78:79], v17 offset:13312
    s_waitcnt lgkmcnt(8)
    v_mfma_f32_32x32x16_bf16 a[64:79], v[44:47], v[64:67], a[64:79]
    v_add_u32 v14, 0xfffe0000, v14
    v_add_u32 v15, 0xfffe0000, v15
    v_add_u32 v16, 0xfffe0000, v16
    v_add_u32 v17, 0xfffe0000, v17
    ds_read_b64_tr_b16 v[48:49], v14 offset:0
    ds_read_b64_tr_b16 v[50:51], v14 offset:1024
    s_add_u32 m0, s57, 98304
    s_add_u32 s38, s67, 576
    buffer_load_dwordx4 v10, s[52:55], s38 offen offset:0 lds
    s_waitcnt lgkmcnt(8)
    v_mfma_f32_32x32x16_bf16 a[80:95], v[44:47], v[68:71], a[80:95]
    ds_read_b64_tr_b16 v[52:53], v15 offset:0
    ds_read_b64_tr_b16 v[54:55], v15 offset:1024
    s_waitcnt lgkmcnt(8)
    v_mfma_f32_32x32x16_bf16 a[96:111], v[44:47], v[72:75], a[96:111]
    ds_read_b64_tr_b16 v[56:57], v16 offset:0
    ds_read_b64_tr_b16 v[58:59], v16 offset:1024
    s_add_u32 m0, s57, 98304
    s_add_u32 s38, s67, 576
    buffer_load_dwordx4 v11, s[52:55], s38 offen offset:1024 lds
    s_waitcnt lgkmcnt(6)
    v_mfma_f32_32x32x16_bf16 a[112:127], v[44:47], v[76:79], a[112:127]
    ds_read_b64_tr_b16 v[60:61], v17 offset:0
    ds_read_b64_tr_b16 v[62:63], v17 offset:1024
    s_waitcnt lgkmcnt(6)
    v_mfma_f32_32x32x16_bf16 a[0:15], v[48:51], v[32:35], a[0:15]
    ds_read_b64_tr_b16 v[64:65], v14 offset:8192
    ds_read_b64_tr_b16 v[66:67], v14 offset:9216
    s_lshr_b32 s39, s57, 1
    s_add_u32 m0, s39, 114688
    s_add_u32 s38, s99, 2359296
    buffer_load_dwordx4 v8, s[68:71], s38 offen lds
    s_waitcnt lgkmcnt(6)
    v_mfma_f32_32x32x16_bf16 a[16:31], v[52:55], v[32:35], a[16:31]
    ds_read_b64_tr_b16 v[68:69], v15 offset:8192
    ds_read_b64_tr_b16 v[70:71], v15 offset:9216
    s_waitcnt lgkmcnt(6)
    v_mfma_f32_32x32x16_bf16 a[32:47], v[56:59], v[32:35], a[32:47]
    ds_read_b64_tr_b16 v[72:73], v16 offset:8192
    ds_read_b64_tr_b16 v[74:75], v16 offset:9216
    s_lshr_b32 s39, s57, 1
    s_add_u32 m0, s39, 122880
    s_add_u32 s38, s99, 2359296
    buffer_load_dwordx4 v8, s[72:75], s38 offen lds
    s_waitcnt lgkmcnt(6)
    v_mfma_f32_32x32x16_bf16 a[48:63], v[60:63], v[32:35], a[48:63]
    ds_read_b64_tr_b16 v[76:77], v17 offset:8192
    ds_read_b64_tr_b16 v[78:79], v17 offset:9216
    s_waitcnt lgkmcnt(6)
    v_mfma_f32_32x32x16_bf16 a[64:79], v[32:35], v[64:67], a[64:79]
    ds_read_b64_tr_b16 v[48:49], v14 offset:4096
    ds_read_b64_tr_b16 v[50:51], v14 offset:5120
    s_waitcnt lgkmcnt(6)
    v_mfma_f32_32x32x16_bf16 a[80:95], v[32:35], v[68:71], a[80:95]
    ds_read_b64_tr_b16 v[52:53], v15 offset:4096
    ds_read_b64_tr_b16 v[54:55], v15 offset:5120
    s_waitcnt lgkmcnt(6)
    v_mfma_f32_32x32x16_bf16 a[96:111], v[32:35], v[72:75], a[96:111]
    ds_read_b64_tr_b16 v[56:57], v16 offset:4096
    ds_read_b64_tr_b16 v[58:59], v16 offset:5120
    s_waitcnt lgkmcnt(6)
    v_mfma_f32_32x32x16_bf16 a[112:127], v[32:35], v[76:79], a[112:127]
    ds_read_b64_tr_b16 v[60:61], v17 offset:4096
    ds_read_b64_tr_b16 v[62:63], v17 offset:5120
    s_waitcnt lgkmcnt(6)
    v_mfma_f32_32x32x16_bf16 a[0:15], v[48:51], v[36:39], a[0:15]
    ds_read_b64_tr_b16 v[64:65], v14 offset:12288
    ds_read_b64_tr_b16 v[66:67], v14 offset:13312
    s_waitcnt lgkmcnt(6)
    v_mfma_f32_32x32x16_bf16 a[16:31], v[52:55], v[36:39], a[16:31]
    ds_read_b64_tr_b16 v[68:69], v15 offset:12288
    ds_read_b64_tr_b16 v[70:71], v15 offset:13312
    s_waitcnt lgkmcnt(6)
    v_mfma_f32_32x32x16_bf16 a[32:47], v[56:59], v[36:39], a[32:47]
    ds_read_b64_tr_b16 v[72:73], v16 offset:12288
    ds_read_b64_tr_b16 v[74:75], v16 offset:13312
    s_waitcnt lgkmcnt(6)
    v_mfma_f32_32x32x16_bf16 a[48:63], v[60:63], v[36:39], a[48:63]
    s_waitcnt vmcnt(8)
    s_barrier
    v_add_u32 v12, 0x8000, v12
    v_add_u32 v13, 0x8000, v13
    ds_read_b128 v[40:43], v12
    ds_read_b128 v[44:47], v13
    ds_read_b64_tr_b16 v[76:77], v17 offset:12288
    ds_read_b64_tr_b16 v[78:79], v17 offset:13312
    s_waitcnt lgkmcnt(8)
    v_mfma_f32_32x32x16_bf16 a[64:79], v[36:39], v[64:67], a[64:79]
    v_add_u32 v14, 0x8000, v14
    v_add_u32 v15, 0x8000, v15
    v_add_u32 v16, 0x8000, v16
    v_add_u32 v17, 0x8000, v17
    ds_read_b64_tr_b16 v[48:49], v14 offset:0
    ds_read_b64_tr_b16 v[50:51], v14 offset:1024
    s_add_u32 m0, s57, 131072
    s_add_u32 s38, s67, 640
    buffer_load_dwordx4 v10, s[52:55], s38 offen offset:0 lds
    s_waitcnt lgkmcnt(8)
    v_mfma_f32_32x32x16_bf16 a[80:95], v[36:39], v[68:71], a[80:95]
    ds_read_b64_tr_b16 v[52:53], v15 offset:0
    ds_read_b64_tr_b16 v[54:55], v15 offset:1024
    s_waitcnt lgkmcnt(8)
    v_mfma_f32_32x32x16_bf16 a[96:111], v[36:39], v[72:75], a[96:111]
    ds_read_b64_tr_b16 v[56:57], v16 offset:0
    ds_read_b64_tr_b16 v[58:59], v16 offset:1024
    s_add_u32 m0, s57, 131072
    s_add_u32 s38, s67, 640
    buffer_load_dwordx4 v11, s[52:55], s38 offen offset:1024 lds
    s_waitcnt lgkmcnt(6)
    v_mfma_f32_32x32x16_bf16 a[112:127], v[36:39], v[76:79], a[112:127]
    ds_read_b64_tr_b16 v[60:61], v17 offset:0
    ds_read_b64_tr_b16 v[62:63], v17 offset:1024
    s_waitcnt lgkmcnt(6)
    v_mfma_f32_32x32x16_bf16 a[0:15], v[48:51], v[40:43], a[0:15]
    ds_read_b64_tr_b16 v[64:65], v14 offset:8192
    ds_read_b64_tr_b16 v[66:67], v14 offset:9216
    s_lshr_b32 s39, s57, 1
    s_add_u32 m0, s39, 147456
    s_add_u32 s38, s99, 2621440
    buffer_load_dwordx4 v8, s[68:71], s38 offen lds
    s_waitcnt lgkmcnt(6)
    v_mfma_f32_32x32x16_bf16 a[16:31], v[52:55], v[40:43], a[16:31]
    ds_read_b64_tr_b16 v[68:69], v15 offset:8192
    ds_read_b64_tr_b16 v[70:71], v15 offset:9216
    s_waitcnt lgkmcnt(6)
    v_mfma_f32_32x32x16_bf16 a[32:47], v[56:59], v[40:43], a[32:47]
    ds_read_b64_tr_b16 v[72:73], v16 offset:8192
    ds_read_b64_tr_b16 v[74:75], v16 offset:9216
    s_lshr_b32 s39, s57, 1
    s_add_u32 m0, s39, 155648
    s_add_u32 s38, s99, 2621440
    buffer_load_dwordx4 v8, s[72:75], s38 offen lds
    s_waitcnt lgkmcnt(6)
    v_mfma_f32_32x32x16_bf16 a[48:63], v[60:63], v[40:43], a[48:63]
    ds_read_b64_tr_b16 v[76:77], v17 offset:8192
    ds_read_b64_tr_b16 v[78:79], v17 offset:9216
    s_waitcnt lgkmcnt(6)
    v_mfma_f32_32x32x16_bf16 a[64:79], v[40:43], v[64:67], a[64:79]
    ds_read_b64_tr_b16 v[48:49], v14 offset:4096
    ds_read_b64_tr_b16 v[50:51], v14 offset:5120
    s_waitcnt lgkmcnt(6)
    v_mfma_f32_32x32x16_bf16 a[80:95], v[40:43], v[68:71], a[80:95]
    ds_read_b64_tr_b16 v[52:53], v15 offset:4096
    ds_read_b64_tr_b16 v[54:55], v15 offset:5120
    s_waitcnt lgkmcnt(6)
    v_mfma_f32_32x32x16_bf16 a[96:111], v[40:43], v[72:75], a[96:111]
    ds_read_b64_tr_b16 v[56:57], v16 offset:4096
    ds_read_b64_tr_b16 v[58:59], v16 offset:5120
    s_waitcnt lgkmcnt(6)
    v_mfma_f32_32x32x16_bf16 a[112:127], v[40:43], v[76:79], a[112:127]
    ds_read_b64_tr_b16 v[60:61], v17 offset:4096
    ds_read_b64_tr_b16 v[62:63], v17 offset:5120
    s_waitcnt lgkmcnt(6)
    v_mfma_f32_32x32x16_bf16 a[0:15], v[48:51], v[44:47], a[0:15]
    ds_read_b64_tr_b16 v[64:65], v14 offset:12288
    ds_read_b64_tr_b16 v[66:67], v14 offset:13312
    s_waitcnt lgkmcnt(6)
    v_mfma_f32_32x32x16_bf16 a[16:31], v[52:55], v[44:47], a[16:31]
    ds_read_b64_tr_b16 v[68:69], v15 offset:12288
    ds_read_b64_tr_b16 v[70:71], v15 offset:13312
    s_waitcnt lgkmcnt(6)
    v_mfma_f32_32x32x16_bf16 a[32:47], v[56:59], v[44:47], a[32:47]
    ds_read_b64_tr_b16 v[72:73], v16 offset:12288
    ds_read_b64_tr_b16 v[74:75], v16 offset:13312
    s_waitcnt lgkmcnt(6)
    v_mfma_f32_32x32x16_bf16 a[48:63], v[60:63], v[44:47], a[48:63]
    s_waitcnt vmcnt(8)
    s_barrier
    v_add_u32 v12, 0x8000, v12
    v_add_u32 v13, 0x8000, v13
    ds_read_b128 v[32:35], v12
    ds_read_b128 v[36:39], v13
    ds_read_b64_tr_b16 v[76:77], v17 offset:12288
    ds_read_b64_tr_b16 v[78:79], v17 offset:13312
    s_waitcnt lgkmcnt(8)
    v_mfma_f32_32x32x16_bf16 a[64:79], v[44:47], v[64:67], a[64:79]
    v_add_u32 v14, 0x8000, v14
    v_add_u32 v15, 0x8000, v15
    v_add_u32 v16, 0x8000, v16
    v_add_u32 v17, 0x8000, v17
    ds_read_b64_tr_b16 v[48:49], v14 offset:0
    ds_read_b64_tr_b16 v[50:51], v14 offset:1024
    s_add_u32 m0, s57, 0
    s_add_u32 s38, s67, 704
    buffer_load_dwordx4 v10, s[52:55], s38 offen offset:0 lds
    s_waitcnt lgkmcnt(8)
    v_mfma_f32_32x32x16_bf16 a[80:95], v[44:47], v[68:71], a[80:95]
    ds_read_b64_tr_b16 v[52:53], v15 offset:0
    ds_read_b64_tr_b16 v[54:55], v15 offset:1024
    s_waitcnt lgkmcnt(8)
    v_mfma_f32_32x32x16_bf16 a[96:111], v[44:47], v[72:75], a[96:111]
    ds_read_b64_tr_b16 v[56:57], v16 offset:0
    ds_read_b64_tr_b16 v[58:59], v16 offset:1024
    s_add_u32 m0, s57, 0
    s_add_u32 s38, s67, 704
    buffer_load_dwordx4 v11, s[52:55], s38 offen offset:1024 lds
    s_waitcnt lgkmcnt(6)
    v_mfma_f32_32x32x16_bf16 a[112:127], v[44:47], v[76:79], a[112:127]
    ds_read_b64_tr_b16 v[60:61], v17 offset:0
    ds_read_b64_tr_b16 v[62:63], v17 offset:1024
    s_waitcnt lgkmcnt(6)
    v_mfma_f32_32x32x16_bf16 a[0:15], v[48:51], v[32:35], a[0:15]
    ds_read_b64_tr_b16 v[64:65], v14 offset:8192
    ds_read_b64_tr_b16 v[66:67], v14 offset:9216
    s_lshr_b32 s39, s57, 1
    s_add_u32 m0, s39, 16384
    s_add_u32 s38, s99, 2883584
    buffer_load_dwordx4 v8, s[68:71], s38 offen lds
    s_waitcnt lgkmcnt(6)
    v_mfma_f32_32x32x16_bf16 a[16:31], v[52:55], v[32:35], a[16:31]
    ds_read_b64_tr_b16 v[68:69], v15 offset:8192
    ds_read_b64_tr_b16 v[70:71], v15 offset:9216
    s_waitcnt lgkmcnt(6)
    v_mfma_f32_32x32x16_bf16 a[32:47], v[56:59], v[32:35], a[32:47]
    ds_read_b64_tr_b16 v[72:73], v16 offset:8192
    ds_read_b64_tr_b16 v[74:75], v16 offset:9216
    s_lshr_b32 s39, s57, 1
    s_add_u32 m0, s39, 24576
    s_add_u32 s38, s99, 2883584
    buffer_load_dwordx4 v8, s[72:75], s38 offen lds
    s_waitcnt lgkmcnt(6)
    v_mfma_f32_32x32x16_bf16 a[48:63], v[60:63], v[32:35], a[48:63]
    ds_read_b64_tr_b16 v[76:77], v17 offset:8192
    ds_read_b64_tr_b16 v[78:79], v17 offset:9216
    s_waitcnt lgkmcnt(6)
    v_mfma_f32_32x32x16_bf16 a[64:79], v[32:35], v[64:67], a[64:79]
    ds_read_b64_tr_b16 v[48:49], v14 offset:4096
    ds_read_b64_tr_b16 v[50:51], v14 offset:5120
    s_waitcnt lgkmcnt(6)
    v_mfma_f32_32x32x16_bf16 a[80:95], v[32:35], v[68:71], a[80:95]
    ds_read_b64_tr_b16 v[52:53], v15 offset:4096
    ds_read_b64_tr_b16 v[54:55], v15 offset:5120
    s_waitcnt lgkmcnt(6)
    v_mfma_f32_32x32x16_bf16 a[96:111], v[32:35], v[72:75], a[96:111]
    ds_read_b64_tr_b16 v[56:57], v16 offset:4096
    ds_read_b64_tr_b16 v[58:59], v16 offset:5120
    s_waitcnt lgkmcnt(6)
    v_mfma_f32_32x32x16_bf16 a[112:127], v[32:35], v[76:79], a[112:127]
    ds_read_b64_tr_b16 v[60:61], v17 offset:4096
    ds_read_b64_tr_b16 v[62:63], v17 offset:5120
    s_waitcnt lgkmcnt(6)
    v_mfma_f32_32x32x16_bf16 a[0:15], v[48:51], v[36:39], a[0:15]
    ds_read_b64_tr_b16 v[64:65], v14 offset:12288
    ds_read_b64_tr_b16 v[66:67], v14 offset:13312
    s_waitcnt lgkmcnt(6)
    v_mfma_f32_32x32x16_bf16 a[16:31], v[52:55], v[36:39], a[16:31]
    ds_read_b64_tr_b16 v[68:69], v15 offset:12288
    ds_read_b64_tr_b16 v[70:71], v15 offset:13312
    s_waitcnt lgkmcnt(6)
    v_mfma_f32_32x32x16_bf16 a[32:47], v[56:59], v[36:39], a[32:47]
    ds_read_b64_tr_b16 v[72:73], v16 offset:12288
    ds_read_b64_tr_b16 v[74:75], v16 offset:13312
    s_waitcnt lgkmcnt(6)
    v_mfma_f32_32x32x16_bf16 a[48:63], v[60:63], v[36:39], a[48:63]
    s_waitcnt vmcnt(8)
    s_barrier
    v_add_u32 v12, 0x8000, v12
    v_add_u32 v13, 0x8000, v13
    ds_read_b128 v[40:43], v12
    ds_read_b128 v[44:47], v13
    ds_read_b64_tr_b16 v[76:77], v17 offset:12288
    ds_read_b64_tr_b16 v[78:79], v17 offset:13312
    s_waitcnt lgkmcnt(8)
    v_mfma_f32_32x32x16_bf16 a[64:79], v[36:39], v[64:67], a[64:79]
    v_add_u32 v14, 0x8000, v14
    v_add_u32 v15, 0x8000, v15
    v_add_u32 v16, 0x8000, v16
    v_add_u32 v17, 0x8000, v17
    ds_read_b64_tr_b16 v[48:49], v14 offset:0
    ds_read_b64_tr_b16 v[50:51], v14 offset:1024
    v_lshlrev_b32 v23, 2, v1
    buffer_load_dword v22, v23, s[32:35], 0 offen sc1
    s_add_u32 m0, s57, 32768
    s_add_u32 s38, s67, 768
    buffer_load_dwordx4 v10, s[52:55], s38 offen offset:0 lds
    s_waitcnt lgkmcnt(8)
    v_mfma_f32_32x32x16_bf16 a[80:95], v[36:39], v[68:71], a[80:95]
    ds_read_b64_tr_b16 v[52:53], v15 offset:0
    ds_read_b64_tr_b16 v[54:55], v15 offset:1024
    s_waitcnt lgkmcnt(8)
    v_mfma_f32_32x32x16_bf16 a[96:111], v[36:39], v[72:75], a[96:111]
    ds_read_b64_tr_b16 v[56:57], v16 offset:0
    ds_read_b64_tr_b16 v[58:59], v16 offset:1024
    s_add_u32 m0, s57, 32768
    s_add_u32 s38, s67, 768
    buffer_load_dwordx4 v11, s[52:55], s38 offen offset:1024 lds
    s_waitcnt lgkmcnt(6)
    v_mfma_f32_32x32x16_bf16 a[112:127], v[36:39], v[76:79], a[112:127]
    ds_read_b64_tr_b16 v[60:61], v17 offset:0
    ds_read_b64_tr_b16 v[62:63], v17 offset:1024
    s_waitcnt lgkmcnt(6)
    v_mfma_f32_32x32x16_bf16 a[0:15], v[48:51], v[40:43], a[0:15]
    ds_read_b64_tr_b16 v[64:65], v14 offset:8192
    ds_read_b64_tr_b16 v[66:67], v14 offset:9216
    s_lshr_b32 s39, s57, 1
    s_add_u32 m0, s39, 49152
    s_add_u32 s38, s99, 3145728
    buffer_load_dwordx4 v8, s[68:71], s38 offen lds
    s_waitcnt lgkmcnt(6)
    v_mfma_f32_32x32x16_bf16 a[16:31], v[52:55], v[40:43], a[16:31]
    ds_read_b64_tr_b16 v[68:69], v15 offset:8192
    ds_read_b64_tr_b16 v[70:71], v15 offset:9216
    s_waitcnt lgkmcnt(6)
    v_mfma_f32_32x32x16_bf16 a[32:47], v[56:59], v[40:43], a[32:47]
    ds_read_b64_tr_b16 v[72:73], v16 offset:8192
    ds_read_b64_tr_b16 v[74:75], v16 offset:9216
    s_lshr_b32 s39, s57, 1
    s_add_u32 m0, s39, 57344
    s_add_u32 s38, s99, 3145728
    buffer_load_dwordx4 v8, s[72:75], s38 offen lds
    s_waitcnt lgkmcnt(6)
    v_mfma_f32_32x32x16_bf16 a[48:63], v[60:63], v[40:43], a[48:63]
    ds_read_b64_tr_b16 v[76:77], v17 offset:8192
    ds_read_b64_tr_b16 v[78:79], v17 offset:9216
    s_waitcnt lgkmcnt(6)
    v_mfma_f32_32x32x16_bf16 a[64:79], v[40:43], v[64:67], a[64:79]
    ds_read_b64_tr_b16 v[48:49], v14 offset:4096
    ds_read_b64_tr_b16 v[50:51], v14 offset:5120
    s_waitcnt lgkmcnt(6)
    v_mfma_f32_32x32x16_bf16 a[80:95], v[40:43], v[68:71], a[80:95]
    ds_read_b64_tr_b16 v[52:53], v15 offset:4096
    ds_read_b64_tr_b16 v[54:55], v15 offset:5120
    s_waitcnt lgkmcnt(6)
    v_mfma_f32_32x32x16_bf16 a[96:111], v[40:43], v[72:75], a[96:111]
    ds_read_b64_tr_b16 v[56:57], v16 offset:4096
    ds_read_b64_tr_b16 v[58:59], v16 offset:5120
    s_waitcnt lgkmcnt(6)
    v_mfma_f32_32x32x16_bf16 a[112:127], v[40:43], v[76:79], a[112:127]
    ds_read_b64_tr_b16 v[60:61], v17 offset:4096
    ds_read_b64_tr_b16 v[62:63], v17 offset:5120
    s_waitcnt lgkmcnt(6)
    v_mfma_f32_32x32x16_bf16 a[0:15], v[48:51], v[44:47], a[0:15]
    ds_read_b64_tr_b16 v[64:65], v14 offset:12288
    ds_read_b64_tr_b16 v[66:67], v14 offset:13312
    s_waitcnt lgkmcnt(6)
    v_mfma_f32_32x32x16_bf16 a[16:31], v[52:55], v[44:47], a[16:31]
    ds_read_b64_tr_b16 v[68:69], v15 offset:12288
    ds_read_b64_tr_b16 v[70:71], v15 offset:13312
    s_waitcnt lgkmcnt(6)
    v_mfma_f32_32x32x16_bf16 a[32:47], v[56:59], v[44:47], a[32:47]
    ds_read_b64_tr_b16 v[72:73], v16 offset:12288
    ds_read_b64_tr_b16 v[74:75], v16 offset:13312
    s_waitcnt lgkmcnt(6)
    v_mfma_f32_32x32x16_bf16 a[48:63], v[60:63], v[44:47], a[48:63]
    s_waitcnt vmcnt(9)
    s_barrier
    v_add_u32 v12, 0x8000, v12
    v_add_u32 v13, 0x8000, v13
    ds_read_b128 v[32:35], v12
    ds_read_b128 v[36:39], v13
    ds_read_b64_tr_b16 v[76:77], v17 offset:12288
    ds_read_b64_tr_b16 v[78:79], v17 offset:13312
    s_waitcnt lgkmcnt(8)
    v_mfma_f32_32x32x16_bf16 a[64:79], v[44:47], v[64:67], a[64:79]
    v_add_u32 v14, 0x8000, v14
    v_add_u32 v15, 0x8000, v15
    v_add_u32 v16, 0x8000, v16
    v_add_u32 v17, 0x8000, v17
    ds_read_b64_tr_b16 v[48:49], v14 offset:0
    ds_read_b64_tr_b16 v[50:51], v14 offset:1024
    s_waitcnt vmcnt(4)
    v_and_b32 v18, 0x80808080, v22
    v_mov_b32 v19, 0x80808080
    v_cmp_ne_u32 vcc, v18, v19
    s_cmp_eq_u64 vcc, 0
    s_cbranch_scc1 S1c2_ok
    s_mov_b32 s95, 0
S1c2_sp:
    v_lshlrev_b32 v23, 2, v1
    buffer_load_dword v22, v23, s[32:35], 0 offen sc1
    s_waitcnt vmcnt(0)
    v_and_b32 v18, 0x80808080, v22
    v_mov_b32 v19, 0x80808080
    v_cmp_ne_u32 vcc, v18, v19
    s_cmp_eq_u64 vcc, 0
    s_cbranch_scc1 S1c2_ok
    s_add_u32 s95, s95, 1
    s_cmp_lt_u32 s95, 262144
    s_cbranch_scc1 S1c2_sp
S1c2_ok:
    s_and_b32 s38, s2, 3
    s_lshl_b32 s38, s38, 3
    v_lshrrev_b32 v18, s38, v22
    v_and_b32 v18, 0x7f, v18
    s_bfe_u32 s39, s2, 0x10002
    v_and_b32 v19, 1, v1
    v_cmp_eq_u32 s[94:95], s39, v19
    v_cmp_ne_u32 vcc, s97, v18
    s_and_b64 vcc, vcc, s[94:95]
    s_cmp_eq_u64 vcc, 0
    s_cselect_b32 s96, 1, 0
    s_add_u32 m0, s57, 65536
    s_add_u32 s38, s67, 832
    buffer_load_dwordx4 v10, s[52:55], s38 offen offset:0 lds
    s_waitcnt lgkmcnt(8)
    v_mfma_f32_32x32x16_bf16 a[80:95], v[44:47], v[68:71], a[80:95]
    ds_read_b64_tr_b16 v[52:53], v15 offset:0
    ds_read_b64_tr_b16 v[54:55], v15 offset:1024
    s_waitcnt lgkmcnt(8)
    v_mfma_f32_32x32x16_bf16 a[96:111], v[44:47], v[72:75], a[96:111]
    ds_read_b64_tr_b16 v[56:57], v16 offset:0
    ds_read_b64_tr_b16 v[58:59], v16 offset:1024
    s_add_u32 m0, s57, 65536
    s_add_u32 s38, s67, 832
    buffer_load_dwordx4 v11, s[52:55], s38 offen offset:1024 lds
    s_waitcnt lgkmcnt(6)
    v_mfma_f32_32x32x16_bf16 a[112:127], v[44:47], v[76:79], a[112:127]
    ds_read_b64_tr_b16 v[60:61], v17 offset:0
    ds_read_b64_tr_b16 v[62:63], v17 offset:1024
    s_waitcnt lgkmcnt(6)
    v_mfma_f32_32x32x16_bf16 a[0:15], v[48:51], v[32:35], a[0:15]
    ds_read_b64_tr_b16 v[64:65], v14 offset:8192
    ds_read_b64_tr_b16 v[66:67], v14 offset:9216
    s_lshr_b32 s39, s57, 1
    s_add_u32 m0, s39, 81920
    s_add_u32 s38, s99, 3407872
    buffer_load_dwordx4 v8, s[68:71], s38 offen lds
    s_waitcnt lgkmcnt(6)
    v_mfma_f32_32x32x16_bf16 a[16:31], v[52:55], v[32:35], a[16:31]
    ds_read_b64_tr_b16 v[68:69], v15 offset:8192
    ds_read_b64_tr_b16 v[70:71], v15 offset:9216
    s_waitcnt lgkmcnt(6)
    v_mfma_f32_32x32x16_bf16 a[32:47], v[56:59], v[32:35], a[32:47]
    ds_read_b64_tr_b16 v[72:73], v16 offset:8192
    ds_read_b64_tr_b16 v[74:75], v16 offset:9216
    s_lshr_b32 s39, s57, 1
    s_add_u32 m0, s39, 90112
    s_add_u32 s38, s99, 3407872
    buffer_load_dwordx4 v8, s[72:75], s38 offen lds
    s_waitcnt lgkmcnt(6)
    v_mfma_f32_32x32x16_bf16 a[48:63], v[60:63], v[32:35], a[48:63]
    ds_read_b64_tr_b16 v[76:77], v17 offset:8192
    ds_read_b64_tr_b16 v[78:79], v17 offset:9216
    s_waitcnt lgkmcnt(6)
    v_mfma_f32_32x32x16_bf16 a[64:79], v[32:35], v[64:67], a[64:79]
    ds_read_b64_tr_b16 v[48:49], v14 offset:4096
    ds_read_b64_tr_b16 v[50:51], v14 offset:5120
    s_waitcnt lgkmcnt(6)
    v_mfma_f32_32x32x16_bf16 a[80:95], v[32:35], v[68:71], a[80:95]
    ds_read_b64_tr_b16 v[52:53], v15 offset:4096
    ds_read_b64_tr_b16 v[54:55], v15 offset:5120
    s_waitcnt lgkmcnt(6)
    v_mfma_f32_32x32x16_bf16 a[96:111], v[32:35], v[72:75], a[96:111]
    ds_read_b64_tr_b16 v[56:57], v16 offset:4096
    ds_read_b64_tr_b16 v[58:59], v16 offset:5120
    s_waitcnt lgkmcnt(6)
    v_mfma_f32_32x32x16_bf16 a[112:127], v[32:35], v[76:79], a[112:127]
    ds_read_b64_tr_b16 v[60:61], v17 offset:4096
    ds_read_b64_tr_b16 v[62:63], v17 offset:5120
    s_waitcnt lgkmcnt(6)
    v_mfma_f32_32x32x16_bf16 a[0:15], v[48:51], v[36:39], a[0:15]
    ds_read_b64_tr_b16 v[64:65], v14 offset:12288
    ds_read_b64_tr_b16 v[66:67], v14 offset:13312
    s_waitcnt lgkmcnt(6)
    v_mfma_f32_32x32x16_bf16 a[16:31], v[52:55], v[36:39], a[16:31]
    ds_read_b64_tr_b16 v[68:69], v15 offset:12288
    ds_read_b64_tr_b16 v[70:71], v15 offset:13312
    s_waitcnt lgkmcnt(6)
    v_mfma_f32_32x32x16_bf16 a[32:47], v[56:59], v[36:39], a[32:47]
    ds_read_b64_tr_b16 v[72:73], v16 offset:12288
    ds_read_b64_tr_b16 v[74:75], v16 offset:13312
    s_waitcnt lgkmcnt(6)
    v_mfma_f32_32x32x16_bf16 a[48:63], v[60:63], v[36:39], a[48:63]
    s_barrier
    v_add_u32 v12, 0xfffe0000, v12
    v_add_u32 v13, 0xfffe0000, v13
    ds_read_b128 v[40:43], v12
    ds_read_b128 v[44:47], v13
    ds_read_b64_tr_b16 v[76:77], v17 offset:12288
    ds_read_b64_tr_b16 v[78:79], v17 offset:13312
    s_waitcnt lgkmcnt(8)
    v_mfma_f32_32x32x16_bf16 a[64:79], v[36:39], v[64:67], a[64:79]
    v_add_u32 v14, 0xfffe0000, v14
    v_add_u32 v15, 0xfffe0000, v15
    v_add_u32 v16, 0xfffe0000, v16
    v_add_u32 v17, 0xfffe0000, v17
    ds_read_b64_tr_b16 v[48:49], v14 offset:0
    ds_read_b64_tr_b16 v[50:51], v14 offset:1024
    s_add_u32 m0, s57, 98304
    s_add_u32 s38, s67, 896
    buffer_load_dwordx4 v10, s[52:55], s38 offen offset:0 lds
    s_waitcnt lgkmcnt(8)
    v_mfma_f32_32x32x16_bf16 a[80:95], v[36:39], v[68:71], a[80:95]
    ds_read_b64_tr_b16 v[52:53], v15 offset:0
    ds_read_b64_tr_b16 v[54:55], v15 offset:1024
    s_waitcnt lgkmcnt(8)
    v_mfma_f32_32x32x16_bf16 a[96:111], v[36:39], v[72:75], a[96:111]
    ds_read_b64_tr_b16 v[56:57], v16 offset:0
    ds_read_b64_tr_b16 v[58:59], v16 offset:1024
    s_add_u32 m0, s57, 98304
    s_add_u32 s38, s67, 896
    buffer_load_dwordx4 v11, s[52:55], s38 offen offset:1024 lds
    s_waitcnt lgkmcnt(6)
    v_mfma_f32_32x32x16_bf16 a[112:127], v[36:39], v[76:79], a[112:127]
    ds_read_b64_tr_b16 v[60:61], v17 offset:0
    ds_read_b64_tr_b16 v[62:63], v17 offset:1024
    s_waitcnt lgkmcnt(6)
    v_mfma_f32_32x32x16_bf16 a[0:15], v[48:51], v[40:43], a[0:15]
    ds_read_b64_tr_b16 v[64:65], v14 offset:8192
    ds_read_b64_tr_b16 v[66:67], v14 offset:9216
    s_lshr_b32 s39, s57, 1
    s_add_u32 m0, s39, 114688
    s_add_u32 s38, s99, 3670016
    buffer_load_dwordx4 v8, s[68:71], s38 offen lds
    s_waitcnt lgkmcnt(6)
    v_mfma_f32_32x32x16_bf16 a[16:31], v[52:55], v[40:43], a[16:31]
    ds_read_b64_tr_b16 v[68:69], v15 offset:8192
    ds_read_b64_tr_b16 v[70:71], v15 offset:9216
    s_waitcnt lgkmcnt(6)
    v_mfma_f32_32x32x16_bf16 a[32:47], v[56:59], v[40:43], a[32:47]
    ds_read_b64_tr_b16 v[72:73], v16 offset:8192
    ds_read_b64_tr_b16 v[74:75], v16 offset:9216
    s_lshr_b32 s39, s57, 1
    s_add_u32 m0, s39, 122880
    s_add_u32 s38, s99, 3670016
    buffer_load_dwordx4 v8, s[72:75], s38 offen lds
    s_waitcnt lgkmcnt(6)
    v_mfma_f32_32x32x16_bf16 a[48:63], v[60:63], v[40:43], a[48:63]
    ds_read_b64_tr_b16 v[76:77], v17 offset:8192
    ds_read_b64_tr_b16 v[78:79], v17 offset:9216
    s_waitcnt lgkmcnt(6)
    v_mfma_f32_32x32x16_bf16 a[64:79], v[40:43], v[64:67], a[64:79]
    ds_read_b64_tr_b16 v[48:49], v14 offset:4096
    ds_read_b64_tr_b16 v[50:51], v14 offset:5120
    s_lshl_b32 s38, s64, 15
    s_and_b32 s39, s36, 3
    s_lshl_b32 s39, s39, 13
    s_add_u32 s38, s38, s39
    s_add_u32 s38, s38, 33554432
    buffer_load_dword v3, v26, s[28:31], s38 offen sc1
    s_waitcnt lgkmcnt(6)
    v_mfma_f32_32x32x16_bf16 a[80:95], v[40:43], v[68:71], a[80:95]
    ds_read_b64_tr_b16 v[52:53], v15 offset:4096
    ds_read_b64_tr_b16 v[54:55], v15 offset:5120
    s_waitcnt lgkmcnt(6)
    v_mfma_f32_32x32x16_bf16 a[96:111], v[40:43], v[72:75], a[96:111]
    ds_read_b64_tr_b16 v[56:57], v16 offset:4096
    ds_read_b64_tr_b16 v[58:59], v16 offset:5120
    s_lshl_b32 s38, s64, 15
    s_and_b32 s39, s36, 3
    s_lshl_b32 s39, s39, 13
    s_add_u32 s38, s38, s39
    s_add_u32 s38, s38, 33558528
    buffer_load_dword v3, v26, s[28:31], s38 offen sc1
    s_waitcnt lgkmcnt(6)
    v_mfma_f32_32x32x16_bf16 a[112:127], v[40:43], v[76:79], a[112:127]
    ds_read_b64_tr_b16 v[60:61], v17 offset:4096
    ds_read_b64_tr_b16 v[62:63], v17 offset:5120
    s_waitcnt lgkmcnt(6)
    v_mfma_f32_32x32x16_bf16 a[0:15], v[48:51], v[44:47], a[0:15]
    ds_read_b64_tr_b16 v[64:65], v14 offset:12288
    ds_read_b64_tr_b16 v[66:67], v14 offset:13312
    s_waitcnt lgkmcnt(6)
    v_mfma_f32_32x32x16_bf16 a[16:31], v[52:55], v[44:47], a[16:31]
    ds_read_b64_tr_b16 v[68:69], v15 offset:12288
    ds_read_b64_tr_b16 v[70:71], v15 offset:13312
    s_waitcnt lgkmcnt(6)
    v_mfma_f32_32x32x16_bf16 a[32:47], v[56:59], v[44:47], a[32:47]
    ds_read_b64_tr_b16 v[72:73], v16 offset:12288
    ds_read_b64_tr_b16 v[74:75], v16 offset:13312
    s_waitcnt lgkmcnt(6)
    v_mfma_f32_32x32x16_bf16 a[48:63], v[60:63], v[44:47], a[48:63]
    s_waitcnt vmcnt(10)
    s_barrier
    v_add_u32 v12, 0x8000, v12
    v_add_u32 v13, 0x8000, v13
    ds_read_b128 v[32:35], v12
    ds_read_b128 v[36:39], v13
    ds_read_b64_tr_b16 v[76:77], v17 offset:12288
    ds_read_b64_tr_b16 v[78:79], v17 offset:13312
    s_waitcnt lgkmcnt(8)
    v_mfma_f32_32x32x16_bf16 a[64:79], v[44:47], v[64:67], a[64:79]
    v_add_u32 v14, 0x8000, v14
    v_add_u32 v15, 0x8000, v15
    v_add_u32 v16, 0x8000, v16
    v_add_u32 v17, 0x8000, v17
    ds_read_b64_tr_b16 v[48:49], v14 offset:0
    ds_read_b64_tr_b16 v[50:51], v14 offset:1024
    s_add_u32 m0, s57, 131072
    s_add_u32 s38, s67, 960
    buffer_load_dwordx4 v10, s[52:55], s38 offen offset:0 lds
    s_waitcnt lgkmcnt(8)
    v_mfma_f32_32x32x16_bf16 a[80:95], v[44:47], v[68:71], a[80:95]
    ds_read_b64_tr_b16 v[52:53], v15 offset:0
    ds_read_b64_tr_b16 v[54:55], v15 offset:1024
    s_waitcnt lgkmcnt(8)
    v_mfma_f32_32x32x16_bf16 a[96:111], v[44:47], v[72:75], a[96:111]
    ds_read_b64_tr_b16 v[56:57], v16 offset:0
    ds_read_b64_tr_b16 v[58:59], v16 offset:1024
    s_add_u32 m0, s57, 131072
    s_add_u32 s38, s67, 960
    buffer_load_dwordx4 v11, s[52:55], s38 offen offset:1024 lds
    s_waitcnt lgkmcnt(6)
    v_mfma_f32_32x32x16_bf16 a[112:127], v[44:47], v[76:79], a[112:127]
    ds_read_b64_tr_b16 v[60:61], v17 offset:0
    ds_read_b64_tr_b16 v[62:63], v17 offset:1024
    s_waitcnt lgkmcnt(6)
    v_mfma_f32_32x32x16_bf16 a[0:15], v[48:51], v[32:35], a[0:15]
    ds_read_b64_tr_b16 v[64:65], v14 offset:8192
    ds_read_b64_tr_b16 v[66:67], v14 offset:9216
    s_lshr_b32 s39, s57, 1
    s_add_u32 m0, s39, 147456
    s_add_u32 s38, s99, 3932160
    buffer_load_dwordx4 v8, s[68:71], s38 offen lds
    s_waitcnt lgkmcnt(6)
    v_mfma_f32_32x32x16_bf16 a[16:31], v[52:55], v[32:35], a[16:31]
    ds_read_b64_tr_b16 v[68:69], v15 offset:8192
    ds_read_b64_tr_b16 v[70:71], v15 offset:9216
    s_waitcnt lgkmcnt(6)
    v_mfma_f32_32x32x16_bf16 a[32:47], v[56:59], v[32:35], a[32:47]
    ds_read_b64_tr_b16 v[72:73], v16 offset:8192
    ds_read_b64_tr_b16 v[74:75], v16 offset:9216
    s_lshr_b32 s39, s57, 1
    s_add_u32 m0, s39, 155648
    s_add_u32 s38, s99, 3932160
    buffer_load_dwordx4 v8, s[72:75], s38 offen lds
    s_waitcnt lgkmcnt(6)
    v_mfma_f32_32x32x16_bf16 a[48:63], v[60:63], v[32:35], a[48:63]
    ds_read_b64_tr_b16 v[76:77], v17 offset:8192
    ds_read_b64_tr_b16 v[78:79], v17 offset:9216
    s_waitcnt lgkmcnt(6)
    v_mfma_f32_32x32x16_bf16 a[64:79], v[32:35], v[64:67], a[64:79]
    ds_read_b64_tr_b16 v[48:49], v14 offset:4096
    ds_read_b64_tr_b16 v[50:51], v14 offset:5120
    s_waitcnt lgkmcnt(6)
    v_mfma_f32_32x32x16_bf16 a[80:95], v[32:35], v[68:71], a[80:95]
    ds_read_b64_tr_b16 v[52:53], v15 offset:4096
    ds_read_b64_tr_b16 v[54:55], v15 offset:5120
    s_waitcnt lgkmcnt(6)
    v_mfma_f32_32x32x16_bf16 a[96:111], v[32:35], v[72:75], a[96:111]
    ds_read_b64_tr_b16 v[56:57], v16 offset:4096
    ds_read_b64_tr_b16 v[58:59], v16 offset:5120
    s_waitcnt lgkmcnt(6)
    v_mfma_f32_32x32x16_bf16 a[112:127], v[32:35], v[76:79], a[112:127]
    ds_read_b64_tr_b16 v[60:61], v17 offset:4096
    ds_read_b64_tr_b16 v[62:63], v17 offset:5120
    s_waitcnt lgkmcnt(6)
    v_mfma_f32_32x32x16_bf16 a[0:15], v[48:51], v[36:39], a[0:15]
    ds_read_b64_tr_b16 v[64:65], v14 offset:12288
    ds_read_b64_tr_b16 v[66:67], v14 offset:13312
    s_waitcnt lgkmcnt(6)
    v_mfma_f32_32x32x16_bf16 a[16:31], v[52:55], v[36:39], a[16:31]
    ds_read_b64_tr_b16 v[68:69], v15 offset:12288
    ds_read_b64_tr_b16 v[70:71], v15 offset:13312
    s_waitcnt lgkmcnt(6)
    v_mfma_f32_32x32x16_bf16 a[32:47], v[56:59], v[36:39], a[32:47]
    ds_read_b64_tr_b16 v[72:73], v16 offset:12288
    ds_read_b64_tr_b16 v[74:75], v16 offset:13312
    s_waitcnt lgkmcnt(6)
    v_mfma_f32_32x32x16_bf16 a[48:63], v[60:63], v[36:39], a[48:63]
    s_waitcnt vmcnt(10)
    s_barrier
    v_add_u32 v12, 0x8000, v12
    v_add_u32 v13, 0x8000, v13
    ds_read_b128 v[40:43], v12
    ds_read_b128 v[44:47], v13
    ds_read_b64_tr_b16 v[76:77], v17 offset:12288
    ds_read_b64_tr_b16 v[78:79], v17 offset:13312
    s_waitcnt lgkmcnt(8)
    v_mfma_f32_32x32x16_bf16 a[64:79], v[36:39], v[64:67], a[64:79]
    v_add_u32 v14, 0x8000, v14
    v_add_u32 v15, 0x8000, v15
    v_add_u32 v16, 0x8000, v16
    v_add_u32 v17, 0x8000, v17
    ds_read_b64_tr_b16 v[48:49], v14 offset:0
    ds_read_b64_tr_b16 v[50:51], v14 offset:1024
    s_add_u32 m0, s47, 0
    s_add_u32 s38, s65, 0
    buffer_load_dwordx4 v8, s[48:51], s38 offen offset:0 lds
    s_waitcnt lgkmcnt(8)
    v_mfma_f32_32x32x16_bf16 a[80:95], v[36:39], v[68:71], a[80:95]
    ds_read_b64_tr_b16 v[52:53], v15 offset:0
    ds_read_b64_tr_b16 v[54:55], v15 offset:1024
    s_waitcnt lgkmcnt(8)
    v_mfma_f32_32x32x16_bf16 a[96:111], v[36:39], v[72:75], a[96:111]
    ds_read_b64_tr_b16 v[56:57], v16 offset:0
    ds_read_b64_tr_b16 v[58:59], v16 offset:1024
    s_add_u32 m0, s47, 0
    s_add_u32 s38, s65, 0
    buffer_load_dwordx4 v9, s[48:51], s38 offen offset:1024 lds
    s_waitcnt lgkmcnt(6)
    v_mfma_f32_32x32x16_bf16 a[112:127], v[36:39], v[76:79], a[112:127]
    ds_read_b64_tr_b16 v[60:61], v17 offset:0
    ds_read_b64_tr_b16 v[62:63], v17 offset:1024
    s_waitcnt lgkmcnt(6)
    v_mfma_f32_32x32x16_bf16 a[0:15], v[48:51], v[40:43], a[0:15]
    ds_read_b64_tr_b16 v[64:65], v14 offset:8192
    ds_read_b64_tr_b16 v[66:67], v14 offset:9216
    s_add_u32 m0, s47, 16384
    s_add_u32 s38, s65, 524288
    buffer_load_dwordx4 v8, s[48:51], s38 offen offset:0 lds
    s_waitcnt lgkmcnt(6)
    v_mfma_f32_32x32x16_bf16 a[16:31], v[52:55], v[40:43], a[16:31]
    ds_read_b64_tr_b16 v[68:69], v15 offset:8192
    ds_read_b64_tr_b16 v[70:71], v15 offset:9216
    s_waitcnt lgkmcnt(6)
    v_mfma_f32_32x32x16_bf16 a[32:47], v[56:59], v[40:43], a[32:47]
    ds_read_b64_tr_b16 v[72:73], v16 offset:8192
    ds_read_b64_tr_b16 v[74:75], v16 offset:9216
    s_add_u32 m0, s47, 16384
    s_add_u32 s38, s65, 524288
    buffer_load_dwordx4 v9, s[48:51], s38 offen offset:1024 lds
    s_waitcnt lgkmcnt(6)
    v_mfma_f32_32x32x16_bf16 a[48:63], v[60:63], v[40:43], a[48:63]
    ds_read_b64_tr_b16 v[76:77], v17 offset:8192
    ds_read_b64_tr_b16 v[78:79], v17 offset:9216
    s_waitcnt lgkmcnt(6)
    v_mfma_f32_32x32x16_bf16 a[64:79], v[40:43], v[64:67], a[64:79]
    ds_read_b64_tr_b16 v[48:49], v14 offset:4096
    ds_read_b64_tr_b16 v[50:51], v14 offset:5120
    s_waitcnt lgkmcnt(6)
    v_mfma_f32_32x32x16_bf16 a[80:95], v[40:43], v[68:71], a[80:95]
    ds_read_b64_tr_b16 v[52:53], v15 offset:4096
    ds_read_b64_tr_b16 v[54:55], v15 offset:5120
    s_waitcnt lgkmcnt(6)
    v_mfma_f32_32x32x16_bf16 a[96:111], v[40:43], v[72:75], a[96:111]
    ds_read_b64_tr_b16 v[56:57], v16 offset:4096
    ds_read_b64_tr_b16 v[58:59], v16 offset:5120
    s_waitcnt lgkmcnt(6)
    v_mfma_f32_32x32x16_bf16 a[112:127], v[40:43], v[76:79], a[112:127]
    ds_read_b64_tr_b16 v[60:61], v17 offset:4096
    ds_read_b64_tr_b16 v[62:63], v17 offset:5120
    s_waitcnt lgkmcnt(6)
    v_mfma_f32_32x32x16_bf16 a[0:15], v[48:51], v[44:47], a[0:15]
    ds_read_b64_tr_b16 v[64:65], v14 offset:12288
    ds_read_b64_tr_b16 v[66:67], v14 offset:13312
    s_waitcnt lgkmcnt(6)
    v_mfma_f32_32x32x16_bf16 a[16:31], v[52:55], v[44:47], a[16:31]
    ds_read_b64_tr_b16 v[68:69], v15 offset:12288
    ds_read_b64_tr_b16 v[70:71], v15 offset:13312
    s_waitcnt lgkmcnt(6)
    v_mfma_f32_32x32x16_bf16 a[32:47], v[56:59], v[44:47], a[32:47]
    ds_read_b64_tr_b16 v[72:73], v16 offset:12288
    ds_read_b64_tr_b16 v[74:75], v16 offset:13312
    s_waitcnt lgkmcnt(6)
    v_mfma_f32_32x32x16_bf16 a[48:63], v[60:63], v[44:47], a[48:63]
    s_waitcnt vmcnt(10)
    s_barrier
    v_add_u32 v12, 0x8000, v12
    v_add_u32 v13, 0x8000, v13
    ds_read_b128 v[32:35], v12
    ds_read_b128 v[36:39], v13
    ds_read_b64_tr_b16 v[76:77], v17 offset:12288
    ds_read_b64_tr_b16 v[78:79], v17 offset:13312
    s_waitcnt lgkmcnt(8)
    v_mfma_f32_32x32x16_bf16 a[64:79], v[44:47], v[64:67], a[64:79]
    v_add_u32 v14, 0x8000, v14
    v_add_u32 v15, 0x8000, v15
    v_add_u32 v16, 0x8000, v16
    v_add_u32 v17, 0x8000, v17
    ds_read_b64_tr_b16 v[48:49], v14 offset:0
    ds_read_b64_tr_b16 v[50:51], v14 offset:1024
    s_add_u32 m0, s47, 32768
    s_add_u32 s38, s65, 1048576
    buffer_load_dwordx4 v8, s[48:51], s38 offen offset:0 lds
    s_waitcnt lgkmcnt(8)
    v_mfma_f32_32x32x16_bf16 a[80:95], v[44:47], v[68:71], a[80:95]
    ds_read_b64_tr_b16 v[52:53], v15 offset:0
    ds_read_b64_tr_b16 v[54:55], v15 offset:1024
    s_waitcnt lgkmcnt(8)
    v_mfma_f32_32x32x16_bf16 a[96:111], v[44:47], v[72:75], a[96:111]
    ds_read_b64_tr_b16 v[56:57], v16 offset:0
    ds_read_b64_tr_b16 v[58:59], v16 offset:1024
    s_add_u32 m0, s47, 32768
    s_add_u32 s38, s65, 1048576
    buffer_load_dwordx4 v9, s[48:51], s38 offen offset:1024 lds
    s_waitcnt lgkmcnt(6)
    v_mfma_f32_32x32x16_bf16 a[112:127], v[44:47], v[76:79], a[112:127]
    ds_read_b64_tr_b16 v[60:61], v17 offset:0
    ds_read_b64_tr_b16 v[62:63], v17 offset:1024
    s_waitcnt lgkmcnt(6)
    v_mfma_f32_32x32x16_bf16 a[0:15], v[48:51], v[32:35], a[0:15]
    ds_read_b64_tr_b16 v[64:65], v14 offset:8192
    ds_read_b64_tr_b16 v[66:67], v14 offset:9216
    s_waitcnt lgkmcnt(6)
    v_mfma_f32_32x32x16_bf16 a[16:31], v[52:55], v[32:35], a[16:31]
    ds_read_b64_tr_b16 v[68:69], v15 offset:8192
    ds_read_b64_tr_b16 v[70:71], v15 offset:9216
    s_waitcnt lgkmcnt(6)
    v_mfma_f32_32x32x16_bf16 a[32:47], v[56:59], v[32:35], a[32:47]
    ds_read_b64_tr_b16 v[72:73], v16 offset:8192
    ds_read_b64_tr_b16 v[74:75], v16 offset:9216
    s_waitcnt lgkmcnt(6)
    v_mfma_f32_32x32x16_bf16 a[48:63], v[60:63], v[32:35], a[48:63]
    ds_read_b64_tr_b16 v[76:77], v17 offset:8192
    ds_read_b64_tr_b16 v[78:79], v17 offset:9216
    s_waitcnt lgkmcnt(6)
    v_mfma_f32_32x32x16_bf16 a[64:79], v[32:35], v[64:67], a[64:79]
    ds_read_b64_tr_b16 v[48:49], v14 offset:4096
    ds_read_b64_tr_b16 v[50:51], v14 offset:5120
    s_waitcnt lgkmcnt(6)
    v_mfma_f32_32x32x16_bf16 a[80:95], v[32:35], v[68:71], a[80:95]
    ds_read_b64_tr_b16 v[52:53], v15 offset:4096
    ds_read_b64_tr_b16 v[54:55], v15 offset:5120
    s_waitcnt lgkmcnt(6)
    v_mfma_f32_32x32x16_bf16 a[96:111], v[32:35], v[72:75], a[96:111]
    ds_read_b64_tr_b16 v[56:57], v16 offset:4096
    ds_read_b64_tr_b16 v[58:59], v16 offset:5120
    s_waitcnt lgkmcnt(6)
    v_mfma_f32_32x32x16_bf16 a[112:127], v[32:35], v[76:79], a[112:127]
    ds_read_b64_tr_b16 v[60:61], v17 offset:4096
    ds_read_b64_tr_b16 v[62:63], v17 offset:5120
    s_waitcnt lgkmcnt(6)
    v_mfma_f32_32x32x16_bf16 a[0:15], v[48:51], v[36:39], a[0:15]
    ds_read_b64_tr_b16 v[64:65], v14 offset:12288
    ds_read_b64_tr_b16 v[66:67], v14 offset:13312
    s_waitcnt lgkmcnt(6)
    v_mfma_f32_32x32x16_bf16 a[16:31], v[52:55], v[36:39], a[16:31]
    ds_read_b64_tr_b16 v[68:69], v15 offset:12288
    ds_read_b64_tr_b16 v[70:71], v15 offset:13312
    s_waitcnt lgkmcnt(6)
    v_mfma_f32_32x32x16_bf16 a[32:47], v[56:59], v[36:39], a[32:47]
    ds_read_b64_tr_b16 v[72:73], v16 offset:12288
    ds_read_b64_tr_b16 v[74:75], v16 offset:13312
    s_waitcnt lgkmcnt(6)
    v_mfma_f32_32x32x16_bf16 a[48:63], v[60:63], v[36:39], a[48:63]
    s_waitcnt vmcnt(6)
    s_barrier
    v_add_u32 v12, 0x8000, v12
    v_add_u32 v13, 0x8000, v13
    ds_read_b128 v[40:43], v12
    ds_read_b128 v[44:47], v13
    ds_read_b64_tr_b16 v[76:77], v17 offset:12288
    ds_read_b64_tr_b16 v[78:79], v17 offset:13312
    s_waitcnt lgkmcnt(8)
    v_mfma_f32_32x32x16_bf16 a[64:79], v[36:39], v[64:67], a[64:79]
    v_add_u32 v14, 0x8000, v14
    v_add_u32 v15, 0x8000, v15
    v_add_u32 v16, 0x8000, v16
    v_add_u32 v17, 0x8000, v17
    ds_read_b64_tr_b16 v[48:49], v14 offset:0
    ds_read_b64_tr_b16 v[50:51], v14 offset:1024
    s_waitcnt lgkmcnt(8)
    v_mfma_f32_32x32x16_bf16 a[80:95], v[36:39], v[68:71], a[80:95]
    ds_read_b64_tr_b16 v[52:53], v15 offset:0
    ds_read_b64_tr_b16 v[54:55], v15 offset:1024
    s_waitcnt lgkmcnt(8)
    v_mfma_f32_32x32x16_bf16 a[96:111], v[36:39], v[72:75], a[96:111]
    ds_read_b64_tr_b16 v[56:57], v16 offset:0
    ds_read_b64_tr_b16 v[58:59], v16 offset:1024
    s_waitcnt lgkmcnt(6)
    v_mfma_f32_32x32x16_bf16 a[112:127], v[36:39], v[76:79], a[112:127]
    ds_read_b64_tr_b16 v[60:61], v17 offset:0
    ds_read_b64_tr_b16 v[62:63], v17 offset:1024
    s_waitcnt lgkmcnt(6)
    v_mfma_f32_32x32x16_bf16 a[0:15], v[48:51], v[40:43], a[0:15]
    ds_read_b64_tr_b16 v[64:65], v14 offset:8192
    ds_read_b64_tr_b16 v[66:67], v14 offset:9216
    s_waitcnt lgkmcnt(6)
    v_mfma_f32_32x32x16_bf16 a[16:31], v[52:55], v[40:43], a[16:31]
    ds_read_b64_tr_b16 v[68:69], v15 offset:8192
    ds_read_b64_tr_b16 v[70:71], v15 offset:9216
    s_waitcnt lgkmcnt(6)
    v_mfma_f32_32x32x16_bf16 a[32:47], v[56:59], v[40:43], a[32:47]
    ds_read_b64_tr_b16 v[72:73], v16 offset:8192
    ds_read_b64_tr_b16 v[74:75], v16 offset:9216
    s_waitcnt lgkmcnt(6)
    v_mfma_f32_32x32x16_bf16 a[48:63], v[60:63], v[40:43], a[48:63]
    ds_read_b64_tr_b16 v[76:77], v17 offset:8192
    ds_read_b64_tr_b16 v[78:79], v17 offset:9216
    s_waitcnt lgkmcnt(6)
    v_mfma_f32_32x32x16_bf16 a[64:79], v[40:43], v[64:67], a[64:79]
    ds_read_b64_tr_b16 v[48:49], v14 offset:4096
    ds_read_b64_tr_b16 v[50:51], v14 offset:5120
    s_waitcnt lgkmcnt(6)
    v_mfma_f32_32x32x16_bf16 a[80:95], v[40:43], v[68:71], a[80:95]
    ds_read_b64_tr_b16 v[52:53], v15 offset:4096
    ds_read_b64_tr_b16 v[54:55], v15 offset:5120
    s_waitcnt lgkmcnt(6)
    v_mfma_f32_32x32x16_bf16 a[96:111], v[40:43], v[72:75], a[96:111]
    ds_read_b64_tr_b16 v[56:57], v16 offset:4096
    ds_read_b64_tr_b16 v[58:59], v16 offset:5120
    s_waitcnt lgkmcnt(6)
    v_mfma_f32_32x32x16_bf16 a[112:127], v[40:43], v[76:79], a[112:127]
    ds_read_b64_tr_b16 v[60:61], v17 offset:4096
    ds_read_b64_tr_b16 v[62:63], v17 offset:5120
    s_waitcnt lgkmcnt(6)
    v_mfma_f32_32x32x16_bf16 a[0:15], v[48:51], v[44:47], a[0:15]
    ds_read_b64_tr_b16 v[64:65], v14 offset:12288
    ds_read_b64_tr_b16 v[66:67], v14 offset:13312
    s_waitcnt lgkmcnt(6)
    v_mfma_f32_32x32x16_bf16 a[16:31], v[52:55], v[44:47], a[16:31]
    ds_read_b64_tr_b16 v[68:69], v15 offset:12288
    ds_read_b64_tr_b16 v[70:71], v15 offset:13312
    s_waitcnt lgkmcnt(6)
    v_mfma_f32_32x32x16_bf16 a[32:47], v[56:59], v[44:47], a[32:47]
    ds_read_b64_tr_b16 v[72:73], v16 offset:12288
    ds_read_b64_tr_b16 v[74:75], v16 offset:13312
    s_waitcnt lgkmcnt(6)
    v_mfma_f32_32x32x16_bf16 a[48:63], v[60:63], v[44:47], a[48:63]
    ds_read_b64_tr_b16 v[76:77], v17 offset:12288
    ds_read_b64_tr_b16 v[78:79], v17 offset:13312
    s_waitcnt lgkmcnt(6)
    v_mfma_f32_32x32x16_bf16 a[64:79], v[44:47], v[64:67], a[64:79]
    s_waitcnt lgkmcnt(4)
    v_mfma_f32_32x32x16_bf16 a[80:95], v[44:47], v[68:71], a[80:95]
    s_waitcnt lgkmcnt(2)
    v_mfma_f32_32x32x16_bf16 a[96:111], v[44:47], v[72:75], a[96:111]
    s_waitcnt lgkmcnt(0)
    v_mfma_f32_32x32x16_bf16 a[112:127], v[44:47], v[76:79], a[112:127]
    v_accvgpr_read_b32 v80, a0
    v_accvgpr_read_b32 v81, a1
    v_accvgpr_read_b32 v82, a2
    v_accvgpr_read_b32 v83, a3
    v_accvgpr_read_b32 v84, a4
    v_accvgpr_read_b32 v85, a5
    v_accvgpr_read_b32 v86, a6
    v_accvgpr_read_b32 v87, a7
    v_cvt_pk_bf16_f32 v112, v80, v81
    v_cvt_pk_bf16_f32 v113, v82, v83
    v_cvt_pk_bf16_f32 v114, v84, v85
    v_cvt_pk_bf16_f32 v115, v86, v87
    s_cmp_eq_u32 s96, 0
    s_cbranch_scc1 DU3s
    s_add_u32 s38, s56, 0
    buffer_store_dwordx4 v[112:115], v2, s[28:31], s38 offen offset:0
    s_branch DU3j
DU3s:
    s_add_u32 s38, s56, 0
    buffer_store_dwordx4 v[112:115], v2, s[28:31], s38 offen offset:0 sc1
DU3j:
    v_accvgpr_read_b32 v88, a8
    v_accvgpr_read_b32 v89, a9
    v_accvgpr_read_b32 v90, a10
    v_accvgpr_read_b32 v91, a11
    v_accvgpr_read_b32 v92, a12
    v_accvgpr_read_b32 v93, a13
    v_accvgpr_read_b32 v94, a14
    v_accvgpr_read_b32 v95, a15
    v_cvt_pk_bf16_f32 v116, v88, v89
    v_cvt_pk_bf16_f32 v117, v90, v91
    v_cvt_pk_bf16_f32 v118, v92, v93
    v_cvt_pk_bf16_f32 v119, v94, v95
    s_cmp_eq_u32 s96, 0
    s_cbranch_scc1 DU4s
    s_add_u32 s38, s56, 0
    buffer_store_dwordx4 v[116:119], v2, s[28:31], s38 offen offset:1024
    s_branch DU4j
DU4s:
    s_add_u32 s38, s56, 0
    buffer_store_dwordx4 v[116:119], v2, s[28:31], s38 offen offset:1024 sc1
DU4j:
    s_lshl_b32 s38, s64, 15
    s_add_u32 s38, s38, 33554432
    buffer_load_dwordx4 a[0:3], v2, s[28:31], s38 offen offset:0 sc1
    s_lshl_b32 s38, s64, 15
    s_add_u32 s38, s38, 33554432
    buffer_load_dwordx4 a[4:7], v2, s[28:31], s38 offen offset:1024 sc1
    s_lshl_b32 s38, s64, 15
    s_add_u32 s38, s38, 33554432
    buffer_load_dwordx4 a[8:11], v2, s[28:31], s38 offen offset:2048 sc1
    s_lshl_b32 s38, s64, 15
    s_add_u32 s38, s38, 33554432
    buffer_load_dwordx4 a[12:15], v2, s[28:31], s38 offen offset:3072 sc1
    v_accvgpr_read_b32 v96, a16
    v_accvgpr_read_b32 v97, a17
    v_accvgpr_read_b32 v98, a18
    v_accvgpr_read_b32 v99, a19
    v_accvgpr_read_b32 v100, a20
    v_accvgpr_read_b32 v101, a21
    v_accvgpr_read_b32 v102, a22
    v_accvgpr_read_b32 v103, a23
    v_cvt_pk_bf16_f32 v120, v96, v97
    v_cvt_pk_bf16_f32 v121, v98, v99
    v_cvt_pk_bf16_f32 v122, v100, v101
    v_cvt_pk_bf16_f32 v123, v102, v103
    s_cmp_eq_u32 s96, 0
    s_cbranch_scc1 DU5s
    s_add_u32 s38, s56, 0
    buffer_store_dwordx4 v[120:123], v2, s[28:31], s38 offen offset:2048
    s_branch DU5j
DU5s:
    s_add_u32 s38, s56, 0
    buffer_store_dwordx4 v[120:123], v2, s[28:31], s38 offen offset:2048 sc1
DU5j:
    v_accvgpr_read_b32 v104, a24
    v_accvgpr_read_b32 v105, a25
    v_accvgpr_read_b32 v106, a26
    v_accvgpr_read_b32 v107, a27
    v_accvgpr_read_b32 v108, a28
    v_accvgpr_read_b32 v109, a29
    v_accvgpr_read_b32 v110, a30
    v_accvgpr_read_b32 v111, a31
    v_cvt_pk_bf16_f32 v124, v104, v105
    v_cvt_pk_bf16_f32 v125, v106, v107
    v_cvt_pk_bf16_f32 v126, v108, v109
    v_cvt_pk_bf16_f32 v127, v110, v111
    s_cmp_eq_u32 s96, 0
    s_cbranch_scc1 DU6s
    s_add_u32 s38, s56, 0
    buffer_store_dwordx4 v[124:127], v2, s[28:31], s38 offen offset:3072
    s_branch DU6j
DU6s:
    s_add_u32 s38, s56, 0
    buffer_store_dwordx4 v[124:127], v2, s[28:31], s38 offen offset:3072 sc1
DU6j:
    s_lshl_b32 s38, s64, 15
    s_add_u32 s38, s38, 33558528
    buffer_load_dwordx4 a[16:19], v2, s[28:31], s38 offen offset:0 sc1
    s_lshl_b32 s38, s64, 15
    s_add_u32 s38, s38, 33558528
    buffer_load_dwordx4 a[20:23], v2, s[28:31], s38 offen offset:1024 sc1
    s_lshl_b32 s38, s64, 15
    s_add_u32 s38, s38, 33558528
    buffer_load_dwordx4 a[24:27], v2, s[28:31], s38 offen offset:2048 sc1
    s_lshl_b32 s38, s64, 15
    s_add_u32 s38, s38, 33558528
    buffer_load_dwordx4 a[28:31], v2, s[28:31], s38 offen offset:3072 sc1
    v_accvgpr_read_b32 v80, a32
    v_accvgpr_read_b32 v81, a33
    v_accvgpr_read_b32 v82, a34
    v_accvgpr_read_b32 v83, a35
    v_accvgpr_read_b32 v84, a36
    v_accvgpr_read_b32 v85, a37
    v_accvgpr_read_b32 v86, a38
    v_accvgpr_read_b32 v87, a39
    v_cvt_pk_bf16_f32 v112, v80, v81
    v_cvt_pk_bf16_f32 v113, v82, v83
    v_cvt_pk_bf16_f32 v114, v84, v85
    v_cvt_pk_bf16_f32 v115, v86, v87
    s_cmp_eq_u32 s96, 0
    s_cbranch_scc1 DU7s
    s_add_u32 s38, s56, 4096
    buffer_store_dwordx4 v[112:115], v2, s[28:31], s38 offen offset:0
    s_branch DU7j
DU7s:
    s_add_u32 s38, s56, 4096
    buffer_store_dwordx4 v[112:115], v2, s[28:31], s38 offen offset:0 sc1
DU7j:
    v_accvgpr_read_b32 v88, a40
    v_accvgpr_read_b32 v89, a41
    v_accvgpr_read_b32 v90, a42
    v_accvgpr_read_b32 v91, a43
    v_accvgpr_read_b32 v92, a44
    v_accvgpr_read_b32 v93, a45
    v_accvgpr_read_b32 v94, a46
    v_accvgpr_read_b32 v95, a47
    v_cvt_pk_bf16_f32 v116, v88, v89
    v_cvt_pk_bf16_f32 v117, v90, v91
    v_cvt_pk_bf16_f32 v118, v92, v93
    v_cvt_pk_bf16_f32 v119, v94, v95
    s_cmp_eq_u32 s96, 0
    s_cbranch_scc1 DU8s
    s_add_u32 s38, s56, 4096
    buffer_store_dwordx4 v[116:119], v2, s[28:31], s38 offen offset:1024
    s_branch DU8j
DU8s:
    s_add_u32 s38, s56, 4096
    buffer_store_dwordx4 v[116:119], v2, s[28:31], s38 offen offset:1024 sc1
DU8j:
    s_lshl_b32 s38, s64, 15
    s_add_u32 s38, s38, 33562624
    buffer_load_dwordx4 a[32:35], v2, s[28:31], s38 offen offset:0 sc1
    s_lshl_b32 s38, s64, 15
    s_add_u32 s38, s38, 33562624
    buffer_load_dwordx4 a[36:39], v2, s[28:31], s38 offen offset:1024 sc1
    s_lshl_b32 s38, s64, 15
    s_add_u32 s38, s38, 33562624
    buffer_load_dwordx4 a[40:43], v2, s[28:31], s38 offen offset:2048 sc1
    s_lshl_b32 s38, s64, 15
    s_add_u32 s38, s38, 33562624
    buffer_load_dwordx4 a[44:47], v2, s[28:31], s38 offen offset:3072 sc1
    s_waitcnt vmcnt(22)
    s_barrier
    ds_read_b64_tr_b16 v[32:33], v4 offset:0
    ds_read_b64_tr_b16 v[34:35], v4 offset:1024
    ds_read_b64_tr_b16 v[36:37], v5 offset:0
    ds_read_b64_tr_b16 v[38:39], v5 offset:1024
    ds_read_b64_tr_b16 v[40:41], v6 offset:0
    ds_read_b64_tr_b16 v[42:43], v6 offset:1024
    ds_read_b64_tr_b16 v[44:45], v7 offset:0
    ds_read_b64_tr_b16 v[46:47], v7 offset:1024
    s_waitcnt vmcnt(15) lgkmcnt(6)
    v_mfma_f32_32x32x16_bf16 v[64:79], v[32:35], a[0:3], 0
    ds_read_b64_tr_b16 v[48:49], v4 offset:4096
    ds_read_b64_tr_b16 v[50:51], v4 offset:5120
    v_accvgpr_read_b32 v10, a48
    v_accvgpr_read_b32 v11, a49
    s_waitcnt lgkmcnt(6)
    v_mfma_f32_32x32x16_bf16 v[80:95], v[36:39], a[0:3], 0
    ds_read_b64_tr_b16 v[52:53], v5 offset:4096
    ds_read_b64_tr_b16 v[54:55], v5 offset:5120
    v_accvgpr_read_b32 v12, a50
    v_accvgpr_read_b32 v13, a51
    s_waitcnt lgkmcnt(6)
    v_mfma_f32_32x32x16_bf16 v[96:111], v[40:43], a[0:3], 0
    ds_read_b64_tr_b16 v[56:57], v6 offset:4096
    ds_read_b64_tr_b16 v[58:59], v6 offset:5120
    v_accvgpr_read_b32 v14, a52
    v_accvgpr_read_b32 v15, a53
    s_waitcnt lgkmcnt(6)
    v_mfma_f32_32x32x16_bf16 v[112:127], v[44:47], a[0:3], 0
    ds_read_b64_tr_b16 v[60:61], v7 offset:4096
    ds_read_b64_tr_b16 v[62:63], v7 offset:5120
    v_accvgpr_read_b32 v16, a54
    v_accvgpr_read_b32 v17, a55
    s_waitcnt vmcnt(14) lgkmcnt(6)
    v_mfma_f32_32x32x16_bf16 v[64:79], v[48:51], a[4:7], v[64:79]
    ds_read_b64_tr_b16 v[32:33], v4 offset:8192
    ds_read_b64_tr_b16 v[34:35], v4 offset:9216
    v_cvt_pk_bf16_f32 v28, v10, v11
    v_cvt_pk_bf16_f32 v29, v12, v13
    s_waitcnt lgkmcnt(6)
    v_mfma_f32_32x32x16_bf16 v[80:95], v[52:55], a[4:7], v[80:95]
    ds_read_b64_tr_b16 v[36:37], v5 offset:8192
    ds_read_b64_tr_b16 v[38:39], v5 offset:9216
    v_cvt_pk_bf16_f32 v30, v14, v15
    v_cvt_pk_bf16_f32 v31, v16, v17
    s_waitcnt lgkmcnt(6)
    v_mfma_f32_32x32x16_bf16 v[96:111], v[56:59], a[4:7], v[96:111]
    ds_read_b64_tr_b16 v[40:41], v6 offset:8192
    ds_read_b64_tr_b16 v[42:43], v6 offset:9216
    s_cmp_eq_u32 s96, 0
    s_cbranch_scc1 DU9s
    s_add_u32 s38, s56, 4096
    buffer_store_dwordx4 v[28:31], v2, s[28:31], s38 offen offset:2048
    s_branch DU9j
DU9s:
    s_add_u32 s38, s56, 4096
    buffer_store_dwordx4 v[28:31], v2, s[28:31], s38 offen offset:2048 sc1
DU9j:
    v_accvgpr_read_b32 v10, a56
    s_waitcnt lgkmcnt(6)
    v_mfma_f32_32x32x16_bf16 v[112:127], v[60:63], a[4:7], v[112:127]
    ds_read_b64_tr_b16 v[44:45], v7 offset:8192
    ds_read_b64_tr_b16 v[46:47], v7 offset:9216
    v_accvgpr_read_b32 v11, a57
    v_accvgpr_read_b32 v12, a58
    s_waitcnt vmcnt(14) lgkmcnt(6)
    v_mfma_f32_32x32x16_bf16 v[64:79], v[32:35], a[8:11], v[64:79]
    ds_read_b64_tr_b16 v[48:49], v4 offset:12288
    ds_read_b64_tr_b16 v[50:51], v4 offset:13312
    v_accvgpr_read_b32 v13, a59
    v_accvgpr_read_b32 v14, a60
    s_waitcnt lgkmcnt(6)
    v_mfma_f32_32x32x16_bf16 v[80:95], v[36:39], a[8:11], v[80:95]
    ds_read_b64_tr_b16 v[52:53], v5 offset:12288
    ds_read_b64_tr_b16 v[54:55], v5 offset:13312
    v_accvgpr_read_b32 v15, a61
    v_accvgpr_read_b32 v16, a62
    s_waitcnt lgkmcnt(6)
    v_mfma_f32_32x32x16_bf16 v[96:111], v[40:43], a[8:11], v[96:111]
    ds_read_b64_tr_b16 v[56:57], v6 offset:12288
    ds_read_b64_tr_b16 v[58:59], v6 offset:13312
    v_accvgpr_read_b32 v17, a63
    v_cvt_pk_bf16_f32 v28, v10, v11
    s_waitcnt lgkmcnt(6)
    v_mfma_f32_32x32x16_bf16 v[112:127], v[44:47], a[8:11], v[112:127]
    s_barrier
    ds_read_b64_tr_b16 v[60:61], v7 offset:12288
    ds_read_b64_tr_b16 v[62:63], v7 offset:13312
    v_cvt_pk_bf16_f32 v29, v12, v13
    v_cvt_pk_bf16_f32 v30, v14, v15
    s_waitcnt vmcnt(13) lgkmcnt(6)
    v_mfma_f32_32x32x16_bf16 v[64:79], v[48:51], a[12:15], v[64:79]
    ds_read_b64_tr_b16 v[32:33], v4 offset:16384
    ds_read_b64_tr_b16 v[34:35], v4 offset:17408
    v_cvt_pk_bf16_f32 v31, v16, v17
    s_cmp_eq_u32 s96, 0
    s_cbranch_scc1 DU10s
    s_add_u32 s38, s56, 4096
    buffer_store_dwordx4 v[28:31], v2, s[28:31], s38 offen offset:3072
    s_branch DU10j
DU10s:
    s_add_u32 s38, s56, 4096
    buffer_store_dwordx4 v[28:31], v2, s[28:31], s38 offen offset:3072 sc1
DU10j:
    s_add_u32 m0, s47, 49152
    s_add_u32 s38, s65, 1572864
    buffer_load_dwordx4 v8, s[48:51], s38 offen offset:0 lds
    s_waitcnt lgkmcnt(6)
    v_mfma_f32_32x32x16_bf16 v[80:95], v[52:55], a[12:15], v[80:95]
    ds_read_b64_tr_b16 v[36:37], v5 offset:16384
    ds_read_b64_tr_b16 v[38:39], v5 offset:17408
    v_accvgpr_read_b32 v10, a64
    s_waitcnt lgkmcnt(6)
    v_mfma_f32_32x32x16_bf16 v[96:111], v[56:59], a[12:15], v[96:111]
    ds_read_b64_tr_b16 v[40:41], v6 offset:16384
    ds_read_b64_tr_b16 v[42:43], v6 offset:17408
    v_accvgpr_read_b32 v11, a65
    v_accvgpr_read_b32 v12, a66
    s_add_u32 m0, s47, 49152
    s_add_u32 s38, s65, 1572864
    buffer_load_dwordx4 v9, s[48:51], s38 offen offset:1024 lds
    s_waitcnt lgkmcnt(6)
    v_mfma_f32_32x32x16_bf16 v[112:127], v[60:63], a[12:15], v[112:127]
    ds_read_b64_tr_b16 v[44:45], v7 offset:16384
    ds_read_b64_tr_b16 v[46:47], v7 offset:17408
    v_accvgpr_read_b32 v13, a67
    v_accvgpr_read_b32 v14, a68
    s_waitcnt vmcnt(13) lgkmcnt(6)
    v_mfma_f32_32x32x16_bf16 v[64:79], v[32:35], a[16:19], v[64:79]
    ds_read_b64_tr_b16 v[48:49], v4 offset:20480
    ds_read_b64_tr_b16 v[50:51], v4 offset:21504
    v_accvgpr_read_b32 v15, a69
    v_accvgpr_read_b32 v16, a70
    s_lshl_b32 s38, s64, 15
    s_add_u32 s38, s38, 33566720
    buffer_load_dwordx4 a[48:51], v2, s[28:31], s38 offen offset:0 sc1
    s_waitcnt lgkmcnt(6)
    v_mfma_f32_32x32x16_bf16 v[80:95], v[36:39], a[16:19], v[80:95]
    ds_read_b64_tr_b16 v[52:53], v5 offset:20480
    ds_read_b64_tr_b16 v[54:55], v5 offset:21504
    v_accvgpr_read_b32 v17, a71
    v_cvt_pk_bf16_f32 v28, v10, v11
    s_waitcnt lgkmcnt(6)
    v_mfma_f32_32x32x16_bf16 v[96:111], v[40:43], a[16:19], v[96:111]
    ds_read_b64_tr_b16 v[56:57], v6 offset:20480
    ds_read_b64_tr_b16 v[58:59], v6 offset:21504
    v_cvt_pk_bf16_f32 v29, v12, v13
    v_cvt_pk_bf16_f32 v30, v14, v15
    s_lshl_b32 s38, s64, 15
    s_add_u32 s38, s38, 33566720
    buffer_load_dwordx4 a[52:55], v2, s[28:31], s38 offen offset:1024 sc1
    s_waitcnt lgkmcnt(6)
    v_mfma_f32_32x32x16_bf16 v[112:127], v[44:47], a[16:19], v[112:127]
    ds_read_b64_tr_b16 v[60:61], v7 offset:20480
    ds_read_b64_tr_b16 v[62:63], v7 offset:21504
    v_cvt_pk_bf16_f32 v31, v16, v17
    s_cmp_eq_u32 s96, 0
    s_cbranch_scc1 DU11s
    s_add_u32 s38, s56, 16777216
    buffer_store_dwordx4 v[28:31], v2, s[28:31], s38 offen offset:0
    s_branch DU11j
DU11s:
    s_add_u32 s38, s56, 16777216
    buffer_store_dwordx4 v[28:31], v2, s[28:31], s38 offen offset:0 sc1
DU11j:
    s_waitcnt vmcnt(15) lgkmcnt(6)
    v_mfma_f32_32x32x16_bf16 v[64:79], v[48:51], a[20:23], v[64:79]
    ds_read_b64_tr_b16 v[32:33], v4 offset:24576
    ds_read_b64_tr_b16 v[34:35], v4 offset:25600
    v_accvgpr_read_b32 v10, a72
    v_accvgpr_read_b32 v11, a73
    s_lshl_b32 s38, s64, 15
    s_add_u32 s38, s38, 33566720
    buffer_load_dwordx4 a[56:59], v2, s[28:31], s38 offen offset:2048 sc1
    s_waitcnt lgkmcnt(6)
    v_mfma_f32_32x32x16_bf16 v[80:95], v[52:55], a[20:23], v[80:95]
    ds_read_b64_tr_b16 v[36:37], v5 offset:24576
    ds_read_b64_tr_b16 v[38:39], v5 offset:25600
    v_accvgpr_read_b32 v12, a74
    v_accvgpr_read_b32 v13, a75
    s_waitcnt lgkmcnt(6)
    v_mfma_f32_32x32x16_bf16 v[96:111], v[56:59], a[20:23], v[96:111]
    ds_read_b64_tr_b16 v[40:41], v6 offset:24576
    ds_read_b64_tr_b16 v[42:43], v6 offset:25600
    v_accvgpr_read_b32 v14, a76
    v_accvgpr_read_b32 v15, a77
    s_lshl_b32 s38, s64, 15
    s_add_u32 s38, s38, 33566720
    buffer_load_dwordx4 a[60:63], v2, s[28:31], s38 offen offset:3072 sc1
    s_waitcnt lgkmcnt(6)
    v_mfma_f32_32x32x16_bf16 v[112:127], v[60:63], a[20:23], v[112:127]
    ds_read_b64_tr_b16 v[44:45], v7 offset:24576
    ds_read_b64_tr_b16 v[46:47], v7 offset:25600
    v_accvgpr_read_b32 v16, a78
    v_accvgpr_read_b32 v17, a79
    s_waitcnt vmcnt(16) lgkmcnt(6)
    v_mfma_f32_32x32x16_bf16 v[64:79], v[32:35], a[24:27], v[64:79]
    ds_read_b64_tr_b16 v[48:49], v4 offset:28672
    ds_read_b64_tr_b16 v[50:51], v4 offset:29696
    v_cvt_pk_bf16_f32 v28, v10, v11
    v_cvt_pk_bf16_f32 v29, v12, v13
    s_waitcnt lgkmcnt(6)
    v_mfma_f32_32x32x16_bf16 v[80:95], v[36:39], a[24:27], v[80:95]
    ds_read_b64_tr_b16 v[52:53], v5 offset:28672
    ds_read_b64_tr_b16 v[54:55], v5 offset:29696
    v_cvt_pk_bf16_f32 v30, v14, v15
    v_cvt_pk_bf16_f32 v31, v16, v17
    s_waitcnt lgkmcnt(6)
    v_mfma_f32_32x32x16_bf16 v[96:111], v[40:43], a[24:27], v[96:111]
    ds_read_b64_tr_b16 v[56:57], v6 offset:28672
    ds_read_b64_tr_b16 v[58:59], v6 offset:29696
    s_cmp_eq_u32 s96, 0
    s_cbranch_scc1 DU12s
    s_add_u32 s38, s56, 16781312
    buffer_store_dwordx4 v[28:31], v2, s[28:31], s38 offen offset:0
    s_branch DU12j
DU12s:
    s_add_u32 s38, s56, 16781312
    buffer_store_dwordx4 v[28:31], v2, s[28:31], s38 offen offset:0 sc1
DU12j:
    s_lshl_b32 s38, s64, 15
    s_add_u32 s38, s38, 33570816
    buffer_load_dwordx4 a[64:67], v2, s[28:31], s38 offen offset:0 sc1
    s_waitcnt lgkmcnt(6)
    v_mfma_f32_32x32x16_bf16 v[112:127], v[44:47], a[24:27], v[112:127]
    s_barrier
    ds_read_b64_tr_b16 v[60:61], v7 offset:28672
    ds_read_b64_tr_b16 v[62:63], v7 offset:29696
    v_accvgpr_read_b32 v10, a80
    v_accvgpr_read_b32 v11, a81
    s_waitcnt vmcnt(17) lgkmcnt(6)
    v_mfma_f32_32x32x16_bf16 v[64:79], v[48:51], a[28:31], v[64:79]
    ds_read_b64_tr_b16 v[32:33], v4 offset:32768
    ds_read_b64_tr_b16 v[34:35], v4 offset:33792
    v_accvgpr_read_b32 v12, a82
    v_accvgpr_read_b32 v13, a83
    s_add_u32 m0, s47, 0
    s_add_u32 s38, s65, 2097152
    buffer_load_dwordx4 v8, s[48:51], s38 offen offset:0 lds
    s_waitcnt lgkmcnt(6)
    v_mfma_f32_32x32x16_bf16 v[80:95], v[52:55], a[28:31], v[80:95]
    ds_read_b64_tr_b16 v[36:37], v5 offset:32768
    ds_read_b64_tr_b16 v[38:39], v5 offset:33792
    v_accvgpr_read_b32 v14, a84
    v_accvgpr_read_b32 v15, a85
    s_waitcnt lgkmcnt(6)
    v_mfma_f32_32x32x16_bf16 v[96:111], v[56:59], a[28:31], v[96:111]
    ds_read_b64_tr_b16 v[40:41], v6 offset:32768
    ds_read_b64_tr_b16 v[42:43], v6 offset:33792
    v_accvgpr_read_b32 v16, a86
    v_accvgpr_read_b32 v17, a87
    s_add_u32 m0, s47, 0
    s_add_u32 s38, s65, 2097152
    buffer_load_dwordx4 v9, s[48:51], s38 offen offset:1024 lds
    s_waitcnt lgkmcnt(6)
    v_mfma_f32_32x32x16_bf16 v[112:127], v[60:63], a[28:31], v[112:127]
    ds_read_b64_tr_b16 v[44:45], v7 offset:32768
    ds_read_b64_tr_b16 v[46:47], v7 offset:33792
    v_cvt_pk_bf16_f32 v28, v10, v11
    v_cvt_pk_bf16_f32 v29, v12, v13
    s_waitcnt vmcnt(16) lgkmcnt(6)
    v_mfma_f32_32x32x16_bf16 v[64:79], v[32:35], a[32:35], v[64:79]
    ds_read_b64_tr_b16 v[48:49], v4 offset:36864
    ds_read_b64_tr_b16 v[50:51], v4 offset:37888
    v_cvt_pk_bf16_f32 v30, v14, v15
    v_cvt_pk_bf16_f32 v31, v16, v17
    s_lshl_b32 s38, s64, 15
    s_add_u32 s38, s38, 33570816
    buffer_load_dwordx4 a[68:71], v2, s[28:31], s38 offen offset:1024 sc1
    s_waitcnt lgkmcnt(6)
    v_mfma_f32_32x32x16_bf16 v[80:95], v[36:39], a[32:35], v[80:95]
    ds_read_b64_tr_b16 v[52:53], v5 offset:36864
    ds_read_b64_tr_b16 v[54:55], v5 offset:37888
    s_cmp_eq_u32 s96, 0
    s_cbranch_scc1 DU13s
    s_add_u32 s38, s56, 16777216
    buffer_store_dwordx4 v[28:31], v2, s[28:31], s38 offen offset:1024
    s_branch DU13j
DU13s:
    s_add_u32 s38, s56, 16777216
    buffer_store_dwordx4 v[28:31], v2, s[28:31], s38 offen offset:1024 sc1
DU13j:
    v_accvgpr_read_b32 v10, a88
    s_waitcnt lgkmcnt(6)
    v_mfma_f32_32x32x16_bf16 v[96:111], v[40:43], a[32:35], v[96:111]
    ds_read_b64_tr_b16 v[56:57], v6 offset:36864
    ds_read_b64_tr_b16 v[58:59], v6 offset:37888
    v_accvgpr_read_b32 v11, a89
    v_accvgpr_read_b32 v12, a90
    s_lshl_b32 s38, s64, 15
    s_add_u32 s38, s38, 33570816
    buffer_load_dwordx4 a[72:75], v2, s[28:31], s38 offen offset:2048 sc1
    s_waitcnt lgkmcnt(6)
    v_mfma_f32_32x32x16_bf16 v[112:127], v[44:47], a[32:35], v[112:127]
    ds_read_b64_tr_b16 v[60:61], v7 offset:36864
    ds_read_b64_tr_b16 v[62:63], v7 offset:37888
    v_accvgpr_read_b32 v13, a91
    v_accvgpr_read_b32 v14, a92
    s_waitcnt vmcnt(18) lgkmcnt(6)
    v_mfma_f32_32x32x16_bf16 v[64:79], v[48:51], a[36:39], v[64:79]
    ds_read_b64_tr_b16 v[32:33], v4 offset:40960
    ds_read_b64_tr_b16 v[34:35], v4 offset:41984
    v_accvgpr_read_b32 v15, a93
    v_accvgpr_read_b32 v16, a94
    s_lshl_b32 s38, s64, 15
    s_add_u32 s38, s38, 33570816
    buffer_load_dwordx4 a[76:79], v2, s[28:31], s38 offen offset:3072 sc1
    s_waitcnt lgkmcnt(6)
    v_mfma_f32_32x32x16_bf16 v[80:95], v[52:55], a[36:39], v[80:95]
    ds_read_b64_tr_b16 v[36:37], v5 offset:40960
    ds_read_b64_tr_b16 v[38:39], v5 offset:41984
    v_accvgpr_read_b32 v17, a95
    v_cvt_pk_bf16_f32 v28, v10, v11
    s_waitcnt lgkmcnt(6)
    v_mfma_f32_32x32x16_bf16 v[96:111], v[56:59], a[36:39], v[96:111]
    ds_read_b64_tr_b16 v[40:41], v6 offset:40960
    ds_read_b64_tr_b16 v[42:43], v6 offset:41984
    v_cvt_pk_bf16_f32 v29, v12, v13
    v_cvt_pk_bf16_f32 v30, v14, v15
    s_waitcnt lgkmcnt(6)
    v_mfma_f32_32x32x16_bf16 v[112:127], v[60:63], a[36:39], v[112:127]
    ds_read_b64_tr_b16 v[44:45], v7 offset:40960
    ds_read_b64_tr_b16 v[46:47], v7 offset:41984
    v_cvt_pk_bf16_f32 v31, v16, v17
    s_cmp_eq_u32 s96, 0
    s_cbranch_scc1 DU14s
    s_add_u32 s38, s56, 16781312
    buffer_store_dwordx4 v[28:31], v2, s[28:31], s38 offen offset:1024
    s_branch DU14j
DU14s:
    s_add_u32 s38, s56, 16781312
    buffer_store_dwordx4 v[28:31], v2, s[28:31], s38 offen offset:1024 sc1
DU14j:
    s_waitcnt vmcnt(19) lgkmcnt(6)
    v_mfma_f32_32x32x16_bf16 v[64:79], v[32:35], a[40:43], v[64:79]
    ds_read_b64_tr_b16 v[48:49], v4 offset:45056
    ds_read_b64_tr_b16 v[50:51], v4 offset:46080
    v_accvgpr_read_b32 v10, a96
    s_lshl_b32 s38, s64, 15
    s_add_u32 s38, s38, 33574912
    buffer_load_dwordx4 a[80:83], v2, s[28:31], s38 offen offset:0 sc1
    s_waitcnt lgkmcnt(6)
    v_mfma_f32_32x32x16_bf16 v[80:95], v[36:39], a[40:43], v[80:95]
    ds_read_b64_tr_b16 v[52:53], v5 offset:45056
    ds_read_b64_tr_b16 v[54:55], v5 offset:46080
    v_accvgpr_read_b32 v11, a97
    v_accvgpr_read_b32 v12, a98
    s_waitcnt lgkmcnt(6)
    v_mfma_f32_32x32x16_bf16 v[96:111], v[40:43], a[40:43], v[96:111]
    ds_read_b64_tr_b16 v[56:57], v6 offset:45056
    ds_read_b64_tr_b16 v[58:59], v6 offset:46080
    v_accvgpr_read_b32 v13, a99
    v_accvgpr_read_b32 v14, a100
    s_lshl_b32 s38, s64, 15
    s_add_u32 s38, s38, 33574912
    buffer_load_dwordx4 a[84:87], v2, s[28:31], s38 offen offset:1024 sc1
    s_waitcnt lgkmcnt(6)
    v_mfma_f32_32x32x16_bf16 v[112:127], v[44:47], a[40:43], v[112:127]
    s_waitcnt vmcnt(16)
    s_barrier
    ds_read_b64_tr_b16 v[60:61], v7 offset:45056
    ds_read_b64_tr_b16 v[62:63], v7 offset:46080
    v_accvgpr_read_b32 v15, a101
    v_accvgpr_read_b32 v16, a102
    s_waitcnt lgkmcnt(6)
    v_mfma_f32_32x32x16_bf16 v[64:79], v[48:51], a[44:47], v[64:79]
    ds_read_b64_tr_b16 v[32:33], v4 offset:49152
    ds_read_b64_tr_b16 v[34:35], v4 offset:50176
    v_accvgpr_read_b32 v17, a103
    v_cvt_pk_bf16_f32 v28, v10, v11
    s_add_u32 m0, s47, 16384
    s_add_u32 s38, s65, 2621440
    buffer_load_dwordx4 v8, s[48:51], s38 offen offset:0 lds
    s_waitcnt lgkmcnt(6)
    v_mfma_f32_32x32x16_bf16 v[80:95], v[52:55], a[44:47], v[80:95]
    ds_read_b64_tr_b16 v[36:37], v5 offset:49152
    ds_read_b64_tr_b16 v[38:39], v5 offset:50176
    v_cvt_pk_bf16_f32 v29, v12, v13
    v_cvt_pk_bf16_f32 v30, v14, v15
    s_waitcnt lgkmcnt(6)
    v_mfma_f32_32x32x16_bf16 v[96:111], v[56:59], a[44:47], v[96:111]
    ds_read_b64_tr_b16 v[40:41], v6 offset:49152
    ds_read_b64_tr_b16 v[42:43], v6 offset:50176
    v_cvt_pk_bf16_f32 v31, v16, v17
    s_cmp_eq_u32 s96, 0
    s_cbranch_scc1 DU15s
    s_add_u32 s38, s56, 16777216
    buffer_store_dwordx4 v[28:31], v2, s[28:31], s38 offen offset:2048
    s_branch DU15j
DU15s:
    s_add_u32 s38, s56, 16777216
    buffer_store_dwordx4 v[28:31], v2, s[28:31], s38 offen offset:2048 sc1
DU15j:
    s_add_u32 m0, s47, 16384
    s_add_u32 s38, s65, 2621440
    buffer_load_dwordx4 v9, s[48:51], s38 offen offset:1024 lds
    s_waitcnt lgkmcnt(6)
    v_mfma_f32_32x32x16_bf16 v[112:127], v[60:63], a[44:47], v[112:127]
    ds_read_b64_tr_b16 v[44:45], v7 offset:49152
    ds_read_b64_tr_b16 v[46:47], v7 offset:50176
    v_accvgpr_read_b32 v10, a104
    v_accvgpr_read_b32 v11, a105
    s_waitcnt vmcnt(18) lgkmcnt(6)
    v_mfma_f32_32x32x16_bf16 v[64:79], v[32:35], a[48:51], v[64:79]
    ds_read_b64_tr_b16 v[48:49], v4 offset:53248
    ds_read_b64_tr_b16 v[50:51], v4 offset:54272
    v_accvgpr_read_b32 v12, a106
    v_accvgpr_read_b32 v13, a107
    s_lshl_b32 s38, s64, 15
    s_add_u32 s38, s38, 33574912
    buffer_load_dwordx4 a[88:91], v2, s[28:31], s38 offen offset:2048 sc1
    s_waitcnt lgkmcnt(6)
    v_mfma_f32_32x32x16_bf16 v[80:95], v[36:39], a[48:51], v[80:95]
    ds_read_b64_tr_b16 v[52:53], v5 offset:53248
    ds_read_b64_tr_b16 v[54:55], v5 offset:54272
    v_accvgpr_read_b32 v14, a108
    v_accvgpr_read_b32 v15, a109
    s_waitcnt lgkmcnt(6)
    v_mfma_f32_32x32x16_bf16 v[96:111], v[40:43], a[48:51], v[96:111]
    ds_read_b64_tr_b16 v[56:57], v6 offset:53248
    ds_read_b64_tr_b16 v[58:59], v6 offset:54272
    v_accvgpr_read_b32 v16, a110
    v_accvgpr_read_b32 v17, a111
    s_lshl_b32 s38, s64, 15
    s_add_u32 s38, s38, 33574912
    buffer_load_dwordx4 a[92:95], v2, s[28:31], s38 offen offset:3072 sc1
    s_waitcnt lgkmcnt(6)
    v_mfma_f32_32x32x16_bf16 v[112:127], v[44:47], a[48:51], v[112:127]
    ds_read_b64_tr_b16 v[60:61], v7 offset:53248
    ds_read_b64_tr_b16 v[62:63], v7 offset:54272
    v_cvt_pk_bf16_f32 v28, v10, v11
    v_cvt_pk_bf16_f32 v29, v12, v13
    s_waitcnt vmcnt(19) lgkmcnt(6)
    v_mfma_f32_32x32x16_bf16 v[64:79], v[48:51], a[52:55], v[64:79]
    ds_read_b64_tr_b16 v[32:33], v4 offset:57344
    ds_read_b64_tr_b16 v[34:35], v4 offset:58368
    v_cvt_pk_bf16_f32 v30, v14, v15
    v_cvt_pk_bf16_f32 v31, v16, v17
    s_waitcnt lgkmcnt(6)
    v_mfma_f32_32x32x16_bf16 v[80:95], v[52:55], a[52:55], v[80:95]
    ds_read_b64_tr_b16 v[36:37], v5 offset:57344
    ds_read_b64_tr_b16 v[38:39], v5 offset:58368
    s_cmp_eq_u32 s96, 0
    s_cbranch_scc1 DU16s
    s_add_u32 s38, s56, 16781312
    buffer_store_dwordx4 v[28:31], v2, s[28:31], s38 offen offset:2048
    s_branch DU16j
DU16s:
    s_add_u32 s38, s56, 16781312
    buffer_store_dwordx4 v[28:31], v2, s[28:31], s38 offen offset:2048 sc1
DU16j:
    s_waitcnt lgkmcnt(6)
    v_mfma_f32_32x32x16_bf16 v[96:111], v[56:59], a[52:55], v[96:111]
    ds_read_b64_tr_b16 v[40:41], v6 offset:57344
    ds_read_b64_tr_b16 v[42:43], v6 offset:58368
    v_accvgpr_read_b32 v10, a112
    v_accvgpr_read_b32 v11, a113
    s_lshl_b32 s38, s64, 15
    s_add_u32 s38, s38, 33579008
    buffer_load_dwordx4 a[96:99], v2, s[28:31], s38 offen offset:0 sc1
    s_waitcnt lgkmcnt(6)
    v_mfma_f32_32x32x16_bf16 v[112:127], v[60:63], a[52:55], v[112:127]
    ds_read_b64_tr_b16 v[44:45], v7 offset:57344
    ds_read_b64_tr_b16 v[46:47], v7 offset:58368
    v_accvgpr_read_b32 v12, a114
    v_accvgpr_read_b32 v13, a115
    s_waitcnt vmcnt(19) lgkmcnt(6)
    v_mfma_f32_32x32x16_bf16 v[64:79], v[32:35], a[56:59], v[64:79]
    ds_read_b64_tr_b16 v[48:49], v4 offset:61440
    ds_read_b64_tr_b16 v[50:51], v4 offset:62464
    v_accvgpr_read_b32 v14, a116
    v_accvgpr_read_b32 v15, a117
    s_lshl_b32 s38, s64, 15
    s_add_u32 s38, s38, 33579008
    buffer_load_dwordx4 a[100:103], v2, s[28:31], s38 offen offset:1024 sc1
    s_waitcnt lgkmcnt(6)
    v_mfma_f32_32x32x16_bf16 v[80:95], v[36:39], a[56:59], v[80:95]
    ds_read_b64_tr_b16 v[52:53], v5 offset:61440
    ds_read_b64_tr_b16 v[54:55], v5 offset:62464
    v_accvgpr_read_b32 v16, a118
    v_accvgpr_read_b32 v17, a119
    s_waitcnt lgkmcnt(6)
    v_mfma_f32_32x32x16_bf16 v[96:111], v[40:43], a[56:59], v[96:111]
    ds_read_b64_tr_b16 v[56:57], v6 offset:61440
    ds_read_b64_tr_b16 v[58:59], v6 offset:62464
    v_cvt_pk_bf16_f32 v28, v10, v11
    v_cvt_pk_bf16_f32 v29, v12, v13
    s_lshl_b32 s38, s64, 15
    s_add_u32 s38, s38, 33579008
    buffer_load_dwordx4 a[104:107], v2, s[28:31], s38 offen offset:2048 sc1
    s_waitcnt lgkmcnt(6)
    v_mfma_f32_32x32x16_bf16 v[112:127], v[44:47], a[56:59], v[112:127]
    s_waitcnt vmcnt(16)
    s_barrier
    ds_read_b64_tr_b16 v[60:61], v7 offset:61440
    ds_read_b64_tr_b16 v[62:63], v7 offset:62464
    v_cvt_pk_bf16_f32 v30, v14, v15
    v_cvt_pk_bf16_f32 v31, v16, v17
    s_waitcnt lgkmcnt(6)
    v_mfma_f32_32x32x16_bf16 v[64:79], v[48:51], a[60:63], v[64:79]
    ds_read_b64_tr_b16 v[32:33], v4 offset:0
    ds_read_b64_tr_b16 v[34:35], v4 offset:1024
    s_cmp_eq_u32 s96, 0
    s_cbranch_scc1 DU17s
    s_add_u32 s38, s56, 16777216
    buffer_store_dwordx4 v[28:31], v2, s[28:31], s38 offen offset:3072
    s_branch DU17j
DU17s:
    s_add_u32 s38, s56, 16777216
    buffer_store_dwordx4 v[28:31], v2, s[28:31], s38 offen offset:3072 sc1
DU17j:
    v_accvgpr_read_b32 v10, a120
    s_add_u32 m0, s47, 32768
    s_add_u32 s38, s65, 3145728
    buffer_load_dwordx4 v8, s[48:51], s38 offen offset:0 lds
    s_waitcnt lgkmcnt(6)
    v_mfma_f32_32x32x16_bf16 v[80:95], v[52:55], a[60:63], v[80:95]
    ds_read_b64_tr_b16 v[36:37], v5 offset:0
    ds_read_b64_tr_b16 v[38:39], v5 offset:1024
    v_accvgpr_read_b32 v11, a121
    v_accvgpr_read_b32 v12, a122
    s_waitcnt lgkmcnt(6)
    v_mfma_f32_32x32x16_bf16 v[96:111], v[56:59], a[60:63], v[96:111]
    ds_read_b64_tr_b16 v[40:41], v6 offset:0
    ds_read_b64_tr_b16 v[42:43], v6 offset:1024
    v_accvgpr_read_b32 v13, a123
    v_accvgpr_read_b32 v14, a124
    s_add_u32 m0, s47, 32768
    s_add_u32 s38, s65, 3145728
    buffer_load_dwordx4 v9, s[48:51], s38 offen offset:1024 lds
    s_waitcnt lgkmcnt(6)
    v_mfma_f32_32x32x16_bf16 v[112:127], v[60:63], a[60:63], v[112:127]
    ds_read_b64_tr_b16 v[44:45], v7 offset:0
    ds_read_b64_tr_b16 v[46:47], v7 offset:1024
    v_accvgpr_read_b32 v15, a125
    v_accvgpr_read_b32 v16, a126
    s_waitcnt lgkmcnt(6)
    v_mfma_f32_32x32x16_bf16 v[64:79], v[32:35], a[64:67], v[64:79]
    ds_read_b64_tr_b16 v[48:49], v4 offset:4096
    ds_read_b64_tr_b16 v[50:51], v4 offset:5120
    v_accvgpr_read_b32 v17, a127
    v_cvt_pk_bf16_f32 v28, v10, v11
    s_lshl_b32 s38, s64, 15
    s_add_u32 s38, s38, 33579008
    buffer_load_dwordx4 a[108:111], v2, s[28:31], s38 offen offset:3072 sc1
    s_waitcnt lgkmcnt(6)
    v_mfma_f32_32x32x16_bf16 v[80:95], v[36:39], a[64:67], v[80:95]
    ds_read_b64_tr_b16 v[52:53], v5 offset:4096
    ds_read_b64_tr_b16 v[54:55], v5 offset:5120
    v_cvt_pk_bf16_f32 v29, v12, v13
    v_cvt_pk_bf16_f32 v30, v14, v15
    s_waitcnt lgkmcnt(6)
    v_mfma_f32_32x32x16_bf16 v[96:111], v[40:43], a[64:67], v[96:111]
    ds_read_b64_tr_b16 v[56:57], v6 offset:4096
    ds_read_b64_tr_b16 v[58:59], v6 offset:5120
    v_cvt_pk_bf16_f32 v31, v16, v17
    s_cmp_eq_u32 s96, 0
    s_cbranch_scc1 DU18s
    s_add_u32 s38, s56, 16781312
    buffer_store_dwordx4 v[28:31], v2, s[28:31], s38 offen offset:3072
    s_branch DU18j
DU18s:
    s_add_u32 s38, s56, 16781312
    buffer_store_dwordx4 v[28:31], v2, s[28:31], s38 offen offset:3072 sc1
DU18j:
    s_add_u32 m0, s42, 0
    s_add_u32 s38, s41, 0
    buffer_load_dwordx4 v2, s[28:31], s38 offen offset:0 sc1 lds
    s_waitcnt lgkmcnt(6)
    v_mfma_f32_32x32x16_bf16 v[112:127], v[44:47], a[64:67], v[112:127]
    ds_read_b64_tr_b16 v[60:61], v7 offset:4096
    ds_read_b64_tr_b16 v[62:63], v7 offset:5120
    s_waitcnt vmcnt(21) lgkmcnt(6)
    v_mfma_f32_32x32x16_bf16 v[64:79], v[48:51], a[68:71], v[64:79]
    ds_read_b64_tr_b16 v[32:33], v4 offset:8192
    ds_read_b64_tr_b16 v[34:35], v4 offset:9216
    s_add_u32 m0, s42, 0
    s_add_u32 s38, s41, 0
    buffer_load_dwordx4 v2, s[28:31], s38 offen offset:1024 sc1 lds
    s_waitcnt lgkmcnt(6)
    v_mfma_f32_32x32x16_bf16 v[80:95], v[52:55], a[68:71], v[80:95]
    ds_read_b64_tr_b16 v[36:37], v5 offset:8192
    ds_read_b64_tr_b16 v[38:39], v5 offset:9216
    s_waitcnt lgkmcnt(6)
    v_mfma_f32_32x32x16_bf16 v[96:111], v[56:59], a[68:71], v[96:111]
    ds_read_b64_tr_b16 v[40:41], v6 offset:8192
    ds_read_b64_tr_b16 v[42:43], v6 offset:9216
    s_add_u32 m0, s42, 0
    s_add_u32 s38, s41, 0
    buffer_load_dwordx4 v2, s[28:31], s38 offen offset:2048 sc1 lds
    s_waitcnt lgkmcnt(6)
    v_mfma_f32_32x32x16_bf16 v[112:127], v[60:63], a[68:71], v[112:127]
    ds_read_b64_tr_b16 v[44:45], v7 offset:8192
    ds_read_b64_tr_b16 v[46:47], v7 offset:9216
    s_waitcnt vmcnt(21) lgkmcnt(6)
    v_mfma_f32_32x32x16_bf16 v[64:79], v[32:35], a[72:75], v[64:79]
    ds_read_b64_tr_b16 v[48:49], v4 offset:12288
    ds_read_b64_tr_b16 v[50:51], v4 offset:13312
    s_lshl_b32 s38, s64, 15
    s_add_u32 s38, s38, 33583104
    buffer_load_dwordx4 a[112:115], v2, s[28:31], s38 offen offset:0 sc1
    s_waitcnt lgkmcnt(6)
    v_mfma_f32_32x32x16_bf16 v[80:95], v[36:39], a[72:75], v[80:95]
    ds_read_b64_tr_b16 v[52:53], v5 offset:12288
    ds_read_b64_tr_b16 v[54:55], v5 offset:13312
    s_waitcnt lgkmcnt(6)
    v_mfma_f32_32x32x16_bf16 v[96:111], v[40:43], a[72:75], v[96:111]
    ds_read_b64_tr_b16 v[56:57], v6 offset:12288
    ds_read_b64_tr_b16 v[58:59], v6 offset:13312
    s_lshl_b32 s38, s64, 15
    s_add_u32 s38, s38, 33583104
    buffer_load_dwordx4 a[116:119], v2, s[28:31], s38 offen offset:1024 sc1
    s_waitcnt lgkmcnt(6)
    v_mfma_f32_32x32x16_bf16 v[112:127], v[44:47], a[72:75], v[112:127]
    s_waitcnt vmcnt(16)
    s_barrier
    ds_read_b64_tr_b16 v[60:61], v7 offset:12288
    ds_read_b64_tr_b16 v[62:63], v7 offset:13312
    s_waitcnt lgkmcnt(6)
    v_mfma_f32_32x32x16_bf16 v[64:79], v[48:51], a[76:79], v[64:79]
    ds_read_b64_tr_b16 v[32:33], v4 offset:16384
    ds_read_b64_tr_b16 v[34:35], v4 offset:17408
    s_add_u32 m0, s47, 49152
    s_add_u32 s38, s65, 3670016
    buffer_load_dwordx4 v8, s[48:51], s38 offen offset:0 lds
    s_waitcnt lgkmcnt(6)
    v_mfma_f32_32x32x16_bf16 v[80:95], v[52:55], a[76:79], v[80:95]
    ds_read_b64_tr_b16 v[36:37], v5 offset:16384
    ds_read_b64_tr_b16 v[38:39], v5 offset:17408
    s_waitcnt lgkmcnt(6)
    v_mfma_f32_32x32x16_bf16 v[96:111], v[56:59], a[76:79], v[96:111]
    ds_read_b64_tr_b16 v[40:41], v6 offset:16384
    ds_read_b64_tr_b16 v[42:43], v6 offset:17408
    s_add_u32 m0, s47, 49152
    s_add_u32 s38, s65, 3670016
    buffer_load_dwordx4 v9, s[48:51], s38 offen offset:1024 lds
    s_waitcnt lgkmcnt(6)
    v_mfma_f32_32x32x16_bf16 v[112:127], v[60:63], a[76:79], v[112:127]
    ds_read_b64_tr_b16 v[44:45], v7 offset:16384
    ds_read_b64_tr_b16 v[46:47], v7 offset:17408
    s_waitcnt lgkmcnt(6)
    v_mfma_f32_32x32x16_bf16 v[64:79], v[32:35], a[80:83], v[64:79]
    ds_read_b64_tr_b16 v[48:49], v4 offset:20480
    ds_read_b64_tr_b16 v[50:51], v4 offset:21504
    s_lshl_b32 s38, s64, 15
    s_add_u32 s38, s38, 33583104
    buffer_load_dwordx4 a[120:123], v2, s[28:31], s38 offen offset:2048 sc1
    s_waitcnt lgkmcnt(6)
    v_mfma_f32_32x32x16_bf16 v[80:95], v[36:39], a[80:83], v[80:95]
    ds_read_b64_tr_b16 v[52:53], v5 offset:20480
    ds_read_b64_tr_b16 v[54:55], v5 offset:21504
    s_waitcnt lgkmcnt(6)
    v_mfma_f32_32x32x16_bf16 v[96:111], v[40:43], a[80:83], v[96:111]
    ds_read_b64_tr_b16 v[56:57], v6 offset:20480
    ds_read_b64_tr_b16 v[58:59], v6 offset:21504
    s_lshl_b32 s38, s64, 15
    s_add_u32 s38, s38, 33583104
    buffer_load_dwordx4 a[124:127], v2, s[28:31], s38 offen offset:3072 sc1
    s_waitcnt lgkmcnt(6)
    v_mfma_f32_32x32x16_bf16 v[112:127], v[44:47], a[80:83], v[112:127]
    ds_read_b64_tr_b16 v[60:61], v7 offset:20480
    ds_read_b64_tr_b16 v[62:63], v7 offset:21504
    s_waitcnt lgkmcnt(6)
    v_mfma_f32_32x32x16_bf16 v[64:79], v[48:51], a[84:87], v[64:79]
    ds_read_b64_tr_b16 v[32:33], v4 offset:24576
    ds_read_b64_tr_b16 v[34:35], v4 offset:25600
    s_add_u32 m0, s42, 24576
    s_add_u32 s38, s41, 24576
    buffer_load_dwordx4 v2, s[28:31], s38 offen offset:0 sc1 lds
    s_waitcnt lgkmcnt(6)
    v_mfma_f32_32x32x16_bf16 v[80:95], v[52:55], a[84:87], v[80:95]
    ds_read_b64_tr_b16 v[36:37], v5 offset:24576
    ds_read_b64_tr_b16 v[38:39], v5 offset:25600
    s_waitcnt lgkmcnt(6)
    v_mfma_f32_32x32x16_bf16 v[96:111], v[56:59], a[84:87], v[96:111]
    ds_read_b64_tr_b16 v[40:41], v6 offset:24576
    ds_read_b64_tr_b16 v[42:43], v6 offset:25600
    s_add_u32 m0, s42, 24576
    s_add_u32 s38, s41, 24576
    buffer_load_dwordx4 v2, s[28:31], s38 offen offset:1024 sc1 lds
    s_waitcnt lgkmcnt(6)
    v_mfma_f32_32x32x16_bf16 v[112:127], v[60:63], a[84:87], v[112:127]
    ds_read_b64_tr_b16 v[44:45], v7 offset:24576
    ds_read_b64_tr_b16 v[46:47], v7 offset:25600
    s_waitcnt vmcnt(21) lgkmcnt(6)
    v_mfma_f32_32x32x16_bf16 v[64:79], v[32:35], a[88:91], v[64:79]
    ds_read_b64_tr_b16 v[48:49], v4 offset:28672
    ds_read_b64_tr_b16 v[50:51], v4 offset:29696
    s_add_u32 m0, s42, 24576
    s_add_u32 s38, s41, 24576
    buffer_load_dwordx4 v2, s[28:31], s38 offen offset:2048 sc1 lds
    s_waitcnt lgkmcnt(6)
    v_mfma_f32_32x32x16_bf16 v[80:95], v[36:39], a[88:91], v[80:95]
    ds_read_b64_tr_b16 v[52:53], v5 offset:28672
    ds_read_b64_tr_b16 v[54:55], v5 offset:29696
    s_waitcnt lgkmcnt(6)
    v_mfma_f32_32x32x16_bf16 v[96:111], v[40:43], a[88:91], v[96:111]
    ds_read_b64_tr_b16 v[56:57], v6 offset:28672
    ds_read_b64_tr_b16 v[58:59], v6 offset:29696
    s_waitcnt lgkmcnt(6)
    v_mfma_f32_32x32x16_bf16 v[112:127], v[44:47], a[88:91], v[112:127]
    s_waitcnt vmcnt(12)
    s_barrier
    s_cmp_lg_u32 s3, 0
    s_cbranch_scc1 ON19
    v_mbcnt_lo_u32_b32 v18, -1, 0
    v_mbcnt_hi_u32_b32 v18, -1, v18
    v_cmp_eq_u32 vcc, 0, v18
    v_mov_b32 v19, 0x7fffff00
    s_nop 0
    v_cndmask_b32 v18, v19, v18, vcc
    v_mov_b32 v19, 1
    buffer_atomic_add v19, v18, s[28:31], s45 offen sc1
ON19:
    ds_read_b64_tr_b16 v[60:61], v7 offset:28672
    ds_read_b64_tr_b16 v[62:63], v7 offset:29696
    s_waitcnt lgkmcnt(6)
    v_mfma_f32_32x32x16_bf16 v[64:79], v[48:51], a[92:95], v[64:79]
    ds_read_b64_tr_b16 v[32:33], v4 offset:32768
    ds_read_b64_tr_b16 v[34:35], v4 offset:33792
    s_add_u32 m0, s42, 49152
    s_add_u32 s38, s41, 49152
    buffer_load_dwordx4 v2, s[28:31], s38 offen offset:0 sc1 lds
    s_waitcnt lgkmcnt(6)
    v_mfma_f32_32x32x16_bf16 v[80:95], v[52:55], a[92:95], v[80:95]
    ds_read_b64_tr_b16 v[36:37], v5 offset:32768
    ds_read_b64_tr_b16 v[38:39], v5 offset:33792
    s_waitcnt lgkmcnt(6)
    v_mfma_f32_32x32x16_bf16 v[96:111], v[56:59], a[92:95], v[96:111]
    ds_read_b64_tr_b16 v[40:41], v6 offset:32768
    ds_read_b64_tr_b16 v[42:43], v6 offset:33792
    s_add_u32 m0, s42, 49152
    s_add_u32 s38, s41, 49152
    buffer_load_dwordx4 v2, s[28:31], s38 offen offset:1024 sc1 lds
    s_waitcnt lgkmcnt(6)
    v_mfma_f32_32x32x16_bf16 v[112:127], v[60:63], a[92:95], v[112:127]
    ds_read_b64_tr_b16 v[44:45], v7 offset:32768
    ds_read_b64_tr_b16 v[46:47], v7 offset:33792
    s_waitcnt lgkmcnt(6)
    v_mfma_f32_32x32x16_bf16 v[64:79], v[32:35], a[96:99], v[64:79]
    ds_read_b64_tr_b16 v[48:49], v4 offset:36864
    ds_read_b64_tr_b16 v[50:51], v4 offset:37888
    s_add_u32 m0, s42, 49152
    s_add_u32 s38, s41, 49152
    buffer_load_dwordx4 v2, s[28:31], s38 offen offset:2048 sc1 lds
    s_waitcnt lgkmcnt(6)
    v_mfma_f32_32x32x16_bf16 v[80:95], v[36:39], a[96:99], v[80:95]
    ds_read_b64_tr_b16 v[52:53], v5 offset:36864
    ds_read_b64_tr_b16 v[54:55], v5 offset:37888
    s_waitcnt lgkmcnt(6)
    v_mfma_f32_32x32x16_bf16 v[96:111], v[40:43], a[96:99], v[96:111]
    ds_read_b64_tr_b16 v[56:57], v6 offset:36864
    ds_read_b64_tr_b16 v[58:59], v6 offset:37888
    s_add_u32 m0, s42, 73728
    s_add_u32 s38, s41, 73728
    buffer_load_dwordx4 v2, s[28:31], s38 offen offset:0 sc1 lds
    s_waitcnt lgkmcnt(6)
    v_mfma_f32_32x32x16_bf16 v[112:127], v[44:47], a[96:99], v[112:127]
    ds_read_b64_tr_b16 v[60:61], v7 offset:36864
    ds_read_b64_tr_b16 v[62:63], v7 offset:37888
    s_waitcnt lgkmcnt(6)
    v_mfma_f32_32x32x16_bf16 v[64:79], v[48:51], a[100:103], v[64:79]
    ds_read_b64_tr_b16 v[32:33], v4 offset:40960
    ds_read_b64_tr_b16 v[34:35], v4 offset:41984
    s_add_u32 m0, s42, 73728
    s_add_u32 s38, s41, 73728
    buffer_load_dwordx4 v2, s[28:31], s38 offen offset:1024 sc1 lds
    s_waitcnt lgkmcnt(6)
    v_mfma_f32_32x32x16_bf16 v[80:95], v[52:55], a[100:103], v[80:95]
    ds_read_b64_tr_b16 v[36:37], v5 offset:40960
    ds_read_b64_tr_b16 v[38:39], v5 offset:41984
    s_waitcnt lgkmcnt(6)
    v_mfma_f32_32x32x16_bf16 v[96:111], v[56:59], a[100:103], v[96:111]
    ds_read_b64_tr_b16 v[40:41], v6 offset:40960
    ds_read_b64_tr_b16 v[42:43], v6 offset:41984
    s_add_u32 m0, s42, 73728
    s_add_u32 s38, s41, 73728
    buffer_load_dwordx4 v2, s[28:31], s38 offen offset:2048 sc1 lds
    s_waitcnt lgkmcnt(6)
    v_mfma_f32_32x32x16_bf16 v[112:127], v[60:63], a[100:103], v[112:127]
    ds_read_b64_tr_b16 v[44:45], v7 offset:40960
    ds_read_b64_tr_b16 v[46:47], v7 offset:41984
    s_waitcnt lgkmcnt(6)
    v_mfma_f32_32x32x16_bf16 v[64:79], v[32:35], a[104:107], v[64:79]
    ds_read_b64_tr_b16 v[48:49], v4 offset:45056
    ds_read_b64_tr_b16 v[50:51], v4 offset:46080
    s_waitcnt lgkmcnt(6)
    v_mfma_f32_32x32x16_bf16 v[80:95], v[36:39], a[104:107], v[80:95]
    ds_read_b64_tr_b16 v[52:53], v5 offset:45056
    ds_read_b64_tr_b16 v[54:55], v5 offset:46080
    s_waitcnt lgkmcnt(6)
    v_mfma_f32_32x32x16_bf16 v[96:111], v[40:43], a[104:107], v[96:111]
    ds_read_b64_tr_b16 v[56:57], v6 offset:45056
    ds_read_b64_tr_b16 v[58:59], v6 offset:46080
    s_waitcnt lgkmcnt(6)
    v_mfma_f32_32x32x16_bf16 v[112:127], v[44:47], a[104:107], v[112:127]
    s_waitcnt vmcnt(11)
    s_barrier
    ds_read_b64_tr_b16 v[60:61], v7 offset:45056
    ds_read_b64_tr_b16 v[62:63], v7 offset:46080
    s_waitcnt lgkmcnt(6)
    v_mfma_f32_32x32x16_bf16 v[64:79], v[48:51], a[108:111], v[64:79]
    ds_read_b64_tr_b16 v[32:33], v4 offset:49152
    ds_read_b64_tr_b16 v[34:35], v4 offset:50176
    s_and_b32 s38, s3, 3
    s_cmp_lg_u32 s38, 0
    s_cbranch_scc1 CP20
    s_mov_b32 s38, ATT_A-parallel_sum__compressed_kv_cla__swiglu_ffn__prompt_kernel+0
    v_lshl_add_u32 v26, v1, 7, s38
    s_mov_b32 s38, ATT_A_end-parallel_sum__compressed_kv_cla__swiglu_ffn__prompt_kernel-128
    v_min_u32 v26, s38, v26
    v_mov_b32 v27, s101
    v_add_co_u32 v26, vcc, s100, v26
    s_nop 1
    v_addc_co_u32 v27, vcc, 0, v27, vcc
    global_load_dword v3, v[26:27], off
    s_mov_b32 s38, ATT_A-parallel_sum__compressed_kv_cla__swiglu_ffn__prompt_kernel+8192
    v_lshl_add_u32 v26, v1, 7, s38
    s_mov_b32 s38, ATT_A_end-parallel_sum__compressed_kv_cla__swiglu_ffn__prompt_kernel-128
    v_min_u32 v26, s38, v26
    v_mov_b32 v27, s101
    v_add_co_u32 v26, vcc, s100, v26
    s_nop 1
    v_addc_co_u32 v27, vcc, 0, v27, vcc
    global_load_dword v3, v[26:27], off
CP20:
    s_waitcnt lgkmcnt(6)
    v_mfma_f32_32x32x16_bf16 v[80:95], v[52:55], a[108:111], v[80:95]
    ds_read_b64_tr_b16 v[36:37], v5 offset:49152
    ds_read_b64_tr_b16 v[38:39], v5 offset:50176
    s_waitcnt lgkmcnt(6)
    v_mfma_f32_32x32x16_bf16 v[96:111], v[56:59], a[108:111], v[96:111]
    ds_read_b64_tr_b16 v[40:41], v6 offset:49152
    ds_read_b64_tr_b16 v[42:43], v6 offset:50176
    s_waitcnt lgkmcnt(6)
    v_mfma_f32_32x32x16_bf16 v[112:127], v[60:63], a[108:111], v[112:127]
    ds_read_b64_tr_b16 v[44:45], v7 offset:49152
    ds_read_b64_tr_b16 v[46:47], v7 offset:50176
    s_waitcnt lgkmcnt(6)
    v_mfma_f32_32x32x16_bf16 v[64:79], v[32:35], a[112:115], v[64:79]
    ds_read_b64_tr_b16 v[48:49], v4 offset:53248
    ds_read_b64_tr_b16 v[50:51], v4 offset:54272
    s_waitcnt lgkmcnt(6)
    v_mfma_f32_32x32x16_bf16 v[80:95], v[36:39], a[112:115], v[80:95]
    ds_read_b64_tr_b16 v[52:53], v5 offset:53248
    ds_read_b64_tr_b16 v[54:55], v5 offset:54272
    s_waitcnt lgkmcnt(6)
    v_mfma_f32_32x32x16_bf16 v[96:111], v[40:43], a[112:115], v[96:111]
    ds_read_b64_tr_b16 v[56:57], v6 offset:53248
    ds_read_b64_tr_b16 v[58:59], v6 offset:54272
    s_waitcnt lgkmcnt(6)
    v_mfma_f32_32x32x16_bf16 v[112:127], v[44:47], a[112:115], v[112:127]
    ds_read_b64_tr_b16 v[60:61], v7 offset:53248
    ds_read_b64_tr_b16 v[62:63], v7 offset:54272
    s_waitcnt lgkmcnt(6)
    v_mfma_f32_32x32x16_bf16 v[64:79], v[48:51], a[116:119], v[64:79]
    ds_read_b64_tr_b16 v[32:33], v4 offset:57344
    ds_read_b64_tr_b16 v[34:35], v4 offset:58368
    s_waitcnt lgkmcnt(6)
    v_mfma_f32_32x32x16_bf16 v[80:95], v[52:55], a[116:119], v[80:95]
    ds_read_b64_tr_b16 v[36:37], v5 offset:57344
    ds_read_b64_tr_b16 v[38:39], v5 offset:58368
    s_waitcnt lgkmcnt(6)
    v_mfma_f32_32x32x16_bf16 v[96:111], v[56:59], a[116:119], v[96:111]
    ds_read_b64_tr_b16 v[40:41], v6 offset:57344
    ds_read_b64_tr_b16 v[42:43], v6 offset:58368
    s_waitcnt lgkmcnt(6)
    v_mfma_f32_32x32x16_bf16 v[112:127], v[60:63], a[116:119], v[112:127]
    ds_read_b64_tr_b16 v[44:45], v7 offset:57344
    ds_read_b64_tr_b16 v[46:47], v7 offset:58368
    s_waitcnt vmcnt(10) lgkmcnt(6)
    v_mfma_f32_32x32x16_bf16 v[64:79], v[32:35], a[120:123], v[64:79]
    ds_read_b64_tr_b16 v[48:49], v4 offset:61440
    ds_read_b64_tr_b16 v[50:51], v4 offset:62464
    s_waitcnt lgkmcnt(6)
    v_mfma_f32_32x32x16_bf16 v[80:95], v[36:39], a[120:123], v[80:95]
    ds_read_b64_tr_b16 v[52:53], v5 offset:61440
    ds_read_b64_tr_b16 v[54:55], v5 offset:62464
    s_waitcnt lgkmcnt(6)
    v_mfma_f32_32x32x16_bf16 v[96:111], v[40:43], a[120:123], v[96:111]
    ds_read_b64_tr_b16 v[56:57], v6 offset:61440
    ds_read_b64_tr_b16 v[58:59], v6 offset:62464
    s_waitcnt lgkmcnt(6)
    v_mfma_f32_32x32x16_bf16 v[112:127], v[44:47], a[120:123], v[112:127]
    s_waitcnt vmcnt(0)
    s_barrier
    ds_read_b64_tr_b16 v[60:61], v7 offset:61440
    ds_read_b64_tr_b16 v[62:63], v7 offset:62464
    s_waitcnt lgkmcnt(6)
    v_mfma_f32_32x32x16_bf16 v[64:79], v[48:51], a[124:127], v[64:79]
    s_cmp_lg_u32 s3, 0
    s_cbranch_scc1 ON21
    v_mov_b32 v23, 0
    buffer_load_dword v22, v23, s[28:31], s45 offen sc1
ON21:
    s_waitcnt lgkmcnt(4)
    v_mfma_f32_32x32x16_bf16 v[80:95], v[52:55], a[124:127], v[80:95]
    s_waitcnt lgkmcnt(2)
    v_mfma_f32_32x32x16_bf16 v[96:111], v[56:59], a[124:127], v[96:111]
    s_waitcnt lgkmcnt(0)
    v_mfma_f32_32x32x16_bf16 v[112:127], v[60:63], a[124:127], v[112:127]
    s_nop 9
    v_mul_f32 v96, 0x3e0293ee, v96
    v_mul_f32 v97, 0x3e0293ee, v97
    v_mul_f32 v98, 0x3e0293ee, v98
    v_mul_f32 v99, 0x3e0293ee, v99
    v_mul_f32 v100, 0x3e0293ee, v100
    v_mul_f32 v101, 0x3e0293ee, v101
    v_mul_f32 v102, 0x3e0293ee, v102
    v_mul_f32 v103, 0x3e0293ee, v103
    v_mul_f32 v104, 0x3e0293ee, v104
    v_mul_f32 v105, 0x3e0293ee, v105
    v_mul_f32 v106, 0x3e0293ee, v106
    v_mul_f32 v107, 0x3e0293ee, v107
    v_mul_f32 v108, 0x3e0293ee, v108
    v_mul_f32 v109, 0x3e0293ee, v109
    v_mul_f32 v110, 0x3e0293ee, v110
    v_mul_f32 v111, 0x3e0293ee, v111
    v_cvt_pk_bf16_f32 v96, v96, v97
    v_cvt_pk_bf16_f32 v97, v98, v99
    v_cvt_pk_bf16_f32 v98, v100, v101
    v_cvt_pk_bf16_f32 v99, v102, v103
    v_cvt_pk_bf16_f32 v100, v104, v105
    v_cvt_pk_bf16_f32 v101, v106, v107
    v_cvt_pk_bf16_f32 v102, v108, v109
    v_cvt_pk_bf16_f32 v103, v110, v111
    v_mul_f32 v112, 0x3e0293ee, v112
    v_mul_f32 v113, 0x3e0293ee, v113
    v_mul_f32 v114, 0x3e0293ee, v114
    v_mul_f32 v115, 0x3e0293ee, v115
    v_mul_f32 v116, 0x3e0293ee, v116
    v_mul_f32 v117, 0x3e0293ee, v117
    v_mul_f32 v118, 0x3e0293ee, v118
    v_mul_f32 v119, 0x3e0293ee, v119
    v_mul_f32 v120, 0x3e0293ee, v120
    v_mul_f32 v121, 0x3e0293ee, v121
    v_mul_f32 v122, 0x3e0293ee, v122
    v_mul_f32 v123, 0x3e0293ee, v123
    v_mul_f32 v124, 0x3e0293ee, v124
    v_mul_f32 v125, 0x3e0293ee, v125
    v_mul_f32 v126, 0x3e0293ee, v126
    v_mul_f32 v127, 0x3e0293ee, v127
    v_cvt_pk_bf16_f32 v112, v112, v113
    v_cvt_pk_bf16_f32 v113, v114, v115
    v_cvt_pk_bf16_f32 v114, v116, v117
    v_cvt_pk_bf16_f32 v115, v118, v119
    v_cvt_pk_bf16_f32 v116, v120, v121
    v_cvt_pk_bf16_f32 v117, v122, v123
    v_cvt_pk_bf16_f32 v118, v124, v125
    v_cvt_pk_bf16_f32 v119, v126, v127
    v_mul_f32 v64, 0x3e0293ee, v64
    v_mul_f32 v65, 0x3e0293ee, v65
    v_mul_f32 v66, 0x3e0293ee, v66
    v_mul_f32 v67, 0x3e0293ee, v67
    v_mul_f32 v68, 0x3e0293ee, v68
    v_mul_f32 v69, 0x3e0293ee, v69
    v_mul_f32 v70, 0x3e0293ee, v70
    v_mul_f32 v71, 0x3e0293ee, v71
    v_mul_f32 v72, 0x3e0293ee, v72
    v_mul_f32 v73, 0x3e0293ee, v73
    v_mul_f32 v74, 0x3e0293ee, v74
    v_mul_f32 v75, 0x3e0293ee, v75
    v_mul_f32 v76, 0x3e0293ee, v76
    v_mul_f32 v77, 0x3e0293ee, v77
    v_mul_f32 v78, 0x3e0293ee, v78
    v_mul_f32 v79, 0x3e0293ee, v79
    v_cvt_pk_bf16_f32 v104, v64, v65
    v_cvt_pk_bf16_f32 v105, v66, v67
    v_cvt_pk_bf16_f32 v106, v68, v69
    v_cvt_pk_bf16_f32 v107, v70, v71
    v_cvt_pk_bf16_f32 v108, v72, v73
    v_cvt_pk_bf16_f32 v109, v74, v75
    v_cvt_pk_bf16_f32 v110, v76, v77
    v_cvt_pk_bf16_f32 v111, v78, v79
    v_mul_f32 v80, 0x3e0293ee, v80
    v_mul_f32 v81, 0x3e0293ee, v81
    v_mul_f32 v82, 0x3e0293ee, v82
    v_mul_f32 v83, 0x3e0293ee, v83
    v_mul_f32 v84, 0x3e0293ee, v84
    v_mul_f32 v85, 0x3e0293ee, v85
    v_mul_f32 v86, 0x3e0293ee, v86
    v_mul_f32 v87, 0x3e0293ee, v87
    v_mul_f32 v88, 0x3e0293ee, v88
    v_mul_f32 v89, 0x3e0293ee, v89
    v_mul_f32 v90, 0x3e0293ee, v90
    v_mul_f32 v91, 0x3e0293ee, v91
    v_mul_f32 v92, 0x3e0293ee, v92
    v_mul_f32 v93, 0x3e0293ee, v93
    v_mul_f32 v94, 0x3e0293ee, v94
    v_mul_f32 v95, 0x3e0293ee, v95
    v_cvt_pk_bf16_f32 v120, v80, v81
    v_cvt_pk_bf16_f32 v121, v82, v83
    v_cvt_pk_bf16_f32 v122, v84, v85
    v_cvt_pk_bf16_f32 v123, v86, v87
    v_cvt_pk_bf16_f32 v124, v88, v89
    v_cvt_pk_bf16_f32 v125, v90, v91
    v_cvt_pk_bf16_f32 v126, v92, v93
    v_cvt_pk_bf16_f32 v127, v94, v95
    s_cmp_ge_u32 s36, 22
    s_cbranch_scc1 K2_gu2A
    ds_read_b64_tr_b16 v[32:33], v24 offset:0
    ds_read_b64_tr_b16 v[34:35], v24 offset:768
    ds_read_b64_tr_b16 v[36:37], v24 offset:64
    ds_read_b64_tr_b16 v[38:39], v24 offset:832
    ds_read_b64_tr_b16 v[40:41], v24 offset:128
    ds_read_b64_tr_b16 v[42:43], v24 offset:896
    ds_read_b64_tr_b16 v[44:45], v24 offset:3072
    ds_read_b64_tr_b16 v[46:47], v24 offset:3840
    s_waitcnt lgkmcnt(6)
    v_mfma_f32_32x32x16_bf16 v[64:79], v[32:35], a[0:3], 0
    ds_read_b64_tr_b16 v[48:49], v24 offset:3136
    ds_read_b64_tr_b16 v[50:51], v24 offset:3904
    s_waitcnt lgkmcnt(6)
    v_mfma_f32_32x32x16_bf16 v[80:95], v[36:39], a[0:3], 0
    ds_read_b64_tr_b16 v[52:53], v24 offset:3200
    ds_read_b64_tr_b16 v[54:55], v24 offset:3968
    s_waitcnt lgkmcnt(6)
    v_mfma_f32_32x32x16_bf16 v[4:19], v[40:43], a[0:3], 0
    ds_read_b64_tr_b16 v[56:57], v24 offset:6144
    ds_read_b64_tr_b16 v[58:59], v24 offset:6912
    s_waitcnt lgkmcnt(6)
    v_mfma_f32_32x32x16_bf16 v[64:79], v[44:47], a[4:7], v[64:79]
    ds_read_b64_tr_b16 v[60:61], v24 offset:6208
    ds_read_b64_tr_b16 v[62:63], v24 offset:6976
    s_waitcnt lgkmcnt(6)
    v_mfma_f32_32x32x16_bf16 v[80:95], v[48:51], a[4:7], v[80:95]
    ds_read_b64_tr_b16 v[32:33], v24 offset:6272
    ds_read_b64_tr_b16 v[34:35], v24 offset:7040
    s_waitcnt lgkmcnt(6)
    v_mfma_f32_32x32x16_bf16 v[4:19], v[52:55], a[4:7], v[4:19]
    ds_read_b64_tr_b16 v[36:37], v24 offset:9216
    ds_read_b64_tr_b16 v[38:39], v24 offset:9984
    s_waitcnt lgkmcnt(6)
    v_mfma_f32_32x32x16_bf16 v[64:79], v[56:59], a[8:11], v[64:79]
    s_cmp_lg_u32 s3, 0
    s_cbranch_scc1 ON22
    s_waitcnt vmcnt(0)
    v_readfirstlane_b32 s38, v22
    s_cmp_ge_u32 s38, 8
    s_cbranch_scc1 SY1_ok
    s_mov_b32 s95, 0
    v_mov_b32 v23, 0
SP2:
    buffer_load_dword v22, v23, s[28:31], s45 offen sc1
    s_waitcnt vmcnt(0)
    v_readfirstlane_b32 s38, v22
    s_cmp_ge_u32 s38, 8
    s_cbranch_scc1 SP2_d
    s_add_u32 s95, s95, 1
    s_cmp_lt_u32 s95, 262144
    s_cbranch_scc1 SP2
SP2_d:
SY1_ok:
ON22:
    ds_read_b64_tr_b16 v[40:41], v24 offset:9280
    ds_read_b64_tr_b16 v[42:43], v24 offset:10048
    s_waitcnt lgkmcnt(6)
    v_mfma_f32_32x32x16_bf16 v[80:95], v[60:63], a[8:11], v[80:95]
    ds_read_b64_tr_b16 v[44:45], v24 offset:9344
    ds_read_b64_tr_b16 v[46:47], v24 offset:10112
    s_waitcnt lgkmcnt(6)
    v_mfma_f32_32x32x16_bf16 v[4:19], v[32:35], a[8:11], v[4:19]
    ds_read_b64_tr_b16 v[48:49], v24 offset:12288
    ds_read_b64_tr_b16 v[50:51], v24 offset:13056
    s_waitcnt lgkmcnt(6)
    v_mfma_f32_32x32x16_bf16 v[64:79], v[36:39], a[12:15], v[64:79]
    ds_read_b64_tr_b16 v[52:53], v24 offset:12352
    ds_read_b64_tr_b16 v[54:55], v24 offset:13120
    s_waitcnt lgkmcnt(6)
    v_mfma_f32_32x32x16_bf16 v[80:95], v[40:43], a[12:15], v[80:95]
    ds_read_b64_tr_b16 v[56:57], v24 offset:12416
    ds_read_b64_tr_b16 v[58:59], v24 offset:13184
    s_waitcnt lgkmcnt(6)
    v_mfma_f32_32x32x16_bf16 v[4:19], v[44:47], a[12:15], v[4:19]
    ds_read_b64_tr_b16 v[60:61], v24 offset:15360
    ds_read_b64_tr_b16 v[62:63], v24 offset:16128
    s_waitcnt lgkmcnt(6)
    v_mfma_f32_32x32x16_bf16 v[64:79], v[48:51], a[16:19], v[64:79]
    ds_read_b64_tr_b16 v[32:33], v24 offset:15424
    ds_read_b64_tr_b16 v[34:35], v24 offset:16192
    s_waitcnt lgkmcnt(6)
    v_mfma_f32_32x32x16_bf16 v[80:95], v[52:55], a[16:19], v[80:95]
    ds_read_b64_tr_b16 v[36:37], v24 offset:15488
    ds_read_b64_tr_b16 v[38:39], v24 offset:16256
    s_waitcnt lgkmcnt(6)
    v_mfma_f32_32x32x16_bf16 v[4:19], v[56:59], a[16:19], v[4:19]
    ds_read_b64_tr_b16 v[40:41], v24 offset:18432
    ds_read_b64_tr_b16 v[42:43], v24 offset:19200
    s_waitcnt lgkmcnt(6)
    v_mfma_f32_32x32x16_bf16 v[64:79], v[60:63], a[20:23], v[64:79]
    ds_read_b64_tr_b16 v[44:45], v24 offset:18496
    ds_read_b64_tr_b16 v[46:47], v24 offset:19264
    s_waitcnt lgkmcnt(6)
    v_mfma_f32_32x32x16_bf16 v[80:95], v[32:35], a[20:23], v[80:95]
    ds_read_b64_tr_b16 v[48:49], v24 offset:18560
    ds_read_b64_tr_b16 v[50:51], v24 offset:19328
    s_waitcnt lgkmcnt(6)
    v_mfma_f32_32x32x16_bf16 v[4:19], v[36:39], a[20:23], v[4:19]
    ds_read_b64_tr_b16 v[52:53], v24 offset:21504
    ds_read_b64_tr_b16 v[54:55], v24 offset:22272
    s_waitcnt lgkmcnt(6)
    v_mfma_f32_32x32x16_bf16 v[64:79], v[40:43], a[24:27], v[64:79]
    ds_read_b64_tr_b16 v[56:57], v24 offset:21568
    ds_read_b64_tr_b16 v[58:59], v24 offset:22336
    s_waitcnt lgkmcnt(6)
    v_mfma_f32_32x32x16_bf16 v[80:95], v[44:47], a[24:27], v[80:95]
    s_barrier
    ds_read_b64_tr_b16 v[60:61], v24 offset:21632
    ds_read_b64_tr_b16 v[62:63], v24 offset:22400
    s_waitcnt lgkmcnt(6)
    v_mfma_f32_32x32x16_bf16 v[4:19], v[48:51], a[24:27], v[4:19]
    ds_read_b64_tr_b16 v[32:33], v24 offset:24576
    ds_read_b64_tr_b16 v[34:35], v24 offset:25344
    s_add_u32 m0, s44, 0
    s_add_u32 s38, s60, 0
    buffer_load_dwordx4 v2, s[28:31], s38 offen offset:0 sc1 lds
    s_waitcnt lgkmcnt(6)
    v_mfma_f32_32x32x16_bf16 v[64:79], v[52:55], a[28:31], v[64:79]
    ds_read_b64_tr_b16 v[36:37], v24 offset:24640
    ds_read_b64_tr_b16 v[38:39], v24 offset:25408
    s_waitcnt lgkmcnt(6)
    v_mfma_f32_32x32x16_bf16 v[80:95], v[56:59], a[28:31], v[80:95]
    ds_read_b64_tr_b16 v[40:41], v24 offset:24704
    ds_read_b64_tr_b16 v[42:43], v24 offset:25472
    s_add_u32 m0, s44, 0
    s_add_u32 s38, s60, 0
    buffer_load_dwordx4 v2, s[28:31], s38 offen offset:1024 sc1 lds
    s_waitcnt lgkmcnt(6)
    v_mfma_f32_32x32x16_bf16 v[4:19], v[60:63], a[28:31], v[4:19]
    ds_read_b64_tr_b16 v[44:45], v24 offset:27648
    ds_read_b64_tr_b16 v[46:47], v24 offset:28416
    s_waitcnt lgkmcnt(6)
    v_mfma_f32_32x32x16_bf16 v[64:79], v[32:35], a[32:35], v[64:79]
    ds_read_b64_tr_b16 v[48:49], v24 offset:27712
    ds_read_b64_tr_b16 v[50:51], v24 offset:28480
    s_add_u32 m0, s44, 0
    s_add_u32 s38, s60, 0
    buffer_load_dwordx4 v2, s[28:31], s38 offen offset:2048 sc1 lds
    s_waitcnt lgkmcnt(6)
    v_mfma_f32_32x32x16_bf16 v[80:95], v[36:39], a[32:35], v[80:95]
    ds_read_b64_tr_b16 v[52:53], v24 offset:27776
    ds_read_b64_tr_b16 v[54:55], v24 offset:28544
    s_waitcnt lgkmcnt(6)
    v_mfma_f32_32x32x16_bf16 v[4:19], v[40:43], a[32:35], v[4:19]
    ds_read_b64_tr_b16 v[56:57], v24 offset:30720
    ds_read_b64_tr_b16 v[58:59], v24 offset:31488
    s_add_u32 m0, s44, 0
    s_add_u32 s38, s60, 0
    buffer_load_dwordx4 v2, s[28:31], s38 offen offset:3072 sc1 lds
    s_waitcnt lgkmcnt(6)
    v_mfma_f32_32x32x16_bf16 v[64:79], v[44:47], a[36:39], v[64:79]
    ds_read_b64_tr_b16 v[60:61], v24 offset:30784
    ds_read_b64_tr_b16 v[62:63], v24 offset:31552
    s_waitcnt lgkmcnt(6)
    v_mfma_f32_32x32x16_bf16 v[80:95], v[48:51], a[36:39], v[80:95]
    ds_read_b64_tr_b16 v[32:33], v24 offset:30848
    ds_read_b64_tr_b16 v[34:35], v24 offset:31616
    s_add_u32 m0, s44, 16384
    s_add_u32 s38, s60, 16384
    buffer_load_dwordx4 v2, s[28:31], s38 offen offset:0 sc1 lds
    s_waitcnt lgkmcnt(6)
    v_mfma_f32_32x32x16_bf16 v[4:19], v[52:55], a[36:39], v[4:19]
    ds_read_b64_tr_b16 v[36:37], v24 offset:33792
    ds_read_b64_tr_b16 v[38:39], v24 offset:34560
    s_waitcnt lgkmcnt(6)
    v_mfma_f32_32x32x16_bf16 v[64:79], v[56:59], a[40:43], v[64:79]
    ds_read_b64_tr_b16 v[40:41], v24 offset:33856
    ds_read_b64_tr_b16 v[42:43], v24 offset:34624
    s_add_u32 m0, s44, 16384
    s_add_u32 s38, s60, 16384
    buffer_load_dwordx4 v2, s[28:31], s38 offen offset:1024 sc1 lds
    s_waitcnt lgkmcnt(6)
    v_mfma_f32_32x32x16_bf16 v[80:95], v[60:63], a[40:43], v[80:95]
    ds_read_b64_tr_b16 v[44:45], v24 offset:33920
    ds_read_b64_tr_b16 v[46:47], v24 offset:34688
    s_waitcnt lgkmcnt(6)
    v_mfma_f32_32x32x16_bf16 v[4:19], v[32:35], a[40:43], v[4:19]
    ds_read_b64_tr_b16 v[48:49], v24 offset:36864
    ds_read_b64_tr_b16 v[50:51], v24 offset:37632
    s_add_u32 m0, s44, 16384
    s_add_u32 s38, s60, 16384
    buffer_load_dwordx4 v2, s[28:31], s38 offen offset:2048 sc1 lds
    s_waitcnt lgkmcnt(6)
    v_mfma_f32_32x32x16_bf16 v[64:79], v[36:39], a[44:47], v[64:79]
    ds_read_b64_tr_b16 v[52:53], v24 offset:36928
    ds_read_b64_tr_b16 v[54:55], v24 offset:37696
    s_waitcnt lgkmcnt(6)
    v_mfma_f32_32x32x16_bf16 v[80:95], v[40:43], a[44:47], v[80:95]
    ds_read_b64_tr_b16 v[56:57], v24 offset:36992
    ds_read_b64_tr_b16 v[58:59], v24 offset:37760
    s_add_u32 m0, s44, 16384
    s_add_u32 s38, s60, 16384
    buffer_load_dwordx4 v2, s[28:31], s38 offen offset:3072 sc1 lds
    s_waitcnt lgkmcnt(6)
    v_mfma_f32_32x32x16_bf16 v[4:19], v[44:47], a[44:47], v[4:19]
    ds_read_b64_tr_b16 v[60:61], v24 offset:39936
    ds_read_b64_tr_b16 v[62:63], v24 offset:40704
    s_waitcnt lgkmcnt(6)
    v_mfma_f32_32x32x16_bf16 v[64:79], v[48:51], a[48:51], v[64:79]
    ds_read_b64_tr_b16 v[32:33], v24 offset:40000
    ds_read_b64_tr_b16 v[34:35], v24 offset:40768
    s_add_u32 m0, s44, 49152
    s_add_u32 s38, s61, 0
    buffer_load_dwordx4 v2, s[28:31], s38 offen offset:0 sc1 lds
    s_waitcnt lgkmcnt(6)
    v_mfma_f32_32x32x16_bf16 v[80:95], v[52:55], a[48:51], v[80:95]
    ds_read_b64_tr_b16 v[36:37], v24 offset:40064
    ds_read_b64_tr_b16 v[38:39], v24 offset:40832
    s_waitcnt lgkmcnt(6)
    v_mfma_f32_32x32x16_bf16 v[4:19], v[56:59], a[48:51], v[4:19]
    ds_read_b64_tr_b16 v[40:41], v24 offset:43008
    ds_read_b64_tr_b16 v[42:43], v24 offset:43776
    s_add_u32 m0, s44, 49152
    s_add_u32 s38, s61, 0
    buffer_load_dwordx4 v2, s[28:31], s38 offen offset:1024 sc1 lds
    s_waitcnt lgkmcnt(6)
    v_mfma_f32_32x32x16_bf16 v[64:79], v[60:63], a[52:55], v[64:79]
    ds_read_b64_tr_b16 v[44:45], v24 offset:43072
    ds_read_b64_tr_b16 v[46:47], v24 offset:43840
    s_waitcnt lgkmcnt(6)
    v_mfma_f32_32x32x16_bf16 v[80:95], v[32:35], a[52:55], v[80:95]
    ds_read_b64_tr_b16 v[48:49], v24 offset:43136
    ds_read_b64_tr_b16 v[50:51], v24 offset:43904
    s_add_u32 m0, s44, 49152
    s_add_u32 s38, s61, 0
    buffer_load_dwordx4 v2, s[28:31], s38 offen offset:2048 sc1 lds
    s_waitcnt lgkmcnt(6)
    v_mfma_f32_32x32x16_bf16 v[4:19], v[36:39], a[52:55], v[4:19]
    ds_read_b64_tr_b16 v[52:53], v24 offset:46080
    ds_read_b64_tr_b16 v[54:55], v24 offset:46848
    s_waitcnt lgkmcnt(6)
    v_mfma_f32_32x32x16_bf16 v[64:79], v[40:43], a[56:59], v[64:79]
    ds_read_b64_tr_b16 v[56:57], v24 offset:46144
    ds_read_b64_tr_b16 v[58:59], v24 offset:46912
    s_add_u32 m0, s44, 49152
    s_add_u32 s38, s61, 0
    buffer_load_dwordx4 v2, s[28:31], s38 offen offset:3072 sc1 lds
    s_waitcnt lgkmcnt(6)
    v_mfma_f32_32x32x16_bf16 v[80:95], v[44:47], a[56:59], v[80:95]
    s_barrier
    ds_read_b64_tr_b16 v[60:61], v24 offset:46208
    ds_read_b64_tr_b16 v[62:63], v24 offset:46976
    s_waitcnt lgkmcnt(6)
    v_mfma_f32_32x32x16_bf16 v[4:19], v[48:51], a[56:59], v[4:19]
    ds_read_b64_tr_b16 v[32:33], v25 offset:0
    ds_read_b64_tr_b16 v[34:35], v25 offset:768
    s_add_u32 m0, s44, 32768
    s_add_u32 s38, s60, 32768
    buffer_load_dwordx4 v2, s[28:31], s38 offen offset:0 sc1 lds
    s_waitcnt lgkmcnt(6)
    v_mfma_f32_32x32x16_bf16 v[64:79], v[52:55], a[60:63], v[64:79]
    ds_read_b64_tr_b16 v[36:37], v25 offset:64
    ds_read_b64_tr_b16 v[38:39], v25 offset:832
    s_waitcnt lgkmcnt(6)
    v_mfma_f32_32x32x16_bf16 v[80:95], v[56:59], a[60:63], v[80:95]
    ds_read_b64_tr_b16 v[40:41], v25 offset:128
    ds_read_b64_tr_b16 v[42:43], v25 offset:896
    s_add_u32 m0, s44, 32768
    s_add_u32 s38, s60, 32768
    buffer_load_dwordx4 v2, s[28:31], s38 offen offset:1024 sc1 lds
    s_waitcnt lgkmcnt(6)
    v_mfma_f32_32x32x16_bf16 v[4:19], v[60:63], a[60:63], v[4:19]
    ds_read_b64_tr_b16 v[44:45], v25 offset:3072
    ds_read_b64_tr_b16 v[46:47], v25 offset:3840
    s_waitcnt lgkmcnt(6)
    v_mfma_f32_32x32x16_bf16 v[64:79], v[32:35], a[64:67], v[64:79]
    ds_read_b64_tr_b16 v[48:49], v25 offset:3136
    ds_read_b64_tr_b16 v[50:51], v25 offset:3904
    s_add_u32 m0, s44, 32768
    s_add_u32 s38, s60, 32768
    buffer_load_dwordx4 v2, s[28:31], s38 offen offset:2048 sc1 lds
    s_waitcnt lgkmcnt(6)
    v_mfma_f32_32x32x16_bf16 v[80:95], v[36:39], a[64:67], v[80:95]
    ds_read_b64_tr_b16 v[52:53], v25 offset:3200
    ds_read_b64_tr_b16 v[54:55], v25 offset:3968
    s_waitcnt lgkmcnt(6)
    v_mfma_f32_32x32x16_bf16 v[4:19], v[40:43], a[64:67], v[4:19]
    ds_read_b64_tr_b16 v[56:57], v25 offset:6144
    ds_read_b64_tr_b16 v[58:59], v25 offset:6912
    s_add_u32 m0, s44, 32768
    s_add_u32 s38, s60, 32768
    buffer_load_dwordx4 v2, s[28:31], s38 offen offset:3072 sc1 lds
    s_waitcnt lgkmcnt(6)
    v_mfma_f32_32x32x16_bf16 v[64:79], v[44:47], a[68:71], v[64:79]
    ds_read_b64_tr_b16 v[60:61], v25 offset:6208
    ds_read_b64_tr_b16 v[62:63], v25 offset:6976
    s_waitcnt lgkmcnt(6)
    v_mfma_f32_32x32x16_bf16 v[80:95], v[48:51], a[68:71], v[80:95]
    ds_read_b64_tr_b16 v[32:33], v25 offset:6272
    ds_read_b64_tr_b16 v[34:35], v25 offset:7040
    s_add_u32 m0, s44, 65536
    s_add_u32 s38, s61, 16384
    buffer_load_dwordx4 v2, s[28:31], s38 offen offset:0 sc1 lds
    s_waitcnt lgkmcnt(6)
    v_mfma_f32_32x32x16_bf16 v[4:19], v[52:55], a[68:71], v[4:19]
    ds_read_b64_tr_b16 v[36:37], v25 offset:9216
    ds_read_b64_tr_b16 v[38:39], v25 offset:9984
    s_waitcnt lgkmcnt(6)
    v_mfma_f32_32x32x16_bf16 v[64:79], v[56:59], a[72:75], v[64:79]
    ds_read_b64_tr_b16 v[40:41], v25 offset:9280
    ds_read_b64_tr_b16 v[42:43], v25 offset:10048
    s_add_u32 m0, s44, 65536
    s_add_u32 s38, s61, 16384
    buffer_load_dwordx4 v2, s[28:31], s38 offen offset:1024 sc1 lds
    s_waitcnt lgkmcnt(6)
    v_mfma_f32_32x32x16_bf16 v[80:95], v[60:63], a[72:75], v[80:95]
    ds_read_b64_tr_b16 v[44:45], v25 offset:9344
    ds_read_b64_tr_b16 v[46:47], v25 offset:10112
    s_waitcnt lgkmcnt(6)
    v_mfma_f32_32x32x16_bf16 v[4:19], v[32:35], a[72:75], v[4:19]
    ds_read_b64_tr_b16 v[48:49], v25 offset:12288
    ds_read_b64_tr_b16 v[50:51], v25 offset:13056
    s_add_u32 m0, s44, 65536
    s_add_u32 s38, s61, 16384
    buffer_load_dwordx4 v2, s[28:31], s38 offen offset:2048 sc1 lds
    s_waitcnt lgkmcnt(6)
    v_mfma_f32_32x32x16_bf16 v[64:79], v[36:39], a[76:79], v[64:79]
    ds_read_b64_tr_b16 v[52:53], v25 offset:12352
    ds_read_b64_tr_b16 v[54:55], v25 offset:13120
    s_waitcnt lgkmcnt(6)
    v_mfma_f32_32x32x16_bf16 v[80:95], v[40:43], a[76:79], v[80:95]
    ds_read_b64_tr_b16 v[56:57], v25 offset:12416
    ds_read_b64_tr_b16 v[58:59], v25 offset:13184
    s_add_u32 m0, s44, 65536
    s_add_u32 s38, s61, 16384
    buffer_load_dwordx4 v2, s[28:31], s38 offen offset:3072 sc1 lds
    s_waitcnt lgkmcnt(6)
    v_mfma_f32_32x32x16_bf16 v[4:19], v[44:47], a[76:79], v[4:19]
    ds_read_b64_tr_b16 v[60:61], v25 offset:15360
    ds_read_b64_tr_b16 v[62:63], v25 offset:16128
    s_waitcnt lgkmcnt(6)
    v_mfma_f32_32x32x16_bf16 v[64:79], v[48:51], a[80:83], v[64:79]
    ds_read_b64_tr_b16 v[32:33], v25 offset:15424
    ds_read_b64_tr_b16 v[34:35], v25 offset:16192
    s_waitcnt lgkmcnt(6)
    v_mfma_f32_32x32x16_bf16 v[80:95], v[52:55], a[80:83], v[80:95]
    ds_read_b64_tr_b16 v[36:37], v25 offset:15488
    ds_read_b64_tr_b16 v[38:39], v25 offset:16256
    s_waitcnt lgkmcnt(6)
    v_mfma_f32_32x32x16_bf16 v[4:19], v[56:59], a[80:83], v[4:19]
    ds_read_b64_tr_b16 v[40:41], v25 offset:18432
    ds_read_b64_tr_b16 v[42:43], v25 offset:19200
    s_waitcnt lgkmcnt(6)
    v_mfma_f32_32x32x16_bf16 v[64:79], v[60:63], a[84:87], v[64:79]
    ds_read_b64_tr_b16 v[44:45], v25 offset:18496
    ds_read_b64_tr_b16 v[46:47], v25 offset:19264
    s_waitcnt lgkmcnt(6)
    v_mfma_f32_32x32x16_bf16 v[80:95], v[32:35], a[84:87], v[80:95]
    ds_read_b64_tr_b16 v[48:49], v25 offset:18560
    ds_read_b64_tr_b16 v[50:51], v25 offset:19328
    s_waitcnt lgkmcnt(6)
    v_mfma_f32_32x32x16_bf16 v[4:19], v[36:39], a[84:87], v[4:19]
    ds_read_b64_tr_b16 v[52:53], v25 offset:21504
    ds_read_b64_tr_b16 v[54:55], v25 offset:22272
    s_waitcnt lgkmcnt(6)
    v_mfma_f32_32x32x16_bf16 v[64:79], v[40:43], a[88:91], v[64:79]
    ds_read_b64_tr_b16 v[56:57], v25 offset:21568
    ds_read_b64_tr_b16 v[58:59], v25 offset:22336
    s_waitcnt lgkmcnt(6)
    v_mfma_f32_32x32x16_bf16 v[80:95], v[44:47], a[88:91], v[80:95]
    ds_read_b64_tr_b16 v[60:61], v25 offset:21632
    ds_read_b64_tr_b16 v[62:63], v25 offset:22400
    s_waitcnt lgkmcnt(6)
    v_mfma_f32_32x32x16_bf16 v[4:19], v[48:51], a[88:91], v[4:19]
    ds_read_b64_tr_b16 v[32:33], v25 offset:24576
    ds_read_b64_tr_b16 v[34:35], v25 offset:25344
    s_waitcnt lgkmcnt(6)
    v_mfma_f32_32x32x16_bf16 v[64:79], v[52:55], a[92:95], v[64:79]
    ds_read_b64_tr_b16 v[36:37], v25 offset:24640
    ds_read_b64_tr_b16 v[38:39], v25 offset:25408
    s_waitcnt lgkmcnt(6)
    v_mfma_f32_32x32x16_bf16 v[80:95], v[56:59], a[92:95], v[80:95]
    ds_read_b64_tr_b16 v[40:41], v25 offset:24704
    ds_read_b64_tr_b16 v[42:43], v25 offset:25472
    s_waitcnt lgkmcnt(6)
    v_mfma_f32_32x32x16_bf16 v[4:19], v[60:63], a[92:95], v[4:19]
    ds_read_b64_tr_b16 v[44:45], v25 offset:27648
    ds_read_b64_tr_b16 v[46:47], v25 offset:28416
    s_waitcnt lgkmcnt(6)
    v_mfma_f32_32x32x16_bf16 v[64:79], v[32:35], a[96:99], v[64:79]
    ds_read_b64_tr_b16 v[48:49], v25 offset:27712
    ds_read_b64_tr_b16 v[50:51], v25 offset:28480
    s_waitcnt lgkmcnt(6)
    v_mfma_f32_32x32x16_bf16 v[80:95], v[36:39], a[96:99], v[80:95]
    ds_read_b64_tr_b16 v[52:53], v25 offset:27776
    ds_read_b64_tr_b16 v[54:55], v25 offset:28544
    s_waitcnt lgkmcnt(6)
    v_mfma_f32_32x32x16_bf16 v[4:19], v[40:43], a[96:99], v[4:19]
    ds_read_b64_tr_b16 v[56:57], v25 offset:30720
    ds_read_b64_tr_b16 v[58:59], v25 offset:31488
    s_waitcnt lgkmcnt(6)
    v_mfma_f32_32x32x16_bf16 v[64:79], v[44:47], a[100:103], v[64:79]
    ds_read_b64_tr_b16 v[60:61], v25 offset:30784
    ds_read_b64_tr_b16 v[62:63], v25 offset:31552
    s_waitcnt lgkmcnt(6)
    v_mfma_f32_32x32x16_bf16 v[80:95], v[48:51], a[100:103], v[80:95]
    ds_read_b64_tr_b16 v[32:33], v25 offset:30848
    ds_read_b64_tr_b16 v[34:35], v25 offset:31616
    s_waitcnt lgkmcnt(6)
    v_mfma_f32_32x32x16_bf16 v[4:19], v[52:55], a[100:103], v[4:19]
    ds_read_b64_tr_b16 v[36:37], v25 offset:33792
    ds_read_b64_tr_b16 v[38:39], v25 offset:34560
    s_waitcnt lgkmcnt(6)
    v_mfma_f32_32x32x16_bf16 v[64:79], v[56:59], a[104:107], v[64:79]
    ds_read_b64_tr_b16 v[40:41], v25 offset:33856
    ds_read_b64_tr_b16 v[42:43], v25 offset:34624
    s_waitcnt lgkmcnt(6)
    v_mfma_f32_32x32x16_bf16 v[80:95], v[60:63], a[104:107], v[80:95]
    ds_read_b64_tr_b16 v[44:45], v25 offset:33920
    ds_read_b64_tr_b16 v[46:47], v25 offset:34688
    s_waitcnt lgkmcnt(6)
    v_mfma_f32_32x32x16_bf16 v[4:19], v[32:35], a[104:107], v[4:19]
    ds_read_b64_tr_b16 v[48:49], v25 offset:36864
    ds_read_b64_tr_b16 v[50:51], v25 offset:37632
    s_waitcnt lgkmcnt(6)
    v_mfma_f32_32x32x16_bf16 v[64:79], v[36:39], a[108:111], v[64:79]
    ds_read_b64_tr_b16 v[52:53], v25 offset:36928
    ds_read_b64_tr_b16 v[54:55], v25 offset:37696
    s_waitcnt lgkmcnt(6)
    v_mfma_f32_32x32x16_bf16 v[80:95], v[40:43], a[108:111], v[80:95]
    ds_read_b64_tr_b16 v[56:57], v25 offset:36992
    ds_read_b64_tr_b16 v[58:59], v25 offset:37760
    s_waitcnt lgkmcnt(6)
    v_mfma_f32_32x32x16_bf16 v[4:19], v[44:47], a[108:111], v[4:19]
    ds_read_b64_tr_b16 v[60:61], v25 offset:39936
    ds_read_b64_tr_b16 v[62:63], v25 offset:40704
    s_waitcnt lgkmcnt(6)
    v_mfma_f32_32x32x16_bf16 v[64:79], v[48:51], a[112:115], v[64:79]
    ds_read_b64_tr_b16 v[32:33], v25 offset:40000
    ds_read_b64_tr_b16 v[34:35], v25 offset:40768
    s_waitcnt lgkmcnt(6)
    v_mfma_f32_32x32x16_bf16 v[80:95], v[52:55], a[112:115], v[80:95]
    ds_read_b64_tr_b16 v[36:37], v25 offset:40064
    ds_read_b64_tr_b16 v[38:39], v25 offset:40832
    s_waitcnt lgkmcnt(6)
    v_mfma_f32_32x32x16_bf16 v[4:19], v[56:59], a[112:115], v[4:19]
    ds_read_b64_tr_b16 v[40:41], v25 offset:43008
    ds_read_b64_tr_b16 v[42:43], v25 offset:43776
    s_waitcnt lgkmcnt(6)
    v_mfma_f32_32x32x16_bf16 v[64:79], v[60:63], a[116:119], v[64:79]
    ds_read_b64_tr_b16 v[44:45], v25 offset:43072
    ds_read_b64_tr_b16 v[46:47], v25 offset:43840
    s_waitcnt lgkmcnt(6)
    v_mfma_f32_32x32x16_bf16 v[80:95], v[32:35], a[116:119], v[80:95]
    ds_read_b64_tr_b16 v[48:49], v25 offset:43136
    ds_read_b64_tr_b16 v[50:51], v25 offset:43904
    s_waitcnt lgkmcnt(6)
    v_mfma_f32_32x32x16_bf16 v[4:19], v[36:39], a[116:119], v[4:19]
    ds_read_b64_tr_b16 v[52:53], v25 offset:46080
    ds_read_b64_tr_b16 v[54:55], v25 offset:46848
    s_waitcnt lgkmcnt(6)
    v_mfma_f32_32x32x16_bf16 v[64:79], v[40:43], a[120:123], v[64:79]
    ds_read_b64_tr_b16 v[56:57], v25 offset:46144
    ds_read_b64_tr_b16 v[58:59], v25 offset:46912
    s_waitcnt lgkmcnt(6)
    v_mfma_f32_32x32x16_bf16 v[80:95], v[44:47], a[120:123], v[80:95]
    ds_read_b64_tr_b16 v[60:61], v25 offset:46208
    ds_read_b64_tr_b16 v[62:63], v25 offset:46976
    s_waitcnt lgkmcnt(6)
    v_mfma_f32_32x32x16_bf16 v[4:19], v[48:51], a[120:123], v[4:19]
    s_waitcnt lgkmcnt(4)
    v_mfma_f32_32x32x16_bf16 v[64:79], v[52:55], a[124:127], v[64:79]
    s_waitcnt lgkmcnt(2)
    v_mfma_f32_32x32x16_bf16 v[80:95], v[56:59], a[124:127], v[80:95]
    s_waitcnt lgkmcnt(0)
    v_mfma_f32_32x32x16_bf16 v[4:19], v[60:63], a[124:127], v[4:19]
    s_nop 7
    v_mul_f32 v32, 0xbfb8aa3b, v64
    v_exp_f32 v32, v32
    v_mul_f32 v33, v64, v72
    v_add_f32 v32, 1.0, v32
    v_rcp_f32 v32, v32
    s_nop 0
    v_mul_f32 v64, v33, v32
    v_mul_f32 v36, 0xbfb8aa3b, v65
    v_exp_f32 v36, v36
    v_mul_f32 v37, v65, v73
    v_add_f32 v36, 1.0, v36
    v_rcp_f32 v36, v36
    s_nop 0
    v_mul_f32 v65, v37, v36
    v_mul_f32 v40, 0xbfb8aa3b, v66
    v_exp_f32 v40, v40
    v_mul_f32 v41, v66, v74
    v_add_f32 v40, 1.0, v40
    v_rcp_f32 v40, v40
    s_nop 0
    v_mul_f32 v66, v41, v40
    v_mul_f32 v44, 0xbfb8aa3b, v67
    v_exp_f32 v44, v44
    v_mul_f32 v45, v67, v75
    v_add_f32 v44, 1.0, v44
    v_rcp_f32 v44, v44
    s_nop 0
    v_mul_f32 v67, v45, v44
    v_mul_f32 v32, 0xbfb8aa3b, v68
    v_exp_f32 v32, v32
    v_mul_f32 v33, v68, v76
    v_add_f32 v32, 1.0, v32
    v_rcp_f32 v32, v32
    s_nop 0
    v_mul_f32 v68, v33, v32
    v_mul_f32 v36, 0xbfb8aa3b, v69
    v_exp_f32 v36, v36
    v_mul_f32 v37, v69, v77
    v_add_f32 v36, 1.0, v36
    v_rcp_f32 v36, v36
    s_nop 0
    v_mul_f32 v69, v37, v36
    v_mul_f32 v40, 0xbfb8aa3b, v70
    v_exp_f32 v40, v40
    v_mul_f32 v41, v70, v78
    v_add_f32 v40, 1.0, v40
    v_rcp_f32 v40, v40
    s_nop 0
    v_mul_f32 v70, v41, v40
    v_mul_f32 v44, 0xbfb8aa3b, v71
    v_exp_f32 v44, v44
    v_mul_f32 v45, v71, v79
    v_add_f32 v44, 1.0, v44
    v_rcp_f32 v44, v44
    s_nop 0
    v_mul_f32 v71, v45, v44
    v_cvt_pk_bf16_f32 v64, v64, v65
    v_cvt_pk_bf16_f32 v65, v66, v67
    v_cvt_pk_bf16_f32 v66, v68, v69
    v_cvt_pk_bf16_f32 v67, v70, v71
    v_mul_f32 v32, 0xbfb8aa3b, v80
    v_exp_f32 v32, v32
    v_mul_f32 v33, v80, v88
    v_add_f32 v32, 1.0, v32
    v_rcp_f32 v32, v32
    s_nop 0
    v_mul_f32 v80, v33, v32
    v_mul_f32 v36, 0xbfb8aa3b, v81
    v_exp_f32 v36, v36
    v_mul_f32 v37, v81, v89
    v_add_f32 v36, 1.0, v36
    v_rcp_f32 v36, v36
    s_nop 0
    v_mul_f32 v81, v37, v36
    v_mul_f32 v40, 0xbfb8aa3b, v82
    v_exp_f32 v40, v40
    v_mul_f32 v41, v82, v90
    v_add_f32 v40, 1.0, v40
    v_rcp_f32 v40, v40
    s_nop 0
    v_mul_f32 v82, v41, v40
    v_mul_f32 v44, 0xbfb8aa3b, v83
    v_exp_f32 v44, v44
    v_mul_f32 v45, v83, v91
    v_add_f32 v44, 1.0, v44
    v_rcp_f32 v44, v44
    s_nop 0
    v_mul_f32 v83, v45, v44
    v_mul_f32 v32, 0xbfb8aa3b, v84
    v_exp_f32 v32, v32
    v_mul_f32 v33, v84, v92
    v_add_f32 v32, 1.0, v32
    v_rcp_f32 v32, v32
    s_nop 0
    v_mul_f32 v84, v33, v32
    v_mul_f32 v36, 0xbfb8aa3b, v85
    v_exp_f32 v36, v36
    v_mul_f32 v37, v85, v93
    v_add_f32 v36, 1.0, v36
    v_rcp_f32 v36, v36
    s_nop 0
    v_mul_f32 v85, v37, v36
    v_mul_f32 v40, 0xbfb8aa3b, v86
    v_exp_f32 v40, v40
    v_mul_f32 v41, v86, v94
    v_add_f32 v40, 1.0, v40
    v_rcp_f32 v40, v40
    s_nop 0
    v_mul_f32 v86, v41, v40
    v_mul_f32 v44, 0xbfb8aa3b, v87
    v_exp_f32 v44, v44
    v_mul_f32 v45, v87, v95
    v_add_f32 v44, 1.0, v44
    v_rcp_f32 v44, v44
    s_nop 0
    v_mul_f32 v87, v45, v44
    v_cvt_pk_bf16_f32 v80, v80, v81
    v_cvt_pk_bf16_f32 v81, v82, v83
    v_cvt_pk_bf16_f32 v82, v84, v85
    v_cvt_pk_bf16_f32 v83, v86, v87
    v_mul_f32 v32, 0xbfb8aa3b, v4
    v_exp_f32 v32, v32
    v_mul_f32 v33, v4, v12
    v_add_f32 v32, 1.0, v32
    v_rcp_f32 v32, v32
    s_nop 0
    v_mul_f32 v4, v33, v32
    v_mul_f32 v36, 0xbfb8aa3b, v5
    v_exp_f32 v36, v36
    v_mul_f32 v37, v5, v13
    v_add_f32 v36, 1.0, v36
    v_rcp_f32 v36, v36
    s_nop 0
    v_mul_f32 v5, v37, v36
    v_mul_f32 v40, 0xbfb8aa3b, v6
    v_exp_f32 v40, v40
    v_mul_f32 v41, v6, v14
    v_add_f32 v40, 1.0, v40
    v_rcp_f32 v40, v40
    s_nop 0
    v_mul_f32 v6, v41, v40
    v_mul_f32 v44, 0xbfb8aa3b, v7
    v_exp_f32 v44, v44
    v_mul_f32 v45, v7, v15
    v_add_f32 v44, 1.0, v44
    v_rcp_f32 v44, v44
    s_nop 0
    v_mul_f32 v7, v45, v44
    v_mul_f32 v32, 0xbfb8aa3b, v8
    v_exp_f32 v32, v32
    v_mul_f32 v33, v8, v16
    v_add_f32 v32, 1.0, v32
    v_rcp_f32 v32, v32
    s_nop 0
    v_mul_f32 v8, v33, v32
    v_mul_f32 v36, 0xbfb8aa3b, v9
    v_exp_f32 v36, v36
    v_mul_f32 v37, v9, v17
    v_add_f32 v36, 1.0, v36
    v_rcp_f32 v36, v36
    s_nop 0
    v_mul_f32 v9, v37, v36
    v_mul_f32 v40, 0xbfb8aa3b, v10
    v_exp_f32 v40, v40
    v_mul_f32 v41, v10, v18
    v_add_f32 v40, 1.0, v40
    v_rcp_f32 v40, v40
    s_nop 0
    v_mul_f32 v10, v41, v40
    v_mul_f32 v44, 0xbfb8aa3b, v11
    v_exp_f32 v44, v44
    v_mul_f32 v45, v11, v19
    v_add_f32 v44, 1.0, v44
    v_rcp_f32 v44, v44
    s_nop 0
    v_mul_f32 v11, v45, v44
    v_cvt_pk_bf16_f32 v4, v4, v5
    v_cvt_pk_bf16_f32 v5, v6, v7
    v_cvt_pk_bf16_f32 v6, v8, v9
    v_cvt_pk_bf16_f32 v7, v10, v11
    buffer_store_dwordx4 v[64:67], v2, s[28:31], s43 offen offset:0 sc1
    buffer_store_dwordx4 v[80:83], v2, s[28:31], s43 offen offset:1024 sc1
    buffer_store_dwordx4 v[4:7], v2, s[28:31], s43 offen offset:2048 sc1
    s_branch K2_gudA
K2_gu2A:
    ds_read_b64_tr_b16 v[32:33], v24 offset:0
    ds_read_b64_tr_b16 v[34:35], v24 offset:768
    ds_read_b64_tr_b16 v[36:37], v24 offset:64
    ds_read_b64_tr_b16 v[38:39], v24 offset:832
    ds_read_b64_tr_b16 v[40:41], v24 offset:3072
    ds_read_b64_tr_b16 v[42:43], v24 offset:3840
    ds_read_b64_tr_b16 v[44:45], v24 offset:3136
    ds_read_b64_tr_b16 v[46:47], v24 offset:3904
    s_waitcnt lgkmcnt(6)
    v_mfma_f32_32x32x16_bf16 v[64:79], v[32:35], a[0:3], 0
    ds_read_b64_tr_b16 v[48:49], v24 offset:6144
    ds_read_b64_tr_b16 v[50:51], v24 offset:6912
    s_waitcnt lgkmcnt(6)
    v_mfma_f32_32x32x16_bf16 v[80:95], v[36:39], a[0:3], 0
    ds_read_b64_tr_b16 v[52:53], v24 offset:6208
    ds_read_b64_tr_b16 v[54:55], v24 offset:6976
    s_waitcnt lgkmcnt(6)
    v_mfma_f32_32x32x16_bf16 v[64:79], v[40:43], a[4:7], v[64:79]
    ds_read_b64_tr_b16 v[56:57], v24 offset:9216
    ds_read_b64_tr_b16 v[58:59], v24 offset:9984
    s_waitcnt lgkmcnt(6)
    v_mfma_f32_32x32x16_bf16 v[80:95], v[44:47], a[4:7], v[80:95]
    ds_read_b64_tr_b16 v[60:61], v24 offset:9280
    ds_read_b64_tr_b16 v[62:63], v24 offset:10048
    s_waitcnt lgkmcnt(6)
    v_mfma_f32_32x32x16_bf16 v[64:79], v[48:51], a[8:11], v[64:79]
    ds_read_b64_tr_b16 v[32:33], v24 offset:12288
    ds_read_b64_tr_b16 v[34:35], v24 offset:13056
    s_waitcnt lgkmcnt(6)
    v_mfma_f32_32x32x16_bf16 v[80:95], v[52:55], a[8:11], v[80:95]
    ds_read_b64_tr_b16 v[36:37], v24 offset:12352
    ds_read_b64_tr_b16 v[38:39], v24 offset:13120
    s_waitcnt lgkmcnt(6)
    v_mfma_f32_32x32x16_bf16 v[64:79], v[56:59], a[12:15], v[64:79]
    s_cmp_lg_u32 s3, 0
    s_cbranch_scc1 ON23
    s_waitcnt vmcnt(0)
    v_readfirstlane_b32 s38, v22
    s_cmp_ge_u32 s38, 8
    s_cbranch_scc1 SY3_ok
    s_mov_b32 s95, 0
    v_mov_b32 v23, 0
SP4:
    buffer_load_dword v22, v23, s[28:31], s45 offen sc1
    s_waitcnt vmcnt(0)
    v_readfirstlane_b32 s38, v22
    s_cmp_ge_u32 s38, 8
    s_cbranch_scc1 SP4_d
    s_add_u32 s95, s95, 1
    s_cmp_lt_u32 s95, 262144
    s_cbranch_scc1 SP4
SP4_d:
SY3_ok:
ON23:
    ds_read_b64_tr_b16 v[40:41], v24 offset:15360
    ds_read_b64_tr_b16 v[42:43], v24 offset:16128
    s_waitcnt lgkmcnt(6)
    v_mfma_f32_32x32x16_bf16 v[80:95], v[60:63], a[12:15], v[80:95]
    ds_read_b64_tr_b16 v[44:45], v24 offset:15424
    ds_read_b64_tr_b16 v[46:47], v24 offset:16192
    s_waitcnt lgkmcnt(6)
    v_mfma_f32_32x32x16_bf16 v[64:79], v[32:35], a[16:19], v[64:79]
    ds_read_b64_tr_b16 v[48:49], v24 offset:18432
    ds_read_b64_tr_b16 v[50:51], v24 offset:19200
    s_waitcnt lgkmcnt(6)
    v_mfma_f32_32x32x16_bf16 v[80:95], v[36:39], a[16:19], v[80:95]
    ds_read_b64_tr_b16 v[52:53], v24 offset:18496
    ds_read_b64_tr_b16 v[54:55], v24 offset:19264
    s_waitcnt lgkmcnt(6)
    v_mfma_f32_32x32x16_bf16 v[64:79], v[40:43], a[20:23], v[64:79]
    ds_read_b64_tr_b16 v[56:57], v24 offset:21504
    ds_read_b64_tr_b16 v[58:59], v24 offset:22272
    s_waitcnt lgkmcnt(6)
    v_mfma_f32_32x32x16_bf16 v[80:95], v[44:47], a[20:23], v[80:95]
    s_barrier
    ds_read_b64_tr_b16 v[60:61], v24 offset:21568
    ds_read_b64_tr_b16 v[62:63], v24 offset:22336
    s_waitcnt lgkmcnt(6)
    v_mfma_f32_32x32x16_bf16 v[64:79], v[48:51], a[24:27], v[64:79]
    ds_read_b64_tr_b16 v[32:33], v24 offset:24576
    ds_read_b64_tr_b16 v[34:35], v24 offset:25344
    s_add_u32 m0, s44, 0
    s_add_u32 s38, s60, 0
    buffer_load_dwordx4 v2, s[28:31], s38 offen offset:0 sc1 lds
    s_waitcnt lgkmcnt(6)
    v_mfma_f32_32x32x16_bf16 v[80:95], v[52:55], a[24:27], v[80:95]
    ds_read_b64_tr_b16 v[36:37], v24 offset:24640
    ds_read_b64_tr_b16 v[38:39], v24 offset:25408
    s_waitcnt lgkmcnt(6)
    v_mfma_f32_32x32x16_bf16 v[64:79], v[56:59], a[28:31], v[64:79]
    ds_read_b64_tr_b16 v[40:41], v24 offset:27648
    ds_read_b64_tr_b16 v[42:43], v24 offset:28416
    s_add_u32 m0, s44, 0
    s_add_u32 s38, s60, 0
    buffer_load_dwordx4 v2, s[28:31], s38 offen offset:1024 sc1 lds
    s_waitcnt lgkmcnt(6)
    v_mfma_f32_32x32x16_bf16 v[80:95], v[60:63], a[28:31], v[80:95]
    ds_read_b64_tr_b16 v[44:45], v24 offset:27712
    ds_read_b64_tr_b16 v[46:47], v24 offset:28480
    s_waitcnt lgkmcnt(6)
    v_mfma_f32_32x32x16_bf16 v[64:79], v[32:35], a[32:35], v[64:79]
    ds_read_b64_tr_b16 v[48:49], v24 offset:30720
    ds_read_b64_tr_b16 v[50:51], v24 offset:31488
    s_add_u32 m0, s44, 0
    s_add_u32 s38, s60, 0
    buffer_load_dwordx4 v2, s[28:31], s38 offen offset:2048 sc1 lds
    s_waitcnt lgkmcnt(6)
    v_mfma_f32_32x32x16_bf16 v[80:95], v[36:39], a[32:35], v[80:95]
    ds_read_b64_tr_b16 v[52:53], v24 offset:30784
    ds_read_b64_tr_b16 v[54:55], v24 offset:31552
    s_waitcnt lgkmcnt(6)
    v_mfma_f32_32x32x16_bf16 v[64:79], v[40:43], a[36:39], v[64:79]
    ds_read_b64_tr_b16 v[56:57], v24 offset:33792
    ds_read_b64_tr_b16 v[58:59], v24 offset:34560
    s_add_u32 m0, s44, 0
    s_add_u32 s38, s60, 0
    buffer_load_dwordx4 v2, s[28:31], s38 offen offset:3072 sc1 lds
    s_waitcnt lgkmcnt(6)
    v_mfma_f32_32x32x16_bf16 v[80:95], v[44:47], a[36:39], v[80:95]
    ds_read_b64_tr_b16 v[60:61], v24 offset:33856
    ds_read_b64_tr_b16 v[62:63], v24 offset:34624
    s_waitcnt lgkmcnt(6)
    v_mfma_f32_32x32x16_bf16 v[64:79], v[48:51], a[40:43], v[64:79]
    ds_read_b64_tr_b16 v[32:33], v24 offset:36864
    ds_read_b64_tr_b16 v[34:35], v24 offset:37632
    s_add_u32 m0, s44, 16384
    s_add_u32 s38, s60, 16384
    buffer_load_dwordx4 v2, s[28:31], s38 offen offset:0 sc1 lds
    s_waitcnt lgkmcnt(6)
    v_mfma_f32_32x32x16_bf16 v[80:95], v[52:55], a[40:43], v[80:95]
    ds_read_b64_tr_b16 v[36:37], v24 offset:36928
    ds_read_b64_tr_b16 v[38:39], v24 offset:37696
    s_waitcnt lgkmcnt(6)
    v_mfma_f32_32x32x16_bf16 v[64:79], v[56:59], a[44:47], v[64:79]
    ds_read_b64_tr_b16 v[40:41], v24 offset:39936
    ds_read_b64_tr_b16 v[42:43], v24 offset:40704
    s_add_u32 m0, s44, 16384
    s_add_u32 s38, s60, 16384
    buffer_load_dwordx4 v2, s[28:31], s38 offen offset:1024 sc1 lds
    s_waitcnt lgkmcnt(6)
    v_mfma_f32_32x32x16_bf16 v[80:95], v[60:63], a[44:47], v[80:95]
    ds_read_b64_tr_b16 v[44:45], v24 offset:40000
    ds_read_b64_tr_b16 v[46:47], v24 offset:40768
    s_waitcnt lgkmcnt(6)
    v_mfma_f32_32x32x16_bf16 v[64:79], v[32:35], a[48:51], v[64:79]
    ds_read_b64_tr_b16 v[48:49], v24 offset:43008
    ds_read_b64_tr_b16 v[50:51], v24 offset:43776
    s_add_u32 m0, s44, 16384
    s_add_u32 s38, s60, 16384
    buffer_load_dwordx4 v2, s[28:31], s38 offen offset:2048 sc1 lds
    s_waitcnt lgkmcnt(6)
    v_mfma_f32_32x32x16_bf16 v[80:95], v[36:39], a[48:51], v[80:95]
    ds_read_b64_tr_b16 v[52:53], v24 offset:43072
    ds_read_b64_tr_b16 v[54:55], v24 offset:43840
    s_waitcnt lgkmcnt(6)
    v_mfma_f32_32x32x16_bf16 v[64:79], v[40:43], a[52:55], v[64:79]
    ds_read_b64_tr_b16 v[56:57], v24 offset:46080
    ds_read_b64_tr_b16 v[58:59], v24 offset:46848
    s_add_u32 m0, s44, 16384
    s_add_u32 s38, s60, 16384
    buffer_load_dwordx4 v2, s[28:31], s38 offen offset:3072 sc1 lds
    s_waitcnt lgkmcnt(6)
    v_mfma_f32_32x32x16_bf16 v[80:95], v[44:47], a[52:55], v[80:95]
    s_barrier
    ds_read_b64_tr_b16 v[60:61], v24 offset:46144
    ds_read_b64_tr_b16 v[62:63], v24 offset:46912
    s_waitcnt lgkmcnt(6)
    v_mfma_f32_32x32x16_bf16 v[64:79], v[48:51], a[56:59], v[64:79]
    ds_read_b64_tr_b16 v[32:33], v25 offset:0
    ds_read_b64_tr_b16 v[34:35], v25 offset:768
    s_add_u32 m0, s44, 49152
    s_add_u32 s38, s61, 0
    buffer_load_dwordx4 v2, s[28:31], s38 offen offset:0 sc1 lds
    s_waitcnt lgkmcnt(6)
    v_mfma_f32_32x32x16_bf16 v[80:95], v[52:55], a[56:59], v[80:95]
    ds_read_b64_tr_b16 v[36:37], v25 offset:64
    ds_read_b64_tr_b16 v[38:39], v25 offset:832
    s_waitcnt lgkmcnt(6)
    v_mfma_f32_32x32x16_bf16 v[64:79], v[56:59], a[60:63], v[64:79]
    ds_read_b64_tr_b16 v[40:41], v25 offset:3072
    ds_read_b64_tr_b16 v[42:43], v25 offset:3840
    s_add_u32 m0, s44, 49152
    s_add_u32 s38, s61, 0
    buffer_load_dwordx4 v2, s[28:31], s38 offen offset:1024 sc1 lds
    s_waitcnt lgkmcnt(6)
    v_mfma_f32_32x32x16_bf16 v[80:95], v[60:63], a[60:63], v[80:95]
    ds_read_b64_tr_b16 v[44:45], v25 offset:3136
    ds_read_b64_tr_b16 v[46:47], v25 offset:3904
    s_waitcnt lgkmcnt(6)
    v_mfma_f32_32x32x16_bf16 v[64:79], v[32:35], a[64:67], v[64:79]
    ds_read_b64_tr_b16 v[48:49], v25 offset:6144
    ds_read_b64_tr_b16 v[50:51], v25 offset:6912
    s_add_u32 m0, s44, 49152
    s_add_u32 s38, s61, 0
    buffer_load_dwordx4 v2, s[28:31], s38 offen offset:2048 sc1 lds
    s_waitcnt lgkmcnt(6)
    v_mfma_f32_32x32x16_bf16 v[80:95], v[36:39], a[64:67], v[80:95]
    ds_read_b64_tr_b16 v[52:53], v25 offset:6208
    ds_read_b64_tr_b16 v[54:55], v25 offset:6976
    s_waitcnt lgkmcnt(6)
    v_mfma_f32_32x32x16_bf16 v[64:79], v[40:43], a[68:71], v[64:79]
    ds_read_b64_tr_b16 v[56:57], v25 offset:9216
    ds_read_b64_tr_b16 v[58:59], v25 offset:9984
    s_add_u32 m0, s44, 49152
    s_add_u32 s38, s61, 0
    buffer_load_dwordx4 v2, s[28:31], s38 offen offset:3072 sc1 lds
    s_waitcnt lgkmcnt(6)
    v_mfma_f32_32x32x16_bf16 v[80:95], v[44:47], a[68:71], v[80:95]
    ds_read_b64_tr_b16 v[60:61], v25 offset:9280
    ds_read_b64_tr_b16 v[62:63], v25 offset:10048
    s_waitcnt lgkmcnt(6)
    v_mfma_f32_32x32x16_bf16 v[64:79], v[48:51], a[72:75], v[64:79]
    ds_read_b64_tr_b16 v[32:33], v25 offset:12288
    ds_read_b64_tr_b16 v[34:35], v25 offset:13056
    s_add_u32 m0, s44, 32768
    s_add_u32 s38, s60, 32768
    buffer_load_dwordx4 v2, s[28:31], s38 offen offset:0 sc1 lds
    s_waitcnt lgkmcnt(6)
    v_mfma_f32_32x32x16_bf16 v[80:95], v[52:55], a[72:75], v[80:95]
    ds_read_b64_tr_b16 v[36:37], v25 offset:12352
    ds_read_b64_tr_b16 v[38:39], v25 offset:13120
    s_waitcnt lgkmcnt(6)
    v_mfma_f32_32x32x16_bf16 v[64:79], v[56:59], a[76:79], v[64:79]
    ds_read_b64_tr_b16 v[40:41], v25 offset:15360
    ds_read_b64_tr_b16 v[42:43], v25 offset:16128
    s_add_u32 m0, s44, 32768
    s_add_u32 s38, s60, 32768
    buffer_load_dwordx4 v2, s[28:31], s38 offen offset:1024 sc1 lds
    s_waitcnt lgkmcnt(6)
    v_mfma_f32_32x32x16_bf16 v[80:95], v[60:63], a[76:79], v[80:95]
    ds_read_b64_tr_b16 v[44:45], v25 offset:15424
    ds_read_b64_tr_b16 v[46:47], v25 offset:16192
    s_waitcnt lgkmcnt(6)
    v_mfma_f32_32x32x16_bf16 v[64:79], v[32:35], a[80:83], v[64:79]
    ds_read_b64_tr_b16 v[48:49], v25 offset:18432
    ds_read_b64_tr_b16 v[50:51], v25 offset:19200
    s_add_u32 m0, s44, 32768
    s_add_u32 s38, s60, 32768
    buffer_load_dwordx4 v2, s[28:31], s38 offen offset:2048 sc1 lds
    s_waitcnt lgkmcnt(6)
    v_mfma_f32_32x32x16_bf16 v[80:95], v[36:39], a[80:83], v[80:95]
    ds_read_b64_tr_b16 v[52:53], v25 offset:18496
    ds_read_b64_tr_b16 v[54:55], v25 offset:19264
    s_waitcnt lgkmcnt(6)
    v_mfma_f32_32x32x16_bf16 v[64:79], v[40:43], a[84:87], v[64:79]
    ds_read_b64_tr_b16 v[56:57], v25 offset:21504
    ds_read_b64_tr_b16 v[58:59], v25 offset:22272
    s_add_u32 m0, s44, 32768
    s_add_u32 s38, s60, 32768
    buffer_load_dwordx4 v2, s[28:31], s38 offen offset:3072 sc1 lds
    s_waitcnt lgkmcnt(6)
    v_mfma_f32_32x32x16_bf16 v[80:95], v[44:47], a[84:87], v[80:95]
    ds_read_b64_tr_b16 v[60:61], v25 offset:21568
    ds_read_b64_tr_b16 v[62:63], v25 offset:22336
    s_waitcnt lgkmcnt(6)
    v_mfma_f32_32x32x16_bf16 v[64:79], v[48:51], a[88:91], v[64:79]
    ds_read_b64_tr_b16 v[32:33], v25 offset:24576
    ds_read_b64_tr_b16 v[34:35], v25 offset:25344
    s_add_u32 m0, s44, 65536
    s_add_u32 s38, s61, 16384
    buffer_load_dwordx4 v2, s[28:31], s38 offen offset:0 sc1 lds
    s_waitcnt lgkmcnt(6)
    v_mfma_f32_32x32x16_bf16 v[80:95], v[52:55], a[88:91], v[80:95]
    ds_read_b64_tr_b16 v[36:37], v25 offset:24640
    ds_read_b64_tr_b16 v[38:39], v25 offset:25408
    s_waitcnt lgkmcnt(6)
    v_mfma_f32_32x32x16_bf16 v[64:79], v[56:59], a[92:95], v[64:79]
    ds_read_b64_tr_b16 v[40:41], v25 offset:27648
    ds_read_b64_tr_b16 v[42:43], v25 offset:28416
    s_add_u32 m0, s44, 65536
    s_add_u32 s38, s61, 16384
    buffer_load_dwordx4 v2, s[28:31], s38 offen offset:1024 sc1 lds
    s_waitcnt lgkmcnt(6)
    v_mfma_f32_32x32x16_bf16 v[80:95], v[60:63], a[92:95], v[80:95]
    ds_read_b64_tr_b16 v[44:45], v25 offset:27712
    ds_read_b64_tr_b16 v[46:47], v25 offset:28480
    s_waitcnt lgkmcnt(6)
    v_mfma_f32_32x32x16_bf16 v[64:79], v[32:35], a[96:99], v[64:79]
    ds_read_b64_tr_b16 v[48:49], v25 offset:30720
    ds_read_b64_tr_b16 v[50:51], v25 offset:31488
    s_add_u32 m0, s44, 65536
    s_add_u32 s38, s61, 16384
    buffer_load_dwordx4 v2, s[28:31], s38 offen offset:2048 sc1 lds
    s_waitcnt lgkmcnt(6)
    v_mfma_f32_32x32x16_bf16 v[80:95], v[36:39], a[96:99], v[80:95]
    ds_read_b64_tr_b16 v[52:53], v25 offset:30784
    ds_read_b64_tr_b16 v[54:55], v25 offset:31552
    s_waitcnt lgkmcnt(6)
    v_mfma_f32_32x32x16_bf16 v[64:79], v[40:43], a[100:103], v[64:79]
    ds_read_b64_tr_b16 v[56:57], v25 offset:33792
    ds_read_b64_tr_b16 v[58:59], v25 offset:34560
    s_add_u32 m0, s44, 65536
    s_add_u32 s38, s61, 16384
    buffer_load_dwordx4 v2, s[28:31], s38 offen offset:3072 sc1 lds
    s_waitcnt lgkmcnt(6)
    v_mfma_f32_32x32x16_bf16 v[80:95], v[44:47], a[100:103], v[80:95]
    ds_read_b64_tr_b16 v[60:61], v25 offset:33856
    ds_read_b64_tr_b16 v[62:63], v25 offset:34624
    s_waitcnt lgkmcnt(6)
    v_mfma_f32_32x32x16_bf16 v[64:79], v[48:51], a[104:107], v[64:79]
    ds_read_b64_tr_b16 v[32:33], v25 offset:36864
    ds_read_b64_tr_b16 v[34:35], v25 offset:37632
    s_waitcnt lgkmcnt(6)
    v_mfma_f32_32x32x16_bf16 v[80:95], v[52:55], a[104:107], v[80:95]
    ds_read_b64_tr_b16 v[36:37], v25 offset:36928
    ds_read_b64_tr_b16 v[38:39], v25 offset:37696
    s_waitcnt lgkmcnt(6)
    v_mfma_f32_32x32x16_bf16 v[64:79], v[56:59], a[108:111], v[64:79]
    ds_read_b64_tr_b16 v[40:41], v25 offset:39936
    ds_read_b64_tr_b16 v[42:43], v25 offset:40704
    s_waitcnt lgkmcnt(6)
    v_mfma_f32_32x32x16_bf16 v[80:95], v[60:63], a[108:111], v[80:95]
    ds_read_b64_tr_b16 v[44:45], v25 offset:40000
    ds_read_b64_tr_b16 v[46:47], v25 offset:40768
    s_waitcnt lgkmcnt(6)
    v_mfma_f32_32x32x16_bf16 v[64:79], v[32:35], a[112:115], v[64:79]
    ds_read_b64_tr_b16 v[48:49], v25 offset:43008
    ds_read_b64_tr_b16 v[50:51], v25 offset:43776
    s_waitcnt lgkmcnt(6)
    v_mfma_f32_32x32x16_bf16 v[80:95], v[36:39], a[112:115], v[80:95]
    ds_read_b64_tr_b16 v[52:53], v25 offset:43072
    ds_read_b64_tr_b16 v[54:55], v25 offset:43840
    s_waitcnt lgkmcnt(6)
    v_mfma_f32_32x32x16_bf16 v[64:79], v[40:43], a[116:119], v[64:79]
    ds_read_b64_tr_b16 v[56:57], v25 offset:46080
    ds_read_b64_tr_b16 v[58:59], v25 offset:46848
    s_waitcnt lgkmcnt(6)
    v_mfma_f32_32x32x16_bf16 v[80:95], v[44:47], a[116:119], v[80:95]
    ds_read_b64_tr_b16 v[60:61], v25 offset:46144
    ds_read_b64_tr_b16 v[62:63], v25 offset:46912
    s_waitcnt lgkmcnt(6)
    v_mfma_f32_32x32x16_bf16 v[64:79], v[48:51], a[120:123], v[64:79]
    s_waitcnt lgkmcnt(4)
    v_mfma_f32_32x32x16_bf16 v[80:95], v[52:55], a[120:123], v[80:95]
    s_waitcnt lgkmcnt(2)
    v_mfma_f32_32x32x16_bf16 v[64:79], v[56:59], a[124:127], v[64:79]
    s_waitcnt lgkmcnt(0)
    v_mfma_f32_32x32x16_bf16 v[80:95], v[60:63], a[124:127], v[80:95]
    s_nop 9
    v_mul_f32 v32, 0xbfb8aa3b, v64
    v_exp_f32 v32, v32
    v_mul_f32 v33, v64, v72
    v_add_f32 v32, 1.0, v32
    v_rcp_f32 v32, v32
    s_nop 0
    v_mul_f32 v64, v33, v32
    v_mul_f32 v36, 0xbfb8aa3b, v65
    v_exp_f32 v36, v36
    v_mul_f32 v37, v65, v73
    v_add_f32 v36, 1.0, v36
    v_rcp_f32 v36, v36
    s_nop 0
    v_mul_f32 v65, v37, v36
    v_mul_f32 v40, 0xbfb8aa3b, v66
    v_exp_f32 v40, v40
    v_mul_f32 v41, v66, v74
    v_add_f32 v40, 1.0, v40
    v_rcp_f32 v40, v40
    s_nop 0
    v_mul_f32 v66, v41, v40
    v_mul_f32 v44, 0xbfb8aa3b, v67
    v_exp_f32 v44, v44
    v_mul_f32 v45, v67, v75
    v_add_f32 v44, 1.0, v44
    v_rcp_f32 v44, v44
    s_nop 0
    v_mul_f32 v67, v45, v44
    v_mul_f32 v32, 0xbfb8aa3b, v68
    v_exp_f32 v32, v32
    v_mul_f32 v33, v68, v76
    v_add_f32 v32, 1.0, v32
    v_rcp_f32 v32, v32
    s_nop 0
    v_mul_f32 v68, v33, v32
    v_mul_f32 v36, 0xbfb8aa3b, v69
    v_exp_f32 v36, v36
    v_mul_f32 v37, v69, v77
    v_add_f32 v36, 1.0, v36
    v_rcp_f32 v36, v36
    s_nop 0
    v_mul_f32 v69, v37, v36
    v_mul_f32 v40, 0xbfb8aa3b, v70
    v_exp_f32 v40, v40
    v_mul_f32 v41, v70, v78
    v_add_f32 v40, 1.0, v40
    v_rcp_f32 v40, v40
    s_nop 0
    v_mul_f32 v70, v41, v40
    v_mul_f32 v44, 0xbfb8aa3b, v71
    v_exp_f32 v44, v44
    v_mul_f32 v45, v71, v79
    v_add_f32 v44, 1.0, v44
    v_rcp_f32 v44, v44
    s_nop 0
    v_mul_f32 v71, v45, v44
    v_cvt_pk_bf16_f32 v64, v64, v65
    v_cvt_pk_bf16_f32 v65, v66, v67
    v_cvt_pk_bf16_f32 v66, v68, v69
    v_cvt_pk_bf16_f32 v67, v70, v71
    v_mul_f32 v32, 0xbfb8aa3b, v80
    v_exp_f32 v32, v32
    v_mul_f32 v33, v80, v88
    v_add_f32 v32, 1.0, v32
    v_rcp_f32 v32, v32
    s_nop 0
    v_mul_f32 v80, v33, v32
    v_mul_f32 v36, 0xbfb8aa3b, v81
    v_exp_f32 v36, v36
    v_mul_f32 v37, v81, v89
    v_add_f32 v36, 1.0, v36
    v_rcp_f32 v36, v36
    s_nop 0
    v_mul_f32 v81, v37, v36
    v_mul_f32 v40, 0xbfb8aa3b, v82
    v_exp_f32 v40, v40
    v_mul_f32 v41, v82, v90
    v_add_f32 v40, 1.0, v40
    v_rcp_f32 v40, v40
    s_nop 0
    v_mul_f32 v82, v41, v40
    v_mul_f32 v44, 0xbfb8aa3b, v83
    v_exp_f32 v44, v44
    v_mul_f32 v45, v83, v91
    v_add_f32 v44, 1.0, v44
    v_rcp_f32 v44, v44
    s_nop 0
    v_mul_f32 v83, v45, v44
    v_mul_f32 v32, 0xbfb8aa3b, v84
    v_exp_f32 v32, v32
    v_mul_f32 v33, v84, v92
    v_add_f32 v32, 1.0, v32
    v_rcp_f32 v32, v32
    s_nop 0
    v_mul_f32 v84, v33, v32
    v_mul_f32 v36, 0xbfb8aa3b, v85
    v_exp_f32 v36, v36
    v_mul_f32 v37, v85, v93
    v_add_f32 v36, 1.0, v36
    v_rcp_f32 v36, v36
    s_nop 0
    v_mul_f32 v85, v37, v36
    v_mul_f32 v40, 0xbfb8aa3b, v86
    v_exp_f32 v40, v40
    v_mul_f32 v41, v86, v94
    v_add_f32 v40, 1.0, v40
    v_rcp_f32 v40, v40
    s_nop 0
    v_mul_f32 v86, v41, v40
    v_mul_f32 v44, 0xbfb8aa3b, v87
    v_exp_f32 v44, v44
    v_mul_f32 v45, v87, v95
    v_add_f32 v44, 1.0, v44
    v_rcp_f32 v44, v44
    s_nop 0
    v_mul_f32 v87, v45, v44
    v_cvt_pk_bf16_f32 v80, v80, v81
    v_cvt_pk_bf16_f32 v81, v82, v83
    v_cvt_pk_bf16_f32 v82, v84, v85
    v_cvt_pk_bf16_f32 v83, v86, v87
    buffer_store_dwordx4 v[64:67], v2, s[28:31], s43 offen offset:0 sc1
    buffer_store_dwordx4 v[80:83], v2, s[28:31], s43 offen offset:1024 sc1
K2_gudA:
    v_accvgpr_write_b32 a64, v104
    v_accvgpr_write_b32 a65, v105
    v_accvgpr_write_b32 a66, v106
    v_accvgpr_write_b32 a67, v107
    v_accvgpr_write_b32 a68, v108
    v_accvgpr_write_b32 a69, v109
    v_accvgpr_write_b32 a70, v110
    v_accvgpr_write_b32 a71, v111
    v_accvgpr_write_b32 a72, v120
    v_accvgpr_write_b32 a73, v121
    v_accvgpr_write_b32 a74, v122
    v_accvgpr_write_b32 a75, v123
    v_accvgpr_write_b32 a76, v124
    v_accvgpr_write_b32 a77, v125
    v_accvgpr_write_b32 a78, v126
    v_accvgpr_write_b32 a79, v127
    v_accvgpr_write_b32 a80, v96
    v_accvgpr_write_b32 a81, v97
    v_accvgpr_write_b32 a82, v98
    v_accvgpr_write_b32 a83, v99
    v_accvgpr_write_b32 a84, v100
    v_accvgpr_write_b32 a85, v101
    v_accvgpr_write_b32 a86, v102
    v_accvgpr_write_b32 a87, v103
    v_accvgpr_write_b32 a88, v112
    v_accvgpr_write_b32 a89, v113
    v_accvgpr_write_b32 a90, v114
    v_accvgpr_write_b32 a91, v115
    v_accvgpr_write_b32 a92, v116
    v_accvgpr_write_b32 a93, v117
    v_accvgpr_write_b32 a94, v118
    v_accvgpr_write_b32 a95, v119
    v_mov_b32 v93, v2
    v_mov_b32 v99, v2
    v_and_b32 v3, 31, v1
    v_lshrrev_b32 v4, 5, v1
    v_lshlrev_b32 v4, 2, v4
    v_sub_u32 v3, v3, v4
    s_lshl_b32 s38, s64, 5
    v_add_u32 v3, s38, v3
    v_cvt_f32_i32 v3, v3
    v_add_f32 v3, 0.5, v3
    v_mul_f32 v94, 0x6c800000, v3
    v_mov_b32 v90, v93
    v_add_u32 v92, 49152, v93
    s_mov_b32 s45, s44
    s_add_u32 s46, s44, 81920
    s_mov_b32 s40, 0
    s_mov_b32 s41, 49152
    s_mov_b32 s47, 0x46800000
    s_mov_b32 s62, 0x80000000
    s_add_u32 s60, s60, 49152
    s_add_u32 s61, s61, 32768
    s_mov_b32 s58, 3
    s_mov_b32 s43, s60
    s_mov_b32 s44, s61
    s_and_b32 s48, s2, 7
    s_lshr_b32 s49, s2, 5
    s_lshr_b32 s50, s2, 3
    s_and_b32 s50, s50, 3
    s_lshl_b32 s38, s48, 2
    s_mul_i32 s39, s38, 3
    s_lshl_b32 s53, s38, 1
    s_add_u32 s53, s53, 22
    s_cmp_lt_u32 s38, 22
    s_cselect_b32 s51, s39, s53
    s_lshl_b32 s52, s50, 8
    s_mov_b32 s68, s14
    s_and_b32 s69, s15, 0xffff
    s_mov_b32 s70, 4194304
    s_mov_b32 s71, 0x20000
    s_mov_b32 s72, s22
    s_and_b32 s73, s23, 0xffff
    s_mov_b32 s74, 1409024
    s_mov_b32 s75, 0x20000
    v_lshrrev_b32 v12, 5, v1
    v_lshlrev_b32 v12, 2, v12
    v_bfe_u32 v13, v1, 2, 2
    v_add_u32 v12, v12, v13
    v_lshlrev_b32 v12, 8, v12
    v_bfe_u32 v4, v1, 4, 1
    v_lshlrev_b32 v4, 5, v4
    v_add_u32 v12, v12, v4
    v_and_b32 v4, 3, v1
    v_lshlrev_b32 v4, 3, v4
    v_add_u32 v12, v12, v4
    v_xor_b32 v4, 0, v13
    v_lshlrev_b32 v4, 6, v4
    v_add_u32 v4, v4, v12
    v_xor_b32 v5, 1, v13
    v_lshlrev_b32 v5, 6, v5
    v_add_u32 v5, v5, v12
    v_xor_b32 v6, 2, v13
    v_lshlrev_b32 v6, 6, v6
    v_add_u32 v6, v6, v12
    v_xor_b32 v7, 3, v13
    v_lshlrev_b32 v7, 6, v7
    v_add_u32 v7, v7, v12
    v_lshrrev_b32 v12, 4, v1
    v_bfe_u32 v13, v1, 2, 2
    v_xor_b32 v13, v13, v12
    v_lshlrev_b32 v13, 6, v13
    v_and_b32 v8, 3, v1
    v_lshlrev_b32 v8, 4, v8
    v_add_u32 v13, v13, v8
    v_mul_u32_u24 v12, 1024, v12
    v_add_u32 v8, v12, v13
    v_add_u32 v9, 3072, v8
ATT_A:
    v_accvgpr_write_b32 a0, 0
    v_accvgpr_write_b32 a1, 0
    v_accvgpr_write_b32 a2, 0
    v_accvgpr_write_b32 a3, 0
    v_accvgpr_write_b32 a4, 0
    v_accvgpr_write_b32 a5, 0
    v_accvgpr_write_b32 a6, 0
    v_accvgpr_write_b32 a7, 0
    v_accvgpr_write_b32 a8, 0
    v_accvgpr_write_b32 a9, 0
    v_accvgpr_write_b32 a10, 0
    v_accvgpr_write_b32 a11, 0
    v_accvgpr_write_b32 a12, 0
    v_accvgpr_write_b32 a13, 0
    v_accvgpr_write_b32 a14, 0
    v_accvgpr_write_b32 a15, 0
    v_accvgpr_write_b32 a16, 0
    v_accvgpr_write_b32 a17, 0
    v_accvgpr_write_b32 a18, 0
    v_accvgpr_write_b32 a19, 0
    v_accvgpr_write_b32 a20, 0
    v_accvgpr_write_b32 a21, 0
    v_accvgpr_write_b32 a22, 0
    v_accvgpr_write_b32 a23, 0
    v_accvgpr_write_b32 a24, 0
    v_accvgpr_write_b32 a25, 0
    v_accvgpr_write_b32 a26, 0
    v_accvgpr_write_b32 a27, 0
    v_accvgpr_write_b32 a28, 0
    v_accvgpr_write_b32 a29, 0
    v_accvgpr_write_b32 a30, 0
    v_accvgpr_write_b32 a31, 0
    v_accvgpr_write_b32 a32, 0
    v_accvgpr_write_b32 a33, 0
    v_accvgpr_write_b32 a34, 0
    v_accvgpr_write_b32 a35, 0
    v_accvgpr_write_b32 a36, 0
    v_accvgpr_write_b32 a37, 0
    v_accvgpr_write_b32 a38, 0
    v_accvgpr_write_b32 a39, 0
    v_accvgpr_write_b32 a40, 0
    v_accvgpr_write_b32 a41, 0
    v_accvgpr_write_b32 a42, 0
    v_accvgpr_write_b32 a43, 0
    v_accvgpr_write_b32 a44, 0
    v_accvgpr_write_b32 a45, 0
    v_accvgpr_write_b32 a46, 0
    v_accvgpr_write_b32 a47, 0
    v_accvgpr_write_b32 a48, 0
    v_accvgpr_write_b32 a49, 0
    v_accvgpr_write_b32 a50, 0
    v_accvgpr_write_b32 a51, 0
    v_accvgpr_write_b32 a52, 0
    v_accvgpr_write_b32 a53, 0
    v_accvgpr_write_b32 a54, 0
    v_accvgpr_write_b32 a55, 0
    v_accvgpr_write_b32 a56, 0
    v_accvgpr_write_b32 a57, 0
    v_accvgpr_write_b32 a58, 0
    v_accvgpr_write_b32 a59, 0
    v_accvgpr_write_b32 a60, 0
    v_accvgpr_write_b32 a61, 0
    v_accvgpr_write_b32 a62, 0
    v_accvgpr_write_b32 a63, 0
    v_mov_b32 v48, 0
    v_mov_b32 v49, 0
    v_mov_b32 v50, 0
    v_mov_b32 v51, 0
    v_mov_b32 v52, 0
    v_mov_b32 v53, 0
    v_mov_b32 v54, 0
    v_mov_b32 v55, 0
    v_mov_b32 v56, 0
    v_mov_b32 v57, 0
    v_mov_b32 v58, 0
    v_mov_b32 v59, 0
    v_mov_b32 v60, 0
    v_mov_b32 v61, 0
    v_mov_b32 v62, 0
    v_mov_b32 v63, 0
    s_waitcnt vmcnt(18)
    s_waitcnt vmcnt(0)
    s_barrier
    s_cmp_lg_u32 s3, 0
    s_cbranch_scc1 ON24
    s_lshr_b32 s55, s37, 1
    s_lshl_b32 s38, s48, 3
    s_add_u32 s55, s55, s38
    s_lshl_b32 s55, s55, 7
    s_add_u32 s55, s55, 83902464
    v_mbcnt_lo_u32_b32 v95, -1, 0
    v_mbcnt_hi_u32_b32 v95, -1, v95
    v_cmp_eq_u32 vcc, 0, v95
    v_mov_b32 v96, 0x7fffff00
    s_nop 0
    v_cndmask_b32 v95, v96, v95, vcc
    v_mov_b32 v96, 1
    buffer_atomic_add v96, v95, s[28:31], s55 offen sc1
    s_sub_u32 s55, 15, s37
    s_lshr_b32 s55, s55, 1
    s_lshl_b32 s38, s48, 3
    s_add_u32 s55, s55, s38
    s_lshl_b32 s55, s55, 7
    s_add_u32 s55, s55, 83902464
    v_mbcnt_lo_u32_b32 v95, -1, 0
    v_mbcnt_hi_u32_b32 v95, -1, v95
    v_cmp_eq_u32 vcc, 0, v95
    v_mov_b32 v96, 0x7fffff00
    s_nop 0
    v_cndmask_b32 v95, v96, v95, vcc
    v_mov_b32 v96, 1
    buffer_atomic_add v96, v95, s[28:31], s55 offen sc1
ON24:
    v_min_f32 v16, v94, v48
    v_add_f32 v17, 0xec800000, v94
    v_min_f32 v17, v17, v49
    v_add_f32 v18, 0xed000000, v94
    v_min_f32 v18, v18, v50
    v_add_f32 v19, 0xed400000, v94
    v_min_f32 v19, v19, v51
    v_add_f32 v20, 0xee000000, v94
    v_min_f32 v20, v20, v52
    v_add_f32 v21, 0xee100000, v94
    v_min_f32 v21, v21, v53
    v_add_f32 v22, 0xee200000, v94
    v_min_f32 v22, v22, v54
    v_add_f32 v23, 0xee300000, v94
    v_min_f32 v23, v23, v55
    v_add_f32 v24, 0xee800000, v94
    v_min_f32 v24, v24, v56
    v_add_f32 v25, 0xee880000, v94
    v_min_f32 v25, v25, v57
    v_add_f32 v26, 0xee900000, v94
    v_min_f32 v26, v26, v58
    v_add_f32 v27, 0xee980000, v94
    v_min_f32 v27, v27, v59
    v_add_f32 v28, 0xeec00000, v94
    v_min_f32 v28, v28, v60
    v_add_f32 v29, 0xeec80000, v94
    v_min_f32 v29, v29, v61
    v_add_f32 v30, 0xeed00000, v94
    v_min_f32 v30, v30, v62
    v_add_f32 v31, 0xeed80000, v94
    v_min_f32 v31, v31, v63
    v_add_f32 v94, 0xef000000, v94
    ds_read_b128 a[96:99], v90 offset:0
    ds_read_b128 a[100:103], v90 offset:1024
    ds_read_b128 a[104:107], v90 offset:2048
    ds_read_b128 a[108:111], v90 offset:3072
    ds_read_b128 a[112:115], v90 offset:4096
    ds_read_b128 a[116:119], v90 offset:5120
    ds_read_b128 a[120:123], v90 offset:6144
    ds_read_b128 a[124:127], v90 offset:7168
    s_waitcnt lgkmcnt(7)
    v_mfma_f32_32x32x16_bf16 v[16:31], a[96:99], a[64:67], v[16:31]
    s_waitcnt lgkmcnt(6)
    v_mfma_f32_32x32x16_bf16 v[16:31], a[100:103], a[68:71], v[16:31]
    s_waitcnt lgkmcnt(5)
    v_mfma_f32_32x32x16_bf16 v[16:31], a[104:107], a[72:75], v[16:31]
    s_waitcnt lgkmcnt(4)
    v_mfma_f32_32x32x16_bf16 v[16:31], a[108:111], a[76:79], v[16:31]
    s_waitcnt lgkmcnt(3)
    v_mfma_f32_32x32x16_bf16 v[16:31], a[112:115], a[80:83], v[16:31]
    s_waitcnt lgkmcnt(2)
    v_mfma_f32_32x32x16_bf16 v[16:31], a[116:119], a[84:87], v[16:31]
    s_waitcnt lgkmcnt(1)
    v_mfma_f32_32x32x16_bf16 v[16:31], a[120:123], a[88:91], v[16:31]
    s_waitcnt lgkmcnt(0)
    v_mfma_f32_32x32x16_bf16 v[16:31], a[124:127], a[92:95], v[16:31]
    ds_read_b128 a[96:99], v90 offset:8192
    ds_read_b128 a[100:103], v90 offset:9216
    ds_read_b128 a[104:107], v90 offset:10240
    ds_read_b128 a[108:111], v90 offset:11264
    ds_read_b128 a[112:115], v90 offset:12288
    ds_read_b128 a[116:119], v90 offset:13312
    ds_read_b128 a[120:123], v90 offset:14336
    ds_read_b128 a[124:127], v90 offset:15360
    s_nop 3
    v_max3_f32 v96, v16, v17, v18
    v_max3_f32 v96, v96, v19, v20
    v_max3_f32 v96, v96, v21, v22
    v_max3_f32 v96, v96, v23, v24
    v_max3_f32 v96, v96, v25, v26
    v_max3_f32 v96, v96, v27, v28
    v_max3_f32 v96, v96, v29, v30
    v_max_f32 v96, v96, v31
    v_mov_b32 v98, v96
    s_nop 1
    v_permlane32_swap_b32 v96, v98
    v_max_f32 v96, v96, v98
    v_sub_f32 v16, v16, v96
    v_sub_f32 v48, 0, v96
    v_sub_f32 v17, v17, v96
    v_sub_f32 v49, 0, v96
    v_sub_f32 v18, v18, v96
    v_sub_f32 v50, 0, v96
    v_sub_f32 v19, v19, v96
    v_sub_f32 v51, 0, v96
    v_sub_f32 v20, v20, v96
    v_sub_f32 v52, 0, v96
    v_sub_f32 v21, v21, v96
    v_sub_f32 v53, 0, v96
    v_sub_f32 v22, v22, v96
    v_sub_f32 v54, 0, v96
    v_sub_f32 v23, v23, v96
    v_sub_f32 v55, 0, v96
    v_sub_f32 v24, v24, v96
    v_sub_f32 v56, 0, v96
    v_sub_f32 v25, v25, v96
    v_sub_f32 v57, 0, v96
    v_sub_f32 v26, v26, v96
    v_sub_f32 v58, 0, v96
    v_sub_f32 v27, v27, v96
    v_sub_f32 v59, 0, v96
    v_sub_f32 v28, v28, v96
    v_sub_f32 v60, 0, v96
    v_sub_f32 v29, v29, v96
    v_sub_f32 v61, 0, v96
    v_sub_f32 v30, v30, v96
    v_sub_f32 v62, 0, v96
    v_sub_f32 v31, v31, v96
    v_sub_f32 v63, 0, v96
    v_min_f32 v32, v94, v48
    v_add_f32 v33, 0xec800000, v94
    v_min_f32 v33, v33, v49
    v_add_f32 v34, 0xed000000, v94
    v_min_f32 v34, v34, v50
    v_add_f32 v35, 0xed400000, v94
    v_min_f32 v35, v35, v51
    v_add_f32 v36, 0xee000000, v94
    v_min_f32 v36, v36, v52
    v_add_f32 v37, 0xee100000, v94
    v_min_f32 v37, v37, v53
    v_add_f32 v38, 0xee200000, v94
    v_min_f32 v38, v38, v54
    v_add_f32 v39, 0xee300000, v94
    v_min_f32 v39, v39, v55
    v_add_f32 v40, 0xee800000, v94
    v_min_f32 v40, v40, v56
    v_add_f32 v41, 0xee880000, v94
    v_min_f32 v41, v41, v57
    v_add_f32 v42, 0xee900000, v94
    v_min_f32 v42, v42, v58
    v_add_f32 v43, 0xee980000, v94
    v_min_f32 v43, v43, v59
    v_add_f32 v44, 0xeec00000, v94
    v_min_f32 v44, v44, v60
    v_add_f32 v45, 0xeec80000, v94
    v_min_f32 v45, v45, v61
    v_add_f32 v46, 0xeed00000, v94
    v_min_f32 v46, v46, v62
    v_add_f32 v47, 0xeed80000, v94
    v_min_f32 v47, v47, v63
    v_add_f32 v94, 0xef000000, v94
    s_waitcnt lgkmcnt(7)
    v_mfma_f32_32x32x16_bf16 v[32:47], a[96:99], a[64:67], v[32:47]
    s_waitcnt lgkmcnt(6)
    v_mfma_f32_32x32x16_bf16 v[32:47], a[100:103], a[68:71], v[32:47]
    s_waitcnt lgkmcnt(5)
    v_mfma_f32_32x32x16_bf16 v[32:47], a[104:107], a[72:75], v[32:47]
    s_waitcnt lgkmcnt(4)
    v_mfma_f32_32x32x16_bf16 v[32:47], a[108:111], a[76:79], v[32:47]
    s_waitcnt lgkmcnt(3)
    v_mfma_f32_32x32x16_bf16 v[32:47], a[112:115], a[80:83], v[32:47]
    s_waitcnt lgkmcnt(2)
    v_mfma_f32_32x32x16_bf16 v[32:47], a[116:119], a[84:87], v[32:47]
    s_waitcnt lgkmcnt(1)
    v_mfma_f32_32x32x16_bf16 v[32:47], a[120:123], a[88:91], v[32:47]
    s_waitcnt lgkmcnt(0)
    v_mfma_f32_32x32x16_bf16 v[32:47], a[124:127], a[92:95], v[32:47]
    s_add_u32 s40, s40, 16384
    s_cmp_eq_u32 s40, 49152
    s_cselect_b32 s40, 0, s40
    v_add_u32 v90, s40, v93
    s_barrier
    ds_read_b128 a[96:99], v90 offset:0
    ds_read_b128 a[100:103], v90 offset:1024
    ds_read_b128 a[104:107], v90 offset:2048
    ds_read_b128 a[108:111], v90 offset:3072
    ds_read_b128 a[112:115], v90 offset:4096
    ds_read_b128 a[116:119], v90 offset:5120
    v_exp_f32 v80, v16
    v_exp_f32 v81, v17
    s_nop 0
    v_add_f32 v88, v80, v81
    v_cvt_pk_bf16_f32 v64, v80, v81
    v_exp_f32 v80, v18
    v_exp_f32 v81, v19
    v_add_f32 v88, v88, v80
    v_add_f32 v88, v88, v81
    v_cvt_pk_bf16_f32 v65, v80, v81
    v_exp_f32 v80, v20
    v_exp_f32 v81, v21
    v_add_f32 v88, v88, v80
    v_add_f32 v88, v88, v81
    v_cvt_pk_bf16_f32 v66, v80, v81
    v_exp_f32 v80, v22
    v_exp_f32 v81, v23
    v_add_f32 v88, v88, v80
    v_add_f32 v88, v88, v81
    v_cvt_pk_bf16_f32 v67, v80, v81
    v_exp_f32 v80, v24
    v_exp_f32 v81, v25
    v_add_f32 v88, v88, v80
    v_add_f32 v88, v88, v81
    v_cvt_pk_bf16_f32 v68, v80, v81
    v_exp_f32 v80, v26
    v_exp_f32 v81, v27
    v_add_f32 v88, v88, v80
    v_add_f32 v88, v88, v81
    v_cvt_pk_bf16_f32 v69, v80, v81
    v_exp_f32 v80, v28
    v_exp_f32 v81, v29
    v_add_f32 v88, v88, v80
    v_add_f32 v88, v88, v81
    v_cvt_pk_bf16_f32 v70, v80, v81
    v_exp_f32 v80, v30
    v_exp_f32 v81, v31
    v_add_f32 v88, v88, v80
    v_add_f32 v88, v88, v81
    v_cvt_pk_bf16_f32 v71, v80, v81
    v_mov_b32 v89, v88
    v_exp_f32 v80, v32
    v_exp_f32 v81, v33
    v_exp_f32 v82, v34
    s_sub_i32 s42, s63, 3
    s_cmp_le_i32 s42, 0
    s_cbranch_scc1 A_masked_setup
A_loop:
    s_waitcnt lgkmcnt(5)
    v_mfma_f32_32x32x16_bf16 v[16:31], a[96:99], a[64:67], v[48:63]
    ds_read_b128 a[120:123], v90 offset:6144
    v_exp_f32 v83, v35
    v_add_f32 v88, v80, v81
    v_add_f32 v88, v88, v82
    v_cvt_pk_bf16_f32 v72, v80, v81
    s_waitcnt lgkmcnt(5)
    v_mfma_f32_32x32x16_bf16 v[16:31], a[100:103], a[68:71], v[16:31]
    ds_read_b128 a[124:127], v90 offset:7168
    v_exp_f32 v84, v36
    v_add_f32 v88, v88, v83
    v_cvt_pk_bf16_f32 v73, v82, v83
    s_mov_b32 m0, s45
    s_waitcnt lgkmcnt(5)
    v_mfma_f32_32x32x16_bf16 v[16:31], a[104:107], a[72:75], v[16:31]
    ds_read_b128 a[96:99], v92 offset:0
    v_exp_f32 v85, v37
    v_add_f32 v88, v88, v84
    s_waitcnt lgkmcnt(5)
    v_mfma_f32_32x32x16_bf16 v[16:31], a[108:111], a[76:79], v[16:31]
    ds_read_b128 a[100:103], v92 offset:1024
    v_exp_f32 v86, v38
    v_add_f32 v88, v88, v85
    v_cvt_pk_bf16_f32 v74, v84, v85
    buffer_load_dwordx4 v99, s[28:31], s43 offen offset:0 sc1 lds
    s_waitcnt lgkmcnt(5)
    v_mfma_f32_32x32x16_bf16 v[16:31], a[112:115], a[80:83], v[16:31]
    ds_read_b128 a[104:107], v92 offset:2048
    v_exp_f32 v87, v39
    v_add_f32 v88, v88, v86
    s_waitcnt lgkmcnt(5)
    v_mfma_f32_32x32x16_bf16 v[16:31], a[116:119], a[84:87], v[16:31]
    ds_read_b128 a[108:111], v92 offset:3072
    v_exp_f32 v80, v40
    v_add_f32 v88, v88, v87
    v_cvt_pk_bf16_f32 v75, v86, v87
    buffer_load_dwordx4 v99, s[28:31], s43 offen offset:1024 sc1 lds
    s_waitcnt lgkmcnt(5)
    v_mfma_f32_32x32x16_bf16 v[16:31], a[120:123], a[88:91], v[16:31]
    ds_read_b128 a[112:115], v92 offset:4096
    v_exp_f32 v81, v41
    v_add_f32 v88, v88, v80
    s_waitcnt lgkmcnt(5)
    v_mfma_f32_32x32x16_bf16 v[16:31], a[124:127], a[92:95], v[16:31]
    ds_read_b128 a[116:119], v92 offset:5120
    v_exp_f32 v82, v42
    v_add_f32 v88, v88, v81
    v_cvt_pk_bf16_f32 v76, v80, v81
    buffer_load_dwordx4 v99, s[28:31], s43 offen offset:2048 sc1 lds
    s_waitcnt lgkmcnt(5)
    v_mfma_f32_32x32x16_bf16 a[0:15], a[96:99], v[64:67], a[0:15]
    ds_read_b128 a[120:123], v92 offset:6144
    v_exp_f32 v83, v43
    v_add_f32 v88, v88, v82
    s_waitcnt lgkmcnt(5)
    v_mfma_f32_32x32x16_bf16 a[16:31], a[100:103], v[64:67], a[16:31]
    ds_read_b128 a[124:127], v92 offset:7168
    v_exp_f32 v84, v44
    v_add_f32 v88, v88, v83
    v_cvt_pk_bf16_f32 v77, v82, v83
    buffer_load_dwordx4 v99, s[28:31], s43 offen offset:3072 sc1 lds
    s_waitcnt lgkmcnt(5)
    v_mfma_f32_32x32x16_bf16 a[32:47], a[104:107], v[64:67], a[32:47]
    ds_read_b128 a[96:99], v90 offset:8192
    v_exp_f32 v85, v45
    v_add_f32 v88, v88, v84
    s_waitcnt lgkmcnt(5)
    v_mfma_f32_32x32x16_bf16 a[48:63], a[108:111], v[64:67], a[48:63]
    ds_read_b128 a[100:103], v90 offset:9216
    v_exp_f32 v86, v46
    v_add_f32 v88, v88, v85
    v_cvt_pk_bf16_f32 v78, v84, v85
    s_mov_b32 m0, s46
    s_waitcnt lgkmcnt(5)
    v_mfma_f32_32x32x16_bf16 a[0:15], a[112:115], v[68:71], a[0:15]
    ds_read_b128 a[104:107], v90 offset:10240
    v_exp_f32 v87, v47
    v_add_f32 v88, v88, v86
    s_waitcnt lgkmcnt(5)
    v_mfma_f32_32x32x16_bf16 a[16:31], a[116:119], v[68:71], a[16:31]
    ds_read_b128 a[108:111], v90 offset:11264
    v_exp_f32 v80, v16
    v_add_f32 v88, v88, v87
    v_cvt_pk_bf16_f32 v79, v86, v87
    buffer_load_dwordx4 v99, s[28:31], s44 offen offset:0 sc1 lds
    s_waitcnt lgkmcnt(5)
    v_mfma_f32_32x32x16_bf16 a[32:47], a[120:123], v[68:71], a[32:47]
    ds_read_b128 a[112:115], v90 offset:12288
    v_exp_f32 v81, v17
    v_cmp_lt_f32 vcc, s47, v88
    s_waitcnt lgkmcnt(5)
    v_mfma_f32_32x32x16_bf16 a[48:63], a[124:127], v[68:71], a[48:63]
    ds_read_b128 a[116:119], v90 offset:13312
    v_exp_f32 v82, v18
    buffer_load_dwordx4 v99, s[28:31], s44 offen offset:1024 sc1 lds
    s_cbranch_vccnz A_r0a
A_r0a_ret:
    v_add_f32 v89, v89, v88
    s_waitcnt lgkmcnt(5)
    v_mfma_f32_32x32x16_bf16 v[32:47], a[96:99], a[64:67], v[48:63]
    ds_read_b128 a[120:123], v90 offset:14336
    v_exp_f32 v83, v19
    v_add_f32 v88, v80, v81
    v_add_f32 v88, v88, v82
    v_cvt_pk_bf16_f32 v64, v80, v81
    s_waitcnt lgkmcnt(5)
    v_mfma_f32_32x32x16_bf16 v[32:47], a[100:103], a[68:71], v[32:47]
    ds_read_b128 a[124:127], v90 offset:15360
    v_exp_f32 v84, v20
    v_add_f32 v88, v88, v83
    v_cvt_pk_bf16_f32 v65, v82, v83
    buffer_load_dwordx4 v99, s[28:31], s44 offen offset:2048 sc1 lds
    s_waitcnt lgkmcnt(5)
    v_mfma_f32_32x32x16_bf16 v[32:47], a[104:107], a[72:75], v[32:47]
    ds_read_b128 a[96:99], v92 offset:8192
    v_exp_f32 v85, v21
    v_add_f32 v88, v88, v84
    s_waitcnt lgkmcnt(5)
    v_mfma_f32_32x32x16_bf16 v[32:47], a[108:111], a[76:79], v[32:47]
    ds_read_b128 a[100:103], v92 offset:9216
    v_exp_f32 v86, v22
    v_add_f32 v88, v88, v85
    v_cvt_pk_bf16_f32 v66, v84, v85
    buffer_load_dwordx4 v99, s[28:31], s44 offen offset:3072 sc1 lds
    s_add_u32 s40, s40, 16384
    s_cmp_eq_u32 s40, 49152
    s_cselect_b32 s40, 0, s40
    s_waitcnt lgkmcnt(5)
    v_mfma_f32_32x32x16_bf16 v[32:47], a[112:115], a[80:83], v[32:47]
    ds_read_b128 a[104:107], v92 offset:10240
    v_exp_f32 v87, v23
    v_add_f32 v88, v88, v86
    s_add_u32 s58, s58, 1
    s_add_u32 s60, s60, 16384
    s_cmp_lt_u32 s58, s59
    v_add_u32 v90, s40, v93
    s_waitcnt lgkmcnt(5)
    v_mfma_f32_32x32x16_bf16 v[32:47], a[116:119], a[84:87], v[32:47]
    ds_read_b128 a[108:111], v92 offset:11264
    v_exp_f32 v80, v24
    v_add_f32 v88, v88, v87
    v_cvt_pk_bf16_f32 v67, v86, v87
    s_cselect_b32 s43, s60, s62
    s_add_u32 s61, s61, 16384
    s_cmp_le_u32 s58, s59
    s_waitcnt lgkmcnt(5)
    v_mfma_f32_32x32x16_bf16 v[32:47], a[120:123], a[88:91], v[32:47]
    ds_read_b128 a[112:115], v92 offset:12288
    v_exp_f32 v81, v25
    v_add_f32 v88, v88, v80
    s_cselect_b32 s44, s61, s62
    s_add_u32 s45, s45, 16384
    s_cmp_ge_u32 s45, 49152
    s_waitcnt lgkmcnt(5)
    v_mfma_f32_32x32x16_bf16 v[32:47], a[124:127], a[92:95], v[32:47]
    ds_read_b128 a[116:119], v92 offset:13312
    v_exp_f32 v82, v26
    v_add_f32 v88, v88, v81
    v_cvt_pk_bf16_f32 v68, v80, v81
    s_cselect_b32 s56, 49152, 0
    s_sub_u32 s45, s45, s56
    s_add_u32 s46, s46, 16384
    s_waitcnt lgkmcnt(5)
    v_mfma_f32_32x32x16_bf16 a[0:15], a[96:99], v[72:75], a[0:15]
    ds_read_b128 a[120:123], v92 offset:14336
    v_exp_f32 v83, v27
    v_add_f32 v88, v88, v82
    s_cmp_ge_u32 s46, 114688
    s_cselect_b32 s56, 65536, 0
    s_sub_u32 s46, s46, s56
    s_waitcnt lgkmcnt(5)
    v_mfma_f32_32x32x16_bf16 a[16:31], a[100:103], v[72:75], a[16:31]
    ds_read_b128 a[124:127], v92 offset:15360
    v_exp_f32 v84, v28
    v_add_f32 v88, v88, v83
    v_cvt_pk_bf16_f32 v69, v82, v83
    s_waitcnt lgkmcnt(5)
    v_mfma_f32_32x32x16_bf16 a[32:47], a[104:107], v[72:75], a[32:47]
    s_waitcnt vmcnt(8)
    s_barrier
    ds_read_b128 a[96:99], v90 offset:0
    v_exp_f32 v85, v29
    v_add_f32 v88, v88, v84
    s_waitcnt lgkmcnt(5)
    v_mfma_f32_32x32x16_bf16 a[48:63], a[108:111], v[72:75], a[48:63]
    ds_read_b128 a[100:103], v90 offset:1024
    v_exp_f32 v86, v30
    v_add_f32 v88, v88, v85
    v_cvt_pk_bf16_f32 v70, v84, v85
    s_add_u32 s41, s41, 16384
    s_cmp_eq_u32 s41, 114688
    s_cselect_b32 s41, 49152, s41
    s_waitcnt lgkmcnt(5)
    v_mfma_f32_32x32x16_bf16 a[0:15], a[112:115], v[76:79], a[0:15]
    ds_read_b128 a[104:107], v90 offset:2048
    v_exp_f32 v87, v31
    v_add_f32 v88, v88, v86
    v_add_u32 v92, s41, v93
    s_waitcnt lgkmcnt(5)
    v_mfma_f32_32x32x16_bf16 a[16:31], a[116:119], v[76:79], a[16:31]
    ds_read_b128 a[108:111], v90 offset:3072
    v_exp_f32 v80, v32
    v_add_f32 v88, v88, v87
    v_cvt_pk_bf16_f32 v71, v86, v87
    s_waitcnt lgkmcnt(5)
    v_mfma_f32_32x32x16_bf16 a[32:47], a[120:123], v[76:79], a[32:47]
    ds_read_b128 a[112:115], v90 offset:4096
    v_exp_f32 v81, v33
    v_cmp_lt_f32 vcc, s47, v88
    s_sub_u32 s42, s42, 1
    s_waitcnt lgkmcnt(5)
    v_mfma_f32_32x32x16_bf16 a[48:63], a[124:127], v[76:79], a[48:63]
    ds_read_b128 a[116:119], v90 offset:5120
    v_exp_f32 v82, v34
    s_cmp_lg_u32 s42, 0
    s_cbranch_vccnz A_r0b
A_r0b_ret:
    v_add_f32 v89, v89, v88
    s_cbranch_scc1 A_loop
A_masked_setup:
    s_sub_i32 s56, s63, 3
    s_max_i32 s56, s56, 0
    s_sub_i32 s42, s63, s56
    s_sub_i32 s42, s42, 1
    s_lshl_b32 s56, s56, 6
    v_cvt_f32_u32 v95, s56
    v_mul_f32 v95, 0x6c800000, v95
    v_sub_f32 v94, v94, v95
A_mloop:
    v_min_f32 v16, v94, v48
    v_add_f32 v17, 0xec800000, v94
    v_min_f32 v17, v17, v49
    v_add_f32 v18, 0xed000000, v94
    v_min_f32 v18, v18, v50
    v_add_f32 v19, 0xed400000, v94
    v_min_f32 v19, v19, v51
    v_add_f32 v20, 0xee000000, v94
    v_min_f32 v20, v20, v52
    v_add_f32 v21, 0xee100000, v94
    v_min_f32 v21, v21, v53
    v_add_f32 v22, 0xee200000, v94
    v_min_f32 v22, v22, v54
    v_add_f32 v23, 0xee300000, v94
    v_min_f32 v23, v23, v55
    v_add_f32 v24, 0xee800000, v94
    v_min_f32 v24, v24, v56
    v_add_f32 v25, 0xee880000, v94
    v_min_f32 v25, v25, v57
    v_add_f32 v26, 0xee900000, v94
    v_min_f32 v26, v26, v58
    v_add_f32 v27, 0xee980000, v94
    v_min_f32 v27, v27, v59
    v_add_f32 v28, 0xeec00000, v94
    v_min_f32 v28, v28, v60
    v_add_f32 v29, 0xeec80000, v94
    v_min_f32 v29, v29, v61
    v_add_f32 v30, 0xeed00000, v94
    v_min_f32 v30, v30, v62
    v_add_f32 v31, 0xeed80000, v94
    v_min_f32 v31, v31, v63
    v_add_f32 v94, 0xef000000, v94
    s_waitcnt lgkmcnt(5)
    v_mfma_f32_32x32x16_bf16 v[16:31], a[96:99], a[64:67], v[16:31]
    ds_read_b128 a[120:123], v90 offset:6144
    v_exp_f32 v83, v35
    v_add_f32 v88, v80, v81
    v_add_f32 v88, v88, v82
    v_cvt_pk_bf16_f32 v72, v80, v81
    s_waitcnt lgkmcnt(5)
    v_mfma_f32_32x32x16_bf16 v[16:31], a[100:103], a[68:71], v[16:31]
    ds_read_b128 a[124:127], v90 offset:7168
    v_exp_f32 v84, v36
    v_add_f32 v88, v88, v83
    v_cvt_pk_bf16_f32 v73, v82, v83
    s_mov_b32 m0, s45
    s_waitcnt lgkmcnt(5)
    v_mfma_f32_32x32x16_bf16 v[16:31], a[104:107], a[72:75], v[16:31]
    ds_read_b128 a[96:99], v92 offset:0
    v_exp_f32 v85, v37
    v_add_f32 v88, v88, v84
    s_waitcnt lgkmcnt(5)
    v_mfma_f32_32x32x16_bf16 v[16:31], a[108:111], a[76:79], v[16:31]
    ds_read_b128 a[100:103], v92 offset:1024
    v_exp_f32 v86, v38
    v_add_f32 v88, v88, v85
    v_cvt_pk_bf16_f32 v74, v84, v85
    buffer_load_dwordx4 v99, s[28:31], s43 offen offset:0 sc1 lds
    s_waitcnt lgkmcnt(5)
    v_mfma_f32_32x32x16_bf16 v[16:31], a[112:115], a[80:83], v[16:31]
    ds_read_b128 a[104:107], v92 offset:2048
    v_exp_f32 v87, v39
    v_add_f32 v88, v88, v86
    s_waitcnt lgkmcnt(5)
    v_mfma_f32_32x32x16_bf16 v[16:31], a[116:119], a[84:87], v[16:31]
    ds_read_b128 a[108:111], v92 offset:3072
    v_exp_f32 v80, v40
    v_add_f32 v88, v88, v87
    v_cvt_pk_bf16_f32 v75, v86, v87
    buffer_load_dwordx4 v99, s[28:31], s43 offen offset:1024 sc1 lds
    s_waitcnt lgkmcnt(5)
    v_mfma_f32_32x32x16_bf16 v[16:31], a[120:123], a[88:91], v[16:31]
    ds_read_b128 a[112:115], v92 offset:4096
    v_exp_f32 v81, v41
    v_add_f32 v88, v88, v80
    s_waitcnt lgkmcnt(5)
    v_mfma_f32_32x32x16_bf16 v[16:31], a[124:127], a[92:95], v[16:31]
    ds_read_b128 a[116:119], v92 offset:5120
    v_exp_f32 v82, v42
    v_add_f32 v88, v88, v81
    v_cvt_pk_bf16_f32 v76, v80, v81
    buffer_load_dwordx4 v99, s[28:31], s43 offen offset:2048 sc1 lds
    s_waitcnt lgkmcnt(5)
    v_mfma_f32_32x32x16_bf16 a[0:15], a[96:99], v[64:67], a[0:15]
    ds_read_b128 a[120:123], v92 offset:6144
    v_exp_f32 v83, v43
    v_add_f32 v88, v88, v82
    s_waitcnt lgkmcnt(5)
    v_mfma_f32_32x32x16_bf16 a[16:31], a[100:103], v[64:67], a[16:31]
    ds_read_b128 a[124:127], v92 offset:7168
    v_exp_f32 v84, v44
    v_add_f32 v88, v88, v83
    v_cvt_pk_bf16_f32 v77, v82, v83
    buffer_load_dwordx4 v99, s[28:31], s43 offen offset:3072 sc1 lds
    s_waitcnt lgkmcnt(5)
    v_mfma_f32_32x32x16_bf16 a[32:47], a[104:107], v[64:67], a[32:47]
    ds_read_b128 a[96:99], v90 offset:8192
    v_exp_f32 v85, v45
    v_add_f32 v88, v88, v84
    s_waitcnt lgkmcnt(5)
    v_mfma_f32_32x32x16_bf16 a[48:63], a[108:111], v[64:67], a[48:63]
    ds_read_b128 a[100:103], v90 offset:9216
    v_exp_f32 v86, v46
    v_add_f32 v88, v88, v85
    v_cvt_pk_bf16_f32 v78, v84, v85
    s_mov_b32 m0, s46
    s_waitcnt lgkmcnt(5)
    v_mfma_f32_32x32x16_bf16 a[0:15], a[112:115], v[68:71], a[0:15]
    ds_read_b128 a[104:107], v90 offset:10240
    v_exp_f32 v87, v47
    v_add_f32 v88, v88, v86
    s_waitcnt lgkmcnt(5)
    v_mfma_f32_32x32x16_bf16 a[16:31], a[116:119], v[68:71], a[16:31]
    ds_read_b128 a[108:111], v90 offset:11264
    v_exp_f32 v80, v16
    v_add_f32 v88, v88, v87
    v_cvt_pk_bf16_f32 v79, v86, v87
    buffer_load_dwordx4 v99, s[28:31], s44 offen offset:0 sc1 lds
    s_waitcnt lgkmcnt(5)
    v_mfma_f32_32x32x16_bf16 a[32:47], a[120:123], v[68:71], a[32:47]
    ds_read_b128 a[112:115], v90 offset:12288
    v_exp_f32 v81, v17
    v_cmp_lt_f32 vcc, s47, v88
    s_waitcnt lgkmcnt(5)
    v_mfma_f32_32x32x16_bf16 a[48:63], a[124:127], v[68:71], a[48:63]
    ds_read_b128 a[116:119], v90 offset:13312
    v_exp_f32 v82, v18
    buffer_load_dwordx4 v99, s[28:31], s44 offen offset:1024 sc1 lds
    s_cbranch_vccnz A_r1a
A_r1a_ret:
    v_add_f32 v89, v89, v88
    v_min_f32 v32, v94, v48
    v_add_f32 v33, 0xec800000, v94
    v_min_f32 v33, v33, v49
    v_add_f32 v34, 0xed000000, v94
    v_min_f32 v34, v34, v50
    v_add_f32 v35, 0xed400000, v94
    v_min_f32 v35, v35, v51
    v_add_f32 v36, 0xee000000, v94
    v_min_f32 v36, v36, v52
    v_add_f32 v37, 0xee100000, v94
    v_min_f32 v37, v37, v53
    v_add_f32 v38, 0xee200000, v94
    v_min_f32 v38, v38, v54
    v_add_f32 v39, 0xee300000, v94
    v_min_f32 v39, v39, v55
    v_add_f32 v40, 0xee800000, v94
    v_min_f32 v40, v40, v56
    v_add_f32 v41, 0xee880000, v94
    v_min_f32 v41, v41, v57
    v_add_f32 v42, 0xee900000, v94
    v_min_f32 v42, v42, v58
    v_add_f32 v43, 0xee980000, v94
    v_min_f32 v43, v43, v59
    v_add_f32 v44, 0xeec00000, v94
    v_min_f32 v44, v44, v60
    v_add_f32 v45, 0xeec80000, v94
    v_min_f32 v45, v45, v61
    v_add_f32 v46, 0xeed00000, v94
    v_min_f32 v46, v46, v62
    v_add_f32 v47, 0xeed80000, v94
    v_min_f32 v47, v47, v63
    v_add_f32 v94, 0xef000000, v94
    s_waitcnt lgkmcnt(5)
    v_mfma_f32_32x32x16_bf16 v[32:47], a[96:99], a[64:67], v[32:47]
    ds_read_b128 a[120:123], v90 offset:14336
    v_exp_f32 v83, v19
    v_add_f32 v88, v80, v81
    v_add_f32 v88, v88, v82
    v_cvt_pk_bf16_f32 v64, v80, v81
    s_waitcnt lgkmcnt(5)
    v_mfma_f32_32x32x16_bf16 v[32:47], a[100:103], a[68:71], v[32:47]
    ds_read_b128 a[124:127], v90 offset:15360
    v_exp_f32 v84, v20
    v_add_f32 v88, v88, v83
    v_cvt_pk_bf16_f32 v65, v82, v83
    buffer_load_dwordx4 v99, s[28:31], s44 offen offset:2048 sc1 lds
    s_waitcnt lgkmcnt(5)
    v_mfma_f32_32x32x16_bf16 v[32:47], a[104:107], a[72:75], v[32:47]
    ds_read_b128 a[96:99], v92 offset:8192
    v_exp_f32 v85, v21
    v_add_f32 v88, v88, v84
    s_waitcnt lgkmcnt(5)
    v_mfma_f32_32x32x16_bf16 v[32:47], a[108:111], a[76:79], v[32:47]
    ds_read_b128 a[100:103], v92 offset:9216
    v_exp_f32 v86, v22
    v_add_f32 v88, v88, v85
    v_cvt_pk_bf16_f32 v66, v84, v85
    buffer_load_dwordx4 v99, s[28:31], s44 offen offset:3072 sc1 lds
    s_add_u32 s40, s40, 16384
    s_cmp_eq_u32 s40, 49152
    s_cselect_b32 s40, 0, s40
    s_waitcnt lgkmcnt(5)
    v_mfma_f32_32x32x16_bf16 v[32:47], a[112:115], a[80:83], v[32:47]
    ds_read_b128 a[104:107], v92 offset:10240
    v_exp_f32 v87, v23
    v_add_f32 v88, v88, v86
    s_add_u32 s58, s58, 1
    s_add_u32 s60, s60, 16384
    s_cmp_lt_u32 s58, s59
    v_add_u32 v90, s40, v93
    s_waitcnt lgkmcnt(5)
    v_mfma_f32_32x32x16_bf16 v[32:47], a[116:119], a[84:87], v[32:47]
    ds_read_b128 a[108:111], v92 offset:11264
    v_exp_f32 v80, v24
    v_add_f32 v88, v88, v87
    v_cvt_pk_bf16_f32 v67, v86, v87
    s_cselect_b32 s43, s60, s62
    s_add_u32 s61, s61, 16384
    s_cmp_le_u32 s58, s59
    s_waitcnt lgkmcnt(5)
    v_mfma_f32_32x32x16_bf16 v[32:47], a[120:123], a[88:91], v[32:47]
    ds_read_b128 a[112:115], v92 offset:12288
    v_exp_f32 v81, v25
    v_add_f32 v88, v88, v80
    s_cselect_b32 s44, s61, s62
    s_add_u32 s45, s45, 16384
    s_cmp_ge_u32 s45, 49152
    s_waitcnt lgkmcnt(5)
    v_mfma_f32_32x32x16_bf16 v[32:47], a[124:127], a[92:95], v[32:47]
    ds_read_b128 a[116:119], v92 offset:13312
    v_exp_f32 v82, v26
    v_add_f32 v88, v88, v81
    v_cvt_pk_bf16_f32 v68, v80, v81
    s_cselect_b32 s56, 49152, 0
    s_sub_u32 s45, s45, s56
    s_add_u32 s46, s46, 16384
    s_waitcnt lgkmcnt(5)
    v_mfma_f32_32x32x16_bf16 a[0:15], a[96:99], v[72:75], a[0:15]
    ds_read_b128 a[120:123], v92 offset:14336
    v_exp_f32 v83, v27
    v_add_f32 v88, v88, v82
    s_cmp_ge_u32 s46, 114688
    s_cselect_b32 s56, 65536, 0
    s_sub_u32 s46, s46, s56
    s_waitcnt lgkmcnt(5)
    v_mfma_f32_32x32x16_bf16 a[16:31], a[100:103], v[72:75], a[16:31]
    ds_read_b128 a[124:127], v92 offset:15360
    v_exp_f32 v84, v28
    v_add_f32 v88, v88, v83
    v_cvt_pk_bf16_f32 v69, v82, v83
    s_waitcnt lgkmcnt(5)
    v_mfma_f32_32x32x16_bf16 a[32:47], a[104:107], v[72:75], a[32:47]
    s_waitcnt vmcnt(8)
    s_barrier
    ds_read_b128 a[96:99], v90 offset:0
    v_exp_f32 v85, v29
    v_add_f32 v88, v88, v84
    s_waitcnt lgkmcnt(5)
    v_mfma_f32_32x32x16_bf16 a[48:63], a[108:111], v[72:75], a[48:63]
    ds_read_b128 a[100:103], v90 offset:1024
    v_exp_f32 v86, v30
    v_add_f32 v88, v88, v85
    v_cvt_pk_bf16_f32 v70, v84, v85
    s_add_u32 s41, s41, 16384
    s_cmp_eq_u32 s41, 114688
    s_cselect_b32 s41, 49152, s41
    s_waitcnt lgkmcnt(5)
    v_mfma_f32_32x32x16_bf16 a[0:15], a[112:115], v[76:79], a[0:15]
    ds_read_b128 a[104:107], v90 offset:2048
    v_exp_f32 v87, v31
    v_add_f32 v88, v88, v86
    v_add_u32 v92, s41, v93
    s_waitcnt lgkmcnt(5)
    v_mfma_f32_32x32x16_bf16 a[16:31], a[116:119], v[76:79], a[16:31]
    ds_read_b128 a[108:111], v90 offset:3072
    v_exp_f32 v80, v32
    v_add_f32 v88, v88, v87
    v_cvt_pk_bf16_f32 v71, v86, v87
    s_waitcnt lgkmcnt(5)
    v_mfma_f32_32x32x16_bf16 a[32:47], a[120:123], v[76:79], a[32:47]
    ds_read_b128 a[112:115], v90 offset:4096
    v_exp_f32 v81, v33
    v_cmp_lt_f32 vcc, s47, v88
    s_sub_u32 s42, s42, 1
    s_waitcnt lgkmcnt(5)
    v_mfma_f32_32x32x16_bf16 a[48:63], a[124:127], v[76:79], a[48:63]
    ds_read_b128 a[116:119], v90 offset:5120
    v_exp_f32 v82, v34
    s_cmp_lg_u32 s42, 0
    s_cbranch_vccnz A_r1b
A_r1b_ret:
    v_add_f32 v89, v89, v88
    s_cbranch_scc1 A_mloop
    v_exp_f32 v83, v35
    v_add_f32 v88, v80, v81
    v_add_f32 v88, v88, v82
    v_cvt_pk_bf16_f32 v72, v80, v81
    v_exp_f32 v84, v36
    v_add_f32 v88, v88, v83
    v_cvt_pk_bf16_f32 v73, v82, v83
    s_mov_b32 m0, s45
    ds_read_b128 a[96:99], v92 offset:0
    v_exp_f32 v85, v37
    v_add_f32 v88, v88, v84
    ds_read_b128 a[100:103], v92 offset:1024
    v_exp_f32 v86, v38
    v_add_f32 v88, v88, v85
    v_cvt_pk_bf16_f32 v74, v84, v85
    buffer_load_dwordx4 v99, s[28:31], s43 offen offset:0 sc1 lds
    ds_read_b128 a[104:107], v92 offset:2048
    v_exp_f32 v87, v39
    v_add_f32 v88, v88, v86
    ds_read_b128 a[108:111], v92 offset:3072
    v_exp_f32 v80, v40
    v_add_f32 v88, v88, v87
    v_cvt_pk_bf16_f32 v75, v86, v87
    buffer_load_dwordx4 v99, s[28:31], s43 offen offset:1024 sc1 lds
    ds_read_b128 a[112:115], v92 offset:4096
    v_exp_f32 v81, v41
    v_add_f32 v88, v88, v80
    ds_read_b128 a[116:119], v92 offset:5120
    v_exp_f32 v82, v42
    v_add_f32 v88, v88, v81
    v_cvt_pk_bf16_f32 v76, v80, v81
    buffer_load_dwordx4 v99, s[28:31], s43 offen offset:2048 sc1 lds
    s_waitcnt lgkmcnt(5)
    v_mfma_f32_32x32x16_bf16 a[0:15], a[96:99], v[64:67], a[0:15]
    ds_read_b128 a[120:123], v92 offset:6144
    v_exp_f32 v83, v43
    v_add_f32 v88, v88, v82
    s_waitcnt lgkmcnt(5)
    v_mfma_f32_32x32x16_bf16 a[16:31], a[100:103], v[64:67], a[16:31]
    ds_read_b128 a[124:127], v92 offset:7168
    v_exp_f32 v84, v44
    v_add_f32 v88, v88, v83
    v_cvt_pk_bf16_f32 v77, v82, v83
    buffer_load_dwordx4 v99, s[28:31], s43 offen offset:3072 sc1 lds
    s_waitcnt lgkmcnt(5)
    v_mfma_f32_32x32x16_bf16 a[32:47], a[104:107], v[64:67], a[32:47]
    v_exp_f32 v85, v45
    v_add_f32 v88, v88, v84
    s_waitcnt lgkmcnt(4)
    v_mfma_f32_32x32x16_bf16 a[48:63], a[108:111], v[64:67], a[48:63]
    v_exp_f32 v86, v46
    v_add_f32 v88, v88, v85
    v_cvt_pk_bf16_f32 v78, v84, v85
    s_mov_b32 m0, s46
    s_waitcnt lgkmcnt(3)
    v_mfma_f32_32x32x16_bf16 a[0:15], a[112:115], v[68:71], a[0:15]
    v_exp_f32 v87, v47
    v_add_f32 v88, v88, v86
    s_waitcnt lgkmcnt(2)
    v_mfma_f32_32x32x16_bf16 a[16:31], a[116:119], v[68:71], a[16:31]
    v_add_f32 v88, v88, v87
    v_cvt_pk_bf16_f32 v79, v86, v87
    buffer_load_dwordx4 v99, s[28:31], s44 offen offset:0 sc1 lds
    s_waitcnt lgkmcnt(1)
    v_mfma_f32_32x32x16_bf16 a[32:47], a[120:123], v[68:71], a[32:47]
    v_cmp_lt_f32 vcc, s47, v88
    s_waitcnt lgkmcnt(0)
    v_mfma_f32_32x32x16_bf16 a[48:63], a[124:127], v[68:71], a[48:63]
    buffer_load_dwordx4 v99, s[28:31], s44 offen offset:1024 sc1 lds
    s_cbranch_vccnz A_r2a
A_r2a_ret:
    v_add_f32 v89, v89, v88
    buffer_load_dwordx4 v99, s[28:31], s44 offen offset:2048 sc1 lds
    ds_read_b128 a[96:99], v92 offset:8192
    ds_read_b128 a[100:103], v92 offset:9216
    buffer_load_dwordx4 v99, s[28:31], s44 offen offset:3072 sc1 lds
    s_add_u32 s40, s40, 16384
    s_cmp_eq_u32 s40, 49152
    s_cselect_b32 s40, 0, s40
    ds_read_b128 a[104:107], v92 offset:10240
    s_add_u32 s58, s58, 1
    s_add_u32 s60, s60, 16384
    s_cmp_lt_u32 s58, s59
    v_add_u32 v90, s40, v93
    ds_read_b128 a[108:111], v92 offset:11264
    s_cselect_b32 s43, s60, s62
    s_add_u32 s61, s61, 16384
    s_cmp_le_u32 s58, s59
    ds_read_b128 a[112:115], v92 offset:12288
    s_cselect_b32 s44, s61, s62
    s_add_u32 s45, s45, 16384
    s_cmp_ge_u32 s45, 49152
    ds_read_b128 a[116:119], v92 offset:13312
    s_cselect_b32 s56, 49152, 0
    s_sub_u32 s45, s45, s56
    s_add_u32 s46, s46, 16384
    s_waitcnt lgkmcnt(5)
    v_mfma_f32_32x32x16_bf16 a[0:15], a[96:99], v[72:75], a[0:15]
    ds_read_b128 a[120:123], v92 offset:14336
    s_cmp_ge_u32 s46, 114688
    s_cselect_b32 s56, 65536, 0
    s_sub_u32 s46, s46, s56
    s_waitcnt lgkmcnt(5)
    v_mfma_f32_32x32x16_bf16 a[16:31], a[100:103], v[72:75], a[16:31]
    ds_read_b128 a[124:127], v92 offset:15360
    s_waitcnt lgkmcnt(5)
    v_mfma_f32_32x32x16_bf16 a[32:47], a[104:107], v[72:75], a[32:47]
    s_waitcnt vmcnt(8)
    s_barrier
    s_waitcnt lgkmcnt(4)
    v_mfma_f32_32x32x16_bf16 a[48:63], a[108:111], v[72:75], a[48:63]
    s_add_u32 s41, s41, 16384
    s_cmp_eq_u32 s41, 114688
    s_cselect_b32 s41, 49152, s41
    s_waitcnt lgkmcnt(3)
    v_mfma_f32_32x32x16_bf16 a[0:15], a[112:115], v[76:79], a[0:15]
    v_add_u32 v92, s41, v93
    s_waitcnt lgkmcnt(2)
    v_mfma_f32_32x32x16_bf16 a[16:31], a[116:119], v[76:79], a[16:31]
    s_waitcnt lgkmcnt(1)
    v_mfma_f32_32x32x16_bf16 a[32:47], a[120:123], v[76:79], a[32:47]
    s_waitcnt lgkmcnt(0)
    v_mfma_f32_32x32x16_bf16 a[48:63], a[124:127], v[76:79], a[48:63]
    s_sub_u32 s42, s59, s63
    s_mov_b32 m0, s45
    s_nop 0
    buffer_load_dwordx4 v99, s[28:31], s43 offen offset:0 sc1 lds
    buffer_load_dwordx4 v99, s[28:31], s43 offen offset:1024 sc1 lds
    buffer_load_dwordx4 v99, s[28:31], s43 offen offset:2048 sc1 lds
    buffer_load_dwordx4 v99, s[28:31], s43 offen offset:3072 sc1 lds
    s_mov_b32 m0, s46
    s_nop 0
    buffer_load_dwordx4 v99, s[28:31], s44 offen offset:0 sc1 lds
    buffer_load_dwordx4 v99, s[28:31], s44 offen offset:1024 sc1 lds
    buffer_load_dwordx4 v99, s[28:31], s44 offen offset:2048 sc1 lds
    buffer_load_dwordx4 v99, s[28:31], s44 offen offset:3072 sc1 lds
    s_add_u32 s58, s58, 1
    s_add_u32 s60, s60, 16384
    s_cmp_lt_u32 s58, s59
    s_cselect_b32 s43, s60, s62
    s_add_u32 s61, s61, 16384
    s_cmp_le_u32 s58, s59
    s_cselect_b32 s44, s61, s62
    s_add_u32 s45, s45, 16384
    s_cmp_ge_u32 s45, 49152
    s_cselect_b32 s56, 49152, 0
    s_sub_u32 s45, s45, s56
    s_add_u32 s46, s46, 16384
    s_cmp_ge_u32 s46, 114688
    s_cselect_b32 s56, 65536, 0
    s_sub_u32 s46, s46, s56
    v_mov_b32 v96, v89
    v_mov_b32 v97, v89
    s_nop 1
    v_permlane32_swap_b32 v96, v97
    v_add_f32 v96, v96, v97
    v_rcp_f32 v96, v96
    v_accvgpr_read_b32 v48, a0
    v_accvgpr_read_b32 v49, a1
    v_accvgpr_read_b32 v50, a2
    v_accvgpr_read_b32 v51, a3
    v_accvgpr_read_b32 v52, a4
    v_accvgpr_read_b32 v53, a5
    v_accvgpr_read_b32 v54, a6
    v_accvgpr_read_b32 v55, a7
    v_mul_f32 v48, v48, v96
    v_mul_f32 v49, v49, v96
    v_mul_f32 v50, v50, v96
    v_mul_f32 v51, v51, v96
    v_mul_f32 v52, v52, v96
    v_mul_f32 v53, v53, v96
    v_mul_f32 v54, v54, v96
    v_mul_f32 v55, v55, v96
    v_cvt_pk_bf16_f32 v16, v48, v49
    v_cvt_pk_bf16_f32 v17, v50, v51
    v_cvt_pk_bf16_f32 v18, v52, v53
    v_cvt_pk_bf16_f32 v19, v54, v55
    v_accvgpr_read_b32 v48, a8
    v_accvgpr_read_b32 v49, a9
    v_accvgpr_read_b32 v50, a10
    v_accvgpr_read_b32 v51, a11
    v_accvgpr_read_b32 v52, a12
    v_accvgpr_read_b32 v53, a13
    v_accvgpr_read_b32 v54, a14
    v_accvgpr_read_b32 v55, a15
    v_mul_f32 v48, v48, v96
    v_mul_f32 v49, v49, v96
    v_mul_f32 v50, v50, v96
    v_mul_f32 v51, v51, v96
    v_mul_f32 v52, v52, v96
    v_mul_f32 v53, v53, v96
    v_mul_f32 v54, v54, v96
    v_mul_f32 v55, v55, v96
    v_cvt_pk_bf16_f32 v20, v48, v49
    v_cvt_pk_bf16_f32 v21, v50, v51
    v_cvt_pk_bf16_f32 v22, v52, v53
    v_cvt_pk_bf16_f32 v23, v54, v55
    v_accvgpr_read_b32 v48, a16
    v_accvgpr_read_b32 v49, a17
    v_accvgpr_read_b32 v50, a18
    v_accvgpr_read_b32 v51, a19
    v_accvgpr_read_b32 v52, a20
    v_accvgpr_read_b32 v53, a21
    v_accvgpr_read_b32 v54, a22
    v_accvgpr_read_b32 v55, a23
    v_mul_f32 v48, v48, v96
    v_mul_f32 v49, v49, v96
    v_mul_f32 v50, v50, v96
    v_mul_f32 v51, v51, v96
    v_mul_f32 v52, v52, v96
    v_mul_f32 v53, v53, v96
    v_mul_f32 v54, v54, v96
    v_mul_f32 v55, v55, v96
    v_cvt_pk_bf16_f32 v24, v48, v49
    v_cvt_pk_bf16_f32 v25, v50, v51
    v_cvt_pk_bf16_f32 v26, v52, v53
    v_cvt_pk_bf16_f32 v27, v54, v55
    v_accvgpr_read_b32 v48, a24
    v_accvgpr_read_b32 v49, a25
    v_accvgpr_read_b32 v50, a26
    v_accvgpr_read_b32 v51, a27
    v_accvgpr_read_b32 v52, a28
    v_accvgpr_read_b32 v53, a29
    v_accvgpr_read_b32 v54, a30
    v_accvgpr_read_b32 v55, a31
    v_mul_f32 v48, v48, v96
    v_mul_f32 v49, v49, v96
    v_mul_f32 v50, v50, v96
    v_mul_f32 v51, v51, v96
    v_mul_f32 v52, v52, v96
    v_mul_f32 v53, v53, v96
    v_mul_f32 v54, v54, v96
    v_mul_f32 v55, v55, v96
    v_cvt_pk_bf16_f32 v28, v48, v49
    v_cvt_pk_bf16_f32 v29, v50, v51
    v_cvt_pk_bf16_f32 v30, v52, v53
    v_cvt_pk_bf16_f32 v31, v54, v55
    v_accvgpr_read_b32 v48, a32
    v_accvgpr_read_b32 v49, a33
    v_accvgpr_read_b32 v50, a34
    v_accvgpr_read_b32 v51, a35
    v_accvgpr_read_b32 v52, a36
    v_accvgpr_read_b32 v53, a37
    v_accvgpr_read_b32 v54, a38
    v_accvgpr_read_b32 v55, a39
    v_mul_f32 v48, v48, v96
    v_mul_f32 v49, v49, v96
    v_mul_f32 v50, v50, v96
    v_mul_f32 v51, v51, v96
    v_mul_f32 v52, v52, v96
    v_mul_f32 v53, v53, v96
    v_mul_f32 v54, v54, v96
    v_mul_f32 v55, v55, v96
    v_cvt_pk_bf16_f32 v32, v48, v49
    v_cvt_pk_bf16_f32 v33, v50, v51
    v_cvt_pk_bf16_f32 v34, v52, v53
    v_cvt_pk_bf16_f32 v35, v54, v55
    v_accvgpr_read_b32 v48, a40
    v_accvgpr_read_b32 v49, a41
    v_accvgpr_read_b32 v50, a42
    v_accvgpr_read_b32 v51, a43
    v_accvgpr_read_b32 v52, a44
    v_accvgpr_read_b32 v53, a45
    v_accvgpr_read_b32 v54, a46
    v_accvgpr_read_b32 v55, a47
    v_mul_f32 v48, v48, v96
    v_mul_f32 v49, v49, v96
    v_mul_f32 v50, v50, v96
    v_mul_f32 v51, v51, v96
    v_mul_f32 v52, v52, v96
    v_mul_f32 v53, v53, v96
    v_mul_f32 v54, v54, v96
    v_mul_f32 v55, v55, v96
    v_cvt_pk_bf16_f32 v36, v48, v49
    v_cvt_pk_bf16_f32 v37, v50, v51
    v_cvt_pk_bf16_f32 v38, v52, v53
    v_cvt_pk_bf16_f32 v39, v54, v55
    v_accvgpr_read_b32 v48, a48
    v_accvgpr_read_b32 v49, a49
    v_accvgpr_read_b32 v50, a50
    v_accvgpr_read_b32 v51, a51
    v_accvgpr_read_b32 v52, a52
    v_accvgpr_read_b32 v53, a53
    v_accvgpr_read_b32 v54, a54
    v_accvgpr_read_b32 v55, a55
    v_mul_f32 v48, v48, v96
    v_mul_f32 v49, v49, v96
    v_mul_f32 v50, v50, v96
    v_mul_f32 v51, v51, v96
    v_mul_f32 v52, v52, v96
    v_mul_f32 v53, v53, v96
    v_mul_f32 v54, v54, v96
    v_mul_f32 v55, v55, v96
    v_cvt_pk_bf16_f32 v40, v48, v49
    v_cvt_pk_bf16_f32 v41, v50, v51
    v_cvt_pk_bf16_f32 v42, v52, v53
    v_cvt_pk_bf16_f32 v43, v54, v55
    v_accvgpr_read_b32 v48, a56
    v_accvgpr_read_b32 v49, a57
    v_accvgpr_read_b32 v50, a58
    v_accvgpr_read_b32 v51, a59
    v_accvgpr_read_b32 v52, a60
    v_accvgpr_read_b32 v53, a61
    v_accvgpr_read_b32 v54, a62
    v_accvgpr_read_b32 v55, a63
    v_mul_f32 v48, v48, v96
    v_mul_f32 v49, v49, v96
    v_mul_f32 v50, v50, v96
    v_mul_f32 v51, v51, v96
    v_mul_f32 v52, v52, v96
    v_mul_f32 v53, v53, v96
    v_mul_f32 v54, v54, v96
    v_mul_f32 v55, v55, v96
    v_cvt_pk_bf16_f32 v44, v48, v49
    v_cvt_pk_bf16_f32 v45, v50, v51
    v_cvt_pk_bf16_f32 v46, v52, v53
    v_cvt_pk_bf16_f32 v47, v54, v55
    s_add_u32 s56, s66, 4096
    buffer_store_dwordx4 v[16:19], v93, s[28:31], s66 offen offset:0 sc1
    buffer_store_dwordx4 v[20:23], v93, s[28:31], s66 offen offset:1024 sc1
    buffer_store_dwordx4 v[24:27], v93, s[28:31], s66 offen offset:2048 sc1
    buffer_store_dwordx4 v[28:31], v93, s[28:31], s66 offen offset:3072 sc1
    buffer_store_dwordx4 v[32:35], v93, s[28:31], s56 offen offset:0 sc1
    buffer_store_dwordx4 v[36:39], v93, s[28:31], s56 offen offset:1024 sc1
    buffer_store_dwordx4 v[40:43], v93, s[28:31], s56 offen offset:2048 sc1
    buffer_store_dwordx4 v[44:47], v93, s[28:31], s56 offen offset:3072 sc1
    s_waitcnt vmcnt(16)
    s_barrier
    s_mov_b32 m0, s45
    s_nop 0
    buffer_load_dwordx4 v99, s[28:31], s43 offen offset:0 sc1 lds
    buffer_load_dwordx4 v99, s[28:31], s43 offen offset:1024 sc1 lds
    buffer_load_dwordx4 v99, s[28:31], s43 offen offset:2048 sc1 lds
    buffer_load_dwordx4 v99, s[28:31], s43 offen offset:3072 sc1 lds
    s_mov_b32 m0, s46
    s_nop 0
    buffer_load_dwordx4 v99, s[28:31], s44 offen offset:0 sc1 lds
    buffer_load_dwordx4 v99, s[28:31], s44 offen offset:1024 sc1 lds
    buffer_load_dwordx4 v99, s[28:31], s44 offen offset:2048 sc1 lds
    buffer_load_dwordx4 v99, s[28:31], s44 offen offset:3072 sc1 lds
    s_add_u32 s58, s58, 1
    s_add_u32 s60, s60, 16384
    s_cmp_lt_u32 s58, s59
    s_cselect_b32 s43, s60, s62
    s_add_u32 s61, s61, 16384
    s_cmp_le_u32 s58, s59
    s_cselect_b32 s44, s61, s62
    s_add_u32 s45, s45, 16384
    s_cmp_ge_u32 s45, 49152
    s_cselect_b32 s56, 49152, 0
    s_sub_u32 s45, s45, s56
    s_add_u32 s46, s46, 16384
    s_cmp_ge_u32 s46, 114688
    s_cselect_b32 s56, 65536, 0
    s_sub_u32 s46, s46, s56
    s_lshl_b32 s53, s3, 11
    s_add_u32 s54, s53, 8192
    s_add_u32 m0, s53, 114688
    s_lshl_b32 s39, s53, 2
    s_add_u32 s39, s39, s52
    s_lshl_b32 s38, s51, 14
    s_add_u32 s38, s38, 0
    s_add_u32 s38, s38, s39
    buffer_load_dwordx4 v8, s[72:75], s38 offen offset:0 lds
    s_add_u32 m0, s53, 114688
    s_lshl_b32 s39, s53, 2
    s_add_u32 s39, s39, s52
    s_lshl_b32 s38, s51, 14
    s_add_u32 s38, s38, 0
    s_add_u32 s38, s38, s39
    buffer_load_dwordx4 v9, s[72:75], s38 offen offset:1024 lds
    s_add_u32 m0, s54, 114688
    s_lshl_b32 s39, s54, 2
    s_add_u32 s39, s39, s52
    s_lshl_b32 s38, s51, 14
    s_add_u32 s38, s38, 0
    s_add_u32 s38, s38, s39
    buffer_load_dwordx4 v8, s[72:75], s38 offen offset:0 lds
    s_add_u32 m0, s54, 114688
    s_lshl_b32 s39, s54, 2
    s_add_u32 s39, s39, s52
    s_lshl_b32 s38, s51, 14
    s_add_u32 s38, s38, 0
    s_add_u32 s38, s38, s39
    buffer_load_dwordx4 v9, s[72:75], s38 offen offset:1024 lds
    s_add_u32 m0, s53, 131072
    s_lshl_b32 s39, s53, 2
    s_add_u32 s39, s39, s52
    s_lshl_b32 s38, s51, 14
    s_add_u32 s38, s38, 65536
    s_add_u32 s38, s38, s39
    buffer_load_dwordx4 v8, s[72:75], s38 offen offset:0 lds
    s_add_u32 m0, s53, 131072
    s_lshl_b32 s39, s53, 2
    s_add_u32 s39, s39, s52
    s_lshl_b32 s38, s51, 14
    s_add_u32 s38, s38, 65536
    s_add_u32 s38, s38, s39
    buffer_load_dwordx4 v9, s[72:75], s38 offen offset:1024 lds
    s_add_u32 m0, s54, 131072
    s_lshl_b32 s39, s54, 2
    s_add_u32 s39, s39, s52
    s_lshl_b32 s38, s51, 14
    s_add_u32 s38, s38, 65536
    s_add_u32 s38, s38, s39
    buffer_load_dwordx4 v8, s[72:75], s38 offen offset:0 lds
    s_add_u32 m0, s54, 131072
    s_lshl_b32 s39, s54, 2
    s_add_u32 s39, s39, s52
    s_lshl_b32 s38, s51, 14
    s_add_u32 s38, s38, 65536
    s_add_u32 s38, s38, s39
    buffer_load_dwordx4 v9, s[72:75], s38 offen offset:1024 lds
    s_add_u32 m0, s53, 147456
    s_lshl_b32 s39, s53, 2
    s_add_u32 s39, s39, s52
    s_lshl_b32 s38, s51, 14
    s_add_u32 s38, s38, 131072
    s_add_u32 s38, s38, s39
    buffer_load_dwordx4 v8, s[72:75], s38 offen offset:0 lds
    s_add_u32 m0, s53, 147456
    s_lshl_b32 s39, s53, 2
    s_add_u32 s39, s39, s52
    s_lshl_b32 s38, s51, 14
    s_add_u32 s38, s38, 131072
    s_add_u32 s38, s38, s39
    buffer_load_dwordx4 v9, s[72:75], s38 offen offset:1024 lds
    s_add_u32 m0, s54, 147456
    s_lshl_b32 s39, s54, 2
    s_add_u32 s39, s39, s52
    s_lshl_b32 s38, s51, 14
    s_add_u32 s38, s38, 131072
    s_add_u32 s38, s38, s39
    buffer_load_dwordx4 v8, s[72:75], s38 offen offset:0 lds
    s_add_u32 m0, s54, 147456
    s_lshl_b32 s39, s54, 2
    s_add_u32 s39, s39, s52
    s_lshl_b32 s38, s51, 14
    s_add_u32 s38, s38, 131072
    s_add_u32 s38, s38, s39
    buffer_load_dwordx4 v9, s[72:75], s38 offen offset:1024 lds
    v_lshlrev_b32 v97, 6, v1
    s_lshr_b32 s38, s2, 3
    s_lshl_b32 s39, s38, 14
    s_lshl_b32 s55, s48, 19
    s_add_u32 s39, s39, s55
    s_lshl_b32 s55, s3, 12
    s_add_u32 s39, s39, s55
    buffer_load_dword v98, v97, s[68:71], s39 offen
    s_mul_i32 s39, s38, 6144
    s_lshl_b32 s55, s51, 14
    s_add_u32 s39, s39, s55
    s_and_b32 s55, s3, 1
    s_lshl_b32 s55, s55, 12
    s_add_u32 s39, s39, s55
    buffer_load_dword v98, v97, s[72:75], s39 offen
    s_waitcnt vmcnt(22)
    s_barrier
    s_lshr_b32 s55, s37, 1
    s_lshl_b32 s38, s48, 3
    s_add_u32 s55, s55, s38
    s_lshl_b32 s55, s55, 7
    s_add_u32 s55, s55, 83890176
    s_cmp_lg_u32 s3, 3
    s_cbranch_scc1 ON25
    v_mbcnt_lo_u32_b32 v95, -1, 0
    v_mbcnt_hi_u32_b32 v95, -1, v95
    v_cmp_eq_u32 vcc, 0, v95
    v_mov_b32 v96, 0x7fffff00
    s_nop 0
    v_cndmask_b32 v95, v96, v95, vcc
    v_mov_b32 v96, 1
    buffer_atomic_add v96, v95, s[28:31], s55 offen sc1
ON25:
    s_sub_u32 s42, s42, 2
    s_cmp_eq_u32 s42, 0
    s_cbranch_scc1 A_done
A_ld:
    s_mov_b32 m0, s45
    s_nop 0
    buffer_load_dwordx4 v99, s[28:31], s43 offen offset:0 sc1 lds
    buffer_load_dwordx4 v99, s[28:31], s43 offen offset:1024 sc1 lds
    buffer_load_dwordx4 v99, s[28:31], s43 offen offset:2048 sc1 lds
    buffer_load_dwordx4 v99, s[28:31], s43 offen offset:3072 sc1 lds
    s_mov_b32 m0, s46
    s_nop 0
    buffer_load_dwordx4 v99, s[28:31], s44 offen offset:0 sc1 lds
    buffer_load_dwordx4 v99, s[28:31], s44 offen offset:1024 sc1 lds
    buffer_load_dwordx4 v99, s[28:31], s44 offen offset:2048 sc1 lds
    buffer_load_dwordx4 v99, s[28:31], s44 offen offset:3072 sc1 lds
    s_add_u32 s58, s58, 1
    s_add_u32 s60, s60, 16384
    s_cmp_lt_u32 s58, s59
    s_cselect_b32 s43, s60, s62
    s_add_u32 s61, s61, 16384
    s_cmp_le_u32 s58, s59
    s_cselect_b32 s44, s61, s62
    s_add_u32 s45, s45, 16384
    s_cmp_ge_u32 s45, 49152
    s_cselect_b32 s56, 49152, 0
    s_sub_u32 s45, s45, s56
    s_add_u32 s46, s46, 16384
    s_cmp_ge_u32 s46, 114688
    s_cselect_b32 s56, 65536, 0
    s_sub_u32 s46, s46, s56
    s_waitcnt vmcnt(8)
    s_barrier
    s_sub_u32 s42, s42, 1
    s_cmp_lg_u32 s42, 0
    s_cbranch_scc1 A_ld
A_done:
    s_cmp_lg_u32 s3, 0
    s_cbranch_scc1 ON26
    s_lshl_b32 s38, s48, 3
    s_add_u32 s55, s49, s38
    s_lshl_b32 s55, s55, 7
    s_add_u32 s55, s55, 83902464
    s_mov_b32 s95, 0
    s_waitcnt vmcnt(0)
    v_mov_b32 v98, 0
SP5:
    buffer_load_dword v97, v98, s[28:31], s55 offen sc1
    s_waitcnt vmcnt(0)
    v_readfirstlane_b32 s38, v97
    s_cmp_ge_u32 s38, 8
    s_cbranch_scc1 SP5_d
    s_add_u32 s95, s95, 1
    s_cmp_lt_u32 s95, 262144
    s_cbranch_scc1 SP5
SP5_d:
ON26:
    s_cmp_lg_u32 s3, 0
    s_cbranch_scc1 ON27
    s_mov_b32 s38, K3_start-parallel_sum__compressed_kv_cla__swiglu_ffn__prompt_kernel+0
    v_lshl_add_u32 v16, v1, 7, s38
    s_mov_b32 s38, K_code_end-parallel_sum__compressed_kv_cla__swiglu_ffn__prompt_kernel-128
    v_min_u32 v16, s38, v16
    v_mov_b32 v17, s101
    v_add_co_u32 v16, vcc, s100, v16
    s_nop 1
    v_addc_co_u32 v17, vcc, 0, v17, vcc
    global_load_dword v18, v[16:17], off
    s_mov_b32 s38, K3_start-parallel_sum__compressed_kv_cla__swiglu_ffn__prompt_kernel+8192
    v_lshl_add_u32 v16, v1, 7, s38
    s_mov_b32 s38, K_code_end-parallel_sum__compressed_kv_cla__swiglu_ffn__prompt_kernel-128
    v_min_u32 v16, s38, v16
    v_mov_b32 v17, s101
    v_add_co_u32 v16, vcc, s100, v16
    s_nop 1
    v_addc_co_u32 v17, vcc, 0, v17, vcc
    global_load_dword v18, v[16:17], off
    s_mov_b32 s38, K3_start-parallel_sum__compressed_kv_cla__swiglu_ffn__prompt_kernel+16384
    v_lshl_add_u32 v16, v1, 7, s38
    s_mov_b32 s38, K_code_end-parallel_sum__compressed_kv_cla__swiglu_ffn__prompt_kernel-128
    v_min_u32 v16, s38, v16
    v_mov_b32 v17, s101
    v_add_co_u32 v16, vcc, s100, v16
    s_nop 1
    v_addc_co_u32 v17, vcc, 0, v17, vcc
    global_load_dword v18, v[16:17], off
ON27:
    s_branch K3_start
ATT_A_end:
A_r0a:
    v_max3_f32 v96, v32, v33, v34
    v_max3_f32 v96, v96, v35, v36
    v_max3_f32 v96, v96, v37, v38
    v_max3_f32 v96, v96, v39, v40
    v_max3_f32 v96, v96, v41, v42
    v_max3_f32 v96, v96, v43, v44
    v_max3_f32 v96, v96, v45, v46
    v_max_f32 v96, v96, v47
    v_mov_b32 v98, v96
    s_nop 1
    v_permlane32_swap_b32 v96, v98
    v_max_f32 v96, v96, v98
    v_max_f32 v96, 0, v96
    v_exp_f32 v97, -v96
    v_sub_f32 v32, v32, v96
    v_sub_f32 v16, v16, v96
    v_sub_f32 v48, v48, v96
    v_sub_f32 v33, v33, v96
    v_sub_f32 v17, v17, v96
    v_sub_f32 v49, v49, v96
    v_sub_f32 v34, v34, v96
    v_sub_f32 v18, v18, v96
    v_sub_f32 v50, v50, v96
    v_sub_f32 v35, v35, v96
    v_sub_f32 v19, v19, v96
    v_sub_f32 v51, v51, v96
    v_sub_f32 v36, v36, v96
    v_sub_f32 v20, v20, v96
    v_sub_f32 v52, v52, v96
    v_sub_f32 v37, v37, v96
    v_sub_f32 v21, v21, v96
    v_sub_f32 v53, v53, v96
    v_sub_f32 v38, v38, v96
    v_sub_f32 v22, v22, v96
    v_sub_f32 v54, v54, v96
    v_sub_f32 v39, v39, v96
    v_sub_f32 v23, v23, v96
    v_sub_f32 v55, v55, v96
    v_sub_f32 v40, v40, v96
    v_sub_f32 v24, v24, v96
    v_sub_f32 v56, v56, v96
    v_sub_f32 v41, v41, v96
    v_sub_f32 v25, v25, v96
    v_sub_f32 v57, v57, v96
    v_sub_f32 v42, v42, v96
    v_sub_f32 v26, v26, v96
    v_sub_f32 v58, v58, v96
    v_sub_f32 v43, v43, v96
    v_sub_f32 v27, v27, v96
    v_sub_f32 v59, v59, v96
    v_sub_f32 v44, v44, v96
    v_sub_f32 v28, v28, v96
    v_sub_f32 v60, v60, v96
    v_sub_f32 v45, v45, v96
    v_sub_f32 v29, v29, v96
    v_sub_f32 v61, v61, v96
    v_sub_f32 v46, v46, v96
    v_sub_f32 v30, v30, v96
    v_sub_f32 v62, v62, v96
    v_sub_f32 v47, v47, v96
    v_sub_f32 v31, v31, v96
    v_sub_f32 v63, v63, v96
    v_mul_f32 v89, v89, v97
    v_accvgpr_read_b32 v80, a0
    v_mul_f32 v80, v80, v97
    v_accvgpr_write_b32 a0, v80
    v_accvgpr_read_b32 v81, a1
    v_mul_f32 v81, v81, v97
    v_accvgpr_write_b32 a1, v81
    v_accvgpr_read_b32 v82, a2
    v_mul_f32 v82, v82, v97
    v_accvgpr_write_b32 a2, v82
    v_accvgpr_read_b32 v83, a3
    v_mul_f32 v83, v83, v97
    v_accvgpr_write_b32 a3, v83
    v_accvgpr_read_b32 v80, a4
    v_mul_f32 v80, v80, v97
    v_accvgpr_write_b32 a4, v80
    v_accvgpr_read_b32 v81, a5
    v_mul_f32 v81, v81, v97
    v_accvgpr_write_b32 a5, v81
    v_accvgpr_read_b32 v82, a6
    v_mul_f32 v82, v82, v97
    v_accvgpr_write_b32 a6, v82
    v_accvgpr_read_b32 v83, a7
    v_mul_f32 v83, v83, v97
    v_accvgpr_write_b32 a7, v83
    v_accvgpr_read_b32 v80, a8
    v_mul_f32 v80, v80, v97
    v_accvgpr_write_b32 a8, v80
    v_accvgpr_read_b32 v81, a9
    v_mul_f32 v81, v81, v97
    v_accvgpr_write_b32 a9, v81
    v_accvgpr_read_b32 v82, a10
    v_mul_f32 v82, v82, v97
    v_accvgpr_write_b32 a10, v82
    v_accvgpr_read_b32 v83, a11
    v_mul_f32 v83, v83, v97
    v_accvgpr_write_b32 a11, v83
    v_accvgpr_read_b32 v80, a12
    v_mul_f32 v80, v80, v97
    v_accvgpr_write_b32 a12, v80
    v_accvgpr_read_b32 v81, a13
    v_mul_f32 v81, v81, v97
    v_accvgpr_write_b32 a13, v81
    v_accvgpr_read_b32 v82, a14
    v_mul_f32 v82, v82, v97
    v_accvgpr_write_b32 a14, v82
    v_accvgpr_read_b32 v83, a15
    v_mul_f32 v83, v83, v97
    v_accvgpr_write_b32 a15, v83
    v_accvgpr_read_b32 v80, a16
    v_mul_f32 v80, v80, v97
    v_accvgpr_write_b32 a16, v80
    v_accvgpr_read_b32 v81, a17
    v_mul_f32 v81, v81, v97
    v_accvgpr_write_b32 a17, v81
    v_accvgpr_read_b32 v82, a18
    v_mul_f32 v82, v82, v97
    v_accvgpr_write_b32 a18, v82
    v_accvgpr_read_b32 v83, a19
    v_mul_f32 v83, v83, v97
    v_accvgpr_write_b32 a19, v83
    v_accvgpr_read_b32 v80, a20
    v_mul_f32 v80, v80, v97
    v_accvgpr_write_b32 a20, v80
    v_accvgpr_read_b32 v81, a21
    v_mul_f32 v81, v81, v97
    v_accvgpr_write_b32 a21, v81
    v_accvgpr_read_b32 v82, a22
    v_mul_f32 v82, v82, v97
    v_accvgpr_write_b32 a22, v82
    v_accvgpr_read_b32 v83, a23
    v_mul_f32 v83, v83, v97
    v_accvgpr_write_b32 a23, v83
    v_accvgpr_read_b32 v80, a24
    v_mul_f32 v80, v80, v97
    v_accvgpr_write_b32 a24, v80
    v_accvgpr_read_b32 v81, a25
    v_mul_f32 v81, v81, v97
    v_accvgpr_write_b32 a25, v81
    v_accvgpr_read_b32 v82, a26
    v_mul_f32 v82, v82, v97
    v_accvgpr_write_b32 a26, v82
    v_accvgpr_read_b32 v83, a27
    v_mul_f32 v83, v83, v97
    v_accvgpr_write_b32 a27, v83
    v_accvgpr_read_b32 v80, a28
    v_mul_f32 v80, v80, v97
    v_accvgpr_write_b32 a28, v80
    v_accvgpr_read_b32 v81, a29
    v_mul_f32 v81, v81, v97
    v_accvgpr_write_b32 a29, v81
    v_accvgpr_read_b32 v82, a30
    v_mul_f32 v82, v82, v97
    v_accvgpr_write_b32 a30, v82
    v_accvgpr_read_b32 v83, a31
    v_mul_f32 v83, v83, v97
    v_accvgpr_write_b32 a31, v83
    v_accvgpr_read_b32 v80, a32
    v_mul_f32 v80, v80, v97
    v_accvgpr_write_b32 a32, v80
    v_accvgpr_read_b32 v81, a33
    v_mul_f32 v81, v81, v97
    v_accvgpr_write_b32 a33, v81
    v_accvgpr_read_b32 v82, a34
    v_mul_f32 v82, v82, v97
    v_accvgpr_write_b32 a34, v82
    v_accvgpr_read_b32 v83, a35
    v_mul_f32 v83, v83, v97
    v_accvgpr_write_b32 a35, v83
    v_accvgpr_read_b32 v80, a36
    v_mul_f32 v80, v80, v97
    v_accvgpr_write_b32 a36, v80
    v_accvgpr_read_b32 v81, a37
    v_mul_f32 v81, v81, v97
    v_accvgpr_write_b32 a37, v81
    v_accvgpr_read_b32 v82, a38
    v_mul_f32 v82, v82, v97
    v_accvgpr_write_b32 a38, v82
    v_accvgpr_read_b32 v83, a39
    v_mul_f32 v83, v83, v97
    v_accvgpr_write_b32 a39, v83
    v_accvgpr_read_b32 v80, a40
    v_mul_f32 v80, v80, v97
    v_accvgpr_write_b32 a40, v80
    v_accvgpr_read_b32 v81, a41
    v_mul_f32 v81, v81, v97
    v_accvgpr_write_b32 a41, v81
    v_accvgpr_read_b32 v82, a42
    v_mul_f32 v82, v82, v97
    v_accvgpr_write_b32 a42, v82
    v_accvgpr_read_b32 v83, a43
    v_mul_f32 v83, v83, v97
    v_accvgpr_write_b32 a43, v83
    v_accvgpr_read_b32 v80, a44
    v_mul_f32 v80, v80, v97
    v_accvgpr_write_b32 a44, v80
    v_accvgpr_read_b32 v81, a45
    v_mul_f32 v81, v81, v97
    v_accvgpr_write_b32 a45, v81
    v_accvgpr_read_b32 v82, a46
    v_mul_f32 v82, v82, v97
    v_accvgpr_write_b32 a46, v82
    v_accvgpr_read_b32 v83, a47
    v_mul_f32 v83, v83, v97
    v_accvgpr_write_b32 a47, v83
    v_accvgpr_read_b32 v80, a48
    v_mul_f32 v80, v80, v97
    v_accvgpr_write_b32 a48, v80
    v_accvgpr_read_b32 v81, a49
    v_mul_f32 v81, v81, v97
    v_accvgpr_write_b32 a49, v81
    v_accvgpr_read_b32 v82, a50
    v_mul_f32 v82, v82, v97
    v_accvgpr_write_b32 a50, v82
    v_accvgpr_read_b32 v83, a51
    v_mul_f32 v83, v83, v97
    v_accvgpr_write_b32 a51, v83
    v_accvgpr_read_b32 v80, a52
    v_mul_f32 v80, v80, v97
    v_accvgpr_write_b32 a52, v80
    v_accvgpr_read_b32 v81, a53
    v_mul_f32 v81, v81, v97
    v_accvgpr_write_b32 a53, v81
    v_accvgpr_read_b32 v82, a54
    v_mul_f32 v82, v82, v97
    v_accvgpr_write_b32 a54, v82
    v_accvgpr_read_b32 v83, a55
    v_mul_f32 v83, v83, v97
    v_accvgpr_write_b32 a55, v83
    v_accvgpr_read_b32 v80, a56
    v_mul_f32 v80, v80, v97
    v_accvgpr_write_b32 a56, v80
    v_accvgpr_read_b32 v81, a57
    v_mul_f32 v81, v81, v97
    v_accvgpr_write_b32 a57, v81
    v_accvgpr_read_b32 v82, a58
    v_mul_f32 v82, v82, v97
    v_accvgpr_write_b32 a58, v82
    v_accvgpr_read_b32 v83, a59
    v_mul_f32 v83, v83, v97
    v_accvgpr_write_b32 a59, v83
    v_accvgpr_read_b32 v80, a60
    v_mul_f32 v80, v80, v97
    v_accvgpr_write_b32 a60, v80
    v_accvgpr_read_b32 v81, a61
    v_mul_f32 v81, v81, v97
    v_accvgpr_write_b32 a61, v81
    v_accvgpr_read_b32 v82, a62
    v_mul_f32 v82, v82, v97
    v_accvgpr_write_b32 a62, v82
    v_accvgpr_read_b32 v83, a63
    v_mul_f32 v83, v83, v97
    v_accvgpr_write_b32 a63, v83
    v_exp_f32 v80, v32
    v_exp_f32 v81, v33
    s_nop 0
    v_add_f32 v88, v80, v81
    v_cvt_pk_bf16_f32 v72, v80, v81
    v_exp_f32 v80, v34
    v_exp_f32 v81, v35
    v_add_f32 v88, v88, v80
    v_add_f32 v88, v88, v81
    v_cvt_pk_bf16_f32 v73, v80, v81
    v_exp_f32 v80, v36
    v_exp_f32 v81, v37
    v_add_f32 v88, v88, v80
    v_add_f32 v88, v88, v81
    v_cvt_pk_bf16_f32 v74, v80, v81
    v_exp_f32 v80, v38
    v_exp_f32 v81, v39
    v_add_f32 v88, v88, v80
    v_add_f32 v88, v88, v81
    v_cvt_pk_bf16_f32 v75, v80, v81
    v_exp_f32 v80, v40
    v_exp_f32 v81, v41
    v_add_f32 v88, v88, v80
    v_add_f32 v88, v88, v81
    v_cvt_pk_bf16_f32 v76, v80, v81
    v_exp_f32 v80, v42
    v_exp_f32 v81, v43
    v_add_f32 v88, v88, v80
    v_add_f32 v88, v88, v81
    v_cvt_pk_bf16_f32 v77, v80, v81
    v_exp_f32 v80, v44
    v_exp_f32 v81, v45
    v_add_f32 v88, v88, v80
    v_add_f32 v88, v88, v81
    v_cvt_pk_bf16_f32 v78, v80, v81
    v_exp_f32 v80, v46
    v_exp_f32 v81, v47
    v_add_f32 v88, v88, v80
    v_add_f32 v88, v88, v81
    v_cvt_pk_bf16_f32 v79, v80, v81
    v_exp_f32 v80, v16
    v_exp_f32 v81, v17
    v_exp_f32 v82, v18
    s_branch A_r0a_ret
A_r0b:
    v_max3_f32 v96, v16, v17, v18
    v_max3_f32 v96, v96, v19, v20
    v_max3_f32 v96, v96, v21, v22
    v_max3_f32 v96, v96, v23, v24
    v_max3_f32 v96, v96, v25, v26
    v_max3_f32 v96, v96, v27, v28
    v_max3_f32 v96, v96, v29, v30
    v_max_f32 v96, v96, v31
    v_mov_b32 v98, v96
    s_nop 1
    v_permlane32_swap_b32 v96, v98
    v_max_f32 v96, v96, v98
    v_max_f32 v96, 0, v96
    v_exp_f32 v97, -v96
    v_sub_f32 v16, v16, v96
    v_sub_f32 v32, v32, v96
    v_sub_f32 v48, v48, v96
    v_sub_f32 v17, v17, v96
    v_sub_f32 v33, v33, v96
    v_sub_f32 v49, v49, v96
    v_sub_f32 v18, v18, v96
    v_sub_f32 v34, v34, v96
    v_sub_f32 v50, v50, v96
    v_sub_f32 v19, v19, v96
    v_sub_f32 v35, v35, v96
    v_sub_f32 v51, v51, v96
    v_sub_f32 v20, v20, v96
    v_sub_f32 v36, v36, v96
    v_sub_f32 v52, v52, v96
    v_sub_f32 v21, v21, v96
    v_sub_f32 v37, v37, v96
    v_sub_f32 v53, v53, v96
    v_sub_f32 v22, v22, v96
    v_sub_f32 v38, v38, v96
    v_sub_f32 v54, v54, v96
    v_sub_f32 v23, v23, v96
    v_sub_f32 v39, v39, v96
    v_sub_f32 v55, v55, v96
    v_sub_f32 v24, v24, v96
    v_sub_f32 v40, v40, v96
    v_sub_f32 v56, v56, v96
    v_sub_f32 v25, v25, v96
    v_sub_f32 v41, v41, v96
    v_sub_f32 v57, v57, v96
    v_sub_f32 v26, v26, v96
    v_sub_f32 v42, v42, v96
    v_sub_f32 v58, v58, v96
    v_sub_f32 v27, v27, v96
    v_sub_f32 v43, v43, v96
    v_sub_f32 v59, v59, v96
    v_sub_f32 v28, v28, v96
    v_sub_f32 v44, v44, v96
    v_sub_f32 v60, v60, v96
    v_sub_f32 v29, v29, v96
    v_sub_f32 v45, v45, v96
    v_sub_f32 v61, v61, v96
    v_sub_f32 v30, v30, v96
    v_sub_f32 v46, v46, v96
    v_sub_f32 v62, v62, v96
    v_sub_f32 v31, v31, v96
    v_sub_f32 v47, v47, v96
    v_sub_f32 v63, v63, v96
    v_mul_f32 v89, v89, v97
    v_accvgpr_read_b32 v80, a0
    v_mul_f32 v80, v80, v97
    v_accvgpr_write_b32 a0, v80
    v_accvgpr_read_b32 v81, a1
    v_mul_f32 v81, v81, v97
    v_accvgpr_write_b32 a1, v81
    v_accvgpr_read_b32 v82, a2
    v_mul_f32 v82, v82, v97
    v_accvgpr_write_b32 a2, v82
    v_accvgpr_read_b32 v83, a3
    v_mul_f32 v83, v83, v97
    v_accvgpr_write_b32 a3, v83
    v_accvgpr_read_b32 v80, a4
    v_mul_f32 v80, v80, v97
    v_accvgpr_write_b32 a4, v80
    v_accvgpr_read_b32 v81, a5
    v_mul_f32 v81, v81, v97
    v_accvgpr_write_b32 a5, v81
    v_accvgpr_read_b32 v82, a6
    v_mul_f32 v82, v82, v97
    v_accvgpr_write_b32 a6, v82
    v_accvgpr_read_b32 v83, a7
    v_mul_f32 v83, v83, v97
    v_accvgpr_write_b32 a7, v83
    v_accvgpr_read_b32 v80, a8
    v_mul_f32 v80, v80, v97
    v_accvgpr_write_b32 a8, v80
    v_accvgpr_read_b32 v81, a9
    v_mul_f32 v81, v81, v97
    v_accvgpr_write_b32 a9, v81
    v_accvgpr_read_b32 v82, a10
    v_mul_f32 v82, v82, v97
    v_accvgpr_write_b32 a10, v82
    v_accvgpr_read_b32 v83, a11
    v_mul_f32 v83, v83, v97
    v_accvgpr_write_b32 a11, v83
    v_accvgpr_read_b32 v80, a12
    v_mul_f32 v80, v80, v97
    v_accvgpr_write_b32 a12, v80
    v_accvgpr_read_b32 v81, a13
    v_mul_f32 v81, v81, v97
    v_accvgpr_write_b32 a13, v81
    v_accvgpr_read_b32 v82, a14
    v_mul_f32 v82, v82, v97
    v_accvgpr_write_b32 a14, v82
    v_accvgpr_read_b32 v83, a15
    v_mul_f32 v83, v83, v97
    v_accvgpr_write_b32 a15, v83
    v_accvgpr_read_b32 v80, a16
    v_mul_f32 v80, v80, v97
    v_accvgpr_write_b32 a16, v80
    v_accvgpr_read_b32 v81, a17
    v_mul_f32 v81, v81, v97
    v_accvgpr_write_b32 a17, v81
    v_accvgpr_read_b32 v82, a18
    v_mul_f32 v82, v82, v97
    v_accvgpr_write_b32 a18, v82
    v_accvgpr_read_b32 v83, a19
    v_mul_f32 v83, v83, v97
    v_accvgpr_write_b32 a19, v83
    v_accvgpr_read_b32 v80, a20
    v_mul_f32 v80, v80, v97
    v_accvgpr_write_b32 a20, v80
    v_accvgpr_read_b32 v81, a21
    v_mul_f32 v81, v81, v97
    v_accvgpr_write_b32 a21, v81
    v_accvgpr_read_b32 v82, a22
    v_mul_f32 v82, v82, v97
    v_accvgpr_write_b32 a22, v82
    v_accvgpr_read_b32 v83, a23
    v_mul_f32 v83, v83, v97
    v_accvgpr_write_b32 a23, v83
    v_accvgpr_read_b32 v80, a24
    v_mul_f32 v80, v80, v97
    v_accvgpr_write_b32 a24, v80
    v_accvgpr_read_b32 v81, a25
    v_mul_f32 v81, v81, v97
    v_accvgpr_write_b32 a25, v81
    v_accvgpr_read_b32 v82, a26
    v_mul_f32 v82, v82, v97
    v_accvgpr_write_b32 a26, v82
    v_accvgpr_read_b32 v83, a27
    v_mul_f32 v83, v83, v97
    v_accvgpr_write_b32 a27, v83
    v_accvgpr_read_b32 v80, a28
    v_mul_f32 v80, v80, v97
    v_accvgpr_write_b32 a28, v80
    v_accvgpr_read_b32 v81, a29
    v_mul_f32 v81, v81, v97
    v_accvgpr_write_b32 a29, v81
    v_accvgpr_read_b32 v82, a30
    v_mul_f32 v82, v82, v97
    v_accvgpr_write_b32 a30, v82
    v_accvgpr_read_b32 v83, a31
    v_mul_f32 v83, v83, v97
    v_accvgpr_write_b32 a31, v83
    v_accvgpr_read_b32 v80, a32
    v_mul_f32 v80, v80, v97
    v_accvgpr_write_b32 a32, v80
    v_accvgpr_read_b32 v81, a33
    v_mul_f32 v81, v81, v97
    v_accvgpr_write_b32 a33, v81
    v_accvgpr_read_b32 v82, a34
    v_mul_f32 v82, v82, v97
    v_accvgpr_write_b32 a34, v82
    v_accvgpr_read_b32 v83, a35
    v_mul_f32 v83, v83, v97
    v_accvgpr_write_b32 a35, v83
    v_accvgpr_read_b32 v80, a36
    v_mul_f32 v80, v80, v97
    v_accvgpr_write_b32 a36, v80
    v_accvgpr_read_b32 v81, a37
    v_mul_f32 v81, v81, v97
    v_accvgpr_write_b32 a37, v81
    v_accvgpr_read_b32 v82, a38
    v_mul_f32 v82, v82, v97
    v_accvgpr_write_b32 a38, v82
    v_accvgpr_read_b32 v83, a39
    v_mul_f32 v83, v83, v97
    v_accvgpr_write_b32 a39, v83
    v_accvgpr_read_b32 v80, a40
    v_mul_f32 v80, v80, v97
    v_accvgpr_write_b32 a40, v80
    v_accvgpr_read_b32 v81, a41
    v_mul_f32 v81, v81, v97
    v_accvgpr_write_b32 a41, v81
    v_accvgpr_read_b32 v82, a42
    v_mul_f32 v82, v82, v97
    v_accvgpr_write_b32 a42, v82
    v_accvgpr_read_b32 v83, a43
    v_mul_f32 v83, v83, v97
    v_accvgpr_write_b32 a43, v83
    v_accvgpr_read_b32 v80, a44
    v_mul_f32 v80, v80, v97
    v_accvgpr_write_b32 a44, v80
    v_accvgpr_read_b32 v81, a45
    v_mul_f32 v81, v81, v97
    v_accvgpr_write_b32 a45, v81
    v_accvgpr_read_b32 v82, a46
    v_mul_f32 v82, v82, v97
    v_accvgpr_write_b32 a46, v82
    v_accvgpr_read_b32 v83, a47
    v_mul_f32 v83, v83, v97
    v_accvgpr_write_b32 a47, v83
    v_accvgpr_read_b32 v80, a48
    v_mul_f32 v80, v80, v97
    v_accvgpr_write_b32 a48, v80
    v_accvgpr_read_b32 v81, a49
    v_mul_f32 v81, v81, v97
    v_accvgpr_write_b32 a49, v81
    v_accvgpr_read_b32 v82, a50
    v_mul_f32 v82, v82, v97
    v_accvgpr_write_b32 a50, v82
    v_accvgpr_read_b32 v83, a51
    v_mul_f32 v83, v83, v97
    v_accvgpr_write_b32 a51, v83
    v_accvgpr_read_b32 v80, a52
    v_mul_f32 v80, v80, v97
    v_accvgpr_write_b32 a52, v80
    v_accvgpr_read_b32 v81, a53
    v_mul_f32 v81, v81, v97
    v_accvgpr_write_b32 a53, v81
    v_accvgpr_read_b32 v82, a54
    v_mul_f32 v82, v82, v97
    v_accvgpr_write_b32 a54, v82
    v_accvgpr_read_b32 v83, a55
    v_mul_f32 v83, v83, v97
    v_accvgpr_write_b32 a55, v83
    v_accvgpr_read_b32 v80, a56
    v_mul_f32 v80, v80, v97
    v_accvgpr_write_b32 a56, v80
    v_accvgpr_read_b32 v81, a57
    v_mul_f32 v81, v81, v97
    v_accvgpr_write_b32 a57, v81
    v_accvgpr_read_b32 v82, a58
    v_mul_f32 v82, v82, v97
    v_accvgpr_write_b32 a58, v82
    v_accvgpr_read_b32 v83, a59
    v_mul_f32 v83, v83, v97
    v_accvgpr_write_b32 a59, v83
    v_accvgpr_read_b32 v80, a60
    v_mul_f32 v80, v80, v97
    v_accvgpr_write_b32 a60, v80
    v_accvgpr_read_b32 v81, a61
    v_mul_f32 v81, v81, v97
    v_accvgpr_write_b32 a61, v81
    v_accvgpr_read_b32 v82, a62
    v_mul_f32 v82, v82, v97
    v_accvgpr_write_b32 a62, v82
    v_accvgpr_read_b32 v83, a63
    v_mul_f32 v83, v83, v97
    v_accvgpr_write_b32 a63, v83
    v_exp_f32 v80, v16
    v_exp_f32 v81, v17
    s_nop 0
    v_add_f32 v88, v80, v81
    v_cvt_pk_bf16_f32 v64, v80, v81
    v_exp_f32 v80, v18
    v_exp_f32 v81, v19
    v_add_f32 v88, v88, v80
    v_add_f32 v88, v88, v81
    v_cvt_pk_bf16_f32 v65, v80, v81
    v_exp_f32 v80, v20
    v_exp_f32 v81, v21
    v_add_f32 v88, v88, v80
    v_add_f32 v88, v88, v81
    v_cvt_pk_bf16_f32 v66, v80, v81
    v_exp_f32 v80, v22
    v_exp_f32 v81, v23
    v_add_f32 v88, v88, v80
    v_add_f32 v88, v88, v81
    v_cvt_pk_bf16_f32 v67, v80, v81
    v_exp_f32 v80, v24
    v_exp_f32 v81, v25
    v_add_f32 v88, v88, v80
    v_add_f32 v88, v88, v81
    v_cvt_pk_bf16_f32 v68, v80, v81
    v_exp_f32 v80, v26
    v_exp_f32 v81, v27
    v_add_f32 v88, v88, v80
    v_add_f32 v88, v88, v81
    v_cvt_pk_bf16_f32 v69, v80, v81
    v_exp_f32 v80, v28
    v_exp_f32 v81, v29
    v_add_f32 v88, v88, v80
    v_add_f32 v88, v88, v81
    v_cvt_pk_bf16_f32 v70, v80, v81
    v_exp_f32 v80, v30
    v_exp_f32 v81, v31
    v_add_f32 v88, v88, v80
    v_add_f32 v88, v88, v81
    v_cvt_pk_bf16_f32 v71, v80, v81
    v_exp_f32 v80, v32
    v_exp_f32 v81, v33
    v_exp_f32 v82, v34
    s_branch A_r0b_ret
A_r1a:
    v_max3_f32 v96, v32, v33, v34
    v_max3_f32 v96, v96, v35, v36
    v_max3_f32 v96, v96, v37, v38
    v_max3_f32 v96, v96, v39, v40
    v_max3_f32 v96, v96, v41, v42
    v_max3_f32 v96, v96, v43, v44
    v_max3_f32 v96, v96, v45, v46
    v_max_f32 v96, v96, v47
    v_mov_b32 v98, v96
    s_nop 1
    v_permlane32_swap_b32 v96, v98
    v_max_f32 v96, v96, v98
    v_max_f32 v96, 0, v96
    v_exp_f32 v97, -v96
    v_sub_f32 v32, v32, v96
    v_sub_f32 v16, v16, v96
    v_sub_f32 v48, v48, v96
    v_sub_f32 v33, v33, v96
    v_sub_f32 v17, v17, v96
    v_sub_f32 v49, v49, v96
    v_sub_f32 v34, v34, v96
    v_sub_f32 v18, v18, v96
    v_sub_f32 v50, v50, v96
    v_sub_f32 v35, v35, v96
    v_sub_f32 v19, v19, v96
    v_sub_f32 v51, v51, v96
    v_sub_f32 v36, v36, v96
    v_sub_f32 v20, v20, v96
    v_sub_f32 v52, v52, v96
    v_sub_f32 v37, v37, v96
    v_sub_f32 v21, v21, v96
    v_sub_f32 v53, v53, v96
    v_sub_f32 v38, v38, v96
    v_sub_f32 v22, v22, v96
    v_sub_f32 v54, v54, v96
    v_sub_f32 v39, v39, v96
    v_sub_f32 v23, v23, v96
    v_sub_f32 v55, v55, v96
    v_sub_f32 v40, v40, v96
    v_sub_f32 v24, v24, v96
    v_sub_f32 v56, v56, v96
    v_sub_f32 v41, v41, v96
    v_sub_f32 v25, v25, v96
    v_sub_f32 v57, v57, v96
    v_sub_f32 v42, v42, v96
    v_sub_f32 v26, v26, v96
    v_sub_f32 v58, v58, v96
    v_sub_f32 v43, v43, v96
    v_sub_f32 v27, v27, v96
    v_sub_f32 v59, v59, v96
    v_sub_f32 v44, v44, v96
    v_sub_f32 v28, v28, v96
    v_sub_f32 v60, v60, v96
    v_sub_f32 v45, v45, v96
    v_sub_f32 v29, v29, v96
    v_sub_f32 v61, v61, v96
    v_sub_f32 v46, v46, v96
    v_sub_f32 v30, v30, v96
    v_sub_f32 v62, v62, v96
    v_sub_f32 v47, v47, v96
    v_sub_f32 v31, v31, v96
    v_sub_f32 v63, v63, v96
    v_mul_f32 v89, v89, v97
    v_accvgpr_read_b32 v80, a0
    v_mul_f32 v80, v80, v97
    v_accvgpr_write_b32 a0, v80
    v_accvgpr_read_b32 v81, a1
    v_mul_f32 v81, v81, v97
    v_accvgpr_write_b32 a1, v81
    v_accvgpr_read_b32 v82, a2
    v_mul_f32 v82, v82, v97
    v_accvgpr_write_b32 a2, v82
    v_accvgpr_read_b32 v83, a3
    v_mul_f32 v83, v83, v97
    v_accvgpr_write_b32 a3, v83
    v_accvgpr_read_b32 v80, a4
    v_mul_f32 v80, v80, v97
    v_accvgpr_write_b32 a4, v80
    v_accvgpr_read_b32 v81, a5
    v_mul_f32 v81, v81, v97
    v_accvgpr_write_b32 a5, v81
    v_accvgpr_read_b32 v82, a6
    v_mul_f32 v82, v82, v97
    v_accvgpr_write_b32 a6, v82
    v_accvgpr_read_b32 v83, a7
    v_mul_f32 v83, v83, v97
    v_accvgpr_write_b32 a7, v83
    v_accvgpr_read_b32 v80, a8
    v_mul_f32 v80, v80, v97
    v_accvgpr_write_b32 a8, v80
    v_accvgpr_read_b32 v81, a9
    v_mul_f32 v81, v81, v97
    v_accvgpr_write_b32 a9, v81
    v_accvgpr_read_b32 v82, a10
    v_mul_f32 v82, v82, v97
    v_accvgpr_write_b32 a10, v82
    v_accvgpr_read_b32 v83, a11
    v_mul_f32 v83, v83, v97
    v_accvgpr_write_b32 a11, v83
    v_accvgpr_read_b32 v80, a12
    v_mul_f32 v80, v80, v97
    v_accvgpr_write_b32 a12, v80
    v_accvgpr_read_b32 v81, a13
    v_mul_f32 v81, v81, v97
    v_accvgpr_write_b32 a13, v81
    v_accvgpr_read_b32 v82, a14
    v_mul_f32 v82, v82, v97
    v_accvgpr_write_b32 a14, v82
    v_accvgpr_read_b32 v83, a15
    v_mul_f32 v83, v83, v97
    v_accvgpr_write_b32 a15, v83
    v_accvgpr_read_b32 v80, a16
    v_mul_f32 v80, v80, v97
    v_accvgpr_write_b32 a16, v80
    v_accvgpr_read_b32 v81, a17
    v_mul_f32 v81, v81, v97
    v_accvgpr_write_b32 a17, v81
    v_accvgpr_read_b32 v82, a18
    v_mul_f32 v82, v82, v97
    v_accvgpr_write_b32 a18, v82
    v_accvgpr_read_b32 v83, a19
    v_mul_f32 v83, v83, v97
    v_accvgpr_write_b32 a19, v83
    v_accvgpr_read_b32 v80, a20
    v_mul_f32 v80, v80, v97
    v_accvgpr_write_b32 a20, v80
    v_accvgpr_read_b32 v81, a21
    v_mul_f32 v81, v81, v97
    v_accvgpr_write_b32 a21, v81
    v_accvgpr_read_b32 v82, a22
    v_mul_f32 v82, v82, v97
    v_accvgpr_write_b32 a22, v82
    v_accvgpr_read_b32 v83, a23
    v_mul_f32 v83, v83, v97
    v_accvgpr_write_b32 a23, v83
    v_accvgpr_read_b32 v80, a24
    v_mul_f32 v80, v80, v97
    v_accvgpr_write_b32 a24, v80
    v_accvgpr_read_b32 v81, a25
    v_mul_f32 v81, v81, v97
    v_accvgpr_write_b32 a25, v81
    v_accvgpr_read_b32 v82, a26
    v_mul_f32 v82, v82, v97
    v_accvgpr_write_b32 a26, v82
    v_accvgpr_read_b32 v83, a27
    v_mul_f32 v83, v83, v97
    v_accvgpr_write_b32 a27, v83
    v_accvgpr_read_b32 v80, a28
    v_mul_f32 v80, v80, v97
    v_accvgpr_write_b32 a28, v80
    v_accvgpr_read_b32 v81, a29
    v_mul_f32 v81, v81, v97
    v_accvgpr_write_b32 a29, v81
    v_accvgpr_read_b32 v82, a30
    v_mul_f32 v82, v82, v97
    v_accvgpr_write_b32 a30, v82
    v_accvgpr_read_b32 v83, a31
    v_mul_f32 v83, v83, v97
    v_accvgpr_write_b32 a31, v83
    v_accvgpr_read_b32 v80, a32
    v_mul_f32 v80, v80, v97
    v_accvgpr_write_b32 a32, v80
    v_accvgpr_read_b32 v81, a33
    v_mul_f32 v81, v81, v97
    v_accvgpr_write_b32 a33, v81
    v_accvgpr_read_b32 v82, a34
    v_mul_f32 v82, v82, v97
    v_accvgpr_write_b32 a34, v82
    v_accvgpr_read_b32 v83, a35
    v_mul_f32 v83, v83, v97
    v_accvgpr_write_b32 a35, v83
    v_accvgpr_read_b32 v80, a36
    v_mul_f32 v80, v80, v97
    v_accvgpr_write_b32 a36, v80
    v_accvgpr_read_b32 v81, a37
    v_mul_f32 v81, v81, v97
    v_accvgpr_write_b32 a37, v81
    v_accvgpr_read_b32 v82, a38
    v_mul_f32 v82, v82, v97
    v_accvgpr_write_b32 a38, v82
    v_accvgpr_read_b32 v83, a39
    v_mul_f32 v83, v83, v97
    v_accvgpr_write_b32 a39, v83
    v_accvgpr_read_b32 v80, a40
    v_mul_f32 v80, v80, v97
    v_accvgpr_write_b32 a40, v80
    v_accvgpr_read_b32 v81, a41
    v_mul_f32 v81, v81, v97
    v_accvgpr_write_b32 a41, v81
    v_accvgpr_read_b32 v82, a42
    v_mul_f32 v82, v82, v97
    v_accvgpr_write_b32 a42, v82
    v_accvgpr_read_b32 v83, a43
    v_mul_f32 v83, v83, v97
    v_accvgpr_write_b32 a43, v83
    v_accvgpr_read_b32 v80, a44
    v_mul_f32 v80, v80, v97
    v_accvgpr_write_b32 a44, v80
    v_accvgpr_read_b32 v81, a45
    v_mul_f32 v81, v81, v97
    v_accvgpr_write_b32 a45, v81
    v_accvgpr_read_b32 v82, a46
    v_mul_f32 v82, v82, v97
    v_accvgpr_write_b32 a46, v82
    v_accvgpr_read_b32 v83, a47
    v_mul_f32 v83, v83, v97
    v_accvgpr_write_b32 a47, v83
    v_accvgpr_read_b32 v80, a48
    v_mul_f32 v80, v80, v97
    v_accvgpr_write_b32 a48, v80
    v_accvgpr_read_b32 v81, a49
    v_mul_f32 v81, v81, v97
    v_accvgpr_write_b32 a49, v81
    v_accvgpr_read_b32 v82, a50
    v_mul_f32 v82, v82, v97
    v_accvgpr_write_b32 a50, v82
    v_accvgpr_read_b32 v83, a51
    v_mul_f32 v83, v83, v97
    v_accvgpr_write_b32 a51, v83
    v_accvgpr_read_b32 v80, a52
    v_mul_f32 v80, v80, v97
    v_accvgpr_write_b32 a52, v80
    v_accvgpr_read_b32 v81, a53
    v_mul_f32 v81, v81, v97
    v_accvgpr_write_b32 a53, v81
    v_accvgpr_read_b32 v82, a54
    v_mul_f32 v82, v82, v97
    v_accvgpr_write_b32 a54, v82
    v_accvgpr_read_b32 v83, a55
    v_mul_f32 v83, v83, v97
    v_accvgpr_write_b32 a55, v83
    v_accvgpr_read_b32 v80, a56
    v_mul_f32 v80, v80, v97
    v_accvgpr_write_b32 a56, v80
    v_accvgpr_read_b32 v81, a57
    v_mul_f32 v81, v81, v97
    v_accvgpr_write_b32 a57, v81
    v_accvgpr_read_b32 v82, a58
    v_mul_f32 v82, v82, v97
    v_accvgpr_write_b32 a58, v82
    v_accvgpr_read_b32 v83, a59
    v_mul_f32 v83, v83, v97
    v_accvgpr_write_b32 a59, v83
    v_accvgpr_read_b32 v80, a60
    v_mul_f32 v80, v80, v97
    v_accvgpr_write_b32 a60, v80
    v_accvgpr_read_b32 v81, a61
    v_mul_f32 v81, v81, v97
    v_accvgpr_write_b32 a61, v81
    v_accvgpr_read_b32 v82, a62
    v_mul_f32 v82, v82, v97
    v_accvgpr_write_b32 a62, v82
    v_accvgpr_read_b32 v83, a63
    v_mul_f32 v83, v83, v97
    v_accvgpr_write_b32 a63, v83
    v_exp_f32 v80, v32
    v_exp_f32 v81, v33
    s_nop 0
    v_add_f32 v88, v80, v81
    v_cvt_pk_bf16_f32 v72, v80, v81
    v_exp_f32 v80, v34
    v_exp_f32 v81, v35
    v_add_f32 v88, v88, v80
    v_add_f32 v88, v88, v81
    v_cvt_pk_bf16_f32 v73, v80, v81
    v_exp_f32 v80, v36
    v_exp_f32 v81, v37
    v_add_f32 v88, v88, v80
    v_add_f32 v88, v88, v81
    v_cvt_pk_bf16_f32 v74, v80, v81
    v_exp_f32 v80, v38
    v_exp_f32 v81, v39
    v_add_f32 v88, v88, v80
    v_add_f32 v88, v88, v81
    v_cvt_pk_bf16_f32 v75, v80, v81
    v_exp_f32 v80, v40
    v_exp_f32 v81, v41
    v_add_f32 v88, v88, v80
    v_add_f32 v88, v88, v81
    v_cvt_pk_bf16_f32 v76, v80, v81
    v_exp_f32 v80, v42
    v_exp_f32 v81, v43
    v_add_f32 v88, v88, v80
    v_add_f32 v88, v88, v81
    v_cvt_pk_bf16_f32 v77, v80, v81
    v_exp_f32 v80, v44
    v_exp_f32 v81, v45
    v_add_f32 v88, v88, v80
    v_add_f32 v88, v88, v81
    v_cvt_pk_bf16_f32 v78, v80, v81
    v_exp_f32 v80, v46
    v_exp_f32 v81, v47
    v_add_f32 v88, v88, v80
    v_add_f32 v88, v88, v81
    v_cvt_pk_bf16_f32 v79, v80, v81
    v_exp_f32 v80, v16
    v_exp_f32 v81, v17
    v_exp_f32 v82, v18
    s_branch A_r1a_ret
A_r1b:
    v_max3_f32 v96, v16, v17, v18
    v_max3_f32 v96, v96, v19, v20
    v_max3_f32 v96, v96, v21, v22
    v_max3_f32 v96, v96, v23, v24
    v_max3_f32 v96, v96, v25, v26
    v_max3_f32 v96, v96, v27, v28
    v_max3_f32 v96, v96, v29, v30
    v_max_f32 v96, v96, v31
    v_mov_b32 v98, v96
    s_nop 1
    v_permlane32_swap_b32 v96, v98
    v_max_f32 v96, v96, v98
    v_max_f32 v96, 0, v96
    v_exp_f32 v97, -v96
    v_sub_f32 v16, v16, v96
    v_sub_f32 v32, v32, v96
    v_sub_f32 v48, v48, v96
    v_sub_f32 v17, v17, v96
    v_sub_f32 v33, v33, v96
    v_sub_f32 v49, v49, v96
    v_sub_f32 v18, v18, v96
    v_sub_f32 v34, v34, v96
    v_sub_f32 v50, v50, v96
    v_sub_f32 v19, v19, v96
    v_sub_f32 v35, v35, v96
    v_sub_f32 v51, v51, v96
    v_sub_f32 v20, v20, v96
    v_sub_f32 v36, v36, v96
    v_sub_f32 v52, v52, v96
    v_sub_f32 v21, v21, v96
    v_sub_f32 v37, v37, v96
    v_sub_f32 v53, v53, v96
    v_sub_f32 v22, v22, v96
    v_sub_f32 v38, v38, v96
    v_sub_f32 v54, v54, v96
    v_sub_f32 v23, v23, v96
    v_sub_f32 v39, v39, v96
    v_sub_f32 v55, v55, v96
    v_sub_f32 v24, v24, v96
    v_sub_f32 v40, v40, v96
    v_sub_f32 v56, v56, v96
    v_sub_f32 v25, v25, v96
    v_sub_f32 v41, v41, v96
    v_sub_f32 v57, v57, v96
    v_sub_f32 v26, v26, v96
    v_sub_f32 v42, v42, v96
    v_sub_f32 v58, v58, v96
    v_sub_f32 v27, v27, v96
    v_sub_f32 v43, v43, v96
    v_sub_f32 v59, v59, v96
    v_sub_f32 v28, v28, v96
    v_sub_f32 v44, v44, v96
    v_sub_f32 v60, v60, v96
    v_sub_f32 v29, v29, v96
    v_sub_f32 v45, v45, v96
    v_sub_f32 v61, v61, v96
    v_sub_f32 v30, v30, v96
    v_sub_f32 v46, v46, v96
    v_sub_f32 v62, v62, v96
    v_sub_f32 v31, v31, v96
    v_sub_f32 v47, v47, v96
    v_sub_f32 v63, v63, v96
    v_mul_f32 v89, v89, v97
    v_accvgpr_read_b32 v80, a0
    v_mul_f32 v80, v80, v97
    v_accvgpr_write_b32 a0, v80
    v_accvgpr_read_b32 v81, a1
    v_mul_f32 v81, v81, v97
    v_accvgpr_write_b32 a1, v81
    v_accvgpr_read_b32 v82, a2
    v_mul_f32 v82, v82, v97
    v_accvgpr_write_b32 a2, v82
    v_accvgpr_read_b32 v83, a3
    v_mul_f32 v83, v83, v97
    v_accvgpr_write_b32 a3, v83
    v_accvgpr_read_b32 v80, a4
    v_mul_f32 v80, v80, v97
    v_accvgpr_write_b32 a4, v80
    v_accvgpr_read_b32 v81, a5
    v_mul_f32 v81, v81, v97
    v_accvgpr_write_b32 a5, v81
    v_accvgpr_read_b32 v82, a6
    v_mul_f32 v82, v82, v97
    v_accvgpr_write_b32 a6, v82
    v_accvgpr_read_b32 v83, a7
    v_mul_f32 v83, v83, v97
    v_accvgpr_write_b32 a7, v83
    v_accvgpr_read_b32 v80, a8
    v_mul_f32 v80, v80, v97
    v_accvgpr_write_b32 a8, v80
    v_accvgpr_read_b32 v81, a9
    v_mul_f32 v81, v81, v97
    v_accvgpr_write_b32 a9, v81
    v_accvgpr_read_b32 v82, a10
    v_mul_f32 v82, v82, v97
    v_accvgpr_write_b32 a10, v82
    v_accvgpr_read_b32 v83, a11
    v_mul_f32 v83, v83, v97
    v_accvgpr_write_b32 a11, v83
    v_accvgpr_read_b32 v80, a12
    v_mul_f32 v80, v80, v97
    v_accvgpr_write_b32 a12, v80
    v_accvgpr_read_b32 v81, a13
    v_mul_f32 v81, v81, v97
    v_accvgpr_write_b32 a13, v81
    v_accvgpr_read_b32 v82, a14
    v_mul_f32 v82, v82, v97
    v_accvgpr_write_b32 a14, v82
    v_accvgpr_read_b32 v83, a15
    v_mul_f32 v83, v83, v97
    v_accvgpr_write_b32 a15, v83
    v_accvgpr_read_b32 v80, a16
    v_mul_f32 v80, v80, v97
    v_accvgpr_write_b32 a16, v80
    v_accvgpr_read_b32 v81, a17
    v_mul_f32 v81, v81, v97
    v_accvgpr_write_b32 a17, v81
    v_accvgpr_read_b32 v82, a18
    v_mul_f32 v82, v82, v97
    v_accvgpr_write_b32 a18, v82
    v_accvgpr_read_b32 v83, a19
    v_mul_f32 v83, v83, v97
    v_accvgpr_write_b32 a19, v83
    v_accvgpr_read_b32 v80, a20
    v_mul_f32 v80, v80, v97
    v_accvgpr_write_b32 a20, v80
    v_accvgpr_read_b32 v81, a21
    v_mul_f32 v81, v81, v97
    v_accvgpr_write_b32 a21, v81
    v_accvgpr_read_b32 v82, a22
    v_mul_f32 v82, v82, v97
    v_accvgpr_write_b32 a22, v82
    v_accvgpr_read_b32 v83, a23
    v_mul_f32 v83, v83, v97
    v_accvgpr_write_b32 a23, v83
    v_accvgpr_read_b32 v80, a24
    v_mul_f32 v80, v80, v97
    v_accvgpr_write_b32 a24, v80
    v_accvgpr_read_b32 v81, a25
    v_mul_f32 v81, v81, v97
    v_accvgpr_write_b32 a25, v81
    v_accvgpr_read_b32 v82, a26
    v_mul_f32 v82, v82, v97
    v_accvgpr_write_b32 a26, v82
    v_accvgpr_read_b32 v83, a27
    v_mul_f32 v83, v83, v97
    v_accvgpr_write_b32 a27, v83
    v_accvgpr_read_b32 v80, a28
    v_mul_f32 v80, v80, v97
    v_accvgpr_write_b32 a28, v80
    v_accvgpr_read_b32 v81, a29
    v_mul_f32 v81, v81, v97
    v_accvgpr_write_b32 a29, v81
    v_accvgpr_read_b32 v82, a30
    v_mul_f32 v82, v82, v97
    v_accvgpr_write_b32 a30, v82
    v_accvgpr_read_b32 v83, a31
    v_mul_f32 v83, v83, v97
    v_accvgpr_write_b32 a31, v83
    v_accvgpr_read_b32 v80, a32
    v_mul_f32 v80, v80, v97
    v_accvgpr_write_b32 a32, v80
    v_accvgpr_read_b32 v81, a33
    v_mul_f32 v81, v81, v97
    v_accvgpr_write_b32 a33, v81
    v_accvgpr_read_b32 v82, a34
    v_mul_f32 v82, v82, v97
    v_accvgpr_write_b32 a34, v82
    v_accvgpr_read_b32 v83, a35
    v_mul_f32 v83, v83, v97
    v_accvgpr_write_b32 a35, v83
    v_accvgpr_read_b32 v80, a36
    v_mul_f32 v80, v80, v97
    v_accvgpr_write_b32 a36, v80
    v_accvgpr_read_b32 v81, a37
    v_mul_f32 v81, v81, v97
    v_accvgpr_write_b32 a37, v81
    v_accvgpr_read_b32 v82, a38
    v_mul_f32 v82, v82, v97
    v_accvgpr_write_b32 a38, v82
    v_accvgpr_read_b32 v83, a39
    v_mul_f32 v83, v83, v97
    v_accvgpr_write_b32 a39, v83
    v_accvgpr_read_b32 v80, a40
    v_mul_f32 v80, v80, v97
    v_accvgpr_write_b32 a40, v80
    v_accvgpr_read_b32 v81, a41
    v_mul_f32 v81, v81, v97
    v_accvgpr_write_b32 a41, v81
    v_accvgpr_read_b32 v82, a42
    v_mul_f32 v82, v82, v97
    v_accvgpr_write_b32 a42, v82
    v_accvgpr_read_b32 v83, a43
    v_mul_f32 v83, v83, v97
    v_accvgpr_write_b32 a43, v83
    v_accvgpr_read_b32 v80, a44
    v_mul_f32 v80, v80, v97
    v_accvgpr_write_b32 a44, v80
    v_accvgpr_read_b32 v81, a45
    v_mul_f32 v81, v81, v97
    v_accvgpr_write_b32 a45, v81
    v_accvgpr_read_b32 v82, a46
    v_mul_f32 v82, v82, v97
    v_accvgpr_write_b32 a46, v82
    v_accvgpr_read_b32 v83, a47
    v_mul_f32 v83, v83, v97
    v_accvgpr_write_b32 a47, v83
    v_accvgpr_read_b32 v80, a48
    v_mul_f32 v80, v80, v97
    v_accvgpr_write_b32 a48, v80
    v_accvgpr_read_b32 v81, a49
    v_mul_f32 v81, v81, v97
    v_accvgpr_write_b32 a49, v81
    v_accvgpr_read_b32 v82, a50
    v_mul_f32 v82, v82, v97
    v_accvgpr_write_b32 a50, v82
    v_accvgpr_read_b32 v83, a51
    v_mul_f32 v83, v83, v97
    v_accvgpr_write_b32 a51, v83
    v_accvgpr_read_b32 v80, a52
    v_mul_f32 v80, v80, v97
    v_accvgpr_write_b32 a52, v80
    v_accvgpr_read_b32 v81, a53
    v_mul_f32 v81, v81, v97
    v_accvgpr_write_b32 a53, v81
    v_accvgpr_read_b32 v82, a54
    v_mul_f32 v82, v82, v97
    v_accvgpr_write_b32 a54, v82
    v_accvgpr_read_b32 v83, a55
    v_mul_f32 v83, v83, v97
    v_accvgpr_write_b32 a55, v83
    v_accvgpr_read_b32 v80, a56
    v_mul_f32 v80, v80, v97
    v_accvgpr_write_b32 a56, v80
    v_accvgpr_read_b32 v81, a57
    v_mul_f32 v81, v81, v97
    v_accvgpr_write_b32 a57, v81
    v_accvgpr_read_b32 v82, a58
    v_mul_f32 v82, v82, v97
    v_accvgpr_write_b32 a58, v82
    v_accvgpr_read_b32 v83, a59
    v_mul_f32 v83, v83, v97
    v_accvgpr_write_b32 a59, v83
    v_accvgpr_read_b32 v80, a60
    v_mul_f32 v80, v80, v97
    v_accvgpr_write_b32 a60, v80
    v_accvgpr_read_b32 v81, a61
    v_mul_f32 v81, v81, v97
    v_accvgpr_write_b32 a61, v81
    v_accvgpr_read_b32 v82, a62
    v_mul_f32 v82, v82, v97
    v_accvgpr_write_b32 a62, v82
    v_accvgpr_read_b32 v83, a63
    v_mul_f32 v83, v83, v97
    v_accvgpr_write_b32 a63, v83
    v_exp_f32 v80, v16
    v_exp_f32 v81, v17
    s_nop 0
    v_add_f32 v88, v80, v81
    v_cvt_pk_bf16_f32 v64, v80, v81
    v_exp_f32 v80, v18
    v_exp_f32 v81, v19
    v_add_f32 v88, v88, v80
    v_add_f32 v88, v88, v81
    v_cvt_pk_bf16_f32 v65, v80, v81
    v_exp_f32 v80, v20
    v_exp_f32 v81, v21
    v_add_f32 v88, v88, v80
    v_add_f32 v88, v88, v81
    v_cvt_pk_bf16_f32 v66, v80, v81
    v_exp_f32 v80, v22
    v_exp_f32 v81, v23
    v_add_f32 v88, v88, v80
    v_add_f32 v88, v88, v81
    v_cvt_pk_bf16_f32 v67, v80, v81
    v_exp_f32 v80, v24
    v_exp_f32 v81, v25
    v_add_f32 v88, v88, v80
    v_add_f32 v88, v88, v81
    v_cvt_pk_bf16_f32 v68, v80, v81
    v_exp_f32 v80, v26
    v_exp_f32 v81, v27
    v_add_f32 v88, v88, v80
    v_add_f32 v88, v88, v81
    v_cvt_pk_bf16_f32 v69, v80, v81
    v_exp_f32 v80, v28
    v_exp_f32 v81, v29
    v_add_f32 v88, v88, v80
    v_add_f32 v88, v88, v81
    v_cvt_pk_bf16_f32 v70, v80, v81
    v_exp_f32 v80, v30
    v_exp_f32 v81, v31
    v_add_f32 v88, v88, v80
    v_add_f32 v88, v88, v81
    v_cvt_pk_bf16_f32 v71, v80, v81
    v_exp_f32 v80, v32
    v_exp_f32 v81, v33
    v_exp_f32 v82, v34
    s_branch A_r1b_ret
A_r2a:
    v_max3_f32 v96, v32, v33, v34
    v_max3_f32 v96, v96, v35, v36
    v_max3_f32 v96, v96, v37, v38
    v_max3_f32 v96, v96, v39, v40
    v_max3_f32 v96, v96, v41, v42
    v_max3_f32 v96, v96, v43, v44
    v_max3_f32 v96, v96, v45, v46
    v_max_f32 v96, v96, v47
    v_mov_b32 v98, v96
    s_nop 1
    v_permlane32_swap_b32 v96, v98
    v_max_f32 v96, v96, v98
    v_max_f32 v96, 0, v96
    v_exp_f32 v97, -v96
    v_sub_f32 v32, v32, v96
    v_sub_f32 v16, v16, v96
    v_sub_f32 v48, v48, v96
    v_sub_f32 v33, v33, v96
    v_sub_f32 v17, v17, v96
    v_sub_f32 v49, v49, v96
    v_sub_f32 v34, v34, v96
    v_sub_f32 v18, v18, v96
    v_sub_f32 v50, v50, v96
    v_sub_f32 v35, v35, v96
    v_sub_f32 v19, v19, v96
    v_sub_f32 v51, v51, v96
    v_sub_f32 v36, v36, v96
    v_sub_f32 v20, v20, v96
    v_sub_f32 v52, v52, v96
    v_sub_f32 v37, v37, v96
    v_sub_f32 v21, v21, v96
    v_sub_f32 v53, v53, v96
    v_sub_f32 v38, v38, v96
    v_sub_f32 v22, v22, v96
    v_sub_f32 v54, v54, v96
    v_sub_f32 v39, v39, v96
    v_sub_f32 v23, v23, v96
    v_sub_f32 v55, v55, v96
    v_sub_f32 v40, v40, v96
    v_sub_f32 v24, v24, v96
    v_sub_f32 v56, v56, v96
    v_sub_f32 v41, v41, v96
    v_sub_f32 v25, v25, v96
    v_sub_f32 v57, v57, v96
    v_sub_f32 v42, v42, v96
    v_sub_f32 v26, v26, v96
    v_sub_f32 v58, v58, v96
    v_sub_f32 v43, v43, v96
    v_sub_f32 v27, v27, v96
    v_sub_f32 v59, v59, v96
    v_sub_f32 v44, v44, v96
    v_sub_f32 v28, v28, v96
    v_sub_f32 v60, v60, v96
    v_sub_f32 v45, v45, v96
    v_sub_f32 v29, v29, v96
    v_sub_f32 v61, v61, v96
    v_sub_f32 v46, v46, v96
    v_sub_f32 v30, v30, v96
    v_sub_f32 v62, v62, v96
    v_sub_f32 v47, v47, v96
    v_sub_f32 v31, v31, v96
    v_sub_f32 v63, v63, v96
    v_mul_f32 v89, v89, v97
    v_accvgpr_read_b32 v80, a0
    v_mul_f32 v80, v80, v97
    v_accvgpr_write_b32 a0, v80
    v_accvgpr_read_b32 v81, a1
    v_mul_f32 v81, v81, v97
    v_accvgpr_write_b32 a1, v81
    v_accvgpr_read_b32 v82, a2
    v_mul_f32 v82, v82, v97
    v_accvgpr_write_b32 a2, v82
    v_accvgpr_read_b32 v83, a3
    v_mul_f32 v83, v83, v97
    v_accvgpr_write_b32 a3, v83
    v_accvgpr_read_b32 v80, a4
    v_mul_f32 v80, v80, v97
    v_accvgpr_write_b32 a4, v80
    v_accvgpr_read_b32 v81, a5
    v_mul_f32 v81, v81, v97
    v_accvgpr_write_b32 a5, v81
    v_accvgpr_read_b32 v82, a6
    v_mul_f32 v82, v82, v97
    v_accvgpr_write_b32 a6, v82
    v_accvgpr_read_b32 v83, a7
    v_mul_f32 v83, v83, v97
    v_accvgpr_write_b32 a7, v83
    v_accvgpr_read_b32 v80, a8
    v_mul_f32 v80, v80, v97
    v_accvgpr_write_b32 a8, v80
    v_accvgpr_read_b32 v81, a9
    v_mul_f32 v81, v81, v97
    v_accvgpr_write_b32 a9, v81
    v_accvgpr_read_b32 v82, a10
    v_mul_f32 v82, v82, v97
    v_accvgpr_write_b32 a10, v82
    v_accvgpr_read_b32 v83, a11
    v_mul_f32 v83, v83, v97
    v_accvgpr_write_b32 a11, v83
    v_accvgpr_read_b32 v80, a12
    v_mul_f32 v80, v80, v97
    v_accvgpr_write_b32 a12, v80
    v_accvgpr_read_b32 v81, a13
    v_mul_f32 v81, v81, v97
    v_accvgpr_write_b32 a13, v81
    v_accvgpr_read_b32 v82, a14
    v_mul_f32 v82, v82, v97
    v_accvgpr_write_b32 a14, v82
    v_accvgpr_read_b32 v83, a15
    v_mul_f32 v83, v83, v97
    v_accvgpr_write_b32 a15, v83
    v_accvgpr_read_b32 v80, a16
    v_mul_f32 v80, v80, v97
    v_accvgpr_write_b32 a16, v80
    v_accvgpr_read_b32 v81, a17
    v_mul_f32 v81, v81, v97
    v_accvgpr_write_b32 a17, v81
    v_accvgpr_read_b32 v82, a18
    v_mul_f32 v82, v82, v97
    v_accvgpr_write_b32 a18, v82
    v_accvgpr_read_b32 v83, a19
    v_mul_f32 v83, v83, v97
    v_accvgpr_write_b32 a19, v83
    v_accvgpr_read_b32 v80, a20
    v_mul_f32 v80, v80, v97
    v_accvgpr_write_b32 a20, v80
    v_accvgpr_read_b32 v81, a21
    v_mul_f32 v81, v81, v97
    v_accvgpr_write_b32 a21, v81
    v_accvgpr_read_b32 v82, a22
    v_mul_f32 v82, v82, v97
    v_accvgpr_write_b32 a22, v82
    v_accvgpr_read_b32 v83, a23
    v_mul_f32 v83, v83, v97
    v_accvgpr_write_b32 a23, v83
    v_accvgpr_read_b32 v80, a24
    v_mul_f32 v80, v80, v97
    v_accvgpr_write_b32 a24, v80
    v_accvgpr_read_b32 v81, a25
    v_mul_f32 v81, v81, v97
    v_accvgpr_write_b32 a25, v81
    v_accvgpr_read_b32 v82, a26
    v_mul_f32 v82, v82, v97
    v_accvgpr_write_b32 a26, v82
    v_accvgpr_read_b32 v83, a27
    v_mul_f32 v83, v83, v97
    v_accvgpr_write_b32 a27, v83
    v_accvgpr_read_b32 v80, a28
    v_mul_f32 v80, v80, v97
    v_accvgpr_write_b32 a28, v80
    v_accvgpr_read_b32 v81, a29
    v_mul_f32 v81, v81, v97
    v_accvgpr_write_b32 a29, v81
    v_accvgpr_read_b32 v82, a30
    v_mul_f32 v82, v82, v97
    v_accvgpr_write_b32 a30, v82
    v_accvgpr_read_b32 v83, a31
    v_mul_f32 v83, v83, v97
    v_accvgpr_write_b32 a31, v83
    v_accvgpr_read_b32 v80, a32
    v_mul_f32 v80, v80, v97
    v_accvgpr_write_b32 a32, v80
    v_accvgpr_read_b32 v81, a33
    v_mul_f32 v81, v81, v97
    v_accvgpr_write_b32 a33, v81
    v_accvgpr_read_b32 v82, a34
    v_mul_f32 v82, v82, v97
    v_accvgpr_write_b32 a34, v82
    v_accvgpr_read_b32 v83, a35
    v_mul_f32 v83, v83, v97
    v_accvgpr_write_b32 a35, v83
    v_accvgpr_read_b32 v80, a36
    v_mul_f32 v80, v80, v97
    v_accvgpr_write_b32 a36, v80
    v_accvgpr_read_b32 v81, a37
    v_mul_f32 v81, v81, v97
    v_accvgpr_write_b32 a37, v81
    v_accvgpr_read_b32 v82, a38
    v_mul_f32 v82, v82, v97
    v_accvgpr_write_b32 a38, v82
    v_accvgpr_read_b32 v83, a39
    v_mul_f32 v83, v83, v97
    v_accvgpr_write_b32 a39, v83
    v_accvgpr_read_b32 v80, a40
    v_mul_f32 v80, v80, v97
    v_accvgpr_write_b32 a40, v80
    v_accvgpr_read_b32 v81, a41
    v_mul_f32 v81, v81, v97
    v_accvgpr_write_b32 a41, v81
    v_accvgpr_read_b32 v82, a42
    v_mul_f32 v82, v82, v97
    v_accvgpr_write_b32 a42, v82
    v_accvgpr_read_b32 v83, a43
    v_mul_f32 v83, v83, v97
    v_accvgpr_write_b32 a43, v83
    v_accvgpr_read_b32 v80, a44
    v_mul_f32 v80, v80, v97
    v_accvgpr_write_b32 a44, v80
    v_accvgpr_read_b32 v81, a45
    v_mul_f32 v81, v81, v97
    v_accvgpr_write_b32 a45, v81
    v_accvgpr_read_b32 v82, a46
    v_mul_f32 v82, v82, v97
    v_accvgpr_write_b32 a46, v82
    v_accvgpr_read_b32 v83, a47
    v_mul_f32 v83, v83, v97
    v_accvgpr_write_b32 a47, v83
    v_accvgpr_read_b32 v80, a48
    v_mul_f32 v80, v80, v97
    v_accvgpr_write_b32 a48, v80
    v_accvgpr_read_b32 v81, a49
    v_mul_f32 v81, v81, v97
    v_accvgpr_write_b32 a49, v81
    v_accvgpr_read_b32 v82, a50
    v_mul_f32 v82, v82, v97
    v_accvgpr_write_b32 a50, v82
    v_accvgpr_read_b32 v83, a51
    v_mul_f32 v83, v83, v97
    v_accvgpr_write_b32 a51, v83
    v_accvgpr_read_b32 v80, a52
    v_mul_f32 v80, v80, v97
    v_accvgpr_write_b32 a52, v80
    v_accvgpr_read_b32 v81, a53
    v_mul_f32 v81, v81, v97
    v_accvgpr_write_b32 a53, v81
    v_accvgpr_read_b32 v82, a54
    v_mul_f32 v82, v82, v97
    v_accvgpr_write_b32 a54, v82
    v_accvgpr_read_b32 v83, a55
    v_mul_f32 v83, v83, v97
    v_accvgpr_write_b32 a55, v83
    v_accvgpr_read_b32 v80, a56
    v_mul_f32 v80, v80, v97
    v_accvgpr_write_b32 a56, v80
    v_accvgpr_read_b32 v81, a57
    v_mul_f32 v81, v81, v97
    v_accvgpr_write_b32 a57, v81
    v_accvgpr_read_b32 v82, a58
    v_mul_f32 v82, v82, v97
    v_accvgpr_write_b32 a58, v82
    v_accvgpr_read_b32 v83, a59
    v_mul_f32 v83, v83, v97
    v_accvgpr_write_b32 a59, v83
    v_accvgpr_read_b32 v80, a60
    v_mul_f32 v80, v80, v97
    v_accvgpr_write_b32 a60, v80
    v_accvgpr_read_b32 v81, a61
    v_mul_f32 v81, v81, v97
    v_accvgpr_write_b32 a61, v81
    v_accvgpr_read_b32 v82, a62
    v_mul_f32 v82, v82, v97
    v_accvgpr_write_b32 a62, v82
    v_accvgpr_read_b32 v83, a63
    v_mul_f32 v83, v83, v97
    v_accvgpr_write_b32 a63, v83
    v_exp_f32 v80, v32
    v_exp_f32 v81, v33
    s_nop 0
    v_add_f32 v88, v80, v81
    v_cvt_pk_bf16_f32 v72, v80, v81
    v_exp_f32 v80, v34
    v_exp_f32 v81, v35
    v_add_f32 v88, v88, v80
    v_add_f32 v88, v88, v81
    v_cvt_pk_bf16_f32 v73, v80, v81
    v_exp_f32 v80, v36
    v_exp_f32 v81, v37
    v_add_f32 v88, v88, v80
    v_add_f32 v88, v88, v81
    v_cvt_pk_bf16_f32 v74, v80, v81
    v_exp_f32 v80, v38
    v_exp_f32 v81, v39
    v_add_f32 v88, v88, v80
    v_add_f32 v88, v88, v81
    v_cvt_pk_bf16_f32 v75, v80, v81
    v_exp_f32 v80, v40
    v_exp_f32 v81, v41
    v_add_f32 v88, v88, v80
    v_add_f32 v88, v88, v81
    v_cvt_pk_bf16_f32 v76, v80, v81
    v_exp_f32 v80, v42
    v_exp_f32 v81, v43
    v_add_f32 v88, v88, v80
    v_add_f32 v88, v88, v81
    v_cvt_pk_bf16_f32 v77, v80, v81
    v_exp_f32 v80, v44
    v_exp_f32 v81, v45
    v_add_f32 v88, v88, v80
    v_add_f32 v88, v88, v81
    v_cvt_pk_bf16_f32 v78, v80, v81
    v_exp_f32 v80, v46
    v_exp_f32 v81, v47
    v_add_f32 v88, v88, v80
    v_add_f32 v88, v88, v81
    v_cvt_pk_bf16_f32 v79, v80, v81
    v_exp_f32 v80, v16
    v_exp_f32 v81, v17
    v_exp_f32 v82, v18
    s_branch A_r2a_ret
K2_B:
    s_waitcnt lgkmcnt(0)
    s_waitcnt vmcnt(5)
    s_barrier
    s_lshl_b32 s38, s3, 10
    s_add_u32 s38, s38, 98304
    v_add_u32 v18, s38, v2
    ds_read_b128 v[28:31], v18
    v_lshrrev_b32 v18, 3, v1
    v_lshlrev_b32 v18, 9, v18
    v_and_b32 v19, 7, v1
    v_lshl_add_u32 v18, v19, 4, v18
    s_lshr_b32 s38, s2, 2
    s_lshl_b32 s38, s38, 15
    s_and_b32 s39, s2, 3
    s_lshl_b32 s39, s39, 7
    s_add_u32 s38, s38, s39
    s_lshl_b32 s39, s3, 12
    s_add_u32 s38, s38, s39
    s_add_u32 s38, s38, 33554432
    s_waitcnt lgkmcnt(0)
    buffer_store_dwordx4 v[28:31], v18, s[28:31], s38 offen sc1
    ds_read_b128 v[32:35], v12
    ds_read_b128 v[36:39], v13
    ds_read_b64_tr_b16 v[48:49], v14 offset:0
    ds_read_b64_tr_b16 v[50:51], v14 offset:1024
    ds_read_b64_tr_b16 v[52:53], v15 offset:0
    ds_read_b64_tr_b16 v[54:55], v15 offset:1024
    ds_read_b64_tr_b16 v[56:57], v16 offset:0
    ds_read_b64_tr_b16 v[58:59], v16 offset:1024
    ds_read_b64_tr_b16 v[60:61], v17 offset:0
    ds_read_b64_tr_b16 v[62:63], v17 offset:1024
    v_lshrrev_b32 v18, 5, v1
    v_lshlrev_b32 v18, 3, v18
    v_bfe_u32 v19, v1, 2, 2
    v_add_u32 v18, v18, v19
    v_mul_u32_u24 v18, 192, v18
    v_bfe_u32 v19, v1, 4, 1
    v_lshlrev_b32 v19, 5, v19
    v_add_u32 v18, v18, v19
    v_and_b32 v19, 3, v1
    v_lshlrev_b32 v19, 3, v19
    v_add_u32 v18, v18, v19
    v_add_u32 v24, 65536, v18
    v_add_u32 v25, 114688, v18
    s_waitcnt lgkmcnt(6)
    v_mfma_f32_32x32x16_bf16 a[0:15], v[48:51], v[32:35], 0
    ds_read_b64_tr_b16 v[64:65], v14 offset:8192
    ds_read_b64_tr_b16 v[66:67], v14 offset:9216
    s_waitcnt lgkmcnt(6)
    v_mfma_f32_32x32x16_bf16 a[16:31], v[52:55], v[32:35], 0
    ds_read_b64_tr_b16 v[68:69], v15 offset:8192
    ds_read_b64_tr_b16 v[70:71], v15 offset:9216
    s_add_u32 m0, s57, 32768
    s_add_u32 s38, s67, 128
    buffer_load_dwordx4 v10, s[52:55], s38 offen offset:0 lds
    s_waitcnt lgkmcnt(6)
    v_mfma_f32_32x32x16_bf16 a[32:47], v[56:59], v[32:35], 0
    ds_read_b64_tr_b16 v[72:73], v16 offset:8192
    ds_read_b64_tr_b16 v[74:75], v16 offset:9216
    s_waitcnt lgkmcnt(6)
    v_mfma_f32_32x32x16_bf16 a[48:63], v[60:63], v[32:35], 0
    ds_read_b64_tr_b16 v[76:77], v17 offset:8192
    ds_read_b64_tr_b16 v[78:79], v17 offset:9216
    s_add_u32 m0, s57, 32768
    s_add_u32 s38, s67, 128
    buffer_load_dwordx4 v11, s[52:55], s38 offen offset:1024 lds
    s_waitcnt lgkmcnt(6)
    v_mfma_f32_32x32x16_bf16 a[64:79], v[32:35], v[64:67], 0
    ds_read_b64_tr_b16 v[48:49], v14 offset:4096
    ds_read_b64_tr_b16 v[50:51], v14 offset:5120
    s_waitcnt lgkmcnt(6)
    v_mfma_f32_32x32x16_bf16 a[80:95], v[32:35], v[68:71], 0
    ds_read_b64_tr_b16 v[52:53], v15 offset:4096
    ds_read_b64_tr_b16 v[54:55], v15 offset:5120
    s_lshr_b32 s39, s57, 1
    s_add_u32 m0, s39, 49152
    s_add_u32 s38, s99, 524288
    buffer_load_dwordx4 v8, s[68:71], s38 offen lds
    s_waitcnt lgkmcnt(6)
    v_mfma_f32_32x32x16_bf16 a[96:111], v[32:35], v[72:75], 0
    ds_read_b64_tr_b16 v[56:57], v16 offset:4096
    ds_read_b64_tr_b16 v[58:59], v16 offset:5120
    s_waitcnt lgkmcnt(6)
    v_mfma_f32_32x32x16_bf16 a[112:127], v[32:35], v[76:79], 0
    ds_read_b64_tr_b16 v[60:61], v17 offset:4096
    ds_read_b64_tr_b16 v[62:63], v17 offset:5120
    s_lshr_b32 s39, s57, 1
    s_add_u32 m0, s39, 57344
    s_add_u32 s38, s99, 524288
    buffer_load_dwordx4 v8, s[72:75], s38 offen lds
    s_waitcnt lgkmcnt(6)
    v_mfma_f32_32x32x16_bf16 a[0:15], v[48:51], v[36:39], a[0:15]
    ds_read_b64_tr_b16 v[64:65], v14 offset:12288
    ds_read_b64_tr_b16 v[66:67], v14 offset:13312
    s_waitcnt lgkmcnt(6)
    v_mfma_f32_32x32x16_bf16 a[16:31], v[52:55], v[36:39], a[16:31]
    ds_read_b64_tr_b16 v[68:69], v15 offset:12288
    ds_read_b64_tr_b16 v[70:71], v15 offset:13312
    buffer_load_dwordx4 v[104:107], v99, s[76:79], 0 offen
    s_waitcnt lgkmcnt(6)
    v_mfma_f32_32x32x16_bf16 a[32:47], v[56:59], v[36:39], a[32:47]
    ds_read_b64_tr_b16 v[72:73], v16 offset:12288
    ds_read_b64_tr_b16 v[74:75], v16 offset:13312
    s_waitcnt lgkmcnt(6)
    v_mfma_f32_32x32x16_bf16 a[48:63], v[60:63], v[36:39], a[48:63]
    s_waitcnt vmcnt(7)
    s_barrier
    v_add_u32 v12, 0xfffe0000, v12
    v_add_u32 v13, 0xfffe0000, v13
    ds_read_b128 v[40:43], v12
    ds_read_b128 v[44:47], v13
    ds_read_b64_tr_b16 v[76:77], v17 offset:12288
    ds_read_b64_tr_b16 v[78:79], v17 offset:13312
    buffer_load_dwordx4 v[108:111], v100, s[80:83], 0 offen
    s_waitcnt lgkmcnt(8)
    v_mfma_f32_32x32x16_bf16 a[64:79], v[36:39], v[64:67], a[64:79]
    v_add_u32 v14, 0xfffe0000, v14
    v_add_u32 v15, 0xfffe0000, v15
    v_add_u32 v16, 0xfffe0000, v16
    v_add_u32 v17, 0xfffe0000, v17
    ds_read_b64_tr_b16 v[48:49], v14 offset:0
    ds_read_b64_tr_b16 v[50:51], v14 offset:1024
    s_waitcnt lgkmcnt(8)
    v_mfma_f32_32x32x16_bf16 a[80:95], v[36:39], v[68:71], a[80:95]
    ds_read_b64_tr_b16 v[52:53], v15 offset:0
    ds_read_b64_tr_b16 v[54:55], v15 offset:1024
    buffer_load_dwordx4 v[120:123], v115, s[76:79], 0 offen
    s_waitcnt lgkmcnt(8)
    v_mfma_f32_32x32x16_bf16 a[96:111], v[36:39], v[72:75], a[96:111]
    ds_read_b64_tr_b16 v[56:57], v16 offset:0
    ds_read_b64_tr_b16 v[58:59], v16 offset:1024
    s_waitcnt lgkmcnt(6)
    v_mfma_f32_32x32x16_bf16 a[112:127], v[36:39], v[76:79], a[112:127]
    ds_read_b64_tr_b16 v[60:61], v17 offset:0
    ds_read_b64_tr_b16 v[62:63], v17 offset:1024
    buffer_load_dwordx4 v[124:127], v116, s[80:83], 0 offen
    s_waitcnt lgkmcnt(6)
    v_mfma_f32_32x32x16_bf16 a[0:15], v[48:51], v[40:43], a[0:15]
    ds_read_b64_tr_b16 v[64:65], v14 offset:8192
    ds_read_b64_tr_b16 v[66:67], v14 offset:9216
    s_waitcnt lgkmcnt(6)
    v_mfma_f32_32x32x16_bf16 a[16:31], v[52:55], v[40:43], a[16:31]
    ds_read_b64_tr_b16 v[68:69], v15 offset:8192
    ds_read_b64_tr_b16 v[70:71], v15 offset:9216
    s_add_u32 m0, s57, 65536
    s_add_u32 s38, s67, 192
    buffer_load_dwordx4 v10, s[52:55], s38 offen offset:0 lds
    s_waitcnt lgkmcnt(6)
    v_mfma_f32_32x32x16_bf16 a[32:47], v[56:59], v[40:43], a[32:47]
    ds_read_b64_tr_b16 v[72:73], v16 offset:8192
    ds_read_b64_tr_b16 v[74:75], v16 offset:9216
    s_waitcnt lgkmcnt(6)
    v_mfma_f32_32x32x16_bf16 a[48:63], v[60:63], v[40:43], a[48:63]
    ds_read_b64_tr_b16 v[76:77], v17 offset:8192
    ds_read_b64_tr_b16 v[78:79], v17 offset:9216
    s_add_u32 m0, s57, 65536
    s_add_u32 s38, s67, 192
    buffer_load_dwordx4 v11, s[52:55], s38 offen offset:1024 lds
    s_waitcnt lgkmcnt(6)
    v_mfma_f32_32x32x16_bf16 a[64:79], v[40:43], v[64:67], a[64:79]
    ds_read_b64_tr_b16 v[48:49], v14 offset:4096
    ds_read_b64_tr_b16 v[50:51], v14 offset:5120
    s_waitcnt lgkmcnt(6)
    v_mfma_f32_32x32x16_bf16 a[80:95], v[40:43], v[68:71], a[80:95]
    ds_read_b64_tr_b16 v[52:53], v15 offset:4096
    ds_read_b64_tr_b16 v[54:55], v15 offset:5120
    s_lshr_b32 s39, s57, 1
    s_add_u32 m0, s39, 81920
    s_add_u32 s38, s99, 786432
    buffer_load_dwordx4 v8, s[68:71], s38 offen lds
    s_waitcnt lgkmcnt(6)
    v_mfma_f32_32x32x16_bf16 a[96:111], v[40:43], v[72:75], a[96:111]
    ds_read_b64_tr_b16 v[56:57], v16 offset:4096
    ds_read_b64_tr_b16 v[58:59], v16 offset:5120
    s_waitcnt lgkmcnt(6)
    v_mfma_f32_32x32x16_bf16 a[112:127], v[40:43], v[76:79], a[112:127]
    ds_read_b64_tr_b16 v[60:61], v17 offset:4096
    ds_read_b64_tr_b16 v[62:63], v17 offset:5120
    s_lshr_b32 s39, s57, 1
    s_add_u32 m0, s39, 90112
    s_add_u32 s38, s99, 786432
    buffer_load_dwordx4 v8, s[72:75], s38 offen lds
    s_waitcnt lgkmcnt(6)
    v_mfma_f32_32x32x16_bf16 a[0:15], v[48:51], v[44:47], a[0:15]
    ds_read_b64_tr_b16 v[64:65], v14 offset:12288
    ds_read_b64_tr_b16 v[66:67], v14 offset:13312
    s_waitcnt lgkmcnt(6)
    v_mfma_f32_32x32x16_bf16 a[16:31], v[52:55], v[44:47], a[16:31]
    ds_read_b64_tr_b16 v[68:69], v15 offset:12288
    ds_read_b64_tr_b16 v[70:71], v15 offset:13312
    s_add_u32 m0, s57, 98304
    s_add_u32 s38, s67, 256
    buffer_load_dwordx4 v10, s[52:55], s38 offen offset:0 lds
    s_waitcnt lgkmcnt(6)
    v_mfma_f32_32x32x16_bf16 a[32:47], v[56:59], v[44:47], a[32:47]
    ds_read_b64_tr_b16 v[72:73], v16 offset:12288
    ds_read_b64_tr_b16 v[74:75], v16 offset:13312
    s_waitcnt lgkmcnt(6)
    v_mfma_f32_32x32x16_bf16 a[48:63], v[60:63], v[44:47], a[48:63]
    s_waitcnt vmcnt(9)
    s_barrier
    v_add_u32 v12, 0x8000, v12
    v_add_u32 v13, 0x8000, v13
    ds_read_b128 v[32:35], v12
    ds_read_b128 v[36:39], v13
    ds_read_b64_tr_b16 v[76:77], v17 offset:12288
    ds_read_b64_tr_b16 v[78:79], v17 offset:13312
    s_add_u32 m0, s57, 98304
    s_add_u32 s38, s67, 256
    buffer_load_dwordx4 v11, s[52:55], s38 offen offset:1024 lds
    s_waitcnt lgkmcnt(8)
    v_mfma_f32_32x32x16_bf16 a[64:79], v[44:47], v[64:67], a[64:79]
    v_add_u32 v14, 0x8000, v14
    v_add_u32 v15, 0x8000, v15
    v_add_u32 v16, 0x8000, v16
    v_add_u32 v17, 0x8000, v17
    ds_read_b64_tr_b16 v[48:49], v14 offset:0
    ds_read_b64_tr_b16 v[50:51], v14 offset:1024
    s_waitcnt lgkmcnt(8)
    v_mfma_f32_32x32x16_bf16 a[80:95], v[44:47], v[68:71], a[80:95]
    ds_read_b64_tr_b16 v[52:53], v15 offset:0
    ds_read_b64_tr_b16 v[54:55], v15 offset:1024
    s_lshr_b32 s39, s57, 1
    s_add_u32 m0, s39, 114688
    s_add_u32 s38, s99, 1048576
    buffer_load_dwordx4 v8, s[68:71], s38 offen lds
    s_waitcnt lgkmcnt(8)
    v_mfma_f32_32x32x16_bf16 a[96:111], v[44:47], v[72:75], a[96:111]
    ds_read_b64_tr_b16 v[56:57], v16 offset:0
    ds_read_b64_tr_b16 v[58:59], v16 offset:1024
    s_waitcnt lgkmcnt(6)
    v_mfma_f32_32x32x16_bf16 a[112:127], v[44:47], v[76:79], a[112:127]
    ds_read_b64_tr_b16 v[60:61], v17 offset:0
    ds_read_b64_tr_b16 v[62:63], v17 offset:1024
    s_lshr_b32 s39, s57, 1
    s_add_u32 m0, s39, 122880
    s_add_u32 s38, s99, 1048576
    buffer_load_dwordx4 v8, s[72:75], s38 offen lds
    s_waitcnt lgkmcnt(6)
    v_mfma_f32_32x32x16_bf16 a[0:15], v[48:51], v[32:35], a[0:15]
    ds_read_b64_tr_b16 v[64:65], v14 offset:8192
    ds_read_b64_tr_b16 v[66:67], v14 offset:9216
    s_waitcnt lgkmcnt(6)
    v_mfma_f32_32x32x16_bf16 a[16:31], v[52:55], v[32:35], a[16:31]
    ds_read_b64_tr_b16 v[68:69], v15 offset:8192
    ds_read_b64_tr_b16 v[70:71], v15 offset:9216
    s_lshr_b32 s38, s2, 3
    s_lshl_b32 s38, s38, 4
    s_and_b32 s39, s3, 3
    s_lshl_b32 s39, s39, 2
    s_add_u32 s38, s38, s39
    s_lshl_b32 s38, s38, 13
    s_and_b32 s39, s2, 7
    s_lshl_b32 s39, s39, 10
    s_add_u32 s38, s38, s39
    buffer_load_dword v3, v27, s[72:75], s38 offen
    s_waitcnt lgkmcnt(6)
    v_mfma_f32_32x32x16_bf16 a[32:47], v[56:59], v[32:35], a[32:47]
    ds_read_b64_tr_b16 v[72:73], v16 offset:8192
    ds_read_b64_tr_b16 v[74:75], v16 offset:9216
    s_waitcnt vmcnt(11)
    v_or_b32 v104, v104, v108
    s_waitcnt lgkmcnt(6)
    v_mfma_f32_32x32x16_bf16 a[48:63], v[60:63], v[32:35], a[48:63]
    ds_read_b64_tr_b16 v[76:77], v17 offset:8192
    ds_read_b64_tr_b16 v[78:79], v17 offset:9216
    v_or_b32 v105, v105, v109
    s_add_u32 m0, s57, 131072
    s_add_u32 s38, s67, 320
    buffer_load_dwordx4 v10, s[52:55], s38 offen offset:0 lds
    s_waitcnt lgkmcnt(6)
    v_mfma_f32_32x32x16_bf16 a[64:79], v[32:35], v[64:67], a[64:79]
    ds_read_b64_tr_b16 v[48:49], v14 offset:4096
    ds_read_b64_tr_b16 v[50:51], v14 offset:5120
    v_or_b32 v106, v106, v110
    s_waitcnt lgkmcnt(6)
    v_mfma_f32_32x32x16_bf16 a[80:95], v[32:35], v[68:71], a[80:95]
    ds_read_b64_tr_b16 v[52:53], v15 offset:4096
    ds_read_b64_tr_b16 v[54:55], v15 offset:5120
    v_or_b32 v107, v107, v111
    s_add_u32 m0, s57, 131072
    s_add_u32 s38, s67, 320
    buffer_load_dwordx4 v11, s[52:55], s38 offen offset:1024 lds
    s_waitcnt lgkmcnt(6)
    v_mfma_f32_32x32x16_bf16 a[96:111], v[32:35], v[72:75], a[96:111]
    ds_read_b64_tr_b16 v[56:57], v16 offset:4096
    ds_read_b64_tr_b16 v[58:59], v16 offset:5120
    buffer_store_dwordx4 v[104:107], v96, s[28:31], s58 offen sc1
    s_waitcnt lgkmcnt(6)
    v_mfma_f32_32x32x16_bf16 a[112:127], v[32:35], v[76:79], a[112:127]
    ds_read_b64_tr_b16 v[60:61], v17 offset:4096
    ds_read_b64_tr_b16 v[62:63], v17 offset:5120
    s_waitcnt vmcnt(12)
    v_or_b32 v120, v120, v124
    s_lshr_b32 s39, s57, 1
    s_add_u32 m0, s39, 147456
    s_add_u32 s38, s99, 1310720
    buffer_load_dwordx4 v8, s[68:71], s38 offen lds
    s_waitcnt lgkmcnt(6)
    v_mfma_f32_32x32x16_bf16 a[0:15], v[48:51], v[36:39], a[0:15]
    ds_read_b64_tr_b16 v[64:65], v14 offset:12288
    ds_read_b64_tr_b16 v[66:67], v14 offset:13312
    v_or_b32 v121, v121, v125
    s_waitcnt lgkmcnt(6)
    v_mfma_f32_32x32x16_bf16 a[16:31], v[52:55], v[36:39], a[16:31]
    ds_read_b64_tr_b16 v[68:69], v15 offset:12288
    ds_read_b64_tr_b16 v[70:71], v15 offset:13312
    v_or_b32 v122, v122, v126
    s_lshr_b32 s39, s57, 1
    s_add_u32 m0, s39, 155648
    s_add_u32 s38, s99, 1310720
    buffer_load_dwordx4 v8, s[72:75], s38 offen lds
    s_waitcnt lgkmcnt(6)
    v_mfma_f32_32x32x16_bf16 a[32:47], v[56:59], v[36:39], a[32:47]
    ds_read_b64_tr_b16 v[72:73], v16 offset:12288
    ds_read_b64_tr_b16 v[74:75], v16 offset:13312
    v_or_b32 v123, v123, v127
    s_waitcnt lgkmcnt(6)
    v_mfma_f32_32x32x16_bf16 a[48:63], v[60:63], v[36:39], a[48:63]
    s_waitcnt vmcnt(10)
    s_barrier
    v_add_u32 v12, 0x8000, v12
    v_add_u32 v13, 0x8000, v13
    ds_read_b128 v[40:43], v12
    ds_read_b128 v[44:47], v13
    ds_read_b64_tr_b16 v[76:77], v17 offset:12288
    ds_read_b64_tr_b16 v[78:79], v17 offset:13312
    buffer_store_dwordx4 v[120:123], v112, s[28:31], s58 offen sc1
    s_waitcnt lgkmcnt(8)
    v_mfma_f32_32x32x16_bf16 a[64:79], v[36:39], v[64:67], a[64:79]
    v_add_u32 v14, 0x8000, v14
    v_add_u32 v15, 0x8000, v15
    v_add_u32 v16, 0x8000, v16
    v_add_u32 v17, 0x8000, v17
    ds_read_b64_tr_b16 v[48:49], v14 offset:0
    ds_read_b64_tr_b16 v[50:51], v14 offset:1024
    s_waitcnt lgkmcnt(8)
    v_mfma_f32_32x32x16_bf16 a[80:95], v[36:39], v[68:71], a[80:95]
    ds_read_b64_tr_b16 v[52:53], v15 offset:0
    ds_read_b64_tr_b16 v[54:55], v15 offset:1024
    s_waitcnt lgkmcnt(8)
    v_mfma_f32_32x32x16_bf16 a[96:111], v[36:39], v[72:75], a[96:111]
    ds_read_b64_tr_b16 v[56:57], v16 offset:0
    ds_read_b64_tr_b16 v[58:59], v16 offset:1024
    s_waitcnt lgkmcnt(6)
    v_mfma_f32_32x32x16_bf16 a[112:127], v[36:39], v[76:79], a[112:127]
    ds_read_b64_tr_b16 v[60:61], v17 offset:0
    ds_read_b64_tr_b16 v[62:63], v17 offset:1024
    s_waitcnt lgkmcnt(6)
    v_mfma_f32_32x32x16_bf16 a[0:15], v[48:51], v[40:43], a[0:15]
    ds_read_b64_tr_b16 v[64:65], v14 offset:8192
    ds_read_b64_tr_b16 v[66:67], v14 offset:9216
    s_waitcnt lgkmcnt(6)
    v_mfma_f32_32x32x16_bf16 a[16:31], v[52:55], v[40:43], a[16:31]
    ds_read_b64_tr_b16 v[68:69], v15 offset:8192
    ds_read_b64_tr_b16 v[70:71], v15 offset:9216
    s_add_u32 m0, s57, 0
    s_add_u32 s38, s67, 384
    buffer_load_dwordx4 v10, s[52:55], s38 offen offset:0 lds
    s_waitcnt lgkmcnt(6)
    v_mfma_f32_32x32x16_bf16 a[32:47], v[56:59], v[40:43], a[32:47]
    ds_read_b64_tr_b16 v[72:73], v16 offset:8192
    ds_read_b64_tr_b16 v[74:75], v16 offset:9216
    s_waitcnt lgkmcnt(6)
    v_mfma_f32_32x32x16_bf16 a[48:63], v[60:63], v[40:43], a[48:63]
    ds_read_b64_tr_b16 v[76:77], v17 offset:8192
    ds_read_b64_tr_b16 v[78:79], v17 offset:9216
    s_add_u32 m0, s57, 0
    s_add_u32 s38, s67, 384
    buffer_load_dwordx4 v11, s[52:55], s38 offen offset:1024 lds
    s_waitcnt lgkmcnt(6)
    v_mfma_f32_32x32x16_bf16 a[64:79], v[40:43], v[64:67], a[64:79]
    ds_read_b64_tr_b16 v[48:49], v14 offset:4096
    ds_read_b64_tr_b16 v[50:51], v14 offset:5120
    s_waitcnt lgkmcnt(6)
    v_mfma_f32_32x32x16_bf16 a[80:95], v[40:43], v[68:71], a[80:95]
    ds_read_b64_tr_b16 v[52:53], v15 offset:4096
    ds_read_b64_tr_b16 v[54:55], v15 offset:5120
    s_lshr_b32 s39, s57, 1
    s_add_u32 m0, s39, 16384
    s_add_u32 s38, s99, 1572864
    buffer_load_dwordx4 v8, s[68:71], s38 offen lds
    s_waitcnt lgkmcnt(6)
    v_mfma_f32_32x32x16_bf16 a[96:111], v[40:43], v[72:75], a[96:111]
    ds_read_b64_tr_b16 v[56:57], v16 offset:4096
    ds_read_b64_tr_b16 v[58:59], v16 offset:5120
    s_waitcnt lgkmcnt(6)
    v_mfma_f32_32x32x16_bf16 a[112:127], v[40:43], v[76:79], a[112:127]
    ds_read_b64_tr_b16 v[60:61], v17 offset:4096
    ds_read_b64_tr_b16 v[62:63], v17 offset:5120
    s_lshr_b32 s39, s57, 1
    s_add_u32 m0, s39, 24576
    s_add_u32 s38, s99, 1572864
    buffer_load_dwordx4 v8, s[72:75], s38 offen lds
    s_waitcnt lgkmcnt(6)
    v_mfma_f32_32x32x16_bf16 a[0:15], v[48:51], v[44:47], a[0:15]
    ds_read_b64_tr_b16 v[64:65], v14 offset:12288
    ds_read_b64_tr_b16 v[66:67], v14 offset:13312
    s_waitcnt lgkmcnt(6)
    v_mfma_f32_32x32x16_bf16 a[16:31], v[52:55], v[44:47], a[16:31]
    ds_read_b64_tr_b16 v[68:69], v15 offset:12288
    ds_read_b64_tr_b16 v[70:71], v15 offset:13312
    s_waitcnt lgkmcnt(6)
    v_mfma_f32_32x32x16_bf16 a[32:47], v[56:59], v[44:47], a[32:47]
    ds_read_b64_tr_b16 v[72:73], v16 offset:12288
    ds_read_b64_tr_b16 v[74:75], v16 offset:13312
    s_waitcnt lgkmcnt(6)
    v_mfma_f32_32x32x16_bf16 a[48:63], v[60:63], v[44:47], a[48:63]
    s_waitcnt vmcnt(4)
    s_barrier
    v_add_u32 v12, 0x8000, v12
    v_add_u32 v13, 0x8000, v13
    ds_read_b128 v[32:35], v12
    ds_read_b128 v[36:39], v13
    ds_read_b64_tr_b16 v[76:77], v17 offset:12288
    ds_read_b64_tr_b16 v[78:79], v17 offset:13312
    s_waitcnt lgkmcnt(8)
    v_mfma_f32_32x32x16_bf16 a[64:79], v[44:47], v[64:67], a[64:79]
    v_add_u32 v14, 0x8000, v14
    v_add_u32 v15, 0x8000, v15
    v_add_u32 v16, 0x8000, v16
    v_add_u32 v17, 0x8000, v17
    ds_read_b64_tr_b16 v[48:49], v14 offset:0
    ds_read_b64_tr_b16 v[50:51], v14 offset:1024
    s_waitcnt lgkmcnt(8)
    v_mfma_f32_32x32x16_bf16 a[80:95], v[44:47], v[68:71], a[80:95]
    ds_read_b64_tr_b16 v[52:53], v15 offset:0
    ds_read_b64_tr_b16 v[54:55], v15 offset:1024
    s_waitcnt lgkmcnt(8)
    v_mfma_f32_32x32x16_bf16 a[96:111], v[44:47], v[72:75], a[96:111]
    ds_read_b64_tr_b16 v[56:57], v16 offset:0
    ds_read_b64_tr_b16 v[58:59], v16 offset:1024
    s_waitcnt lgkmcnt(6)
    v_mfma_f32_32x32x16_bf16 a[112:127], v[44:47], v[76:79], a[112:127]
    ds_read_b64_tr_b16 v[60:61], v17 offset:0
    ds_read_b64_tr_b16 v[62:63], v17 offset:1024
    s_waitcnt lgkmcnt(6)
    v_mfma_f32_32x32x16_bf16 a[0:15], v[48:51], v[32:35], a[0:15]
    ds_read_b64_tr_b16 v[64:65], v14 offset:8192
    ds_read_b64_tr_b16 v[66:67], v14 offset:9216
    s_waitcnt lgkmcnt(6)
    v_mfma_f32_32x32x16_bf16 a[16:31], v[52:55], v[32:35], a[16:31]
    ds_read_b64_tr_b16 v[68:69], v15 offset:8192
    ds_read_b64_tr_b16 v[70:71], v15 offset:9216
    s_add_u32 m0, s57, 32768
    s_add_u32 s38, s67, 448
    buffer_load_dwordx4 v10, s[52:55], s38 offen offset:0 lds
    s_waitcnt lgkmcnt(6)
    v_mfma_f32_32x32x16_bf16 a[32:47], v[56:59], v[32:35], a[32:47]
    ds_read_b64_tr_b16 v[72:73], v16 offset:8192
    ds_read_b64_tr_b16 v[74:75], v16 offset:9216
    s_waitcnt lgkmcnt(6)
    v_mfma_f32_32x32x16_bf16 a[48:63], v[60:63], v[32:35], a[48:63]
    ds_read_b64_tr_b16 v[76:77], v17 offset:8192
    ds_read_b64_tr_b16 v[78:79], v17 offset:9216
    s_add_u32 m0, s57, 32768
    s_add_u32 s38, s67, 448
    buffer_load_dwordx4 v11, s[52:55], s38 offen offset:1024 lds
    s_waitcnt lgkmcnt(6)
    v_mfma_f32_32x32x16_bf16 a[64:79], v[32:35], v[64:67], a[64:79]
    ds_read_b64_tr_b16 v[48:49], v14 offset:4096
    ds_read_b64_tr_b16 v[50:51], v14 offset:5120
    s_waitcnt lgkmcnt(6)
    v_mfma_f32_32x32x16_bf16 a[80:95], v[32:35], v[68:71], a[80:95]
    ds_read_b64_tr_b16 v[52:53], v15 offset:4096
    ds_read_b64_tr_b16 v[54:55], v15 offset:5120
    s_lshr_b32 s39, s57, 1
    s_add_u32 m0, s39, 49152
    s_add_u32 s38, s99, 1835008
    buffer_load_dwordx4 v8, s[68:71], s38 offen lds
    s_waitcnt lgkmcnt(6)
    v_mfma_f32_32x32x16_bf16 a[96:111], v[32:35], v[72:75], a[96:111]
    ds_read_b64_tr_b16 v[56:57], v16 offset:4096
    ds_read_b64_tr_b16 v[58:59], v16 offset:5120
    s_waitcnt lgkmcnt(6)
    v_mfma_f32_32x32x16_bf16 a[112:127], v[32:35], v[76:79], a[112:127]
    ds_read_b64_tr_b16 v[60:61], v17 offset:4096
    ds_read_b64_tr_b16 v[62:63], v17 offset:5120
    s_lshr_b32 s39, s57, 1
    s_add_u32 m0, s39, 57344
    s_add_u32 s38, s99, 1835008
    buffer_load_dwordx4 v8, s[72:75], s38 offen lds
    s_waitcnt lgkmcnt(6)
    v_mfma_f32_32x32x16_bf16 a[0:15], v[48:51], v[36:39], a[0:15]
    ds_read_b64_tr_b16 v[64:65], v14 offset:12288
    ds_read_b64_tr_b16 v[66:67], v14 offset:13312
    s_waitcnt lgkmcnt(6)
    v_mfma_f32_32x32x16_bf16 a[16:31], v[52:55], v[36:39], a[16:31]
    ds_read_b64_tr_b16 v[68:69], v15 offset:12288
    ds_read_b64_tr_b16 v[70:71], v15 offset:13312
    s_waitcnt lgkmcnt(6)
    v_mfma_f32_32x32x16_bf16 a[32:47], v[56:59], v[36:39], a[32:47]
    ds_read_b64_tr_b16 v[72:73], v16 offset:12288
    ds_read_b64_tr_b16 v[74:75], v16 offset:13312
    s_waitcnt lgkmcnt(6)
    v_mfma_f32_32x32x16_bf16 a[48:63], v[60:63], v[36:39], a[48:63]
    s_barrier
    v_add_u32 v12, 0x8000, v12
    v_add_u32 v13, 0x8000, v13
    ds_read_b128 v[40:43], v12
    ds_read_b128 v[44:47], v13
    ds_read_b64_tr_b16 v[76:77], v17 offset:12288
    ds_read_b64_tr_b16 v[78:79], v17 offset:13312
    s_waitcnt lgkmcnt(8)
    v_mfma_f32_32x32x16_bf16 a[64:79], v[36:39], v[64:67], a[64:79]
    v_add_u32 v14, 0x8000, v14
    v_add_u32 v15, 0x8000, v15
    v_add_u32 v16, 0x8000, v16
    v_add_u32 v17, 0x8000, v17
    ds_read_b64_tr_b16 v[48:49], v14 offset:0
    ds_read_b64_tr_b16 v[50:51], v14 offset:1024
    s_waitcnt lgkmcnt(8)
    v_mfma_f32_32x32x16_bf16 a[80:95], v[36:39], v[68:71], a[80:95]
    ds_read_b64_tr_b16 v[52:53], v15 offset:0
    ds_read_b64_tr_b16 v[54:55], v15 offset:1024
    s_waitcnt lgkmcnt(8)
    v_mfma_f32_32x32x16_bf16 a[96:111], v[36:39], v[72:75], a[96:111]
    ds_read_b64_tr_b16 v[56:57], v16 offset:0
    ds_read_b64_tr_b16 v[58:59], v16 offset:1024
    s_waitcnt lgkmcnt(6)
    v_mfma_f32_32x32x16_bf16 a[112:127], v[36:39], v[76:79], a[112:127]
    ds_read_b64_tr_b16 v[60:61], v17 offset:0
    ds_read_b64_tr_b16 v[62:63], v17 offset:1024
    s_waitcnt lgkmcnt(6)
    v_mfma_f32_32x32x16_bf16 a[0:15], v[48:51], v[40:43], a[0:15]
    ds_read_b64_tr_b16 v[64:65], v14 offset:8192
    ds_read_b64_tr_b16 v[66:67], v14 offset:9216
    s_waitcnt lgkmcnt(6)
    v_mfma_f32_32x32x16_bf16 a[16:31], v[52:55], v[40:43], a[16:31]
    ds_read_b64_tr_b16 v[68:69], v15 offset:8192
    ds_read_b64_tr_b16 v[70:71], v15 offset:9216
    s_add_u32 m0, s57, 65536
    s_add_u32 s38, s67, 512
    buffer_load_dwordx4 v10, s[52:55], s38 offen offset:0 lds
    s_waitcnt lgkmcnt(6)
    v_mfma_f32_32x32x16_bf16 a[32:47], v[56:59], v[40:43], a[32:47]
    ds_read_b64_tr_b16 v[72:73], v16 offset:8192
    ds_read_b64_tr_b16 v[74:75], v16 offset:9216
    s_waitcnt lgkmcnt(6)
    v_mfma_f32_32x32x16_bf16 a[48:63], v[60:63], v[40:43], a[48:63]
    ds_read_b64_tr_b16 v[76:77], v17 offset:8192
    ds_read_b64_tr_b16 v[78:79], v17 offset:9216
    s_add_u32 m0, s57, 65536
    s_add_u32 s38, s67, 512
    buffer_load_dwordx4 v11, s[52:55], s38 offen offset:1024 lds
    s_waitcnt lgkmcnt(6)
    v_mfma_f32_32x32x16_bf16 a[64:79], v[40:43], v[64:67], a[64:79]
    ds_read_b64_tr_b16 v[48:49], v14 offset:4096
    ds_read_b64_tr_b16 v[50:51], v14 offset:5120
    s_waitcnt lgkmcnt(6)
    v_mfma_f32_32x32x16_bf16 a[80:95], v[40:43], v[68:71], a[80:95]
    ds_read_b64_tr_b16 v[52:53], v15 offset:4096
    ds_read_b64_tr_b16 v[54:55], v15 offset:5120
    s_lshr_b32 s39, s57, 1
    s_add_u32 m0, s39, 81920
    s_add_u32 s38, s99, 2097152
    buffer_load_dwordx4 v8, s[68:71], s38 offen lds
    s_waitcnt lgkmcnt(6)
    v_mfma_f32_32x32x16_bf16 a[96:111], v[40:43], v[72:75], a[96:111]
    ds_read_b64_tr_b16 v[56:57], v16 offset:4096
    ds_read_b64_tr_b16 v[58:59], v16 offset:5120
    s_waitcnt lgkmcnt(6)
    v_mfma_f32_32x32x16_bf16 a[112:127], v[40:43], v[76:79], a[112:127]
    ds_read_b64_tr_b16 v[60:61], v17 offset:4096
    ds_read_b64_tr_b16 v[62:63], v17 offset:5120
    s_lshr_b32 s39, s57, 1
    s_add_u32 m0, s39, 90112
    s_add_u32 s38, s99, 2097152
    buffer_load_dwordx4 v8, s[72:75], s38 offen lds
    s_waitcnt lgkmcnt(6)
    v_mfma_f32_32x32x16_bf16 a[0:15], v[48:51], v[44:47], a[0:15]
    ds_read_b64_tr_b16 v[64:65], v14 offset:12288
    ds_read_b64_tr_b16 v[66:67], v14 offset:13312
    s_waitcnt lgkmcnt(6)
    v_mfma_f32_32x32x16_bf16 a[16:31], v[52:55], v[44:47], a[16:31]
    ds_read_b64_tr_b16 v[68:69], v15 offset:12288
    ds_read_b64_tr_b16 v[70:71], v15 offset:13312
    s_waitcnt lgkmcnt(6)
    v_mfma_f32_32x32x16_bf16 a[32:47], v[56:59], v[44:47], a[32:47]
    ds_read_b64_tr_b16 v[72:73], v16 offset:12288
    ds_read_b64_tr_b16 v[74:75], v16 offset:13312
    s_waitcnt lgkmcnt(6)
    v_mfma_f32_32x32x16_bf16 a[48:63], v[60:63], v[44:47], a[48:63]
    s_waitcnt vmcnt(8)
    s_barrier
    v_add_u32 v12, 0xfffe0000, v12
    v_add_u32 v13, 0xfffe0000, v13
    ds_read_b128 v[32:35], v12
    ds_read_b128 v[36:39], v13
    ds_read_b64_tr_b16 v[76:77], v17 offset:12288
    ds_read_b64_tr_b16 v[78:79], v17 offset:13312
    s_waitcnt lgkmcnt(8)
    v_mfma_f32_32x32x16_bf16 a[64:79], v[44:47], v[64:67], a[64:79]
    v_add_u32 v14, 0xfffe0000, v14
    v_add_u32 v15, 0xfffe0000, v15
    v_add_u32 v16, 0xfffe0000, v16
    v_add_u32 v17, 0xfffe0000, v17
    ds_read_b64_tr_b16 v[48:49], v14 offset:0
    ds_read_b64_tr_b16 v[50:51], v14 offset:1024
    s_waitcnt lgkmcnt(8)
    v_mfma_f32_32x32x16_bf16 a[80:95], v[44:47], v[68:71], a[80:95]
    ds_read_b64_tr_b16 v[52:53], v15 offset:0
    ds_read_b64_tr_b16 v[54:55], v15 offset:1024
    s_waitcnt lgkmcnt(8)
    v_mfma_f32_32x32x16_bf16 a[96:111], v[44:47], v[72:75], a[96:111]
    ds_read_b64_tr_b16 v[56:57], v16 offset:0
    ds_read_b64_tr_b16 v[58:59], v16 offset:1024
    s_waitcnt lgkmcnt(6)
    v_mfma_f32_32x32x16_bf16 a[112:127], v[44:47], v[76:79], a[112:127]
    ds_read_b64_tr_b16 v[60:61], v17 offset:0
    ds_read_b64_tr_b16 v[62:63], v17 offset:1024
    s_waitcnt lgkmcnt(6)
    v_mfma_f32_32x32x16_bf16 a[0:15], v[48:51], v[32:35], a[0:15]
    ds_read_b64_tr_b16 v[64:65], v14 offset:8192
    ds_read_b64_tr_b16 v[66:67], v14 offset:9216
    s_waitcnt lgkmcnt(6)
    v_mfma_f32_32x32x16_bf16 a[16:31], v[52:55], v[32:35], a[16:31]
    ds_read_b64_tr_b16 v[68:69], v15 offset:8192
    ds_read_b64_tr_b16 v[70:71], v15 offset:9216
    s_add_u32 m0, s57, 98304
    s_add_u32 s38, s67, 576
    buffer_load_dwordx4 v10, s[52:55], s38 offen offset:0 lds
    s_waitcnt lgkmcnt(6)
    v_mfma_f32_32x32x16_bf16 a[32:47], v[56:59], v[32:35], a[32:47]
    ds_read_b64_tr_b16 v[72:73], v16 offset:8192
    ds_read_b64_tr_b16 v[74:75], v16 offset:9216
    s_waitcnt lgkmcnt(6)
    v_mfma_f32_32x32x16_bf16 a[48:63], v[60:63], v[32:35], a[48:63]
    ds_read_b64_tr_b16 v[76:77], v17 offset:8192
    ds_read_b64_tr_b16 v[78:79], v17 offset:9216
    s_add_u32 m0, s57, 98304
    s_add_u32 s38, s67, 576
    buffer_load_dwordx4 v11, s[52:55], s38 offen offset:1024 lds
    s_waitcnt lgkmcnt(6)
    v_mfma_f32_32x32x16_bf16 a[64:79], v[32:35], v[64:67], a[64:79]
    ds_read_b64_tr_b16 v[48:49], v14 offset:4096
    ds_read_b64_tr_b16 v[50:51], v14 offset:5120
    s_waitcnt lgkmcnt(6)
    v_mfma_f32_32x32x16_bf16 a[80:95], v[32:35], v[68:71], a[80:95]
    ds_read_b64_tr_b16 v[52:53], v15 offset:4096
    ds_read_b64_tr_b16 v[54:55], v15 offset:5120
    s_lshr_b32 s39, s57, 1
    s_add_u32 m0, s39, 114688
    s_add_u32 s38, s99, 2359296
    buffer_load_dwordx4 v8, s[68:71], s38 offen lds
    s_waitcnt lgkmcnt(6)
    v_mfma_f32_32x32x16_bf16 a[96:111], v[32:35], v[72:75], a[96:111]
    ds_read_b64_tr_b16 v[56:57], v16 offset:4096
    ds_read_b64_tr_b16 v[58:59], v16 offset:5120
    s_waitcnt lgkmcnt(6)
    v_mfma_f32_32x32x16_bf16 a[112:127], v[32:35], v[76:79], a[112:127]
    ds_read_b64_tr_b16 v[60:61], v17 offset:4096
    ds_read_b64_tr_b16 v[62:63], v17 offset:5120
    s_lshr_b32 s39, s57, 1
    s_add_u32 m0, s39, 122880
    s_add_u32 s38, s99, 2359296
    buffer_load_dwordx4 v8, s[72:75], s38 offen lds
    s_waitcnt lgkmcnt(6)
    v_mfma_f32_32x32x16_bf16 a[0:15], v[48:51], v[36:39], a[0:15]
    ds_read_b64_tr_b16 v[64:65], v14 offset:12288
    ds_read_b64_tr_b16 v[66:67], v14 offset:13312
    s_waitcnt lgkmcnt(6)
    v_mfma_f32_32x32x16_bf16 a[16:31], v[52:55], v[36:39], a[16:31]
    ds_read_b64_tr_b16 v[68:69], v15 offset:12288
    ds_read_b64_tr_b16 v[70:71], v15 offset:13312
    s_waitcnt lgkmcnt(6)
    v_mfma_f32_32x32x16_bf16 a[32:47], v[56:59], v[36:39], a[32:47]
    ds_read_b64_tr_b16 v[72:73], v16 offset:12288
    ds_read_b64_tr_b16 v[74:75], v16 offset:13312
    s_waitcnt lgkmcnt(6)
    v_mfma_f32_32x32x16_bf16 a[48:63], v[60:63], v[36:39], a[48:63]
    s_waitcnt vmcnt(8)
    s_barrier
    v_add_u32 v12, 0x8000, v12
    v_add_u32 v13, 0x8000, v13
    ds_read_b128 v[40:43], v12
    ds_read_b128 v[44:47], v13
    ds_read_b64_tr_b16 v[76:77], v17 offset:12288
    ds_read_b64_tr_b16 v[78:79], v17 offset:13312
    s_waitcnt lgkmcnt(8)
    v_mfma_f32_32x32x16_bf16 a[64:79], v[36:39], v[64:67], a[64:79]
    v_add_u32 v14, 0x8000, v14
    v_add_u32 v15, 0x8000, v15
    v_add_u32 v16, 0x8000, v16
    v_add_u32 v17, 0x8000, v17
    ds_read_b64_tr_b16 v[48:49], v14 offset:0
    ds_read_b64_tr_b16 v[50:51], v14 offset:1024
    s_waitcnt lgkmcnt(8)
    v_mfma_f32_32x32x16_bf16 a[80:95], v[36:39], v[68:71], a[80:95]
    ds_read_b64_tr_b16 v[52:53], v15 offset:0
    ds_read_b64_tr_b16 v[54:55], v15 offset:1024
    s_waitcnt lgkmcnt(8)
    v_mfma_f32_32x32x16_bf16 a[96:111], v[36:39], v[72:75], a[96:111]
    ds_read_b64_tr_b16 v[56:57], v16 offset:0
    ds_read_b64_tr_b16 v[58:59], v16 offset:1024
    s_waitcnt lgkmcnt(6)
    v_mfma_f32_32x32x16_bf16 a[112:127], v[36:39], v[76:79], a[112:127]
    ds_read_b64_tr_b16 v[60:61], v17 offset:0
    ds_read_b64_tr_b16 v[62:63], v17 offset:1024
    s_waitcnt lgkmcnt(6)
    v_mfma_f32_32x32x16_bf16 a[0:15], v[48:51], v[40:43], a[0:15]
    ds_read_b64_tr_b16 v[64:65], v14 offset:8192
    ds_read_b64_tr_b16 v[66:67], v14 offset:9216
    s_waitcnt lgkmcnt(6)
    v_mfma_f32_32x32x16_bf16 a[16:31], v[52:55], v[40:43], a[16:31]
    ds_read_b64_tr_b16 v[68:69], v15 offset:8192
    ds_read_b64_tr_b16 v[70:71], v15 offset:9216
    s_add_u32 m0, s57, 131072
    s_add_u32 s38, s67, 640
    buffer_load_dwordx4 v10, s[52:55], s38 offen offset:0 lds
    s_waitcnt lgkmcnt(6)
    v_mfma_f32_32x32x16_bf16 a[32:47], v[56:59], v[40:43], a[32:47]
    ds_read_b64_tr_b16 v[72:73], v16 offset:8192
    ds_read_b64_tr_b16 v[74:75], v16 offset:9216
    s_waitcnt lgkmcnt(6)
    v_mfma_f32_32x32x16_bf16 a[48:63], v[60:63], v[40:43], a[48:63]
    ds_read_b64_tr_b16 v[76:77], v17 offset:8192
    ds_read_b64_tr_b16 v[78:79], v17 offset:9216
    s_add_u32 m0, s57, 131072
    s_add_u32 s38, s67, 640
    buffer_load_dwordx4 v11, s[52:55], s38 offen offset:1024 lds
    s_waitcnt lgkmcnt(6)
    v_mfma_f32_32x32x16_bf16 a[64:79], v[40:43], v[64:67], a[64:79]
    ds_read_b64_tr_b16 v[48:49], v14 offset:4096
    ds_read_b64_tr_b16 v[50:51], v14 offset:5120
    s_waitcnt lgkmcnt(6)
    v_mfma_f32_32x32x16_bf16 a[80:95], v[40:43], v[68:71], a[80:95]
    ds_read_b64_tr_b16 v[52:53], v15 offset:4096
    ds_read_b64_tr_b16 v[54:55], v15 offset:5120
    s_lshr_b32 s39, s57, 1
    s_add_u32 m0, s39, 147456
    s_add_u32 s38, s99, 2621440
    buffer_load_dwordx4 v8, s[68:71], s38 offen lds
    s_waitcnt lgkmcnt(6)
    v_mfma_f32_32x32x16_bf16 a[96:111], v[40:43], v[72:75], a[96:111]
    ds_read_b64_tr_b16 v[56:57], v16 offset:4096
    ds_read_b64_tr_b16 v[58:59], v16 offset:5120
    s_waitcnt lgkmcnt(6)
    v_mfma_f32_32x32x16_bf16 a[112:127], v[40:43], v[76:79], a[112:127]
    ds_read_b64_tr_b16 v[60:61], v17 offset:4096
    ds_read_b64_tr_b16 v[62:63], v17 offset:5120
    s_lshr_b32 s39, s57, 1
    s_add_u32 m0, s39, 155648
    s_add_u32 s38, s99, 2621440
    buffer_load_dwordx4 v8, s[72:75], s38 offen lds
    s_waitcnt lgkmcnt(6)
    v_mfma_f32_32x32x16_bf16 a[0:15], v[48:51], v[44:47], a[0:15]
    ds_read_b64_tr_b16 v[64:65], v14 offset:12288
    ds_read_b64_tr_b16 v[66:67], v14 offset:13312
    s_waitcnt lgkmcnt(6)
    v_mfma_f32_32x32x16_bf16 a[16:31], v[52:55], v[44:47], a[16:31]
    ds_read_b64_tr_b16 v[68:69], v15 offset:12288
    ds_read_b64_tr_b16 v[70:71], v15 offset:13312
    s_lshr_b32 s38, s2, 3
    s_lshl_b32 s38, s38, 4
    s_and_b32 s39, s3, 3
    s_lshl_b32 s39, s39, 2
    s_add_u32 s38, s38, s39
    s_lshl_b32 s38, s38, 13
    s_and_b32 s39, s2, 7
    s_lshl_b32 s39, s39, 10
    s_add_u32 s38, s38, s39
    buffer_load_dword v3, v27, s[48:51], s38 offen
    s_waitcnt lgkmcnt(6)
    v_mfma_f32_32x32x16_bf16 a[32:47], v[56:59], v[44:47], a[32:47]
    ds_read_b64_tr_b16 v[72:73], v16 offset:12288
    ds_read_b64_tr_b16 v[74:75], v16 offset:13312
    s_waitcnt lgkmcnt(6)
    v_mfma_f32_32x32x16_bf16 a[48:63], v[60:63], v[44:47], a[48:63]
    s_waitcnt vmcnt(9)
    s_barrier
    v_add_u32 v12, 0x8000, v12
    v_add_u32 v13, 0x8000, v13
    ds_read_b128 v[32:35], v12
    ds_read_b128 v[36:39], v13
    ds_read_b64_tr_b16 v[76:77], v17 offset:12288
    ds_read_b64_tr_b16 v[78:79], v17 offset:13312
    s_waitcnt lgkmcnt(8)
    v_mfma_f32_32x32x16_bf16 a[64:79], v[44:47], v[64:67], a[64:79]
    v_add_u32 v14, 0x8000, v14
    v_add_u32 v15, 0x8000, v15
    v_add_u32 v16, 0x8000, v16
    v_add_u32 v17, 0x8000, v17
    ds_read_b64_tr_b16 v[48:49], v14 offset:0
    ds_read_b64_tr_b16 v[50:51], v14 offset:1024
    s_waitcnt lgkmcnt(8)
    v_mfma_f32_32x32x16_bf16 a[80:95], v[44:47], v[68:71], a[80:95]
    ds_read_b64_tr_b16 v[52:53], v15 offset:0
    ds_read_b64_tr_b16 v[54:55], v15 offset:1024
    s_waitcnt lgkmcnt(8)
    v_mfma_f32_32x32x16_bf16 a[96:111], v[44:47], v[72:75], a[96:111]
    ds_read_b64_tr_b16 v[56:57], v16 offset:0
    ds_read_b64_tr_b16 v[58:59], v16 offset:1024
    s_waitcnt lgkmcnt(6)
    v_mfma_f32_32x32x16_bf16 a[112:127], v[44:47], v[76:79], a[112:127]
    ds_read_b64_tr_b16 v[60:61], v17 offset:0
    ds_read_b64_tr_b16 v[62:63], v17 offset:1024
    s_waitcnt lgkmcnt(6)
    v_mfma_f32_32x32x16_bf16 a[0:15], v[48:51], v[32:35], a[0:15]
    ds_read_b64_tr_b16 v[64:65], v14 offset:8192
    ds_read_b64_tr_b16 v[66:67], v14 offset:9216
    s_waitcnt lgkmcnt(6)
    v_mfma_f32_32x32x16_bf16 a[16:31], v[52:55], v[32:35], a[16:31]
    ds_read_b64_tr_b16 v[68:69], v15 offset:8192
    ds_read_b64_tr_b16 v[70:71], v15 offset:9216
    s_add_u32 m0, s57, 0
    s_add_u32 s38, s67, 704
    buffer_load_dwordx4 v10, s[52:55], s38 offen offset:0 lds
    s_waitcnt lgkmcnt(6)
    v_mfma_f32_32x32x16_bf16 a[32:47], v[56:59], v[32:35], a[32:47]
    ds_read_b64_tr_b16 v[72:73], v16 offset:8192
    ds_read_b64_tr_b16 v[74:75], v16 offset:9216
    s_waitcnt lgkmcnt(6)
    v_mfma_f32_32x32x16_bf16 a[48:63], v[60:63], v[32:35], a[48:63]
    ds_read_b64_tr_b16 v[76:77], v17 offset:8192
    ds_read_b64_tr_b16 v[78:79], v17 offset:9216
    s_add_u32 m0, s57, 0
    s_add_u32 s38, s67, 704
    buffer_load_dwordx4 v11, s[52:55], s38 offen offset:1024 lds
    s_waitcnt lgkmcnt(6)
    v_mfma_f32_32x32x16_bf16 a[64:79], v[32:35], v[64:67], a[64:79]
    ds_read_b64_tr_b16 v[48:49], v14 offset:4096
    ds_read_b64_tr_b16 v[50:51], v14 offset:5120
    s_waitcnt lgkmcnt(6)
    v_mfma_f32_32x32x16_bf16 a[80:95], v[32:35], v[68:71], a[80:95]
    ds_read_b64_tr_b16 v[52:53], v15 offset:4096
    ds_read_b64_tr_b16 v[54:55], v15 offset:5120
    s_lshr_b32 s39, s57, 1
    s_add_u32 m0, s39, 16384
    s_add_u32 s38, s99, 2883584
    buffer_load_dwordx4 v8, s[68:71], s38 offen lds
    s_waitcnt lgkmcnt(6)
    v_mfma_f32_32x32x16_bf16 a[96:111], v[32:35], v[72:75], a[96:111]
    ds_read_b64_tr_b16 v[56:57], v16 offset:4096
    ds_read_b64_tr_b16 v[58:59], v16 offset:5120
    s_waitcnt lgkmcnt(6)
    v_mfma_f32_32x32x16_bf16 a[112:127], v[32:35], v[76:79], a[112:127]
    ds_read_b64_tr_b16 v[60:61], v17 offset:4096
    ds_read_b64_tr_b16 v[62:63], v17 offset:5120
    s_lshr_b32 s39, s57, 1
    s_add_u32 m0, s39, 24576
    s_add_u32 s38, s99, 2883584
    buffer_load_dwordx4 v8, s[72:75], s38 offen lds
    s_waitcnt lgkmcnt(6)
    v_mfma_f32_32x32x16_bf16 a[0:15], v[48:51], v[36:39], a[0:15]
    ds_read_b64_tr_b16 v[64:65], v14 offset:12288
    ds_read_b64_tr_b16 v[66:67], v14 offset:13312
    s_waitcnt lgkmcnt(6)
    v_mfma_f32_32x32x16_bf16 a[16:31], v[52:55], v[36:39], a[16:31]
    ds_read_b64_tr_b16 v[68:69], v15 offset:12288
    ds_read_b64_tr_b16 v[70:71], v15 offset:13312
    s_waitcnt lgkmcnt(6)
    v_mfma_f32_32x32x16_bf16 a[32:47], v[56:59], v[36:39], a[32:47]
    ds_read_b64_tr_b16 v[72:73], v16 offset:12288
    ds_read_b64_tr_b16 v[74:75], v16 offset:13312
    s_waitcnt lgkmcnt(6)
    v_mfma_f32_32x32x16_bf16 a[48:63], v[60:63], v[36:39], a[48:63]
    s_waitcnt vmcnt(9)
    s_barrier
    v_add_u32 v12, 0x8000, v12
    v_add_u32 v13, 0x8000, v13
    ds_read_b128 v[40:43], v12
    ds_read_b128 v[44:47], v13
    ds_read_b64_tr_b16 v[76:77], v17 offset:12288
    ds_read_b64_tr_b16 v[78:79], v17 offset:13312
    s_waitcnt lgkmcnt(8)
    v_mfma_f32_32x32x16_bf16 a[64:79], v[36:39], v[64:67], a[64:79]
    v_add_u32 v14, 0x8000, v14
    v_add_u32 v15, 0x8000, v15
    v_add_u32 v16, 0x8000, v16
    v_add_u32 v17, 0x8000, v17
    ds_read_b64_tr_b16 v[48:49], v14 offset:0
    ds_read_b64_tr_b16 v[50:51], v14 offset:1024
    v_lshlrev_b32 v23, 2, v1
    buffer_load_dword v22, v23, s[32:35], 0 offen sc1
    s_waitcnt lgkmcnt(8)
    v_mfma_f32_32x32x16_bf16 a[80:95], v[36:39], v[68:71], a[80:95]
    ds_read_b64_tr_b16 v[52:53], v15 offset:0
    ds_read_b64_tr_b16 v[54:55], v15 offset:1024
    s_waitcnt lgkmcnt(8)
    v_mfma_f32_32x32x16_bf16 a[96:111], v[36:39], v[72:75], a[96:111]
    ds_read_b64_tr_b16 v[56:57], v16 offset:0
    ds_read_b64_tr_b16 v[58:59], v16 offset:1024
    s_waitcnt lgkmcnt(6)
    v_mfma_f32_32x32x16_bf16 a[112:127], v[36:39], v[76:79], a[112:127]
    ds_read_b64_tr_b16 v[60:61], v17 offset:0
    ds_read_b64_tr_b16 v[62:63], v17 offset:1024
    s_waitcnt lgkmcnt(6)
    v_mfma_f32_32x32x16_bf16 a[0:15], v[48:51], v[40:43], a[0:15]
    ds_read_b64_tr_b16 v[64:65], v14 offset:8192
    ds_read_b64_tr_b16 v[66:67], v14 offset:9216
    s_waitcnt lgkmcnt(6)
    v_mfma_f32_32x32x16_bf16 a[16:31], v[52:55], v[40:43], a[16:31]
    ds_read_b64_tr_b16 v[68:69], v15 offset:8192
    ds_read_b64_tr_b16 v[70:71], v15 offset:9216
    s_add_u32 m0, s57, 32768
    s_add_u32 s38, s67, 768
    buffer_load_dwordx4 v10, s[52:55], s38 offen offset:0 lds
    s_waitcnt lgkmcnt(6)
    v_mfma_f32_32x32x16_bf16 a[32:47], v[56:59], v[40:43], a[32:47]
    ds_read_b64_tr_b16 v[72:73], v16 offset:8192
    ds_read_b64_tr_b16 v[74:75], v16 offset:9216
    s_waitcnt lgkmcnt(6)
    v_mfma_f32_32x32x16_bf16 a[48:63], v[60:63], v[40:43], a[48:63]
    ds_read_b64_tr_b16 v[76:77], v17 offset:8192
    ds_read_b64_tr_b16 v[78:79], v17 offset:9216
    s_add_u32 m0, s57, 32768
    s_add_u32 s38, s67, 768
    buffer_load_dwordx4 v11, s[52:55], s38 offen offset:1024 lds
    s_waitcnt lgkmcnt(6)
    v_mfma_f32_32x32x16_bf16 a[64:79], v[40:43], v[64:67], a[64:79]
    ds_read_b64_tr_b16 v[48:49], v14 offset:4096
    ds_read_b64_tr_b16 v[50:51], v14 offset:5120
    s_waitcnt lgkmcnt(6)
    v_mfma_f32_32x32x16_bf16 a[80:95], v[40:43], v[68:71], a[80:95]
    ds_read_b64_tr_b16 v[52:53], v15 offset:4096
    ds_read_b64_tr_b16 v[54:55], v15 offset:5120
    s_lshr_b32 s39, s57, 1
    s_add_u32 m0, s39, 49152
    s_add_u32 s38, s99, 3145728
    buffer_load_dwordx4 v8, s[68:71], s38 offen lds
    s_waitcnt lgkmcnt(6)
    v_mfma_f32_32x32x16_bf16 a[96:111], v[40:43], v[72:75], a[96:111]
    ds_read_b64_tr_b16 v[56:57], v16 offset:4096
    ds_read_b64_tr_b16 v[58:59], v16 offset:5120
    s_waitcnt lgkmcnt(6)
    v_mfma_f32_32x32x16_bf16 a[112:127], v[40:43], v[76:79], a[112:127]
    ds_read_b64_tr_b16 v[60:61], v17 offset:4096
    ds_read_b64_tr_b16 v[62:63], v17 offset:5120
    s_lshr_b32 s39, s57, 1
    s_add_u32 m0, s39, 57344
    s_add_u32 s38, s99, 3145728
    buffer_load_dwordx4 v8, s[72:75], s38 offen lds
    s_waitcnt lgkmcnt(6)
    v_mfma_f32_32x32x16_bf16 a[0:15], v[48:51], v[44:47], a[0:15]
    ds_read_b64_tr_b16 v[64:65], v14 offset:12288
    ds_read_b64_tr_b16 v[66:67], v14 offset:13312
    s_waitcnt lgkmcnt(6)
    v_mfma_f32_32x32x16_bf16 a[16:31], v[52:55], v[44:47], a[16:31]
    ds_read_b64_tr_b16 v[68:69], v15 offset:12288
    ds_read_b64_tr_b16 v[70:71], v15 offset:13312
    s_waitcnt lgkmcnt(6)
    v_mfma_f32_32x32x16_bf16 a[32:47], v[56:59], v[44:47], a[32:47]
    ds_read_b64_tr_b16 v[72:73], v16 offset:12288
    ds_read_b64_tr_b16 v[74:75], v16 offset:13312
    s_waitcnt lgkmcnt(6)
    v_mfma_f32_32x32x16_bf16 a[48:63], v[60:63], v[44:47], a[48:63]
    s_waitcnt vmcnt(10)
    s_barrier
    v_add_u32 v12, 0x8000, v12
    v_add_u32 v13, 0x8000, v13
    ds_read_b128 v[32:35], v12
    ds_read_b128 v[36:39], v13
    ds_read_b64_tr_b16 v[76:77], v17 offset:12288
    ds_read_b64_tr_b16 v[78:79], v17 offset:13312
    s_waitcnt lgkmcnt(8)
    v_mfma_f32_32x32x16_bf16 a[64:79], v[44:47], v[64:67], a[64:79]
    v_add_u32 v14, 0x8000, v14
    v_add_u32 v15, 0x8000, v15
    v_add_u32 v16, 0x8000, v16
    v_add_u32 v17, 0x8000, v17
    ds_read_b64_tr_b16 v[48:49], v14 offset:0
    ds_read_b64_tr_b16 v[50:51], v14 offset:1024
    s_waitcnt vmcnt(4)
    v_and_b32 v18, 0x80808080, v22
    v_mov_b32 v19, 0x80808080
    v_cmp_ne_u32 vcc, v18, v19
    s_cmp_eq_u64 vcc, 0
    s_cbranch_scc1 S1c28_ok
    s_mov_b32 s95, 0
S1c28_sp:
    v_lshlrev_b32 v23, 2, v1
    buffer_load_dword v22, v23, s[32:35], 0 offen sc1
    s_waitcnt vmcnt(0)
    v_and_b32 v18, 0x80808080, v22
    v_mov_b32 v19, 0x80808080
    v_cmp_ne_u32 vcc, v18, v19
    s_cmp_eq_u64 vcc, 0
    s_cbranch_scc1 S1c28_ok
    s_add_u32 s95, s95, 1
    s_cmp_lt_u32 s95, 262144
    s_cbranch_scc1 S1c28_sp
S1c28_ok:
    s_and_b32 s38, s2, 3
    s_lshl_b32 s38, s38, 3
    v_lshrrev_b32 v18, s38, v22
    v_and_b32 v18, 0x7f, v18
    s_bfe_u32 s39, s2, 0x10002
    v_and_b32 v19, 1, v1
    v_cmp_eq_u32 s[94:95], s39, v19
    v_cmp_ne_u32 vcc, s97, v18
    s_and_b64 vcc, vcc, s[94:95]
    s_cmp_eq_u64 vcc, 0
    s_cselect_b32 s96, 1, 0
    s_waitcnt lgkmcnt(8)
    v_mfma_f32_32x32x16_bf16 a[80:95], v[44:47], v[68:71], a[80:95]
    ds_read_b64_tr_b16 v[52:53], v15 offset:0
    ds_read_b64_tr_b16 v[54:55], v15 offset:1024
    s_waitcnt lgkmcnt(8)
    v_mfma_f32_32x32x16_bf16 a[96:111], v[44:47], v[72:75], a[96:111]
    ds_read_b64_tr_b16 v[56:57], v16 offset:0
    ds_read_b64_tr_b16 v[58:59], v16 offset:1024
    s_waitcnt lgkmcnt(6)
    v_mfma_f32_32x32x16_bf16 a[112:127], v[44:47], v[76:79], a[112:127]
    ds_read_b64_tr_b16 v[60:61], v17 offset:0
    ds_read_b64_tr_b16 v[62:63], v17 offset:1024
    s_waitcnt lgkmcnt(6)
    v_mfma_f32_32x32x16_bf16 a[0:15], v[48:51], v[32:35], a[0:15]
    ds_read_b64_tr_b16 v[64:65], v14 offset:8192
    ds_read_b64_tr_b16 v[66:67], v14 offset:9216
    s_waitcnt lgkmcnt(6)
    v_mfma_f32_32x32x16_bf16 a[16:31], v[52:55], v[32:35], a[16:31]
    ds_read_b64_tr_b16 v[68:69], v15 offset:8192
    ds_read_b64_tr_b16 v[70:71], v15 offset:9216
    s_add_u32 m0, s57, 65536
    s_add_u32 s38, s67, 832
    buffer_load_dwordx4 v10, s[52:55], s38 offen offset:0 lds
    s_waitcnt lgkmcnt(6)
    v_mfma_f32_32x32x16_bf16 a[32:47], v[56:59], v[32:35], a[32:47]
    ds_read_b64_tr_b16 v[72:73], v16 offset:8192
    ds_read_b64_tr_b16 v[74:75], v16 offset:9216
    s_waitcnt lgkmcnt(6)
    v_mfma_f32_32x32x16_bf16 a[48:63], v[60:63], v[32:35], a[48:63]
    ds_read_b64_tr_b16 v[76:77], v17 offset:8192
    ds_read_b64_tr_b16 v[78:79], v17 offset:9216
    s_add_u32 m0, s57, 65536
    s_add_u32 s38, s67, 832
    buffer_load_dwordx4 v11, s[52:55], s38 offen offset:1024 lds
    s_waitcnt lgkmcnt(6)
    v_mfma_f32_32x32x16_bf16 a[64:79], v[32:35], v[64:67], a[64:79]
    ds_read_b64_tr_b16 v[48:49], v14 offset:4096
    ds_read_b64_tr_b16 v[50:51], v14 offset:5120
    s_waitcnt lgkmcnt(6)
    v_mfma_f32_32x32x16_bf16 a[80:95], v[32:35], v[68:71], a[80:95]
    ds_read_b64_tr_b16 v[52:53], v15 offset:4096
    ds_read_b64_tr_b16 v[54:55], v15 offset:5120
    s_lshr_b32 s39, s57, 1
    s_add_u32 m0, s39, 81920
    s_add_u32 s38, s99, 3407872
    buffer_load_dwordx4 v8, s[68:71], s38 offen lds
    s_waitcnt lgkmcnt(6)
    v_mfma_f32_32x32x16_bf16 a[96:111], v[32:35], v[72:75], a[96:111]
    ds_read_b64_tr_b16 v[56:57], v16 offset:4096
    ds_read_b64_tr_b16 v[58:59], v16 offset:5120
    s_waitcnt lgkmcnt(6)
    v_mfma_f32_32x32x16_bf16 a[112:127], v[32:35], v[76:79], a[112:127]
    ds_read_b64_tr_b16 v[60:61], v17 offset:4096
    ds_read_b64_tr_b16 v[62:63], v17 offset:5120
    s_lshr_b32 s39, s57, 1
    s_add_u32 m0, s39, 90112
    s_add_u32 s38, s99, 3407872
    buffer_load_dwordx4 v8, s[72:75], s38 offen lds
    s_waitcnt lgkmcnt(6)
    v_mfma_f32_32x32x16_bf16 a[0:15], v[48:51], v[36:39], a[0:15]
    ds_read_b64_tr_b16 v[64:65], v14 offset:12288
    ds_read_b64_tr_b16 v[66:67], v14 offset:13312
    s_waitcnt lgkmcnt(6)
    v_mfma_f32_32x32x16_bf16 a[16:31], v[52:55], v[36:39], a[16:31]
    ds_read_b64_tr_b16 v[68:69], v15 offset:12288
    ds_read_b64_tr_b16 v[70:71], v15 offset:13312
    s_waitcnt lgkmcnt(6)
    v_mfma_f32_32x32x16_bf16 a[32:47], v[56:59], v[36:39], a[32:47]
    ds_read_b64_tr_b16 v[72:73], v16 offset:12288
    ds_read_b64_tr_b16 v[74:75], v16 offset:13312
    s_waitcnt lgkmcnt(6)
    v_mfma_f32_32x32x16_bf16 a[48:63], v[60:63], v[36:39], a[48:63]
    s_barrier
    v_add_u32 v12, 0xfffe0000, v12
    v_add_u32 v13, 0xfffe0000, v13
    ds_read_b128 v[40:43], v12
    ds_read_b128 v[44:47], v13
    ds_read_b64_tr_b16 v[76:77], v17 offset:12288
    ds_read_b64_tr_b16 v[78:79], v17 offset:13312
    s_waitcnt lgkmcnt(8)
    v_mfma_f32_32x32x16_bf16 a[64:79], v[36:39], v[64:67], a[64:79]
    v_add_u32 v14, 0xfffe0000, v14
    v_add_u32 v15, 0xfffe0000, v15
    v_add_u32 v16, 0xfffe0000, v16
    v_add_u32 v17, 0xfffe0000, v17
    ds_read_b64_tr_b16 v[48:49], v14 offset:0
    ds_read_b64_tr_b16 v[50:51], v14 offset:1024
    s_waitcnt lgkmcnt(8)
    v_mfma_f32_32x32x16_bf16 a[80:95], v[36:39], v[68:71], a[80:95]
    ds_read_b64_tr_b16 v[52:53], v15 offset:0
    ds_read_b64_tr_b16 v[54:55], v15 offset:1024
    s_waitcnt lgkmcnt(8)
    v_mfma_f32_32x32x16_bf16 a[96:111], v[36:39], v[72:75], a[96:111]
    ds_read_b64_tr_b16 v[56:57], v16 offset:0
    ds_read_b64_tr_b16 v[58:59], v16 offset:1024
    s_waitcnt lgkmcnt(6)
    v_mfma_f32_32x32x16_bf16 a[112:127], v[36:39], v[76:79], a[112:127]
    ds_read_b64_tr_b16 v[60:61], v17 offset:0
    ds_read_b64_tr_b16 v[62:63], v17 offset:1024
    s_waitcnt lgkmcnt(6)
    v_mfma_f32_32x32x16_bf16 a[0:15], v[48:51], v[40:43], a[0:15]
    ds_read_b64_tr_b16 v[64:65], v14 offset:8192
    ds_read_b64_tr_b16 v[66:67], v14 offset:9216
    s_waitcnt lgkmcnt(6)
    v_mfma_f32_32x32x16_bf16 a[16:31], v[52:55], v[40:43], a[16:31]
    ds_read_b64_tr_b16 v[68:69], v15 offset:8192
    ds_read_b64_tr_b16 v[70:71], v15 offset:9216
    s_add_u32 m0, s57, 98304
    s_add_u32 s38, s67, 896
    buffer_load_dwordx4 v10, s[52:55], s38 offen offset:0 lds
    s_waitcnt lgkmcnt(6)
    v_mfma_f32_32x32x16_bf16 a[32:47], v[56:59], v[40:43], a[32:47]
    ds_read_b64_tr_b16 v[72:73], v16 offset:8192
    ds_read_b64_tr_b16 v[74:75], v16 offset:9216
    s_waitcnt lgkmcnt(6)
    v_mfma_f32_32x32x16_bf16 a[48:63], v[60:63], v[40:43], a[48:63]
    ds_read_b64_tr_b16 v[76:77], v17 offset:8192
    ds_read_b64_tr_b16 v[78:79], v17 offset:9216
    s_add_u32 m0, s57, 98304
    s_add_u32 s38, s67, 896
    buffer_load_dwordx4 v11, s[52:55], s38 offen offset:1024 lds
    s_waitcnt lgkmcnt(6)
    v_mfma_f32_32x32x16_bf16 a[64:79], v[40:43], v[64:67], a[64:79]
    ds_read_b64_tr_b16 v[48:49], v14 offset:4096
    ds_read_b64_tr_b16 v[50:51], v14 offset:5120
    s_waitcnt lgkmcnt(6)
    v_mfma_f32_32x32x16_bf16 a[80:95], v[40:43], v[68:71], a[80:95]
    ds_read_b64_tr_b16 v[52:53], v15 offset:4096
    ds_read_b64_tr_b16 v[54:55], v15 offset:5120
    s_lshr_b32 s39, s57, 1
    s_add_u32 m0, s39, 114688
    s_add_u32 s38, s99, 3670016
    buffer_load_dwordx4 v8, s[68:71], s38 offen lds
    s_waitcnt lgkmcnt(6)
    v_mfma_f32_32x32x16_bf16 a[96:111], v[40:43], v[72:75], a[96:111]
    ds_read_b64_tr_b16 v[56:57], v16 offset:4096
    ds_read_b64_tr_b16 v[58:59], v16 offset:5120
    s_waitcnt lgkmcnt(6)
    v_mfma_f32_32x32x16_bf16 a[112:127], v[40:43], v[76:79], a[112:127]
    ds_read_b64_tr_b16 v[60:61], v17 offset:4096
    ds_read_b64_tr_b16 v[62:63], v17 offset:5120
    s_lshr_b32 s39, s57, 1
    s_add_u32 m0, s39, 122880
    s_add_u32 s38, s99, 3670016
    buffer_load_dwordx4 v8, s[72:75], s38 offen lds
    s_waitcnt lgkmcnt(6)
    v_mfma_f32_32x32x16_bf16 a[0:15], v[48:51], v[44:47], a[0:15]
    ds_read_b64_tr_b16 v[64:65], v14 offset:12288
    ds_read_b64_tr_b16 v[66:67], v14 offset:13312
    s_waitcnt lgkmcnt(6)
    v_mfma_f32_32x32x16_bf16 a[16:31], v[52:55], v[44:47], a[16:31]
    ds_read_b64_tr_b16 v[68:69], v15 offset:12288
    ds_read_b64_tr_b16 v[70:71], v15 offset:13312
    s_lshl_b32 s38, s64, 15
    s_and_b32 s39, s36, 3
    s_lshl_b32 s39, s39, 13
    s_add_u32 s38, s38, s39
    s_add_u32 s38, s38, 33554432
    buffer_load_dword v3, v26, s[28:31], s38 offen sc1
    s_waitcnt lgkmcnt(6)
    v_mfma_f32_32x32x16_bf16 a[32:47], v[56:59], v[44:47], a[32:47]
    ds_read_b64_tr_b16 v[72:73], v16 offset:12288
    ds_read_b64_tr_b16 v[74:75], v16 offset:13312
    s_waitcnt lgkmcnt(6)
    v_mfma_f32_32x32x16_bf16 a[48:63], v[60:63], v[44:47], a[48:63]
    s_waitcnt vmcnt(9)
    s_barrier
    v_add_u32 v12, 0x8000, v12
    v_add_u32 v13, 0x8000, v13
    ds_read_b128 v[32:35], v12
    ds_read_b128 v[36:39], v13
    ds_read_b64_tr_b16 v[76:77], v17 offset:12288
    ds_read_b64_tr_b16 v[78:79], v17 offset:13312
    s_lshl_b32 s38, s64, 15
    s_and_b32 s39, s36, 3
    s_lshl_b32 s39, s39, 13
    s_add_u32 s38, s38, s39
    s_add_u32 s38, s38, 33558528
    buffer_load_dword v3, v26, s[28:31], s38 offen sc1
    s_waitcnt lgkmcnt(8)
    v_mfma_f32_32x32x16_bf16 a[64:79], v[44:47], v[64:67], a[64:79]
    v_add_u32 v14, 0x8000, v14
    v_add_u32 v15, 0x8000, v15
    v_add_u32 v16, 0x8000, v16
    v_add_u32 v17, 0x8000, v17
    ds_read_b64_tr_b16 v[48:49], v14 offset:0
    ds_read_b64_tr_b16 v[50:51], v14 offset:1024
    s_waitcnt lgkmcnt(8)
    v_mfma_f32_32x32x16_bf16 a[80:95], v[44:47], v[68:71], a[80:95]
    ds_read_b64_tr_b16 v[52:53], v15 offset:0
    ds_read_b64_tr_b16 v[54:55], v15 offset:1024
    s_waitcnt lgkmcnt(8)
    v_mfma_f32_32x32x16_bf16 a[96:111], v[44:47], v[72:75], a[96:111]
    ds_read_b64_tr_b16 v[56:57], v16 offset:0
    ds_read_b64_tr_b16 v[58:59], v16 offset:1024
    s_waitcnt lgkmcnt(6)
    v_mfma_f32_32x32x16_bf16 a[112:127], v[44:47], v[76:79], a[112:127]
    ds_read_b64_tr_b16 v[60:61], v17 offset:0
    ds_read_b64_tr_b16 v[62:63], v17 offset:1024
    s_waitcnt lgkmcnt(6)
    v_mfma_f32_32x32x16_bf16 a[0:15], v[48:51], v[32:35], a[0:15]
    ds_read_b64_tr_b16 v[64:65], v14 offset:8192
    ds_read_b64_tr_b16 v[66:67], v14 offset:9216
    s_waitcnt lgkmcnt(6)
    v_mfma_f32_32x32x16_bf16 a[16:31], v[52:55], v[32:35], a[16:31]
    ds_read_b64_tr_b16 v[68:69], v15 offset:8192
    ds_read_b64_tr_b16 v[70:71], v15 offset:9216
    s_add_u32 m0, s57, 131072
    s_add_u32 s38, s67, 960
    buffer_load_dwordx4 v10, s[52:55], s38 offen offset:0 lds
    s_waitcnt lgkmcnt(6)
    v_mfma_f32_32x32x16_bf16 a[32:47], v[56:59], v[32:35], a[32:47]
    ds_read_b64_tr_b16 v[72:73], v16 offset:8192
    ds_read_b64_tr_b16 v[74:75], v16 offset:9216
    s_waitcnt lgkmcnt(6)
    v_mfma_f32_32x32x16_bf16 a[48:63], v[60:63], v[32:35], a[48:63]
    ds_read_b64_tr_b16 v[76:77], v17 offset:8192
    ds_read_b64_tr_b16 v[78:79], v17 offset:9216
    s_add_u32 m0, s57, 131072
    s_add_u32 s38, s67, 960
    buffer_load_dwordx4 v11, s[52:55], s38 offen offset:1024 lds
    s_waitcnt lgkmcnt(6)
    v_mfma_f32_32x32x16_bf16 a[64:79], v[32:35], v[64:67], a[64:79]
    ds_read_b64_tr_b16 v[48:49], v14 offset:4096
    ds_read_b64_tr_b16 v[50:51], v14 offset:5120
    s_waitcnt lgkmcnt(6)
    v_mfma_f32_32x32x16_bf16 a[80:95], v[32:35], v[68:71], a[80:95]
    ds_read_b64_tr_b16 v[52:53], v15 offset:4096
    ds_read_b64_tr_b16 v[54:55], v15 offset:5120
    s_lshr_b32 s39, s57, 1
    s_add_u32 m0, s39, 147456
    s_add_u32 s38, s99, 3932160
    buffer_load_dwordx4 v8, s[68:71], s38 offen lds
    s_waitcnt lgkmcnt(6)
    v_mfma_f32_32x32x16_bf16 a[96:111], v[32:35], v[72:75], a[96:111]
    ds_read_b64_tr_b16 v[56:57], v16 offset:4096
    ds_read_b64_tr_b16 v[58:59], v16 offset:5120
    s_waitcnt lgkmcnt(6)
    v_mfma_f32_32x32x16_bf16 a[112:127], v[32:35], v[76:79], a[112:127]
    ds_read_b64_tr_b16 v[60:61], v17 offset:4096
    ds_read_b64_tr_b16 v[62:63], v17 offset:5120
    s_lshr_b32 s39, s57, 1
    s_add_u32 m0, s39, 155648
    s_add_u32 s38, s99, 3932160
    buffer_load_dwordx4 v8, s[72:75], s38 offen lds
    s_waitcnt lgkmcnt(6)
    v_mfma_f32_32x32x16_bf16 a[0:15], v[48:51], v[36:39], a[0:15]
    ds_read_b64_tr_b16 v[64:65], v14 offset:12288
    ds_read_b64_tr_b16 v[66:67], v14 offset:13312
    s_waitcnt lgkmcnt(6)
    v_mfma_f32_32x32x16_bf16 a[16:31], v[52:55], v[36:39], a[16:31]
    ds_read_b64_tr_b16 v[68:69], v15 offset:12288
    ds_read_b64_tr_b16 v[70:71], v15 offset:13312
    s_waitcnt lgkmcnt(6)
    v_mfma_f32_32x32x16_bf16 a[32:47], v[56:59], v[36:39], a[32:47]
    ds_read_b64_tr_b16 v[72:73], v16 offset:12288
    ds_read_b64_tr_b16 v[74:75], v16 offset:13312
    s_waitcnt lgkmcnt(6)
    v_mfma_f32_32x32x16_bf16 a[48:63], v[60:63], v[36:39], a[48:63]
    s_waitcnt vmcnt(10)
    s_barrier
    v_add_u32 v12, 0x8000, v12
    v_add_u32 v13, 0x8000, v13
    ds_read_b128 v[40:43], v12
    ds_read_b128 v[44:47], v13
    ds_read_b64_tr_b16 v[76:77], v17 offset:12288
    ds_read_b64_tr_b16 v[78:79], v17 offset:13312
    s_waitcnt lgkmcnt(8)
    v_mfma_f32_32x32x16_bf16 a[64:79], v[36:39], v[64:67], a[64:79]
    v_add_u32 v14, 0x8000, v14
    v_add_u32 v15, 0x8000, v15
    v_add_u32 v16, 0x8000, v16
    v_add_u32 v17, 0x8000, v17
    ds_read_b64_tr_b16 v[48:49], v14 offset:0
    ds_read_b64_tr_b16 v[50:51], v14 offset:1024
    s_waitcnt lgkmcnt(8)
    v_mfma_f32_32x32x16_bf16 a[80:95], v[36:39], v[68:71], a[80:95]
    ds_read_b64_tr_b16 v[52:53], v15 offset:0
    ds_read_b64_tr_b16 v[54:55], v15 offset:1024
    s_waitcnt lgkmcnt(8)
    v_mfma_f32_32x32x16_bf16 a[96:111], v[36:39], v[72:75], a[96:111]
    ds_read_b64_tr_b16 v[56:57], v16 offset:0
    ds_read_b64_tr_b16 v[58:59], v16 offset:1024
    s_waitcnt lgkmcnt(6)
    v_mfma_f32_32x32x16_bf16 a[112:127], v[36:39], v[76:79], a[112:127]
    ds_read_b64_tr_b16 v[60:61], v17 offset:0
    ds_read_b64_tr_b16 v[62:63], v17 offset:1024
    s_waitcnt lgkmcnt(6)
    v_mfma_f32_32x32x16_bf16 a[0:15], v[48:51], v[40:43], a[0:15]
    ds_read_b64_tr_b16 v[64:65], v14 offset:8192
    ds_read_b64_tr_b16 v[66:67], v14 offset:9216
    s_waitcnt lgkmcnt(6)
    v_mfma_f32_32x32x16_bf16 a[16:31], v[52:55], v[40:43], a[16:31]
    ds_read_b64_tr_b16 v[68:69], v15 offset:8192
    ds_read_b64_tr_b16 v[70:71], v15 offset:9216
    s_add_u32 m0, s47, 0
    s_add_u32 s38, s65, 0
    buffer_load_dwordx4 v8, s[48:51], s38 offen offset:0 lds
    s_waitcnt lgkmcnt(6)
    v_mfma_f32_32x32x16_bf16 a[32:47], v[56:59], v[40:43], a[32:47]
    ds_read_b64_tr_b16 v[72:73], v16 offset:8192
    ds_read_b64_tr_b16 v[74:75], v16 offset:9216
    s_waitcnt lgkmcnt(6)
    v_mfma_f32_32x32x16_bf16 a[48:63], v[60:63], v[40:43], a[48:63]
    ds_read_b64_tr_b16 v[76:77], v17 offset:8192
    ds_read_b64_tr_b16 v[78:79], v17 offset:9216
    s_add_u32 m0, s47, 0
    s_add_u32 s38, s65, 0
    buffer_load_dwordx4 v9, s[48:51], s38 offen offset:1024 lds
    s_waitcnt lgkmcnt(6)
    v_mfma_f32_32x32x16_bf16 a[64:79], v[40:43], v[64:67], a[64:79]
    ds_read_b64_tr_b16 v[48:49], v14 offset:4096
    ds_read_b64_tr_b16 v[50:51], v14 offset:5120
    s_waitcnt lgkmcnt(6)
    v_mfma_f32_32x32x16_bf16 a[80:95], v[40:43], v[68:71], a[80:95]
    ds_read_b64_tr_b16 v[52:53], v15 offset:4096
    ds_read_b64_tr_b16 v[54:55], v15 offset:5120
    s_add_u32 m0, s47, 16384
    s_add_u32 s38, s65, 524288
    buffer_load_dwordx4 v8, s[48:51], s38 offen offset:0 lds
    s_waitcnt lgkmcnt(6)
    v_mfma_f32_32x32x16_bf16 a[96:111], v[40:43], v[72:75], a[96:111]
    ds_read_b64_tr_b16 v[56:57], v16 offset:4096
    ds_read_b64_tr_b16 v[58:59], v16 offset:5120
    s_waitcnt lgkmcnt(6)
    v_mfma_f32_32x32x16_bf16 a[112:127], v[40:43], v[76:79], a[112:127]
    ds_read_b64_tr_b16 v[60:61], v17 offset:4096
    ds_read_b64_tr_b16 v[62:63], v17 offset:5120
    s_add_u32 m0, s47, 16384
    s_add_u32 s38, s65, 524288
    buffer_load_dwordx4 v9, s[48:51], s38 offen offset:1024 lds
    s_waitcnt lgkmcnt(6)
    v_mfma_f32_32x32x16_bf16 a[0:15], v[48:51], v[44:47], a[0:15]
    ds_read_b64_tr_b16 v[64:65], v14 offset:12288
    ds_read_b64_tr_b16 v[66:67], v14 offset:13312
    s_waitcnt lgkmcnt(6)
    v_mfma_f32_32x32x16_bf16 a[16:31], v[52:55], v[44:47], a[16:31]
    ds_read_b64_tr_b16 v[68:69], v15 offset:12288
    ds_read_b64_tr_b16 v[70:71], v15 offset:13312
    s_waitcnt lgkmcnt(6)
    v_mfma_f32_32x32x16_bf16 a[32:47], v[56:59], v[44:47], a[32:47]
    ds_read_b64_tr_b16 v[72:73], v16 offset:12288
    ds_read_b64_tr_b16 v[74:75], v16 offset:13312
    s_waitcnt lgkmcnt(6)
    v_mfma_f32_32x32x16_bf16 a[48:63], v[60:63], v[44:47], a[48:63]
    s_waitcnt vmcnt(10)
    s_barrier
    v_add_u32 v12, 0x8000, v12
    v_add_u32 v13, 0x8000, v13
    ds_read_b128 v[32:35], v12
    ds_read_b128 v[36:39], v13
    ds_read_b64_tr_b16 v[76:77], v17 offset:12288
    ds_read_b64_tr_b16 v[78:79], v17 offset:13312
    s_waitcnt lgkmcnt(8)
    v_mfma_f32_32x32x16_bf16 a[64:79], v[44:47], v[64:67], a[64:79]
    v_add_u32 v14, 0x8000, v14
    v_add_u32 v15, 0x8000, v15
    v_add_u32 v16, 0x8000, v16
    v_add_u32 v17, 0x8000, v17
    ds_read_b64_tr_b16 v[48:49], v14 offset:0
    ds_read_b64_tr_b16 v[50:51], v14 offset:1024
    s_waitcnt lgkmcnt(8)
    v_mfma_f32_32x32x16_bf16 a[80:95], v[44:47], v[68:71], a[80:95]
    ds_read_b64_tr_b16 v[52:53], v15 offset:0
    ds_read_b64_tr_b16 v[54:55], v15 offset:1024
    s_waitcnt lgkmcnt(8)
    v_mfma_f32_32x32x16_bf16 a[96:111], v[44:47], v[72:75], a[96:111]
    ds_read_b64_tr_b16 v[56:57], v16 offset:0
    ds_read_b64_tr_b16 v[58:59], v16 offset:1024
    s_waitcnt lgkmcnt(6)
    v_mfma_f32_32x32x16_bf16 a[112:127], v[44:47], v[76:79], a[112:127]
    ds_read_b64_tr_b16 v[60:61], v17 offset:0
    ds_read_b64_tr_b16 v[62:63], v17 offset:1024
    s_waitcnt lgkmcnt(6)
    v_mfma_f32_32x32x16_bf16 a[0:15], v[48:51], v[32:35], a[0:15]
    ds_read_b64_tr_b16 v[64:65], v14 offset:8192
    ds_read_b64_tr_b16 v[66:67], v14 offset:9216
    s_waitcnt lgkmcnt(6)
    v_mfma_f32_32x32x16_bf16 a[16:31], v[52:55], v[32:35], a[16:31]
    ds_read_b64_tr_b16 v[68:69], v15 offset:8192
    ds_read_b64_tr_b16 v[70:71], v15 offset:9216
    s_add_u32 m0, s47, 32768
    s_add_u32 s38, s65, 1048576
    buffer_load_dwordx4 v8, s[48:51], s38 offen offset:0 lds
    s_waitcnt lgkmcnt(6)
    v_mfma_f32_32x32x16_bf16 a[32:47], v[56:59], v[32:35], a[32:47]
    ds_read_b64_tr_b16 v[72:73], v16 offset:8192
    ds_read_b64_tr_b16 v[74:75], v16 offset:9216
    s_waitcnt lgkmcnt(6)
    v_mfma_f32_32x32x16_bf16 a[48:63], v[60:63], v[32:35], a[48:63]
    ds_read_b64_tr_b16 v[76:77], v17 offset:8192
    ds_read_b64_tr_b16 v[78:79], v17 offset:9216
    s_add_u32 m0, s47, 32768
    s_add_u32 s38, s65, 1048576
    buffer_load_dwordx4 v9, s[48:51], s38 offen offset:1024 lds
    s_waitcnt lgkmcnt(6)
    v_mfma_f32_32x32x16_bf16 a[64:79], v[32:35], v[64:67], a[64:79]
    ds_read_b64_tr_b16 v[48:49], v14 offset:4096
    ds_read_b64_tr_b16 v[50:51], v14 offset:5120
    s_waitcnt lgkmcnt(6)
    v_mfma_f32_32x32x16_bf16 a[80:95], v[32:35], v[68:71], a[80:95]
    ds_read_b64_tr_b16 v[52:53], v15 offset:4096
    ds_read_b64_tr_b16 v[54:55], v15 offset:5120
    s_waitcnt lgkmcnt(6)
    v_mfma_f32_32x32x16_bf16 a[96:111], v[32:35], v[72:75], a[96:111]
    ds_read_b64_tr_b16 v[56:57], v16 offset:4096
    ds_read_b64_tr_b16 v[58:59], v16 offset:5120
    s_waitcnt lgkmcnt(6)
    v_mfma_f32_32x32x16_bf16 a[112:127], v[32:35], v[76:79], a[112:127]
    ds_read_b64_tr_b16 v[60:61], v17 offset:4096
    ds_read_b64_tr_b16 v[62:63], v17 offset:5120
    s_waitcnt lgkmcnt(6)
    v_mfma_f32_32x32x16_bf16 a[0:15], v[48:51], v[36:39], a[0:15]
    ds_read_b64_tr_b16 v[64:65], v14 offset:12288
    ds_read_b64_tr_b16 v[66:67], v14 offset:13312
    s_waitcnt lgkmcnt(6)
    v_mfma_f32_32x32x16_bf16 a[16:31], v[52:55], v[36:39], a[16:31]
    ds_read_b64_tr_b16 v[68:69], v15 offset:12288
    ds_read_b64_tr_b16 v[70:71], v15 offset:13312
    s_waitcnt lgkmcnt(6)
    v_mfma_f32_32x32x16_bf16 a[32:47], v[56:59], v[36:39], a[32:47]
    ds_read_b64_tr_b16 v[72:73], v16 offset:12288
    ds_read_b64_tr_b16 v[74:75], v16 offset:13312
    s_waitcnt lgkmcnt(6)
    v_mfma_f32_32x32x16_bf16 a[48:63], v[60:63], v[36:39], a[48:63]
    s_waitcnt vmcnt(6)
    s_barrier
    v_add_u32 v12, 0x8000, v12
    v_add_u32 v13, 0x8000, v13
    ds_read_b128 v[40:43], v12
    ds_read_b128 v[44:47], v13
    ds_read_b64_tr_b16 v[76:77], v17 offset:12288
    ds_read_b64_tr_b16 v[78:79], v17 offset:13312
    s_waitcnt lgkmcnt(8)
    v_mfma_f32_32x32x16_bf16 a[64:79], v[36:39], v[64:67], a[64:79]
    v_add_u32 v14, 0x8000, v14
    v_add_u32 v15, 0x8000, v15
    v_add_u32 v16, 0x8000, v16
    v_add_u32 v17, 0x8000, v17
    ds_read_b64_tr_b16 v[48:49], v14 offset:0
    ds_read_b64_tr_b16 v[50:51], v14 offset:1024
    s_waitcnt lgkmcnt(8)
    v_mfma_f32_32x32x16_bf16 a[80:95], v[36:39], v[68:71], a[80:95]
    ds_read_b64_tr_b16 v[52:53], v15 offset:0
    ds_read_b64_tr_b16 v[54:55], v15 offset:1024
    s_waitcnt lgkmcnt(8)
    v_mfma_f32_32x32x16_bf16 a[96:111], v[36:39], v[72:75], a[96:111]
    ds_read_b64_tr_b16 v[56:57], v16 offset:0
    ds_read_b64_tr_b16 v[58:59], v16 offset:1024
    s_waitcnt lgkmcnt(6)
    v_mfma_f32_32x32x16_bf16 a[112:127], v[36:39], v[76:79], a[112:127]
    ds_read_b64_tr_b16 v[60:61], v17 offset:0
    ds_read_b64_tr_b16 v[62:63], v17 offset:1024
    s_waitcnt lgkmcnt(6)
    v_mfma_f32_32x32x16_bf16 a[0:15], v[48:51], v[40:43], a[0:15]
    ds_read_b64_tr_b16 v[64:65], v14 offset:8192
    ds_read_b64_tr_b16 v[66:67], v14 offset:9216
    s_waitcnt lgkmcnt(6)
    v_mfma_f32_32x32x16_bf16 a[16:31], v[52:55], v[40:43], a[16:31]
    ds_read_b64_tr_b16 v[68:69], v15 offset:8192
    ds_read_b64_tr_b16 v[70:71], v15 offset:9216
    s_waitcnt lgkmcnt(6)
    v_mfma_f32_32x32x16_bf16 a[32:47], v[56:59], v[40:43], a[32:47]
    ds_read_b64_tr_b16 v[72:73], v16 offset:8192
    ds_read_b64_tr_b16 v[74:75], v16 offset:9216
    s_waitcnt lgkmcnt(6)
    v_mfma_f32_32x32x16_bf16 a[48:63], v[60:63], v[40:43], a[48:63]
    ds_read_b64_tr_b16 v[76:77], v17 offset:8192
    ds_read_b64_tr_b16 v[78:79], v17 offset:9216
    s_waitcnt lgkmcnt(6)
    v_mfma_f32_32x32x16_bf16 a[64:79], v[40:43], v[64:67], a[64:79]
    ds_read_b64_tr_b16 v[48:49], v14 offset:4096
    ds_read_b64_tr_b16 v[50:51], v14 offset:5120
    s_waitcnt lgkmcnt(6)
    v_mfma_f32_32x32x16_bf16 a[80:95], v[40:43], v[68:71], a[80:95]
    ds_read_b64_tr_b16 v[52:53], v15 offset:4096
    ds_read_b64_tr_b16 v[54:55], v15 offset:5120
    s_waitcnt lgkmcnt(6)
    v_mfma_f32_32x32x16_bf16 a[96:111], v[40:43], v[72:75], a[96:111]
    ds_read_b64_tr_b16 v[56:57], v16 offset:4096
    ds_read_b64_tr_b16 v[58:59], v16 offset:5120
    s_waitcnt lgkmcnt(6)
    v_mfma_f32_32x32x16_bf16 a[112:127], v[40:43], v[76:79], a[112:127]
    ds_read_b64_tr_b16 v[60:61], v17 offset:4096
    ds_read_b64_tr_b16 v[62:63], v17 offset:5120
    s_waitcnt lgkmcnt(6)
    v_mfma_f32_32x32x16_bf16 a[0:15], v[48:51], v[44:47], a[0:15]
    ds_read_b64_tr_b16 v[64:65], v14 offset:12288
    ds_read_b64_tr_b16 v[66:67], v14 offset:13312
    s_waitcnt lgkmcnt(6)
    v_mfma_f32_32x32x16_bf16 a[16:31], v[52:55], v[44:47], a[16:31]
    ds_read_b64_tr_b16 v[68:69], v15 offset:12288
    ds_read_b64_tr_b16 v[70:71], v15 offset:13312
    s_waitcnt lgkmcnt(6)
    v_mfma_f32_32x32x16_bf16 a[32:47], v[56:59], v[44:47], a[32:47]
    ds_read_b64_tr_b16 v[72:73], v16 offset:12288
    ds_read_b64_tr_b16 v[74:75], v16 offset:13312
    s_waitcnt lgkmcnt(6)
    v_mfma_f32_32x32x16_bf16 a[48:63], v[60:63], v[44:47], a[48:63]
    ds_read_b64_tr_b16 v[76:77], v17 offset:12288
    ds_read_b64_tr_b16 v[78:79], v17 offset:13312
    s_waitcnt lgkmcnt(6)
    v_mfma_f32_32x32x16_bf16 a[64:79], v[44:47], v[64:67], a[64:79]
    s_waitcnt lgkmcnt(4)
    v_mfma_f32_32x32x16_bf16 a[80:95], v[44:47], v[68:71], a[80:95]
    s_waitcnt lgkmcnt(2)
    v_mfma_f32_32x32x16_bf16 a[96:111], v[44:47], v[72:75], a[96:111]
    s_waitcnt lgkmcnt(0)
    v_mfma_f32_32x32x16_bf16 a[112:127], v[44:47], v[76:79], a[112:127]
    v_accvgpr_read_b32 v80, a0
    v_accvgpr_read_b32 v81, a1
    v_accvgpr_read_b32 v82, a2
    v_accvgpr_read_b32 v83, a3
    v_accvgpr_read_b32 v84, a4
    v_accvgpr_read_b32 v85, a5
    v_accvgpr_read_b32 v86, a6
    v_accvgpr_read_b32 v87, a7
    v_cvt_pk_bf16_f32 v112, v80, v81
    v_cvt_pk_bf16_f32 v113, v82, v83
    v_cvt_pk_bf16_f32 v114, v84, v85
    v_cvt_pk_bf16_f32 v115, v86, v87
    s_cmp_eq_u32 s96, 0
    s_cbranch_scc1 DU29s
    s_add_u32 s38, s56, 0
    buffer_store_dwordx4 v[112:115], v2, s[28:31], s38 offen offset:0
    s_branch DU29j
DU29s:
    s_add_u32 s38, s56, 0
    buffer_store_dwordx4 v[112:115], v2, s[28:31], s38 offen offset:0 sc1
DU29j:
    v_accvgpr_read_b32 v88, a8
    v_accvgpr_read_b32 v89, a9
    v_accvgpr_read_b32 v90, a10
    v_accvgpr_read_b32 v91, a11
    v_accvgpr_read_b32 v92, a12
    v_accvgpr_read_b32 v93, a13
    v_accvgpr_read_b32 v94, a14
    v_accvgpr_read_b32 v95, a15
    v_cvt_pk_bf16_f32 v116, v88, v89
    v_cvt_pk_bf16_f32 v117, v90, v91
    v_cvt_pk_bf16_f32 v118, v92, v93
    v_cvt_pk_bf16_f32 v119, v94, v95
    s_cmp_eq_u32 s96, 0
    s_cbranch_scc1 DU30s
    s_add_u32 s38, s56, 0
    buffer_store_dwordx4 v[116:119], v2, s[28:31], s38 offen offset:1024
    s_branch DU30j
DU30s:
    s_add_u32 s38, s56, 0
    buffer_store_dwordx4 v[116:119], v2, s[28:31], s38 offen offset:1024 sc1
DU30j:
    s_lshl_b32 s38, s64, 15
    s_add_u32 s38, s38, 33554432
    buffer_load_dwordx4 a[0:3], v2, s[28:31], s38 offen offset:0 sc1
    s_lshl_b32 s38, s64, 15
    s_add_u32 s38, s38, 33554432
    buffer_load_dwordx4 a[4:7], v2, s[28:31], s38 offen offset:1024 sc1
    s_lshl_b32 s38, s64, 15
    s_add_u32 s38, s38, 33554432
    buffer_load_dwordx4 a[8:11], v2, s[28:31], s38 offen offset:2048 sc1
    s_lshl_b32 s38, s64, 15
    s_add_u32 s38, s38, 33554432
    buffer_load_dwordx4 a[12:15], v2, s[28:31], s38 offen offset:3072 sc1
    v_accvgpr_read_b32 v96, a16
    v_accvgpr_read_b32 v97, a17
    v_accvgpr_read_b32 v98, a18
    v_accvgpr_read_b32 v99, a19
    v_accvgpr_read_b32 v100, a20
    v_accvgpr_read_b32 v101, a21
    v_accvgpr_read_b32 v102, a22
    v_accvgpr_read_b32 v103, a23
    v_cvt_pk_bf16_f32 v120, v96, v97
    v_cvt_pk_bf16_f32 v121, v98, v99
    v_cvt_pk_bf16_f32 v122, v100, v101
    v_cvt_pk_bf16_f32 v123, v102, v103
    s_cmp_eq_u32 s96, 0
    s_cbranch_scc1 DU31s
    s_add_u32 s38, s56, 0
    buffer_store_dwordx4 v[120:123], v2, s[28:31], s38 offen offset:2048
    s_branch DU31j
DU31s:
    s_add_u32 s38, s56, 0
    buffer_store_dwordx4 v[120:123], v2, s[28:31], s38 offen offset:2048 sc1
DU31j:
    v_accvgpr_read_b32 v104, a24
    v_accvgpr_read_b32 v105, a25
    v_accvgpr_read_b32 v106, a26
    v_accvgpr_read_b32 v107, a27
    v_accvgpr_read_b32 v108, a28
    v_accvgpr_read_b32 v109, a29
    v_accvgpr_read_b32 v110, a30
    v_accvgpr_read_b32 v111, a31
    v_cvt_pk_bf16_f32 v124, v104, v105
    v_cvt_pk_bf16_f32 v125, v106, v107
    v_cvt_pk_bf16_f32 v126, v108, v109
    v_cvt_pk_bf16_f32 v127, v110, v111
    s_cmp_eq_u32 s96, 0
    s_cbranch_scc1 DU32s
    s_add_u32 s38, s56, 0
    buffer_store_dwordx4 v[124:127], v2, s[28:31], s38 offen offset:3072
    s_branch DU32j
DU32s:
    s_add_u32 s38, s56, 0
    buffer_store_dwordx4 v[124:127], v2, s[28:31], s38 offen offset:3072 sc1
DU32j:
    s_lshl_b32 s38, s64, 15
    s_add_u32 s38, s38, 33558528
    buffer_load_dwordx4 a[16:19], v2, s[28:31], s38 offen offset:0 sc1
    s_lshl_b32 s38, s64, 15
    s_add_u32 s38, s38, 33558528
    buffer_load_dwordx4 a[20:23], v2, s[28:31], s38 offen offset:1024 sc1
    s_lshl_b32 s38, s64, 15
    s_add_u32 s38, s38, 33558528
    buffer_load_dwordx4 a[24:27], v2, s[28:31], s38 offen offset:2048 sc1
    s_lshl_b32 s38, s64, 15
    s_add_u32 s38, s38, 33558528
    buffer_load_dwordx4 a[28:31], v2, s[28:31], s38 offen offset:3072 sc1
    v_accvgpr_read_b32 v80, a32
    v_accvgpr_read_b32 v81, a33
    v_accvgpr_read_b32 v82, a34
    v_accvgpr_read_b32 v83, a35
    v_accvgpr_read_b32 v84, a36
    v_accvgpr_read_b32 v85, a37
    v_accvgpr_read_b32 v86, a38
    v_accvgpr_read_b32 v87, a39
    v_cvt_pk_bf16_f32 v112, v80, v81
    v_cvt_pk_bf16_f32 v113, v82, v83
    v_cvt_pk_bf16_f32 v114, v84, v85
    v_cvt_pk_bf16_f32 v115, v86, v87
    s_cmp_eq_u32 s96, 0
    s_cbranch_scc1 DU33s
    s_add_u32 s38, s56, 4096
    buffer_store_dwordx4 v[112:115], v2, s[28:31], s38 offen offset:0
    s_branch DU33j
DU33s:
    s_add_u32 s38, s56, 4096
    buffer_store_dwordx4 v[112:115], v2, s[28:31], s38 offen offset:0 sc1
DU33j:
    v_accvgpr_read_b32 v88, a40
    v_accvgpr_read_b32 v89, a41
    v_accvgpr_read_b32 v90, a42
    v_accvgpr_read_b32 v91, a43
    v_accvgpr_read_b32 v92, a44
    v_accvgpr_read_b32 v93, a45
    v_accvgpr_read_b32 v94, a46
    v_accvgpr_read_b32 v95, a47
    v_cvt_pk_bf16_f32 v116, v88, v89
    v_cvt_pk_bf16_f32 v117, v90, v91
    v_cvt_pk_bf16_f32 v118, v92, v93
    v_cvt_pk_bf16_f32 v119, v94, v95
    s_cmp_eq_u32 s96, 0
    s_cbranch_scc1 DU34s
    s_add_u32 s38, s56, 4096
    buffer_store_dwordx4 v[116:119], v2, s[28:31], s38 offen offset:1024
    s_branch DU34j
DU34s:
    s_add_u32 s38, s56, 4096
    buffer_store_dwordx4 v[116:119], v2, s[28:31], s38 offen offset:1024 sc1
DU34j:
    s_lshl_b32 s38, s64, 15
    s_add_u32 s38, s38, 33562624
    buffer_load_dwordx4 a[32:35], v2, s[28:31], s38 offen offset:0 sc1
    s_lshl_b32 s38, s64, 15
    s_add_u32 s38, s38, 33562624
    buffer_load_dwordx4 a[36:39], v2, s[28:31], s38 offen offset:1024 sc1
    s_lshl_b32 s38, s64, 15
    s_add_u32 s38, s38, 33562624
    buffer_load_dwordx4 a[40:43], v2, s[28:31], s38 offen offset:2048 sc1
    s_lshl_b32 s38, s64, 15
    s_add_u32 s38, s38, 33562624
    buffer_load_dwordx4 a[44:47], v2, s[28:31], s38 offen offset:3072 sc1
    s_waitcnt vmcnt(22)
    s_barrier
    ds_read_b64_tr_b16 v[32:33], v4 offset:0
    ds_read_b64_tr_b16 v[34:35], v4 offset:1024
    ds_read_b64_tr_b16 v[36:37], v5 offset:0
    ds_read_b64_tr_b16 v[38:39], v5 offset:1024
    ds_read_b64_tr_b16 v[40:41], v6 offset:0
    ds_read_b64_tr_b16 v[42:43], v6 offset:1024
    ds_read_b64_tr_b16 v[44:45], v7 offset:0
    ds_read_b64_tr_b16 v[46:47], v7 offset:1024
    s_waitcnt vmcnt(15) lgkmcnt(6)
    v_mfma_f32_32x32x16_bf16 v[64:79], v[32:35], a[0:3], 0
    ds_read_b64_tr_b16 v[48:49], v4 offset:4096
    ds_read_b64_tr_b16 v[50:51], v4 offset:5120
    v_accvgpr_read_b32 v10, a48
    v_accvgpr_read_b32 v11, a49
    s_waitcnt lgkmcnt(6)
    v_mfma_f32_32x32x16_bf16 v[80:95], v[36:39], a[0:3], 0
    ds_read_b64_tr_b16 v[52:53], v5 offset:4096
    ds_read_b64_tr_b16 v[54:55], v5 offset:5120
    v_accvgpr_read_b32 v12, a50
    v_accvgpr_read_b32 v13, a51
    s_waitcnt lgkmcnt(6)
    v_mfma_f32_32x32x16_bf16 v[96:111], v[40:43], a[0:3], 0
    ds_read_b64_tr_b16 v[56:57], v6 offset:4096
    ds_read_b64_tr_b16 v[58:59], v6 offset:5120
    v_accvgpr_read_b32 v14, a52
    v_accvgpr_read_b32 v15, a53
    s_waitcnt lgkmcnt(6)
    v_mfma_f32_32x32x16_bf16 v[112:127], v[44:47], a[0:3], 0
    ds_read_b64_tr_b16 v[60:61], v7 offset:4096
    ds_read_b64_tr_b16 v[62:63], v7 offset:5120
    v_accvgpr_read_b32 v16, a54
    v_accvgpr_read_b32 v17, a55
    s_waitcnt vmcnt(14) lgkmcnt(6)
    v_mfma_f32_32x32x16_bf16 v[64:79], v[48:51], a[4:7], v[64:79]
    ds_read_b64_tr_b16 v[32:33], v4 offset:8192
    ds_read_b64_tr_b16 v[34:35], v4 offset:9216
    v_cvt_pk_bf16_f32 v28, v10, v11
    v_cvt_pk_bf16_f32 v29, v12, v13
    s_waitcnt lgkmcnt(6)
    v_mfma_f32_32x32x16_bf16 v[80:95], v[52:55], a[4:7], v[80:95]
    ds_read_b64_tr_b16 v[36:37], v5 offset:8192
    ds_read_b64_tr_b16 v[38:39], v5 offset:9216
    v_cvt_pk_bf16_f32 v30, v14, v15
    v_cvt_pk_bf16_f32 v31, v16, v17
    s_waitcnt lgkmcnt(6)
    v_mfma_f32_32x32x16_bf16 v[96:111], v[56:59], a[4:7], v[96:111]
    ds_read_b64_tr_b16 v[40:41], v6 offset:8192
    ds_read_b64_tr_b16 v[42:43], v6 offset:9216
    s_cmp_eq_u32 s96, 0
    s_cbranch_scc1 DU35s
    s_add_u32 s38, s56, 4096
    buffer_store_dwordx4 v[28:31], v2, s[28:31], s38 offen offset:2048
    s_branch DU35j
DU35s:
    s_add_u32 s38, s56, 4096
    buffer_store_dwordx4 v[28:31], v2, s[28:31], s38 offen offset:2048 sc1
DU35j:
    v_accvgpr_read_b32 v10, a56
    s_waitcnt lgkmcnt(6)
    v_mfma_f32_32x32x16_bf16 v[112:127], v[60:63], a[4:7], v[112:127]
    ds_read_b64_tr_b16 v[44:45], v7 offset:8192
    ds_read_b64_tr_b16 v[46:47], v7 offset:9216
    v_accvgpr_read_b32 v11, a57
    v_accvgpr_read_b32 v12, a58
    s_waitcnt vmcnt(14) lgkmcnt(6)
    v_mfma_f32_32x32x16_bf16 v[64:79], v[32:35], a[8:11], v[64:79]
    ds_read_b64_tr_b16 v[48:49], v4 offset:12288
    ds_read_b64_tr_b16 v[50:51], v4 offset:13312
    v_accvgpr_read_b32 v13, a59
    v_accvgpr_read_b32 v14, a60
    s_waitcnt lgkmcnt(6)
    v_mfma_f32_32x32x16_bf16 v[80:95], v[36:39], a[8:11], v[80:95]
    ds_read_b64_tr_b16 v[52:53], v5 offset:12288
    ds_read_b64_tr_b16 v[54:55], v5 offset:13312
    v_accvgpr_read_b32 v15, a61
    v_accvgpr_read_b32 v16, a62
    s_waitcnt lgkmcnt(6)
    v_mfma_f32_32x32x16_bf16 v[96:111], v[40:43], a[8:11], v[96:111]
    ds_read_b64_tr_b16 v[56:57], v6 offset:12288
    ds_read_b64_tr_b16 v[58:59], v6 offset:13312
    v_accvgpr_read_b32 v17, a63
    v_cvt_pk_bf16_f32 v28, v10, v11
    s_waitcnt lgkmcnt(6)
    v_mfma_f32_32x32x16_bf16 v[112:127], v[44:47], a[8:11], v[112:127]
    s_barrier
    ds_read_b64_tr_b16 v[60:61], v7 offset:12288
    ds_read_b64_tr_b16 v[62:63], v7 offset:13312
    v_cvt_pk_bf16_f32 v29, v12, v13
    v_cvt_pk_bf16_f32 v30, v14, v15
    s_waitcnt vmcnt(13) lgkmcnt(6)
    v_mfma_f32_32x32x16_bf16 v[64:79], v[48:51], a[12:15], v[64:79]
    ds_read_b64_tr_b16 v[32:33], v4 offset:16384
    ds_read_b64_tr_b16 v[34:35], v4 offset:17408
    v_cvt_pk_bf16_f32 v31, v16, v17
    s_cmp_eq_u32 s96, 0
    s_cbranch_scc1 DU36s
    s_add_u32 s38, s56, 4096
    buffer_store_dwordx4 v[28:31], v2, s[28:31], s38 offen offset:3072
    s_branch DU36j
DU36s:
    s_add_u32 s38, s56, 4096
    buffer_store_dwordx4 v[28:31], v2, s[28:31], s38 offen offset:3072 sc1
DU36j:
    s_waitcnt lgkmcnt(6)
    v_mfma_f32_32x32x16_bf16 v[80:95], v[52:55], a[12:15], v[80:95]
    ds_read_b64_tr_b16 v[36:37], v5 offset:16384
    ds_read_b64_tr_b16 v[38:39], v5 offset:17408
    v_accvgpr_read_b32 v10, a64
    s_lshl_b32 s38, s64, 15
    s_add_u32 s38, s38, 33566720
    buffer_load_dwordx4 a[48:51], v2, s[28:31], s38 offen offset:0 sc1
    s_waitcnt lgkmcnt(6)
    v_mfma_f32_32x32x16_bf16 v[96:111], v[56:59], a[12:15], v[96:111]
    ds_read_b64_tr_b16 v[40:41], v6 offset:16384
    ds_read_b64_tr_b16 v[42:43], v6 offset:17408
    v_accvgpr_read_b32 v11, a65
    v_accvgpr_read_b32 v12, a66
    s_waitcnt lgkmcnt(6)
    v_mfma_f32_32x32x16_bf16 v[112:127], v[60:63], a[12:15], v[112:127]
    ds_read_b64_tr_b16 v[44:45], v7 offset:16384
    ds_read_b64_tr_b16 v[46:47], v7 offset:17408
    v_accvgpr_read_b32 v13, a67
    v_accvgpr_read_b32 v14, a68
    s_lshl_b32 s38, s64, 15
    s_add_u32 s38, s38, 33566720
    buffer_load_dwordx4 a[52:55], v2, s[28:31], s38 offen offset:1024 sc1
    s_waitcnt vmcnt(13) lgkmcnt(6)
    v_mfma_f32_32x32x16_bf16 v[64:79], v[32:35], a[16:19], v[64:79]
    ds_read_b64_tr_b16 v[48:49], v4 offset:20480
    ds_read_b64_tr_b16 v[50:51], v4 offset:21504
    v_accvgpr_read_b32 v15, a69
    v_accvgpr_read_b32 v16, a70
    s_waitcnt lgkmcnt(6)
    v_mfma_f32_32x32x16_bf16 v[80:95], v[36:39], a[16:19], v[80:95]
    ds_read_b64_tr_b16 v[52:53], v5 offset:20480
    ds_read_b64_tr_b16 v[54:55], v5 offset:21504
    v_accvgpr_read_b32 v17, a71
    v_cvt_pk_bf16_f32 v28, v10, v11
    s_add_u32 m0, s47, 49152
    s_add_u32 s38, s65, 1572864
    buffer_load_dwordx4 v8, s[48:51], s38 offen offset:0 lds
    s_waitcnt lgkmcnt(6)
    v_mfma_f32_32x32x16_bf16 v[96:111], v[40:43], a[16:19], v[96:111]
    ds_read_b64_tr_b16 v[56:57], v6 offset:20480
    ds_read_b64_tr_b16 v[58:59], v6 offset:21504
    v_cvt_pk_bf16_f32 v29, v12, v13
    v_cvt_pk_bf16_f32 v30, v14, v15
    s_waitcnt lgkmcnt(6)
    v_mfma_f32_32x32x16_bf16 v[112:127], v[44:47], a[16:19], v[112:127]
    ds_read_b64_tr_b16 v[60:61], v7 offset:20480
    ds_read_b64_tr_b16 v[62:63], v7 offset:21504
    v_cvt_pk_bf16_f32 v31, v16, v17
    s_cmp_eq_u32 s96, 0
    s_cbranch_scc1 DU37s
    s_add_u32 s38, s56, 16777216
    buffer_store_dwordx4 v[28:31], v2, s[28:31], s38 offen offset:0
    s_branch DU37j
DU37s:
    s_add_u32 s38, s56, 16777216
    buffer_store_dwordx4 v[28:31], v2, s[28:31], s38 offen offset:0 sc1
DU37j:
    s_add_u32 m0, s47, 49152
    s_add_u32 s38, s65, 1572864
    buffer_load_dwordx4 v9, s[48:51], s38 offen offset:1024 lds
    s_waitcnt vmcnt(15) lgkmcnt(6)
    v_mfma_f32_32x32x16_bf16 v[64:79], v[48:51], a[20:23], v[64:79]
    ds_read_b64_tr_b16 v[32:33], v4 offset:24576
    ds_read_b64_tr_b16 v[34:35], v4 offset:25600
    v_accvgpr_read_b32 v10, a72
    v_accvgpr_read_b32 v11, a73
    s_waitcnt lgkmcnt(6)
    v_mfma_f32_32x32x16_bf16 v[80:95], v[52:55], a[20:23], v[80:95]
    ds_read_b64_tr_b16 v[36:37], v5 offset:24576
    ds_read_b64_tr_b16 v[38:39], v5 offset:25600
    v_accvgpr_read_b32 v12, a74
    v_accvgpr_read_b32 v13, a75
    s_lshl_b32 s38, s64, 15
    s_add_u32 s38, s38, 33566720
    buffer_load_dwordx4 a[56:59], v2, s[28:31], s38 offen offset:2048 sc1
    s_waitcnt lgkmcnt(6)
    v_mfma_f32_32x32x16_bf16 v[96:111], v[56:59], a[20:23], v[96:111]
    ds_read_b64_tr_b16 v[40:41], v6 offset:24576
    ds_read_b64_tr_b16 v[42:43], v6 offset:25600
    v_accvgpr_read_b32 v14, a76
    v_accvgpr_read_b32 v15, a77
    s_waitcnt lgkmcnt(6)
    v_mfma_f32_32x32x16_bf16 v[112:127], v[60:63], a[20:23], v[112:127]
    ds_read_b64_tr_b16 v[44:45], v7 offset:24576
    ds_read_b64_tr_b16 v[46:47], v7 offset:25600
    v_accvgpr_read_b32 v16, a78
    v_accvgpr_read_b32 v17, a79
    s_lshl_b32 s38, s64, 15
    s_add_u32 s38, s38, 33566720
    buffer_load_dwordx4 a[60:63], v2, s[28:31], s38 offen offset:3072 sc1
    s_waitcnt vmcnt(16) lgkmcnt(6)
    v_mfma_f32_32x32x16_bf16 v[64:79], v[32:35], a[24:27], v[64:79]
    ds_read_b64_tr_b16 v[48:49], v4 offset:28672
    ds_read_b64_tr_b16 v[50:51], v4 offset:29696
    v_cvt_pk_bf16_f32 v28, v10, v11
    v_cvt_pk_bf16_f32 v29, v12, v13
    s_waitcnt lgkmcnt(6)
    v_mfma_f32_32x32x16_bf16 v[80:95], v[36:39], a[24:27], v[80:95]
    ds_read_b64_tr_b16 v[52:53], v5 offset:28672
    ds_read_b64_tr_b16 v[54:55], v5 offset:29696
    v_cvt_pk_bf16_f32 v30, v14, v15
    v_cvt_pk_bf16_f32 v31, v16, v17
    s_waitcnt lgkmcnt(6)
    v_mfma_f32_32x32x16_bf16 v[96:111], v[40:43], a[24:27], v[96:111]
    ds_read_b64_tr_b16 v[56:57], v6 offset:28672
    ds_read_b64_tr_b16 v[58:59], v6 offset:29696
    s_cmp_eq_u32 s96, 0
    s_cbranch_scc1 DU38s
    s_add_u32 s38, s56, 16781312
    buffer_store_dwordx4 v[28:31], v2, s[28:31], s38 offen offset:0
    s_branch DU38j
DU38s:
    s_add_u32 s38, s56, 16781312
    buffer_store_dwordx4 v[28:31], v2, s[28:31], s38 offen offset:0 sc1
DU38j:
    s_waitcnt lgkmcnt(6)
    v_mfma_f32_32x32x16_bf16 v[112:127], v[44:47], a[24:27], v[112:127]
    s_barrier
    ds_read_b64_tr_b16 v[60:61], v7 offset:28672
    ds_read_b64_tr_b16 v[62:63], v7 offset:29696
    v_accvgpr_read_b32 v10, a80
    v_accvgpr_read_b32 v11, a81
    s_lshl_b32 s38, s64, 15
    s_add_u32 s38, s38, 33570816
    buffer_load_dwordx4 a[64:67], v2, s[28:31], s38 offen offset:0 sc1
    s_waitcnt vmcnt(17) lgkmcnt(6)
    v_mfma_f32_32x32x16_bf16 v[64:79], v[48:51], a[28:31], v[64:79]
    ds_read_b64_tr_b16 v[32:33], v4 offset:32768
    ds_read_b64_tr_b16 v[34:35], v4 offset:33792
    v_accvgpr_read_b32 v12, a82
    v_accvgpr_read_b32 v13, a83
    s_waitcnt lgkmcnt(6)
    v_mfma_f32_32x32x16_bf16 v[80:95], v[52:55], a[28:31], v[80:95]
    ds_read_b64_tr_b16 v[36:37], v5 offset:32768
    ds_read_b64_tr_b16 v[38:39], v5 offset:33792
    v_accvgpr_read_b32 v14, a84
    v_accvgpr_read_b32 v15, a85
    s_lshl_b32 s38, s64, 15
    s_add_u32 s38, s38, 33570816
    buffer_load_dwordx4 a[68:71], v2, s[28:31], s38 offen offset:1024 sc1
    s_waitcnt lgkmcnt(6)
    v_mfma_f32_32x32x16_bf16 v[96:111], v[56:59], a[28:31], v[96:111]
    ds_read_b64_tr_b16 v[40:41], v6 offset:32768
    ds_read_b64_tr_b16 v[42:43], v6 offset:33792
    v_accvgpr_read_b32 v16, a86
    v_accvgpr_read_b32 v17, a87
    s_waitcnt lgkmcnt(6)
    v_mfma_f32_32x32x16_bf16 v[112:127], v[60:63], a[28:31], v[112:127]
    ds_read_b64_tr_b16 v[44:45], v7 offset:32768
    ds_read_b64_tr_b16 v[46:47], v7 offset:33792
    v_cvt_pk_bf16_f32 v28, v10, v11
    v_cvt_pk_bf16_f32 v29, v12, v13
    s_lshl_b32 s38, s64, 15
    s_add_u32 s38, s38, 33570816
    buffer_load_dwordx4 a[72:75], v2, s[28:31], s38 offen offset:2048 sc1
    s_waitcnt vmcnt(16) lgkmcnt(6)
    v_mfma_f32_32x32x16_bf16 v[64:79], v[32:35], a[32:35], v[64:79]
    ds_read_b64_tr_b16 v[48:49], v4 offset:36864
    ds_read_b64_tr_b16 v[50:51], v4 offset:37888
    v_cvt_pk_bf16_f32 v30, v14, v15
    v_cvt_pk_bf16_f32 v31, v16, v17
    s_waitcnt lgkmcnt(6)
    v_mfma_f32_32x32x16_bf16 v[80:95], v[36:39], a[32:35], v[80:95]
    ds_read_b64_tr_b16 v[52:53], v5 offset:36864
    ds_read_b64_tr_b16 v[54:55], v5 offset:37888
    s_cmp_eq_u32 s96, 0
    s_cbranch_scc1 DU39s
    s_add_u32 s38, s56, 16777216
    buffer_store_dwordx4 v[28:31], v2, s[28:31], s38 offen offset:1024
    s_branch DU39j
DU39s:
    s_add_u32 s38, s56, 16777216
    buffer_store_dwordx4 v[28:31], v2, s[28:31], s38 offen offset:1024 sc1
DU39j:
    v_accvgpr_read_b32 v10, a88
    s_add_u32 m0, s47, 0
    s_add_u32 s38, s65, 2097152
    buffer_load_dwordx4 v8, s[48:51], s38 offen offset:0 lds
    s_waitcnt lgkmcnt(6)
    v_mfma_f32_32x32x16_bf16 v[96:111], v[40:43], a[32:35], v[96:111]
    ds_read_b64_tr_b16 v[56:57], v6 offset:36864
    ds_read_b64_tr_b16 v[58:59], v6 offset:37888
    v_accvgpr_read_b32 v11, a89
    v_accvgpr_read_b32 v12, a90
    s_waitcnt lgkmcnt(6)
    v_mfma_f32_32x32x16_bf16 v[112:127], v[44:47], a[32:35], v[112:127]
    ds_read_b64_tr_b16 v[60:61], v7 offset:36864
    ds_read_b64_tr_b16 v[62:63], v7 offset:37888
    v_accvgpr_read_b32 v13, a91
    v_accvgpr_read_b32 v14, a92
    s_add_u32 m0, s47, 0
    s_add_u32 s38, s65, 2097152
    buffer_load_dwordx4 v9, s[48:51], s38 offen offset:1024 lds
    s_waitcnt vmcnt(18) lgkmcnt(6)
    v_mfma_f32_32x32x16_bf16 v[64:79], v[48:51], a[36:39], v[64:79]
    ds_read_b64_tr_b16 v[32:33], v4 offset:40960
    ds_read_b64_tr_b16 v[34:35], v4 offset:41984
    v_accvgpr_read_b32 v15, a93
    v_accvgpr_read_b32 v16, a94
    s_waitcnt lgkmcnt(6)
    v_mfma_f32_32x32x16_bf16 v[80:95], v[52:55], a[36:39], v[80:95]
    ds_read_b64_tr_b16 v[36:37], v5 offset:40960
    ds_read_b64_tr_b16 v[38:39], v5 offset:41984
    v_accvgpr_read_b32 v17, a95
    v_cvt_pk_bf16_f32 v28, v10, v11
    s_lshl_b32 s38, s64, 15
    s_add_u32 s38, s38, 33570816
    buffer_load_dwordx4 a[76:79], v2, s[28:31], s38 offen offset:3072 sc1
    s_waitcnt lgkmcnt(6)
    v_mfma_f32_32x32x16_bf16 v[96:111], v[56:59], a[36:39], v[96:111]
    ds_read_b64_tr_b16 v[40:41], v6 offset:40960
    ds_read_b64_tr_b16 v[42:43], v6 offset:41984
    v_cvt_pk_bf16_f32 v29, v12, v13
    v_cvt_pk_bf16_f32 v30, v14, v15
    s_waitcnt lgkmcnt(6)
    v_mfma_f32_32x32x16_bf16 v[112:127], v[60:63], a[36:39], v[112:127]
    ds_read_b64_tr_b16 v[44:45], v7 offset:40960
    ds_read_b64_tr_b16 v[46:47], v7 offset:41984
    v_cvt_pk_bf16_f32 v31, v16, v17
    s_cmp_eq_u32 s96, 0
    s_cbranch_scc1 DU40s
    s_add_u32 s38, s56, 16781312
    buffer_store_dwordx4 v[28:31], v2, s[28:31], s38 offen offset:1024
    s_branch DU40j
DU40s:
    s_add_u32 s38, s56, 16781312
    buffer_store_dwordx4 v[28:31], v2, s[28:31], s38 offen offset:1024 sc1
DU40j:
    s_waitcnt vmcnt(19) lgkmcnt(6)
    v_mfma_f32_32x32x16_bf16 v[64:79], v[32:35], a[40:43], v[64:79]
    ds_read_b64_tr_b16 v[48:49], v4 offset:45056
    ds_read_b64_tr_b16 v[50:51], v4 offset:46080
    v_accvgpr_read_b32 v10, a96
    s_waitcnt lgkmcnt(6)
    v_mfma_f32_32x32x16_bf16 v[80:95], v[36:39], a[40:43], v[80:95]
    ds_read_b64_tr_b16 v[52:53], v5 offset:45056
    ds_read_b64_tr_b16 v[54:55], v5 offset:46080
    v_accvgpr_read_b32 v11, a97
    v_accvgpr_read_b32 v12, a98
    s_lshl_b32 s38, s64, 15
    s_add_u32 s38, s38, 33574912
    buffer_load_dwordx4 a[80:83], v2, s[28:31], s38 offen offset:0 sc1
    s_waitcnt lgkmcnt(6)
    v_mfma_f32_32x32x16_bf16 v[96:111], v[40:43], a[40:43], v[96:111]
    ds_read_b64_tr_b16 v[56:57], v6 offset:45056
    ds_read_b64_tr_b16 v[58:59], v6 offset:46080
    v_accvgpr_read_b32 v13, a99
    v_accvgpr_read_b32 v14, a100
    s_waitcnt lgkmcnt(6)
    v_mfma_f32_32x32x16_bf16 v[112:127], v[44:47], a[40:43], v[112:127]
    s_waitcnt vmcnt(12)
    s_barrier
    ds_read_b64_tr_b16 v[60:61], v7 offset:45056
    ds_read_b64_tr_b16 v[62:63], v7 offset:46080
    v_accvgpr_read_b32 v15, a101
    v_accvgpr_read_b32 v16, a102
    s_lshl_b32 s38, s64, 15
    s_add_u32 s38, s38, 33574912
    buffer_load_dwordx4 a[84:87], v2, s[28:31], s38 offen offset:1024 sc1
    s_waitcnt lgkmcnt(6)
    v_mfma_f32_32x32x16_bf16 v[64:79], v[48:51], a[44:47], v[64:79]
    ds_read_b64_tr_b16 v[32:33], v4 offset:49152
    ds_read_b64_tr_b16 v[34:35], v4 offset:50176
    v_accvgpr_read_b32 v17, a103
    v_cvt_pk_bf16_f32 v28, v10, v11
    s_waitcnt lgkmcnt(6)
    v_mfma_f32_32x32x16_bf16 v[80:95], v[52:55], a[44:47], v[80:95]
    ds_read_b64_tr_b16 v[36:37], v5 offset:49152
    ds_read_b64_tr_b16 v[38:39], v5 offset:50176
    v_cvt_pk_bf16_f32 v29, v12, v13
    v_cvt_pk_bf16_f32 v30, v14, v15
    s_lshl_b32 s38, s64, 15
    s_add_u32 s38, s38, 33574912
    buffer_load_dwordx4 a[88:91], v2, s[28:31], s38 offen offset:2048 sc1
    s_waitcnt lgkmcnt(6)
    v_mfma_f32_32x32x16_bf16 v[96:111], v[56:59], a[44:47], v[96:111]
    ds_read_b64_tr_b16 v[40:41], v6 offset:49152
    ds_read_b64_tr_b16 v[42:43], v6 offset:50176
    v_cvt_pk_bf16_f32 v31, v16, v17
    s_cmp_eq_u32 s96, 0
    s_cbranch_scc1 DU41s
    s_add_u32 s38, s56, 16777216
    buffer_store_dwordx4 v[28:31], v2, s[28:31], s38 offen offset:2048
    s_branch DU41j
DU41s:
    s_add_u32 s38, s56, 16777216
    buffer_store_dwordx4 v[28:31], v2, s[28:31], s38 offen offset:2048 sc1
DU41j:
    s_waitcnt lgkmcnt(6)
    v_mfma_f32_32x32x16_bf16 v[112:127], v[60:63], a[44:47], v[112:127]
    ds_read_b64_tr_b16 v[44:45], v7 offset:49152
    ds_read_b64_tr_b16 v[46:47], v7 offset:50176
    v_accvgpr_read_b32 v10, a104
    v_accvgpr_read_b32 v11, a105
    s_lshl_b32 s38, s64, 15
    s_add_u32 s38, s38, 33574912
    buffer_load_dwordx4 a[92:95], v2, s[28:31], s38 offen offset:3072 sc1
    s_waitcnt lgkmcnt(6)
    v_mfma_f32_32x32x16_bf16 v[64:79], v[32:35], a[48:51], v[64:79]
    ds_read_b64_tr_b16 v[48:49], v4 offset:53248
    ds_read_b64_tr_b16 v[50:51], v4 offset:54272
    v_accvgpr_read_b32 v12, a106
    v_accvgpr_read_b32 v13, a107
    s_waitcnt lgkmcnt(6)
    v_mfma_f32_32x32x16_bf16 v[80:95], v[36:39], a[48:51], v[80:95]
    ds_read_b64_tr_b16 v[52:53], v5 offset:53248
    ds_read_b64_tr_b16 v[54:55], v5 offset:54272
    v_accvgpr_read_b32 v14, a108
    v_accvgpr_read_b32 v15, a109
    s_add_u32 m0, s47, 16384
    s_add_u32 s38, s65, 2621440
    buffer_load_dwordx4 v8, s[48:51], s38 offen offset:0 lds
    s_waitcnt lgkmcnt(6)
    v_mfma_f32_32x32x16_bf16 v[96:111], v[40:43], a[48:51], v[96:111]
    ds_read_b64_tr_b16 v[56:57], v6 offset:53248
    ds_read_b64_tr_b16 v[58:59], v6 offset:54272
    v_accvgpr_read_b32 v16, a110
    v_accvgpr_read_b32 v17, a111
    s_waitcnt lgkmcnt(6)
    v_mfma_f32_32x32x16_bf16 v[112:127], v[44:47], a[48:51], v[112:127]
    ds_read_b64_tr_b16 v[60:61], v7 offset:53248
    ds_read_b64_tr_b16 v[62:63], v7 offset:54272
    v_cvt_pk_bf16_f32 v28, v10, v11
    v_cvt_pk_bf16_f32 v29, v12, v13
    s_add_u32 m0, s47, 16384
    s_add_u32 s38, s65, 2621440
    buffer_load_dwordx4 v9, s[48:51], s38 offen offset:1024 lds
    s_waitcnt lgkmcnt(6)
    v_mfma_f32_32x32x16_bf16 v[64:79], v[48:51], a[52:55], v[64:79]
    ds_read_b64_tr_b16 v[32:33], v4 offset:57344
    ds_read_b64_tr_b16 v[34:35], v4 offset:58368
    v_cvt_pk_bf16_f32 v30, v14, v15
    v_cvt_pk_bf16_f32 v31, v16, v17
    s_waitcnt lgkmcnt(6)
    v_mfma_f32_32x32x16_bf16 v[80:95], v[52:55], a[52:55], v[80:95]
    ds_read_b64_tr_b16 v[36:37], v5 offset:57344
    ds_read_b64_tr_b16 v[38:39], v5 offset:58368
    s_cmp_eq_u32 s96, 0
    s_cbranch_scc1 DU42s
    s_add_u32 s38, s56, 16781312
    buffer_store_dwordx4 v[28:31], v2, s[28:31], s38 offen offset:2048
    s_branch DU42j
DU42s:
    s_add_u32 s38, s56, 16781312
    buffer_store_dwordx4 v[28:31], v2, s[28:31], s38 offen offset:2048 sc1
DU42j:
    s_lshl_b32 s38, s64, 15
    s_add_u32 s38, s38, 33579008
    buffer_load_dwordx4 a[96:99], v2, s[28:31], s38 offen offset:0 sc1
    s_waitcnt lgkmcnt(6)
    v_mfma_f32_32x32x16_bf16 v[96:111], v[56:59], a[52:55], v[96:111]
    ds_read_b64_tr_b16 v[40:41], v6 offset:57344
    ds_read_b64_tr_b16 v[42:43], v6 offset:58368
    v_accvgpr_read_b32 v10, a112
    v_accvgpr_read_b32 v11, a113
    s_waitcnt lgkmcnt(6)
    v_mfma_f32_32x32x16_bf16 v[112:127], v[60:63], a[52:55], v[112:127]
    ds_read_b64_tr_b16 v[44:45], v7 offset:57344
    ds_read_b64_tr_b16 v[46:47], v7 offset:58368
    v_accvgpr_read_b32 v12, a114
    v_accvgpr_read_b32 v13, a115
    s_lshl_b32 s38, s64, 15
    s_add_u32 s38, s38, 33579008
    buffer_load_dwordx4 a[100:103], v2, s[28:31], s38 offen offset:1024 sc1
    s_waitcnt vmcnt(20) lgkmcnt(6)
    v_mfma_f32_32x32x16_bf16 v[64:79], v[32:35], a[56:59], v[64:79]
    ds_read_b64_tr_b16 v[48:49], v4 offset:61440
    ds_read_b64_tr_b16 v[50:51], v4 offset:62464
    v_accvgpr_read_b32 v14, a116
    v_accvgpr_read_b32 v15, a117
    s_waitcnt lgkmcnt(6)
    v_mfma_f32_32x32x16_bf16 v[80:95], v[36:39], a[56:59], v[80:95]
    ds_read_b64_tr_b16 v[52:53], v5 offset:61440
    ds_read_b64_tr_b16 v[54:55], v5 offset:62464
    v_accvgpr_read_b32 v16, a118
    v_accvgpr_read_b32 v17, a119
    s_lshl_b32 s38, s64, 15
    s_add_u32 s38, s38, 33579008
    buffer_load_dwordx4 a[104:107], v2, s[28:31], s38 offen offset:2048 sc1
    s_waitcnt lgkmcnt(6)
    v_mfma_f32_32x32x16_bf16 v[96:111], v[40:43], a[56:59], v[96:111]
    ds_read_b64_tr_b16 v[56:57], v6 offset:61440
    ds_read_b64_tr_b16 v[58:59], v6 offset:62464
    v_cvt_pk_bf16_f32 v28, v10, v11
    v_cvt_pk_bf16_f32 v29, v12, v13
    s_waitcnt lgkmcnt(6)
    v_mfma_f32_32x32x16_bf16 v[112:127], v[44:47], a[56:59], v[112:127]
    s_waitcnt vmcnt(13)
    s_barrier
    ds_read_b64_tr_b16 v[60:61], v7 offset:61440
    ds_read_b64_tr_b16 v[62:63], v7 offset:62464
    v_cvt_pk_bf16_f32 v30, v14, v15
    v_cvt_pk_bf16_f32 v31, v16, v17
    s_lshl_b32 s38, s64, 15
    s_add_u32 s38, s38, 33579008
    buffer_load_dwordx4 a[108:111], v2, s[28:31], s38 offen offset:3072 sc1
    s_waitcnt lgkmcnt(6)
    v_mfma_f32_32x32x16_bf16 v[64:79], v[48:51], a[60:63], v[64:79]
    ds_read_b64_tr_b16 v[32:33], v4 offset:0
    ds_read_b64_tr_b16 v[34:35], v4 offset:1024
    s_cmp_eq_u32 s96, 0
    s_cbranch_scc1 DU43s
    s_add_u32 s38, s56, 16777216
    buffer_store_dwordx4 v[28:31], v2, s[28:31], s38 offen offset:3072
    s_branch DU43j
DU43s:
    s_add_u32 s38, s56, 16777216
    buffer_store_dwordx4 v[28:31], v2, s[28:31], s38 offen offset:3072 sc1
DU43j:
    v_accvgpr_read_b32 v10, a120
    s_waitcnt lgkmcnt(6)
    v_mfma_f32_32x32x16_bf16 v[80:95], v[52:55], a[60:63], v[80:95]
    ds_read_b64_tr_b16 v[36:37], v5 offset:0
    ds_read_b64_tr_b16 v[38:39], v5 offset:1024
    v_accvgpr_read_b32 v11, a121
    v_accvgpr_read_b32 v12, a122
    s_waitcnt lgkmcnt(6)
    v_mfma_f32_32x32x16_bf16 v[96:111], v[56:59], a[60:63], v[96:111]
    ds_read_b64_tr_b16 v[40:41], v6 offset:0
    ds_read_b64_tr_b16 v[42:43], v6 offset:1024
    v_accvgpr_read_b32 v13, a123
    v_accvgpr_read_b32 v14, a124
    s_waitcnt lgkmcnt(6)
    v_mfma_f32_32x32x16_bf16 v[112:127], v[60:63], a[60:63], v[112:127]
    ds_read_b64_tr_b16 v[44:45], v7 offset:0
    ds_read_b64_tr_b16 v[46:47], v7 offset:1024
    v_accvgpr_read_b32 v15, a125
    v_accvgpr_read_b32 v16, a126
    s_waitcnt lgkmcnt(6)
    v_mfma_f32_32x32x16_bf16 v[64:79], v[32:35], a[64:67], v[64:79]
    ds_read_b64_tr_b16 v[48:49], v4 offset:4096
    ds_read_b64_tr_b16 v[50:51], v4 offset:5120
    v_accvgpr_read_b32 v17, a127
    v_cvt_pk_bf16_f32 v28, v10, v11
    s_waitcnt lgkmcnt(6)
    v_mfma_f32_32x32x16_bf16 v[80:95], v[36:39], a[64:67], v[80:95]
    ds_read_b64_tr_b16 v[52:53], v5 offset:4096
    ds_read_b64_tr_b16 v[54:55], v5 offset:5120
    v_cvt_pk_bf16_f32 v29, v12, v13
    v_cvt_pk_bf16_f32 v30, v14, v15
    s_add_u32 m0, s47, 32768
    s_add_u32 s38, s65, 3145728
    buffer_load_dwordx4 v8, s[48:51], s38 offen offset:0 lds
    s_waitcnt lgkmcnt(6)
    v_mfma_f32_32x32x16_bf16 v[96:111], v[40:43], a[64:67], v[96:111]
    ds_read_b64_tr_b16 v[56:57], v6 offset:4096
    ds_read_b64_tr_b16 v[58:59], v6 offset:5120
    v_cvt_pk_bf16_f32 v31, v16, v17
    s_cmp_eq_u32 s96, 0
    s_cbranch_scc1 DU44s
    s_add_u32 s38, s56, 16781312
    buffer_store_dwordx4 v[28:31], v2, s[28:31], s38 offen offset:3072
    s_branch DU44j
DU44s:
    s_add_u32 s38, s56, 16781312
    buffer_store_dwordx4 v[28:31], v2, s[28:31], s38 offen offset:3072 sc1
DU44j:
    s_waitcnt lgkmcnt(6)
    v_mfma_f32_32x32x16_bf16 v[112:127], v[44:47], a[64:67], v[112:127]
    ds_read_b64_tr_b16 v[60:61], v7 offset:4096
    ds_read_b64_tr_b16 v[62:63], v7 offset:5120
    s_add_u32 m0, s47, 32768
    s_add_u32 s38, s65, 3145728
    buffer_load_dwordx4 v9, s[48:51], s38 offen offset:1024 lds
    s_waitcnt lgkmcnt(6)
    v_mfma_f32_32x32x16_bf16 v[64:79], v[48:51], a[68:71], v[64:79]
    ds_read_b64_tr_b16 v[32:33], v4 offset:8192
    ds_read_b64_tr_b16 v[34:35], v4 offset:9216
    s_waitcnt lgkmcnt(6)
    v_mfma_f32_32x32x16_bf16 v[80:95], v[52:55], a[68:71], v[80:95]
    ds_read_b64_tr_b16 v[36:37], v5 offset:8192
    ds_read_b64_tr_b16 v[38:39], v5 offset:9216
    s_add_u32 m0, s42, 0
    s_add_u32 s38, s41, 0
    buffer_load_dwordx4 v2, s[28:31], s38 offen offset:0 sc1 lds
    s_waitcnt lgkmcnt(6)
    v_mfma_f32_32x32x16_bf16 v[96:111], v[56:59], a[68:71], v[96:111]
    ds_read_b64_tr_b16 v[40:41], v6 offset:8192
    ds_read_b64_tr_b16 v[42:43], v6 offset:9216
    s_waitcnt lgkmcnt(6)
    v_mfma_f32_32x32x16_bf16 v[112:127], v[60:63], a[68:71], v[112:127]
    ds_read_b64_tr_b16 v[44:45], v7 offset:8192
    ds_read_b64_tr_b16 v[46:47], v7 offset:9216
    s_add_u32 m0, s42, 0
    s_add_u32 s38, s41, 0
    buffer_load_dwordx4 v2, s[28:31], s38 offen offset:1024 sc1 lds
    s_waitcnt lgkmcnt(6)
    v_mfma_f32_32x32x16_bf16 v[64:79], v[32:35], a[72:75], v[64:79]
    ds_read_b64_tr_b16 v[48:49], v4 offset:12288
    ds_read_b64_tr_b16 v[50:51], v4 offset:13312
    s_waitcnt lgkmcnt(6)
    v_mfma_f32_32x32x16_bf16 v[80:95], v[36:39], a[72:75], v[80:95]
    ds_read_b64_tr_b16 v[52:53], v5 offset:12288
    ds_read_b64_tr_b16 v[54:55], v5 offset:13312
    s_add_u32 m0, s42, 0
    s_add_u32 s38, s41, 0
    buffer_load_dwordx4 v2, s[28:31], s38 offen offset:2048 sc1 lds
    s_waitcnt lgkmcnt(6)
    v_mfma_f32_32x32x16_bf16 v[96:111], v[40:43], a[72:75], v[96:111]
    ds_read_b64_tr_b16 v[56:57], v6 offset:12288
    ds_read_b64_tr_b16 v[58:59], v6 offset:13312
    s_waitcnt lgkmcnt(6)
    v_mfma_f32_32x32x16_bf16 v[112:127], v[44:47], a[72:75], v[112:127]
    s_waitcnt vmcnt(12)
    s_barrier
    ds_read_b64_tr_b16 v[60:61], v7 offset:12288
    ds_read_b64_tr_b16 v[62:63], v7 offset:13312
    s_lshl_b32 s38, s64, 15
    s_add_u32 s38, s38, 33583104
    buffer_load_dwordx4 a[112:115], v2, s[28:31], s38 offen offset:0 sc1
    s_waitcnt lgkmcnt(6)
    v_mfma_f32_32x32x16_bf16 v[64:79], v[48:51], a[76:79], v[64:79]
    ds_read_b64_tr_b16 v[32:33], v4 offset:16384
    ds_read_b64_tr_b16 v[34:35], v4 offset:17408
    s_waitcnt lgkmcnt(6)
    v_mfma_f32_32x32x16_bf16 v[80:95], v[52:55], a[76:79], v[80:95]
    ds_read_b64_tr_b16 v[36:37], v5 offset:16384
    ds_read_b64_tr_b16 v[38:39], v5 offset:17408
    s_lshl_b32 s38, s64, 15
    s_add_u32 s38, s38, 33583104
    buffer_load_dwordx4 a[116:119], v2, s[28:31], s38 offen offset:1024 sc1
    s_waitcnt lgkmcnt(6)
    v_mfma_f32_32x32x16_bf16 v[96:111], v[56:59], a[76:79], v[96:111]
    ds_read_b64_tr_b16 v[40:41], v6 offset:16384
    ds_read_b64_tr_b16 v[42:43], v6 offset:17408
    s_waitcnt lgkmcnt(6)
    v_mfma_f32_32x32x16_bf16 v[112:127], v[60:63], a[76:79], v[112:127]
    ds_read_b64_tr_b16 v[44:45], v7 offset:16384
    ds_read_b64_tr_b16 v[46:47], v7 offset:17408
    s_lshl_b32 s38, s64, 15
    s_add_u32 s38, s38, 33583104
    buffer_load_dwordx4 a[120:123], v2, s[28:31], s38 offen offset:2048 sc1
    s_waitcnt lgkmcnt(6)
    v_mfma_f32_32x32x16_bf16 v[64:79], v[32:35], a[80:83], v[64:79]
    ds_read_b64_tr_b16 v[48:49], v4 offset:20480
    ds_read_b64_tr_b16 v[50:51], v4 offset:21504
    s_waitcnt lgkmcnt(6)
    v_mfma_f32_32x32x16_bf16 v[80:95], v[36:39], a[80:83], v[80:95]
    ds_read_b64_tr_b16 v[52:53], v5 offset:20480
    ds_read_b64_tr_b16 v[54:55], v5 offset:21504
    s_add_u32 m0, s47, 49152
    s_add_u32 s38, s65, 3670016
    buffer_load_dwordx4 v8, s[48:51], s38 offen offset:0 lds
    s_waitcnt lgkmcnt(6)
    v_mfma_f32_32x32x16_bf16 v[96:111], v[40:43], a[80:83], v[96:111]
    ds_read_b64_tr_b16 v[56:57], v6 offset:20480
    ds_read_b64_tr_b16 v[58:59], v6 offset:21504
    s_waitcnt lgkmcnt(6)
    v_mfma_f32_32x32x16_bf16 v[112:127], v[44:47], a[80:83], v[112:127]
    ds_read_b64_tr_b16 v[60:61], v7 offset:20480
    ds_read_b64_tr_b16 v[62:63], v7 offset:21504
    s_add_u32 m0, s47, 49152
    s_add_u32 s38, s65, 3670016
    buffer_load_dwordx4 v9, s[48:51], s38 offen offset:1024 lds
    s_waitcnt lgkmcnt(6)
    v_mfma_f32_32x32x16_bf16 v[64:79], v[48:51], a[84:87], v[64:79]
    ds_read_b64_tr_b16 v[32:33], v4 offset:24576
    ds_read_b64_tr_b16 v[34:35], v4 offset:25600
    s_waitcnt lgkmcnt(6)
    v_mfma_f32_32x32x16_bf16 v[80:95], v[52:55], a[84:87], v[80:95]
    ds_read_b64_tr_b16 v[36:37], v5 offset:24576
    ds_read_b64_tr_b16 v[38:39], v5 offset:25600
    s_lshl_b32 s38, s64, 15
    s_add_u32 s38, s38, 33583104
    buffer_load_dwordx4 a[124:127], v2, s[28:31], s38 offen offset:3072 sc1
    s_waitcnt lgkmcnt(6)
    v_mfma_f32_32x32x16_bf16 v[96:111], v[56:59], a[84:87], v[96:111]
    ds_read_b64_tr_b16 v[40:41], v6 offset:24576
    ds_read_b64_tr_b16 v[42:43], v6 offset:25600
    s_waitcnt lgkmcnt(6)
    v_mfma_f32_32x32x16_bf16 v[112:127], v[60:63], a[84:87], v[112:127]
    ds_read_b64_tr_b16 v[44:45], v7 offset:24576
    ds_read_b64_tr_b16 v[46:47], v7 offset:25600
    s_add_u32 m0, s42, 24576
    s_add_u32 s38, s41, 24576
    buffer_load_dwordx4 v2, s[28:31], s38 offen offset:0 sc1 lds
    s_waitcnt lgkmcnt(6)
    v_mfma_f32_32x32x16_bf16 v[64:79], v[32:35], a[88:91], v[64:79]
    ds_read_b64_tr_b16 v[48:49], v4 offset:28672
    ds_read_b64_tr_b16 v[50:51], v4 offset:29696
    s_waitcnt lgkmcnt(6)
    v_mfma_f32_32x32x16_bf16 v[80:95], v[36:39], a[88:91], v[80:95]
    ds_read_b64_tr_b16 v[52:53], v5 offset:28672
    ds_read_b64_tr_b16 v[54:55], v5 offset:29696
    s_add_u32 m0, s42, 24576
    s_add_u32 s38, s41, 24576
    buffer_load_dwordx4 v2, s[28:31], s38 offen offset:1024 sc1 lds
    s_waitcnt lgkmcnt(6)
    v_mfma_f32_32x32x16_bf16 v[96:111], v[40:43], a[88:91], v[96:111]
    ds_read_b64_tr_b16 v[56:57], v6 offset:28672
    ds_read_b64_tr_b16 v[58:59], v6 offset:29696
    s_waitcnt lgkmcnt(6)
    v_mfma_f32_32x32x16_bf16 v[112:127], v[44:47], a[88:91], v[112:127]
    s_waitcnt vmcnt(11)
    s_barrier
    ds_read_b64_tr_b16 v[60:61], v7 offset:28672
    ds_read_b64_tr_b16 v[62:63], v7 offset:29696
    s_add_u32 m0, s42, 24576
    s_add_u32 s38, s41, 24576
    buffer_load_dwordx4 v2, s[28:31], s38 offen offset:2048 sc1 lds
    s_waitcnt lgkmcnt(6)
    v_mfma_f32_32x32x16_bf16 v[64:79], v[48:51], a[92:95], v[64:79]
    ds_read_b64_tr_b16 v[32:33], v4 offset:32768
    ds_read_b64_tr_b16 v[34:35], v4 offset:33792
    s_waitcnt lgkmcnt(6)
    v_mfma_f32_32x32x16_bf16 v[80:95], v[52:55], a[92:95], v[80:95]
    ds_read_b64_tr_b16 v[36:37], v5 offset:32768
    ds_read_b64_tr_b16 v[38:39], v5 offset:33792
    s_waitcnt lgkmcnt(6)
    v_mfma_f32_32x32x16_bf16 v[96:111], v[56:59], a[92:95], v[96:111]
    ds_read_b64_tr_b16 v[40:41], v6 offset:32768
    ds_read_b64_tr_b16 v[42:43], v6 offset:33792
    s_waitcnt lgkmcnt(6)
    v_mfma_f32_32x32x16_bf16 v[112:127], v[60:63], a[92:95], v[112:127]
    ds_read_b64_tr_b16 v[44:45], v7 offset:32768
    ds_read_b64_tr_b16 v[46:47], v7 offset:33792
    s_waitcnt lgkmcnt(6)
    v_mfma_f32_32x32x16_bf16 v[64:79], v[32:35], a[96:99], v[64:79]
    ds_read_b64_tr_b16 v[48:49], v4 offset:36864
    ds_read_b64_tr_b16 v[50:51], v4 offset:37888
    s_waitcnt lgkmcnt(6)
    v_mfma_f32_32x32x16_bf16 v[80:95], v[36:39], a[96:99], v[80:95]
    ds_read_b64_tr_b16 v[52:53], v5 offset:36864
    ds_read_b64_tr_b16 v[54:55], v5 offset:37888
    s_add_u32 m0, s42, 49152
    s_add_u32 s38, s41, 49152
    buffer_load_dwordx4 v2, s[28:31], s38 offen offset:0 sc1 lds
    s_waitcnt lgkmcnt(6)
    v_mfma_f32_32x32x16_bf16 v[96:111], v[40:43], a[96:99], v[96:111]
    ds_read_b64_tr_b16 v[56:57], v6 offset:36864
    ds_read_b64_tr_b16 v[58:59], v6 offset:37888
    s_waitcnt lgkmcnt(6)
    v_mfma_f32_32x32x16_bf16 v[112:127], v[44:47], a[96:99], v[112:127]
    ds_read_b64_tr_b16 v[60:61], v7 offset:36864
    ds_read_b64_tr_b16 v[62:63], v7 offset:37888
    s_add_u32 m0, s42, 49152
    s_add_u32 s38, s41, 49152
    buffer_load_dwordx4 v2, s[28:31], s38 offen offset:1024 sc1 lds
    s_waitcnt lgkmcnt(6)
    v_mfma_f32_32x32x16_bf16 v[64:79], v[48:51], a[100:103], v[64:79]
    ds_read_b64_tr_b16 v[32:33], v4 offset:40960
    ds_read_b64_tr_b16 v[34:35], v4 offset:41984
    s_waitcnt lgkmcnt(6)
    v_mfma_f32_32x32x16_bf16 v[80:95], v[52:55], a[100:103], v[80:95]
    ds_read_b64_tr_b16 v[36:37], v5 offset:40960
    ds_read_b64_tr_b16 v[38:39], v5 offset:41984
    s_add_u32 m0, s42, 49152
    s_add_u32 s38, s41, 49152
    buffer_load_dwordx4 v2, s[28:31], s38 offen offset:2048 sc1 lds
    s_waitcnt lgkmcnt(6)
    v_mfma_f32_32x32x16_bf16 v[96:111], v[56:59], a[100:103], v[96:111]
    ds_read_b64_tr_b16 v[40:41], v6 offset:40960
    ds_read_b64_tr_b16 v[42:43], v6 offset:41984
    s_waitcnt lgkmcnt(6)
    v_mfma_f32_32x32x16_bf16 v[112:127], v[60:63], a[100:103], v[112:127]
    ds_read_b64_tr_b16 v[44:45], v7 offset:40960
    ds_read_b64_tr_b16 v[46:47], v7 offset:41984
    s_add_u32 m0, s42, 73728
    s_add_u32 s38, s41, 73728
    buffer_load_dwordx4 v2, s[28:31], s38 offen offset:0 sc1 lds
    s_waitcnt lgkmcnt(6)
    v_mfma_f32_32x32x16_bf16 v[64:79], v[32:35], a[104:107], v[64:79]
    ds_read_b64_tr_b16 v[48:49], v4 offset:45056
    ds_read_b64_tr_b16 v[50:51], v4 offset:46080
    s_waitcnt lgkmcnt(6)
    v_mfma_f32_32x32x16_bf16 v[80:95], v[36:39], a[104:107], v[80:95]
    ds_read_b64_tr_b16 v[52:53], v5 offset:45056
    ds_read_b64_tr_b16 v[54:55], v5 offset:46080
    s_add_u32 m0, s42, 73728
    s_add_u32 s38, s41, 73728
    buffer_load_dwordx4 v2, s[28:31], s38 offen offset:1024 sc1 lds
    s_waitcnt lgkmcnt(6)
    v_mfma_f32_32x32x16_bf16 v[96:111], v[40:43], a[104:107], v[96:111]
    ds_read_b64_tr_b16 v[56:57], v6 offset:45056
    ds_read_b64_tr_b16 v[58:59], v6 offset:46080
    s_waitcnt lgkmcnt(6)
    v_mfma_f32_32x32x16_bf16 v[112:127], v[44:47], a[104:107], v[112:127]
    s_waitcnt vmcnt(9)
    s_barrier
    ds_read_b64_tr_b16 v[60:61], v7 offset:45056
    ds_read_b64_tr_b16 v[62:63], v7 offset:46080
    s_add_u32 m0, s42, 73728
    s_add_u32 s38, s41, 73728
    buffer_load_dwordx4 v2, s[28:31], s38 offen offset:2048 sc1 lds
    s_waitcnt lgkmcnt(6)
    v_mfma_f32_32x32x16_bf16 v[64:79], v[48:51], a[108:111], v[64:79]
    ds_read_b64_tr_b16 v[32:33], v4 offset:49152
    ds_read_b64_tr_b16 v[34:35], v4 offset:50176
    s_and_b32 s38, s3, 3
    s_cmp_lg_u32 s38, 0
    s_cbranch_scc1 CP45
    s_mov_b32 s38, ATT_B-parallel_sum__compressed_kv_cla__swiglu_ffn__prompt_kernel+0
    v_lshl_add_u32 v26, v1, 7, s38
    s_mov_b32 s38, ATT_B_end-parallel_sum__compressed_kv_cla__swiglu_ffn__prompt_kernel-128
    v_min_u32 v26, s38, v26
    v_mov_b32 v27, s101
    v_add_co_u32 v26, vcc, s100, v26
    s_nop 1
    v_addc_co_u32 v27, vcc, 0, v27, vcc
    global_load_dword v3, v[26:27], off
    s_mov_b32 s38, ATT_B-parallel_sum__compressed_kv_cla__swiglu_ffn__prompt_kernel+8192
    v_lshl_add_u32 v26, v1, 7, s38
    s_mov_b32 s38, ATT_B_end-parallel_sum__compressed_kv_cla__swiglu_ffn__prompt_kernel-128
    v_min_u32 v26, s38, v26
    v_mov_b32 v27, s101
    v_add_co_u32 v26, vcc, s100, v26
    s_nop 1
    v_addc_co_u32 v27, vcc, 0, v27, vcc
    global_load_dword v3, v[26:27], off
CP45:
    s_waitcnt lgkmcnt(6)
    v_mfma_f32_32x32x16_bf16 v[80:95], v[52:55], a[108:111], v[80:95]
    ds_read_b64_tr_b16 v[36:37], v5 offset:49152
    ds_read_b64_tr_b16 v[38:39], v5 offset:50176
    s_waitcnt lgkmcnt(6)
    v_mfma_f32_32x32x16_bf16 v[96:111], v[56:59], a[108:111], v[96:111]
    ds_read_b64_tr_b16 v[40:41], v6 offset:49152
    ds_read_b64_tr_b16 v[42:43], v6 offset:50176
    s_waitcnt lgkmcnt(6)
    v_mfma_f32_32x32x16_bf16 v[112:127], v[60:63], a[108:111], v[112:127]
    ds_read_b64_tr_b16 v[44:45], v7 offset:49152
    ds_read_b64_tr_b16 v[46:47], v7 offset:50176
    s_waitcnt lgkmcnt(6)
    v_mfma_f32_32x32x16_bf16 v[64:79], v[32:35], a[112:115], v[64:79]
    ds_read_b64_tr_b16 v[48:49], v4 offset:53248
    ds_read_b64_tr_b16 v[50:51], v4 offset:54272
    s_waitcnt lgkmcnt(6)
    v_mfma_f32_32x32x16_bf16 v[80:95], v[36:39], a[112:115], v[80:95]
    ds_read_b64_tr_b16 v[52:53], v5 offset:53248
    ds_read_b64_tr_b16 v[54:55], v5 offset:54272
    s_waitcnt lgkmcnt(6)
    v_mfma_f32_32x32x16_bf16 v[96:111], v[40:43], a[112:115], v[96:111]
    ds_read_b64_tr_b16 v[56:57], v6 offset:53248
    ds_read_b64_tr_b16 v[58:59], v6 offset:54272
    s_waitcnt lgkmcnt(6)
    v_mfma_f32_32x32x16_bf16 v[112:127], v[44:47], a[112:115], v[112:127]
    ds_read_b64_tr_b16 v[60:61], v7 offset:53248
    ds_read_b64_tr_b16 v[62:63], v7 offset:54272
    s_waitcnt lgkmcnt(6)
    v_mfma_f32_32x32x16_bf16 v[64:79], v[48:51], a[116:119], v[64:79]
    ds_read_b64_tr_b16 v[32:33], v4 offset:57344
    ds_read_b64_tr_b16 v[34:35], v4 offset:58368
    s_waitcnt lgkmcnt(6)
    v_mfma_f32_32x32x16_bf16 v[80:95], v[52:55], a[116:119], v[80:95]
    ds_read_b64_tr_b16 v[36:37], v5 offset:57344
    ds_read_b64_tr_b16 v[38:39], v5 offset:58368
    s_waitcnt lgkmcnt(6)
    v_mfma_f32_32x32x16_bf16 v[96:111], v[56:59], a[116:119], v[96:111]
    ds_read_b64_tr_b16 v[40:41], v6 offset:57344
    ds_read_b64_tr_b16 v[42:43], v6 offset:58368
    s_waitcnt lgkmcnt(6)
    v_mfma_f32_32x32x16_bf16 v[112:127], v[60:63], a[116:119], v[112:127]
    ds_read_b64_tr_b16 v[44:45], v7 offset:57344
    ds_read_b64_tr_b16 v[46:47], v7 offset:58368
    s_waitcnt lgkmcnt(6)
    v_mfma_f32_32x32x16_bf16 v[64:79], v[32:35], a[120:123], v[64:79]
    ds_read_b64_tr_b16 v[48:49], v4 offset:61440
    ds_read_b64_tr_b16 v[50:51], v4 offset:62464
    s_waitcnt lgkmcnt(6)
    v_mfma_f32_32x32x16_bf16 v[80:95], v[36:39], a[120:123], v[80:95]
    ds_read_b64_tr_b16 v[52:53], v5 offset:61440
    ds_read_b64_tr_b16 v[54:55], v5 offset:62464
    s_waitcnt lgkmcnt(6)
    v_mfma_f32_32x32x16_bf16 v[96:111], v[40:43], a[120:123], v[96:111]
    ds_read_b64_tr_b16 v[56:57], v6 offset:61440
    ds_read_b64_tr_b16 v[58:59], v6 offset:62464
    s_waitcnt lgkmcnt(6)
    v_mfma_f32_32x32x16_bf16 v[112:127], v[44:47], a[120:123], v[112:127]
    s_waitcnt vmcnt(0)
    s_barrier
    ds_read_b64_tr_b16 v[60:61], v7 offset:61440
    ds_read_b64_tr_b16 v[62:63], v7 offset:62464
    s_waitcnt lgkmcnt(6)
    v_mfma_f32_32x32x16_bf16 v[64:79], v[48:51], a[124:127], v[64:79]
    s_waitcnt lgkmcnt(4)
    v_mfma_f32_32x32x16_bf16 v[80:95], v[52:55], a[124:127], v[80:95]
    s_waitcnt lgkmcnt(2)
    v_mfma_f32_32x32x16_bf16 v[96:111], v[56:59], a[124:127], v[96:111]
    s_waitcnt lgkmcnt(0)
    v_mfma_f32_32x32x16_bf16 v[112:127], v[60:63], a[124:127], v[112:127]
    s_nop 9
    v_mul_f32 v96, 0x3e0293ee, v96
    v_mul_f32 v97, 0x3e0293ee, v97
    v_mul_f32 v98, 0x3e0293ee, v98
    v_mul_f32 v99, 0x3e0293ee, v99
    v_mul_f32 v100, 0x3e0293ee, v100
    v_mul_f32 v101, 0x3e0293ee, v101
    v_mul_f32 v102, 0x3e0293ee, v102
    v_mul_f32 v103, 0x3e0293ee, v103
    v_mul_f32 v104, 0x3e0293ee, v104
    v_mul_f32 v105, 0x3e0293ee, v105
    v_mul_f32 v106, 0x3e0293ee, v106
    v_mul_f32 v107, 0x3e0293ee, v107
    v_mul_f32 v108, 0x3e0293ee, v108
    v_mul_f32 v109, 0x3e0293ee, v109
    v_mul_f32 v110, 0x3e0293ee, v110
    v_mul_f32 v111, 0x3e0293ee, v111
    v_cvt_pk_bf16_f32 v96, v96, v97
    v_cvt_pk_bf16_f32 v97, v98, v99
    v_cvt_pk_bf16_f32 v98, v100, v101
    v_cvt_pk_bf16_f32 v99, v102, v103
    v_cvt_pk_bf16_f32 v100, v104, v105
    v_cvt_pk_bf16_f32 v101, v106, v107
    v_cvt_pk_bf16_f32 v102, v108, v109
    v_cvt_pk_bf16_f32 v103, v110, v111
    v_mul_f32 v112, 0x3e0293ee, v112
    v_mul_f32 v113, 0x3e0293ee, v113
    v_mul_f32 v114, 0x3e0293ee, v114
    v_mul_f32 v115, 0x3e0293ee, v115
    v_mul_f32 v116, 0x3e0293ee, v116
    v_mul_f32 v117, 0x3e0293ee, v117
    v_mul_f32 v118, 0x3e0293ee, v118
    v_mul_f32 v119, 0x3e0293ee, v119
    v_mul_f32 v120, 0x3e0293ee, v120
    v_mul_f32 v121, 0x3e0293ee, v121
    v_mul_f32 v122, 0x3e0293ee, v122
    v_mul_f32 v123, 0x3e0293ee, v123
    v_mul_f32 v124, 0x3e0293ee, v124
    v_mul_f32 v125, 0x3e0293ee, v125
    v_mul_f32 v126, 0x3e0293ee, v126
    v_mul_f32 v127, 0x3e0293ee, v127
    v_cvt_pk_bf16_f32 v112, v112, v113
    v_cvt_pk_bf16_f32 v113, v114, v115
    v_cvt_pk_bf16_f32 v114, v116, v117
    v_cvt_pk_bf16_f32 v115, v118, v119
    v_cvt_pk_bf16_f32 v116, v120, v121
    v_cvt_pk_bf16_f32 v117, v122, v123
    v_cvt_pk_bf16_f32 v118, v124, v125
    v_cvt_pk_bf16_f32 v119, v126, v127
    v_mul_f32 v64, 0x3e0293ee, v64
    v_mul_f32 v65, 0x3e0293ee, v65
    v_mul_f32 v66, 0x3e0293ee, v66
    v_mul_f32 v67, 0x3e0293ee, v67
    v_mul_f32 v68, 0x3e0293ee, v68
    v_mul_f32 v69, 0x3e0293ee, v69
    v_mul_f32 v70, 0x3e0293ee, v70
    v_mul_f32 v71, 0x3e0293ee, v71
    v_mul_f32 v72, 0x3e0293ee, v72
    v_mul_f32 v73, 0x3e0293ee, v73
    v_mul_f32 v74, 0x3e0293ee, v74
    v_mul_f32 v75, 0x3e0293ee, v75
    v_mul_f32 v76, 0x3e0293ee, v76
    v_mul_f32 v77, 0x3e0293ee, v77
    v_mul_f32 v78, 0x3e0293ee, v78
    v_mul_f32 v79, 0x3e0293ee, v79
    v_cvt_pk_bf16_f32 v104, v64, v65
    v_cvt_pk_bf16_f32 v105, v66, v67
    v_cvt_pk_bf16_f32 v106, v68, v69
    v_cvt_pk_bf16_f32 v107, v70, v71
    v_cvt_pk_bf16_f32 v108, v72, v73
    v_cvt_pk_bf16_f32 v109, v74, v75
    v_cvt_pk_bf16_f32 v110, v76, v77
    v_cvt_pk_bf16_f32 v111, v78, v79
    v_mul_f32 v80, 0x3e0293ee, v80
    v_mul_f32 v81, 0x3e0293ee, v81
    v_mul_f32 v82, 0x3e0293ee, v82
    v_mul_f32 v83, 0x3e0293ee, v83
    v_mul_f32 v84, 0x3e0293ee, v84
    v_mul_f32 v85, 0x3e0293ee, v85
    v_mul_f32 v86, 0x3e0293ee, v86
    v_mul_f32 v87, 0x3e0293ee, v87
    v_mul_f32 v88, 0x3e0293ee, v88
    v_mul_f32 v89, 0x3e0293ee, v89
    v_mul_f32 v90, 0x3e0293ee, v90
    v_mul_f32 v91, 0x3e0293ee, v91
    v_mul_f32 v92, 0x3e0293ee, v92
    v_mul_f32 v93, 0x3e0293ee, v93
    v_mul_f32 v94, 0x3e0293ee, v94
    v_mul_f32 v95, 0x3e0293ee, v95
    v_cvt_pk_bf16_f32 v120, v80, v81
    v_cvt_pk_bf16_f32 v121, v82, v83
    v_cvt_pk_bf16_f32 v122, v84, v85
    v_cvt_pk_bf16_f32 v123, v86, v87
    v_cvt_pk_bf16_f32 v124, v88, v89
    v_cvt_pk_bf16_f32 v125, v90, v91
    v_cvt_pk_bf16_f32 v126, v92, v93
    v_cvt_pk_bf16_f32 v127, v94, v95
    s_cmp_ge_u32 s36, 22
    s_cbranch_scc1 K2_gu2B
    ds_read_b64_tr_b16 v[32:33], v24 offset:0
    ds_read_b64_tr_b16 v[34:35], v24 offset:768
    ds_read_b64_tr_b16 v[36:37], v24 offset:64
    ds_read_b64_tr_b16 v[38:39], v24 offset:832
    ds_read_b64_tr_b16 v[40:41], v24 offset:128
    ds_read_b64_tr_b16 v[42:43], v24 offset:896
    ds_read_b64_tr_b16 v[44:45], v24 offset:3072
    ds_read_b64_tr_b16 v[46:47], v24 offset:3840
    s_waitcnt lgkmcnt(6)
    v_mfma_f32_32x32x16_bf16 v[64:79], v[32:35], a[0:3], 0
    ds_read_b64_tr_b16 v[48:49], v24 offset:3136
    ds_read_b64_tr_b16 v[50:51], v24 offset:3904
    s_waitcnt lgkmcnt(6)
    v_mfma_f32_32x32x16_bf16 v[80:95], v[36:39], a[0:3], 0
    ds_read_b64_tr_b16 v[52:53], v24 offset:3200
    ds_read_b64_tr_b16 v[54:55], v24 offset:3968
    s_waitcnt lgkmcnt(6)
    v_mfma_f32_32x32x16_bf16 v[4:19], v[40:43], a[0:3], 0
    ds_read_b64_tr_b16 v[56:57], v24 offset:6144
    ds_read_b64_tr_b16 v[58:59], v24 offset:6912
    s_waitcnt lgkmcnt(6)
    v_mfma_f32_32x32x16_bf16 v[64:79], v[44:47], a[4:7], v[64:79]
    ds_read_b64_tr_b16 v[60:61], v24 offset:6208
    ds_read_b64_tr_b16 v[62:63], v24 offset:6976
    s_waitcnt lgkmcnt(6)
    v_mfma_f32_32x32x16_bf16 v[80:95], v[48:51], a[4:7], v[80:95]
    ds_read_b64_tr_b16 v[32:33], v24 offset:6272
    ds_read_b64_tr_b16 v[34:35], v24 offset:7040
    s_waitcnt lgkmcnt(6)
    v_mfma_f32_32x32x16_bf16 v[4:19], v[52:55], a[4:7], v[4:19]
    ds_read_b64_tr_b16 v[36:37], v24 offset:9216
    ds_read_b64_tr_b16 v[38:39], v24 offset:9984
    s_waitcnt lgkmcnt(6)
    v_mfma_f32_32x32x16_bf16 v[64:79], v[56:59], a[8:11], v[64:79]
    ds_read_b64_tr_b16 v[40:41], v24 offset:9280
    ds_read_b64_tr_b16 v[42:43], v24 offset:10048
    s_waitcnt lgkmcnt(6)
    v_mfma_f32_32x32x16_bf16 v[80:95], v[60:63], a[8:11], v[80:95]
    ds_read_b64_tr_b16 v[44:45], v24 offset:9344
    ds_read_b64_tr_b16 v[46:47], v24 offset:10112
    s_waitcnt lgkmcnt(6)
    v_mfma_f32_32x32x16_bf16 v[4:19], v[32:35], a[8:11], v[4:19]
    ds_read_b64_tr_b16 v[48:49], v24 offset:12288
    ds_read_b64_tr_b16 v[50:51], v24 offset:13056
    s_waitcnt lgkmcnt(6)
    v_mfma_f32_32x32x16_bf16 v[64:79], v[36:39], a[12:15], v[64:79]
    ds_read_b64_tr_b16 v[52:53], v24 offset:12352
    ds_read_b64_tr_b16 v[54:55], v24 offset:13120
    s_waitcnt lgkmcnt(6)
    v_mfma_f32_32x32x16_bf16 v[80:95], v[40:43], a[12:15], v[80:95]
    ds_read_b64_tr_b16 v[56:57], v24 offset:12416
    ds_read_b64_tr_b16 v[58:59], v24 offset:13184
    s_waitcnt lgkmcnt(6)
    v_mfma_f32_32x32x16_bf16 v[4:19], v[44:47], a[12:15], v[4:19]
    ds_read_b64_tr_b16 v[60:61], v24 offset:15360
    ds_read_b64_tr_b16 v[62:63], v24 offset:16128
    s_waitcnt lgkmcnt(6)
    v_mfma_f32_32x32x16_bf16 v[64:79], v[48:51], a[16:19], v[64:79]
    ds_read_b64_tr_b16 v[32:33], v24 offset:15424
    ds_read_b64_tr_b16 v[34:35], v24 offset:16192
    s_waitcnt lgkmcnt(6)
    v_mfma_f32_32x32x16_bf16 v[80:95], v[52:55], a[16:19], v[80:95]
    ds_read_b64_tr_b16 v[36:37], v24 offset:15488
    ds_read_b64_tr_b16 v[38:39], v24 offset:16256
    s_waitcnt lgkmcnt(6)
    v_mfma_f32_32x32x16_bf16 v[4:19], v[56:59], a[16:19], v[4:19]
    ds_read_b64_tr_b16 v[40:41], v24 offset:18432
    ds_read_b64_tr_b16 v[42:43], v24 offset:19200
    s_waitcnt lgkmcnt(6)
    v_mfma_f32_32x32x16_bf16 v[64:79], v[60:63], a[20:23], v[64:79]
    ds_read_b64_tr_b16 v[44:45], v24 offset:18496
    ds_read_b64_tr_b16 v[46:47], v24 offset:19264
    s_waitcnt lgkmcnt(6)
    v_mfma_f32_32x32x16_bf16 v[80:95], v[32:35], a[20:23], v[80:95]
    ds_read_b64_tr_b16 v[48:49], v24 offset:18560
    ds_read_b64_tr_b16 v[50:51], v24 offset:19328
    s_waitcnt lgkmcnt(6)
    v_mfma_f32_32x32x16_bf16 v[4:19], v[36:39], a[20:23], v[4:19]
    ds_read_b64_tr_b16 v[52:53], v24 offset:21504
    ds_read_b64_tr_b16 v[54:55], v24 offset:22272
    s_waitcnt lgkmcnt(6)
    v_mfma_f32_32x32x16_bf16 v[64:79], v[40:43], a[24:27], v[64:79]
    ds_read_b64_tr_b16 v[56:57], v24 offset:21568
    ds_read_b64_tr_b16 v[58:59], v24 offset:22336
    s_waitcnt lgkmcnt(6)
    v_mfma_f32_32x32x16_bf16 v[80:95], v[44:47], a[24:27], v[80:95]
    s_barrier
    ds_read_b64_tr_b16 v[60:61], v24 offset:21632
    ds_read_b64_tr_b16 v[62:63], v24 offset:22400
    s_waitcnt lgkmcnt(6)
    v_mfma_f32_32x32x16_bf16 v[4:19], v[48:51], a[24:27], v[4:19]
    ds_read_b64_tr_b16 v[32:33], v24 offset:24576
    ds_read_b64_tr_b16 v[34:35], v24 offset:25344
    s_waitcnt lgkmcnt(6)
    v_mfma_f32_32x32x16_bf16 v[64:79], v[52:55], a[28:31], v[64:79]
    ds_read_b64_tr_b16 v[36:37], v24 offset:24640
    ds_read_b64_tr_b16 v[38:39], v24 offset:25408
    s_waitcnt lgkmcnt(6)
    v_mfma_f32_32x32x16_bf16 v[80:95], v[56:59], a[28:31], v[80:95]
    ds_read_b64_tr_b16 v[40:41], v24 offset:24704
    ds_read_b64_tr_b16 v[42:43], v24 offset:25472
    s_waitcnt lgkmcnt(6)
    v_mfma_f32_32x32x16_bf16 v[4:19], v[60:63], a[28:31], v[4:19]
    ds_read_b64_tr_b16 v[44:45], v24 offset:27648
    ds_read_b64_tr_b16 v[46:47], v24 offset:28416
    s_waitcnt lgkmcnt(6)
    v_mfma_f32_32x32x16_bf16 v[64:79], v[32:35], a[32:35], v[64:79]
    ds_read_b64_tr_b16 v[48:49], v24 offset:27712
    ds_read_b64_tr_b16 v[50:51], v24 offset:28480
    s_waitcnt lgkmcnt(6)
    v_mfma_f32_32x32x16_bf16 v[80:95], v[36:39], a[32:35], v[80:95]
    ds_read_b64_tr_b16 v[52:53], v24 offset:27776
    ds_read_b64_tr_b16 v[54:55], v24 offset:28544
    s_waitcnt lgkmcnt(6)
    v_mfma_f32_32x32x16_bf16 v[4:19], v[40:43], a[32:35], v[4:19]
    ds_read_b64_tr_b16 v[56:57], v24 offset:30720
    ds_read_b64_tr_b16 v[58:59], v24 offset:31488
    s_waitcnt lgkmcnt(6)
    v_mfma_f32_32x32x16_bf16 v[64:79], v[44:47], a[36:39], v[64:79]
    ds_read_b64_tr_b16 v[60:61], v24 offset:30784
    ds_read_b64_tr_b16 v[62:63], v24 offset:31552
    s_waitcnt lgkmcnt(6)
    v_mfma_f32_32x32x16_bf16 v[80:95], v[48:51], a[36:39], v[80:95]
    ds_read_b64_tr_b16 v[32:33], v24 offset:30848
    ds_read_b64_tr_b16 v[34:35], v24 offset:31616
    s_waitcnt lgkmcnt(6)
    v_mfma_f32_32x32x16_bf16 v[4:19], v[52:55], a[36:39], v[4:19]
    ds_read_b64_tr_b16 v[36:37], v24 offset:33792
    ds_read_b64_tr_b16 v[38:39], v24 offset:34560
    s_waitcnt lgkmcnt(6)
    v_mfma_f32_32x32x16_bf16 v[64:79], v[56:59], a[40:43], v[64:79]
    ds_read_b64_tr_b16 v[40:41], v24 offset:33856
    ds_read_b64_tr_b16 v[42:43], v24 offset:34624
    s_waitcnt lgkmcnt(6)
    v_mfma_f32_32x32x16_bf16 v[80:95], v[60:63], a[40:43], v[80:95]
    ds_read_b64_tr_b16 v[44:45], v24 offset:33920
    ds_read_b64_tr_b16 v[46:47], v24 offset:34688
    s_waitcnt lgkmcnt(6)
    v_mfma_f32_32x32x16_bf16 v[4:19], v[32:35], a[40:43], v[4:19]
    ds_read_b64_tr_b16 v[48:49], v24 offset:36864
    ds_read_b64_tr_b16 v[50:51], v24 offset:37632
    s_waitcnt lgkmcnt(6)
    v_mfma_f32_32x32x16_bf16 v[64:79], v[36:39], a[44:47], v[64:79]
    ds_read_b64_tr_b16 v[52:53], v24 offset:36928
    ds_read_b64_tr_b16 v[54:55], v24 offset:37696
    s_waitcnt lgkmcnt(6)
    v_mfma_f32_32x32x16_bf16 v[80:95], v[40:43], a[44:47], v[80:95]
    ds_read_b64_tr_b16 v[56:57], v24 offset:36992
    ds_read_b64_tr_b16 v[58:59], v24 offset:37760
    s_waitcnt lgkmcnt(6)
    v_mfma_f32_32x32x16_bf16 v[4:19], v[44:47], a[44:47], v[4:19]
    ds_read_b64_tr_b16 v[60:61], v24 offset:39936
    ds_read_b64_tr_b16 v[62:63], v24 offset:40704
    s_waitcnt lgkmcnt(6)
    v_mfma_f32_32x32x16_bf16 v[64:79], v[48:51], a[48:51], v[64:79]
    ds_read_b64_tr_b16 v[32:33], v24 offset:40000
    ds_read_b64_tr_b16 v[34:35], v24 offset:40768
    s_waitcnt lgkmcnt(6)
    v_mfma_f32_32x32x16_bf16 v[80:95], v[52:55], a[48:51], v[80:95]
    ds_read_b64_tr_b16 v[36:37], v24 offset:40064
    ds_read_b64_tr_b16 v[38:39], v24 offset:40832
    s_waitcnt lgkmcnt(6)
    v_mfma_f32_32x32x16_bf16 v[4:19], v[56:59], a[48:51], v[4:19]
    ds_read_b64_tr_b16 v[40:41], v24 offset:43008
    ds_read_b64_tr_b16 v[42:43], v24 offset:43776
    s_waitcnt lgkmcnt(6)
    v_mfma_f32_32x32x16_bf16 v[64:79], v[60:63], a[52:55], v[64:79]
    ds_read_b64_tr_b16 v[44:45], v24 offset:43072
    ds_read_b64_tr_b16 v[46:47], v24 offset:43840
    s_waitcnt lgkmcnt(6)
    v_mfma_f32_32x32x16_bf16 v[80:95], v[32:35], a[52:55], v[80:95]
    ds_read_b64_tr_b16 v[48:49], v24 offset:43136
    ds_read_b64_tr_b16 v[50:51], v24 offset:43904
    s_waitcnt lgkmcnt(6)
    v_mfma_f32_32x32x16_bf16 v[4:19], v[36:39], a[52:55], v[4:19]
    ds_read_b64_tr_b16 v[52:53], v24 offset:46080
    ds_read_b64_tr_b16 v[54:55], v24 offset:46848
    s_waitcnt lgkmcnt(6)
    v_mfma_f32_32x32x16_bf16 v[64:79], v[40:43], a[56:59], v[64:79]
    ds_read_b64_tr_b16 v[56:57], v24 offset:46144
    ds_read_b64_tr_b16 v[58:59], v24 offset:46912
    s_waitcnt lgkmcnt(6)
    v_mfma_f32_32x32x16_bf16 v[80:95], v[44:47], a[56:59], v[80:95]
    s_barrier
    ds_read_b64_tr_b16 v[60:61], v24 offset:46208
    ds_read_b64_tr_b16 v[62:63], v24 offset:46976
    s_waitcnt lgkmcnt(6)
    v_mfma_f32_32x32x16_bf16 v[4:19], v[48:51], a[56:59], v[4:19]
    ds_read_b64_tr_b16 v[32:33], v25 offset:0
    ds_read_b64_tr_b16 v[34:35], v25 offset:768
    s_waitcnt lgkmcnt(6)
    v_mfma_f32_32x32x16_bf16 v[64:79], v[52:55], a[60:63], v[64:79]
    ds_read_b64_tr_b16 v[36:37], v25 offset:64
    ds_read_b64_tr_b16 v[38:39], v25 offset:832
    s_waitcnt lgkmcnt(6)
    v_mfma_f32_32x32x16_bf16 v[80:95], v[56:59], a[60:63], v[80:95]
    ds_read_b64_tr_b16 v[40:41], v25 offset:128
    ds_read_b64_tr_b16 v[42:43], v25 offset:896
    s_waitcnt lgkmcnt(6)
    v_mfma_f32_32x32x16_bf16 v[4:19], v[60:63], a[60:63], v[4:19]
    ds_read_b64_tr_b16 v[44:45], v25 offset:3072
    ds_read_b64_tr_b16 v[46:47], v25 offset:3840
    s_waitcnt lgkmcnt(6)
    v_mfma_f32_32x32x16_bf16 v[64:79], v[32:35], a[64:67], v[64:79]
    ds_read_b64_tr_b16 v[48:49], v25 offset:3136
    ds_read_b64_tr_b16 v[50:51], v25 offset:3904
    s_waitcnt lgkmcnt(6)
    v_mfma_f32_32x32x16_bf16 v[80:95], v[36:39], a[64:67], v[80:95]
    ds_read_b64_tr_b16 v[52:53], v25 offset:3200
    ds_read_b64_tr_b16 v[54:55], v25 offset:3968
    s_waitcnt lgkmcnt(6)
    v_mfma_f32_32x32x16_bf16 v[4:19], v[40:43], a[64:67], v[4:19]
    ds_read_b64_tr_b16 v[56:57], v25 offset:6144
    ds_read_b64_tr_b16 v[58:59], v25 offset:6912
    s_waitcnt lgkmcnt(6)
    v_mfma_f32_32x32x16_bf16 v[64:79], v[44:47], a[68:71], v[64:79]
    ds_read_b64_tr_b16 v[60:61], v25 offset:6208
    ds_read_b64_tr_b16 v[62:63], v25 offset:6976
    s_waitcnt lgkmcnt(6)
    v_mfma_f32_32x32x16_bf16 v[80:95], v[48:51], a[68:71], v[80:95]
    ds_read_b64_tr_b16 v[32:33], v25 offset:6272
    ds_read_b64_tr_b16 v[34:35], v25 offset:7040
    s_waitcnt lgkmcnt(6)
    v_mfma_f32_32x32x16_bf16 v[4:19], v[52:55], a[68:71], v[4:19]
    ds_read_b64_tr_b16 v[36:37], v25 offset:9216
    ds_read_b64_tr_b16 v[38:39], v25 offset:9984
    s_waitcnt lgkmcnt(6)
    v_mfma_f32_32x32x16_bf16 v[64:79], v[56:59], a[72:75], v[64:79]
    ds_read_b64_tr_b16 v[40:41], v25 offset:9280
    ds_read_b64_tr_b16 v[42:43], v25 offset:10048
    s_waitcnt lgkmcnt(6)
    v_mfma_f32_32x32x16_bf16 v[80:95], v[60:63], a[72:75], v[80:95]
    ds_read_b64_tr_b16 v[44:45], v25 offset:9344
    ds_read_b64_tr_b16 v[46:47], v25 offset:10112
    s_waitcnt lgkmcnt(6)
    v_mfma_f32_32x32x16_bf16 v[4:19], v[32:35], a[72:75], v[4:19]
    ds_read_b64_tr_b16 v[48:49], v25 offset:12288
    ds_read_b64_tr_b16 v[50:51], v25 offset:13056
    s_waitcnt lgkmcnt(6)
    v_mfma_f32_32x32x16_bf16 v[64:79], v[36:39], a[76:79], v[64:79]
    ds_read_b64_tr_b16 v[52:53], v25 offset:12352
    ds_read_b64_tr_b16 v[54:55], v25 offset:13120
    s_waitcnt lgkmcnt(6)
    v_mfma_f32_32x32x16_bf16 v[80:95], v[40:43], a[76:79], v[80:95]
    ds_read_b64_tr_b16 v[56:57], v25 offset:12416
    ds_read_b64_tr_b16 v[58:59], v25 offset:13184
    s_waitcnt lgkmcnt(6)
    v_mfma_f32_32x32x16_bf16 v[4:19], v[44:47], a[76:79], v[4:19]
    ds_read_b64_tr_b16 v[60:61], v25 offset:15360
    ds_read_b64_tr_b16 v[62:63], v25 offset:16128
    s_waitcnt lgkmcnt(6)
    v_mfma_f32_32x32x16_bf16 v[64:79], v[48:51], a[80:83], v[64:79]
    ds_read_b64_tr_b16 v[32:33], v25 offset:15424
    ds_read_b64_tr_b16 v[34:35], v25 offset:16192
    s_waitcnt lgkmcnt(6)
    v_mfma_f32_32x32x16_bf16 v[80:95], v[52:55], a[80:83], v[80:95]
    ds_read_b64_tr_b16 v[36:37], v25 offset:15488
    ds_read_b64_tr_b16 v[38:39], v25 offset:16256
    s_waitcnt lgkmcnt(6)
    v_mfma_f32_32x32x16_bf16 v[4:19], v[56:59], a[80:83], v[4:19]
    ds_read_b64_tr_b16 v[40:41], v25 offset:18432
    ds_read_b64_tr_b16 v[42:43], v25 offset:19200
    s_waitcnt lgkmcnt(6)
    v_mfma_f32_32x32x16_bf16 v[64:79], v[60:63], a[84:87], v[64:79]
    ds_read_b64_tr_b16 v[44:45], v25 offset:18496
    ds_read_b64_tr_b16 v[46:47], v25 offset:19264
    s_waitcnt lgkmcnt(6)
    v_mfma_f32_32x32x16_bf16 v[80:95], v[32:35], a[84:87], v[80:95]
    ds_read_b64_tr_b16 v[48:49], v25 offset:18560
    ds_read_b64_tr_b16 v[50:51], v25 offset:19328
    s_waitcnt lgkmcnt(6)
    v_mfma_f32_32x32x16_bf16 v[4:19], v[36:39], a[84:87], v[4:19]
    ds_read_b64_tr_b16 v[52:53], v25 offset:21504
    ds_read_b64_tr_b16 v[54:55], v25 offset:22272
    s_waitcnt lgkmcnt(6)
    v_mfma_f32_32x32x16_bf16 v[64:79], v[40:43], a[88:91], v[64:79]
    ds_read_b64_tr_b16 v[56:57], v25 offset:21568
    ds_read_b64_tr_b16 v[58:59], v25 offset:22336
    s_waitcnt lgkmcnt(6)
    v_mfma_f32_32x32x16_bf16 v[80:95], v[44:47], a[88:91], v[80:95]
    ds_read_b64_tr_b16 v[60:61], v25 offset:21632
    ds_read_b64_tr_b16 v[62:63], v25 offset:22400
    s_waitcnt lgkmcnt(6)
    v_mfma_f32_32x32x16_bf16 v[4:19], v[48:51], a[88:91], v[4:19]
    ds_read_b64_tr_b16 v[32:33], v25 offset:24576
    ds_read_b64_tr_b16 v[34:35], v25 offset:25344
    s_waitcnt lgkmcnt(6)
    v_mfma_f32_32x32x16_bf16 v[64:79], v[52:55], a[92:95], v[64:79]
    ds_read_b64_tr_b16 v[36:37], v25 offset:24640
    ds_read_b64_tr_b16 v[38:39], v25 offset:25408
    s_waitcnt lgkmcnt(6)
    v_mfma_f32_32x32x16_bf16 v[80:95], v[56:59], a[92:95], v[80:95]
    ds_read_b64_tr_b16 v[40:41], v25 offset:24704
    ds_read_b64_tr_b16 v[42:43], v25 offset:25472
    s_waitcnt lgkmcnt(6)
    v_mfma_f32_32x32x16_bf16 v[4:19], v[60:63], a[92:95], v[4:19]
    ds_read_b64_tr_b16 v[44:45], v25 offset:27648
    ds_read_b64_tr_b16 v[46:47], v25 offset:28416
    s_waitcnt lgkmcnt(6)
    v_mfma_f32_32x32x16_bf16 v[64:79], v[32:35], a[96:99], v[64:79]
    ds_read_b64_tr_b16 v[48:49], v25 offset:27712
    ds_read_b64_tr_b16 v[50:51], v25 offset:28480
    s_waitcnt lgkmcnt(6)
    v_mfma_f32_32x32x16_bf16 v[80:95], v[36:39], a[96:99], v[80:95]
    ds_read_b64_tr_b16 v[52:53], v25 offset:27776
    ds_read_b64_tr_b16 v[54:55], v25 offset:28544
    s_waitcnt lgkmcnt(6)
    v_mfma_f32_32x32x16_bf16 v[4:19], v[40:43], a[96:99], v[4:19]
    ds_read_b64_tr_b16 v[56:57], v25 offset:30720
    ds_read_b64_tr_b16 v[58:59], v25 offset:31488
    s_waitcnt lgkmcnt(6)
    v_mfma_f32_32x32x16_bf16 v[64:79], v[44:47], a[100:103], v[64:79]
    ds_read_b64_tr_b16 v[60:61], v25 offset:30784
    ds_read_b64_tr_b16 v[62:63], v25 offset:31552
    s_waitcnt lgkmcnt(6)
    v_mfma_f32_32x32x16_bf16 v[80:95], v[48:51], a[100:103], v[80:95]
    ds_read_b64_tr_b16 v[32:33], v25 offset:30848
    ds_read_b64_tr_b16 v[34:35], v25 offset:31616
    s_waitcnt lgkmcnt(6)
    v_mfma_f32_32x32x16_bf16 v[4:19], v[52:55], a[100:103], v[4:19]
    ds_read_b64_tr_b16 v[36:37], v25 offset:33792
    ds_read_b64_tr_b16 v[38:39], v25 offset:34560
    s_waitcnt lgkmcnt(6)
    v_mfma_f32_32x32x16_bf16 v[64:79], v[56:59], a[104:107], v[64:79]
    ds_read_b64_tr_b16 v[40:41], v25 offset:33856
    ds_read_b64_tr_b16 v[42:43], v25 offset:34624
    s_waitcnt lgkmcnt(6)
    v_mfma_f32_32x32x16_bf16 v[80:95], v[60:63], a[104:107], v[80:95]
    ds_read_b64_tr_b16 v[44:45], v25 offset:33920
    ds_read_b64_tr_b16 v[46:47], v25 offset:34688
    s_waitcnt lgkmcnt(6)
    v_mfma_f32_32x32x16_bf16 v[4:19], v[32:35], a[104:107], v[4:19]
    ds_read_b64_tr_b16 v[48:49], v25 offset:36864
    ds_read_b64_tr_b16 v[50:51], v25 offset:37632
    s_waitcnt lgkmcnt(6)
    v_mfma_f32_32x32x16_bf16 v[64:79], v[36:39], a[108:111], v[64:79]
    ds_read_b64_tr_b16 v[52:53], v25 offset:36928
    ds_read_b64_tr_b16 v[54:55], v25 offset:37696
    s_waitcnt lgkmcnt(6)
    v_mfma_f32_32x32x16_bf16 v[80:95], v[40:43], a[108:111], v[80:95]
    ds_read_b64_tr_b16 v[56:57], v25 offset:36992
    ds_read_b64_tr_b16 v[58:59], v25 offset:37760
    s_waitcnt lgkmcnt(6)
    v_mfma_f32_32x32x16_bf16 v[4:19], v[44:47], a[108:111], v[4:19]
    ds_read_b64_tr_b16 v[60:61], v25 offset:39936
    ds_read_b64_tr_b16 v[62:63], v25 offset:40704
    s_waitcnt lgkmcnt(6)
    v_mfma_f32_32x32x16_bf16 v[64:79], v[48:51], a[112:115], v[64:79]
    ds_read_b64_tr_b16 v[32:33], v25 offset:40000
    ds_read_b64_tr_b16 v[34:35], v25 offset:40768
    s_waitcnt lgkmcnt(6)
    v_mfma_f32_32x32x16_bf16 v[80:95], v[52:55], a[112:115], v[80:95]
    ds_read_b64_tr_b16 v[36:37], v25 offset:40064
    ds_read_b64_tr_b16 v[38:39], v25 offset:40832
    s_waitcnt lgkmcnt(6)
    v_mfma_f32_32x32x16_bf16 v[4:19], v[56:59], a[112:115], v[4:19]
    ds_read_b64_tr_b16 v[40:41], v25 offset:43008
    ds_read_b64_tr_b16 v[42:43], v25 offset:43776
    s_waitcnt lgkmcnt(6)
    v_mfma_f32_32x32x16_bf16 v[64:79], v[60:63], a[116:119], v[64:79]
    ds_read_b64_tr_b16 v[44:45], v25 offset:43072
    ds_read_b64_tr_b16 v[46:47], v25 offset:43840
    s_waitcnt lgkmcnt(6)
    v_mfma_f32_32x32x16_bf16 v[80:95], v[32:35], a[116:119], v[80:95]
    ds_read_b64_tr_b16 v[48:49], v25 offset:43136
    ds_read_b64_tr_b16 v[50:51], v25 offset:43904
    s_waitcnt lgkmcnt(6)
    v_mfma_f32_32x32x16_bf16 v[4:19], v[36:39], a[116:119], v[4:19]
    ds_read_b64_tr_b16 v[52:53], v25 offset:46080
    ds_read_b64_tr_b16 v[54:55], v25 offset:46848
    s_waitcnt lgkmcnt(6)
    v_mfma_f32_32x32x16_bf16 v[64:79], v[40:43], a[120:123], v[64:79]
    ds_read_b64_tr_b16 v[56:57], v25 offset:46144
    ds_read_b64_tr_b16 v[58:59], v25 offset:46912
    s_waitcnt lgkmcnt(6)
    v_mfma_f32_32x32x16_bf16 v[80:95], v[44:47], a[120:123], v[80:95]
    ds_read_b64_tr_b16 v[60:61], v25 offset:46208
    ds_read_b64_tr_b16 v[62:63], v25 offset:46976
    s_waitcnt lgkmcnt(6)
    v_mfma_f32_32x32x16_bf16 v[4:19], v[48:51], a[120:123], v[4:19]
    s_waitcnt lgkmcnt(4)
    v_mfma_f32_32x32x16_bf16 v[64:79], v[52:55], a[124:127], v[64:79]
    s_waitcnt lgkmcnt(2)
    v_mfma_f32_32x32x16_bf16 v[80:95], v[56:59], a[124:127], v[80:95]
    s_waitcnt lgkmcnt(0)
    v_mfma_f32_32x32x16_bf16 v[4:19], v[60:63], a[124:127], v[4:19]
    s_nop 7
    v_mul_f32 v32, 0xbfb8aa3b, v64
    v_exp_f32 v32, v32
    v_mul_f32 v33, v64, v72
    v_add_f32 v32, 1.0, v32
    v_rcp_f32 v32, v32
    s_nop 0
    v_mul_f32 v64, v33, v32
    v_mul_f32 v36, 0xbfb8aa3b, v65
    v_exp_f32 v36, v36
    v_mul_f32 v37, v65, v73
    v_add_f32 v36, 1.0, v36
    v_rcp_f32 v36, v36
    s_nop 0
    v_mul_f32 v65, v37, v36
    v_mul_f32 v40, 0xbfb8aa3b, v66
    v_exp_f32 v40, v40
    v_mul_f32 v41, v66, v74
    v_add_f32 v40, 1.0, v40
    v_rcp_f32 v40, v40
    s_nop 0
    v_mul_f32 v66, v41, v40
    v_mul_f32 v44, 0xbfb8aa3b, v67
    v_exp_f32 v44, v44
    v_mul_f32 v45, v67, v75
    v_add_f32 v44, 1.0, v44
    v_rcp_f32 v44, v44
    s_nop 0
    v_mul_f32 v67, v45, v44
    v_mul_f32 v32, 0xbfb8aa3b, v68
    v_exp_f32 v32, v32
    v_mul_f32 v33, v68, v76
    v_add_f32 v32, 1.0, v32
    v_rcp_f32 v32, v32
    s_nop 0
    v_mul_f32 v68, v33, v32
    v_mul_f32 v36, 0xbfb8aa3b, v69
    v_exp_f32 v36, v36
    v_mul_f32 v37, v69, v77
    v_add_f32 v36, 1.0, v36
    v_rcp_f32 v36, v36
    s_nop 0
    v_mul_f32 v69, v37, v36
    v_mul_f32 v40, 0xbfb8aa3b, v70
    v_exp_f32 v40, v40
    v_mul_f32 v41, v70, v78
    v_add_f32 v40, 1.0, v40
    v_rcp_f32 v40, v40
    s_nop 0
    v_mul_f32 v70, v41, v40
    v_mul_f32 v44, 0xbfb8aa3b, v71
    v_exp_f32 v44, v44
    v_mul_f32 v45, v71, v79
    v_add_f32 v44, 1.0, v44
    v_rcp_f32 v44, v44
    s_nop 0
    v_mul_f32 v71, v45, v44
    v_cvt_pk_bf16_f32 v64, v64, v65
    v_cvt_pk_bf16_f32 v65, v66, v67
    v_cvt_pk_bf16_f32 v66, v68, v69
    v_cvt_pk_bf16_f32 v67, v70, v71
    v_mul_f32 v32, 0xbfb8aa3b, v80
    v_exp_f32 v32, v32
    v_mul_f32 v33, v80, v88
    v_add_f32 v32, 1.0, v32
    v_rcp_f32 v32, v32
    s_nop 0
    v_mul_f32 v80, v33, v32
    v_mul_f32 v36, 0xbfb8aa3b, v81
    v_exp_f32 v36, v36
    v_mul_f32 v37, v81, v89
    v_add_f32 v36, 1.0, v36
    v_rcp_f32 v36, v36
    s_nop 0
    v_mul_f32 v81, v37, v36
    v_mul_f32 v40, 0xbfb8aa3b, v82
    v_exp_f32 v40, v40
    v_mul_f32 v41, v82, v90
    v_add_f32 v40, 1.0, v40
    v_rcp_f32 v40, v40
    s_nop 0
    v_mul_f32 v82, v41, v40
    v_mul_f32 v44, 0xbfb8aa3b, v83
    v_exp_f32 v44, v44
    v_mul_f32 v45, v83, v91
    v_add_f32 v44, 1.0, v44
    v_rcp_f32 v44, v44
    s_nop 0
    v_mul_f32 v83, v45, v44
    v_mul_f32 v32, 0xbfb8aa3b, v84
    v_exp_f32 v32, v32
    v_mul_f32 v33, v84, v92
    v_add_f32 v32, 1.0, v32
    v_rcp_f32 v32, v32
    s_nop 0
    v_mul_f32 v84, v33, v32
    v_mul_f32 v36, 0xbfb8aa3b, v85
    v_exp_f32 v36, v36
    v_mul_f32 v37, v85, v93
    v_add_f32 v36, 1.0, v36
    v_rcp_f32 v36, v36
    s_nop 0
    v_mul_f32 v85, v37, v36
    v_mul_f32 v40, 0xbfb8aa3b, v86
    v_exp_f32 v40, v40
    v_mul_f32 v41, v86, v94
    v_add_f32 v40, 1.0, v40
    v_rcp_f32 v40, v40
    s_nop 0
    v_mul_f32 v86, v41, v40
    v_mul_f32 v44, 0xbfb8aa3b, v87
    v_exp_f32 v44, v44
    v_mul_f32 v45, v87, v95
    v_add_f32 v44, 1.0, v44
    v_rcp_f32 v44, v44
    s_nop 0
    v_mul_f32 v87, v45, v44
    v_cvt_pk_bf16_f32 v80, v80, v81
    v_cvt_pk_bf16_f32 v81, v82, v83
    v_cvt_pk_bf16_f32 v82, v84, v85
    v_cvt_pk_bf16_f32 v83, v86, v87
    v_mul_f32 v32, 0xbfb8aa3b, v4
    v_exp_f32 v32, v32
    v_mul_f32 v33, v4, v12
    v_add_f32 v32, 1.0, v32
    v_rcp_f32 v32, v32
    s_nop 0
    v_mul_f32 v4, v33, v32
    v_mul_f32 v36, 0xbfb8aa3b, v5
    v_exp_f32 v36, v36
    v_mul_f32 v37, v5, v13
    v_add_f32 v36, 1.0, v36
    v_rcp_f32 v36, v36
    s_nop 0
    v_mul_f32 v5, v37, v36
    v_mul_f32 v40, 0xbfb8aa3b, v6
    v_exp_f32 v40, v40
    v_mul_f32 v41, v6, v14
    v_add_f32 v40, 1.0, v40
    v_rcp_f32 v40, v40
    s_nop 0
    v_mul_f32 v6, v41, v40
    v_mul_f32 v44, 0xbfb8aa3b, v7
    v_exp_f32 v44, v44
    v_mul_f32 v45, v7, v15
    v_add_f32 v44, 1.0, v44
    v_rcp_f32 v44, v44
    s_nop 0
    v_mul_f32 v7, v45, v44
    v_mul_f32 v32, 0xbfb8aa3b, v8
    v_exp_f32 v32, v32
    v_mul_f32 v33, v8, v16
    v_add_f32 v32, 1.0, v32
    v_rcp_f32 v32, v32
    s_nop 0
    v_mul_f32 v8, v33, v32
    v_mul_f32 v36, 0xbfb8aa3b, v9
    v_exp_f32 v36, v36
    v_mul_f32 v37, v9, v17
    v_add_f32 v36, 1.0, v36
    v_rcp_f32 v36, v36
    s_nop 0
    v_mul_f32 v9, v37, v36
    v_mul_f32 v40, 0xbfb8aa3b, v10
    v_exp_f32 v40, v40
    v_mul_f32 v41, v10, v18
    v_add_f32 v40, 1.0, v40
    v_rcp_f32 v40, v40
    s_nop 0
    v_mul_f32 v10, v41, v40
    v_mul_f32 v44, 0xbfb8aa3b, v11
    v_exp_f32 v44, v44
    v_mul_f32 v45, v11, v19
    v_add_f32 v44, 1.0, v44
    v_rcp_f32 v44, v44
    s_nop 0
    v_mul_f32 v11, v45, v44
    v_cvt_pk_bf16_f32 v4, v4, v5
    v_cvt_pk_bf16_f32 v5, v6, v7
    v_cvt_pk_bf16_f32 v6, v8, v9
    v_cvt_pk_bf16_f32 v7, v10, v11
    buffer_store_dwordx4 v[64:67], v2, s[28:31], s43 offen offset:0 sc1
    buffer_store_dwordx4 v[80:83], v2, s[28:31], s43 offen offset:1024 sc1
    buffer_store_dwordx4 v[4:7], v2, s[28:31], s43 offen offset:2048 sc1
    s_branch K2_gudB
K2_gu2B:
    ds_read_b64_tr_b16 v[32:33], v24 offset:0
    ds_read_b64_tr_b16 v[34:35], v24 offset:768
    ds_read_b64_tr_b16 v[36:37], v24 offset:64
    ds_read_b64_tr_b16 v[38:39], v24 offset:832
    ds_read_b64_tr_b16 v[40:41], v24 offset:3072
    ds_read_b64_tr_b16 v[42:43], v24 offset:3840
    ds_read_b64_tr_b16 v[44:45], v24 offset:3136
    ds_read_b64_tr_b16 v[46:47], v24 offset:3904
    s_waitcnt lgkmcnt(6)
    v_mfma_f32_32x32x16_bf16 v[64:79], v[32:35], a[0:3], 0
    ds_read_b64_tr_b16 v[48:49], v24 offset:6144
    ds_read_b64_tr_b16 v[50:51], v24 offset:6912
    s_waitcnt lgkmcnt(6)
    v_mfma_f32_32x32x16_bf16 v[80:95], v[36:39], a[0:3], 0
    ds_read_b64_tr_b16 v[52:53], v24 offset:6208
    ds_read_b64_tr_b16 v[54:55], v24 offset:6976
    s_waitcnt lgkmcnt(6)
    v_mfma_f32_32x32x16_bf16 v[64:79], v[40:43], a[4:7], v[64:79]
    ds_read_b64_tr_b16 v[56:57], v24 offset:9216
    ds_read_b64_tr_b16 v[58:59], v24 offset:9984
    s_waitcnt lgkmcnt(6)
    v_mfma_f32_32x32x16_bf16 v[80:95], v[44:47], a[4:7], v[80:95]
    ds_read_b64_tr_b16 v[60:61], v24 offset:9280
    ds_read_b64_tr_b16 v[62:63], v24 offset:10048
    s_waitcnt lgkmcnt(6)
    v_mfma_f32_32x32x16_bf16 v[64:79], v[48:51], a[8:11], v[64:79]
    ds_read_b64_tr_b16 v[32:33], v24 offset:12288
    ds_read_b64_tr_b16 v[34:35], v24 offset:13056
    s_waitcnt lgkmcnt(6)
    v_mfma_f32_32x32x16_bf16 v[80:95], v[52:55], a[8:11], v[80:95]
    ds_read_b64_tr_b16 v[36:37], v24 offset:12352
    ds_read_b64_tr_b16 v[38:39], v24 offset:13120
    s_waitcnt lgkmcnt(6)
    v_mfma_f32_32x32x16_bf16 v[64:79], v[56:59], a[12:15], v[64:79]
    ds_read_b64_tr_b16 v[40:41], v24 offset:15360
    ds_read_b64_tr_b16 v[42:43], v24 offset:16128
    s_waitcnt lgkmcnt(6)
    v_mfma_f32_32x32x16_bf16 v[80:95], v[60:63], a[12:15], v[80:95]
    ds_read_b64_tr_b16 v[44:45], v24 offset:15424
    ds_read_b64_tr_b16 v[46:47], v24 offset:16192
    s_waitcnt lgkmcnt(6)
    v_mfma_f32_32x32x16_bf16 v[64:79], v[32:35], a[16:19], v[64:79]
    ds_read_b64_tr_b16 v[48:49], v24 offset:18432
    ds_read_b64_tr_b16 v[50:51], v24 offset:19200
    s_waitcnt lgkmcnt(6)
    v_mfma_f32_32x32x16_bf16 v[80:95], v[36:39], a[16:19], v[80:95]
    ds_read_b64_tr_b16 v[52:53], v24 offset:18496
    ds_read_b64_tr_b16 v[54:55], v24 offset:19264
    s_waitcnt lgkmcnt(6)
    v_mfma_f32_32x32x16_bf16 v[64:79], v[40:43], a[20:23], v[64:79]
    ds_read_b64_tr_b16 v[56:57], v24 offset:21504
    ds_read_b64_tr_b16 v[58:59], v24 offset:22272
    s_waitcnt lgkmcnt(6)
    v_mfma_f32_32x32x16_bf16 v[80:95], v[44:47], a[20:23], v[80:95]
    s_barrier
    ds_read_b64_tr_b16 v[60:61], v24 offset:21568
    ds_read_b64_tr_b16 v[62:63], v24 offset:22336
    s_waitcnt lgkmcnt(6)
    v_mfma_f32_32x32x16_bf16 v[64:79], v[48:51], a[24:27], v[64:79]
    ds_read_b64_tr_b16 v[32:33], v24 offset:24576
    ds_read_b64_tr_b16 v[34:35], v24 offset:25344
    s_waitcnt lgkmcnt(6)
    v_mfma_f32_32x32x16_bf16 v[80:95], v[52:55], a[24:27], v[80:95]
    ds_read_b64_tr_b16 v[36:37], v24 offset:24640
    ds_read_b64_tr_b16 v[38:39], v24 offset:25408
    s_waitcnt lgkmcnt(6)
    v_mfma_f32_32x32x16_bf16 v[64:79], v[56:59], a[28:31], v[64:79]
    ds_read_b64_tr_b16 v[40:41], v24 offset:27648
    ds_read_b64_tr_b16 v[42:43], v24 offset:28416
    s_waitcnt lgkmcnt(6)
    v_mfma_f32_32x32x16_bf16 v[80:95], v[60:63], a[28:31], v[80:95]
    ds_read_b64_tr_b16 v[44:45], v24 offset:27712
    ds_read_b64_tr_b16 v[46:47], v24 offset:28480
    s_waitcnt lgkmcnt(6)
    v_mfma_f32_32x32x16_bf16 v[64:79], v[32:35], a[32:35], v[64:79]
    ds_read_b64_tr_b16 v[48:49], v24 offset:30720
    ds_read_b64_tr_b16 v[50:51], v24 offset:31488
    s_waitcnt lgkmcnt(6)
    v_mfma_f32_32x32x16_bf16 v[80:95], v[36:39], a[32:35], v[80:95]
    ds_read_b64_tr_b16 v[52:53], v24 offset:30784
    ds_read_b64_tr_b16 v[54:55], v24 offset:31552
    s_waitcnt lgkmcnt(6)
    v_mfma_f32_32x32x16_bf16 v[64:79], v[40:43], a[36:39], v[64:79]
    ds_read_b64_tr_b16 v[56:57], v24 offset:33792
    ds_read_b64_tr_b16 v[58:59], v24 offset:34560
    s_waitcnt lgkmcnt(6)
    v_mfma_f32_32x32x16_bf16 v[80:95], v[44:47], a[36:39], v[80:95]
    ds_read_b64_tr_b16 v[60:61], v24 offset:33856
    ds_read_b64_tr_b16 v[62:63], v24 offset:34624
    s_waitcnt lgkmcnt(6)
    v_mfma_f32_32x32x16_bf16 v[64:79], v[48:51], a[40:43], v[64:79]
    ds_read_b64_tr_b16 v[32:33], v24 offset:36864
    ds_read_b64_tr_b16 v[34:35], v24 offset:37632
    s_waitcnt lgkmcnt(6)
    v_mfma_f32_32x32x16_bf16 v[80:95], v[52:55], a[40:43], v[80:95]
    ds_read_b64_tr_b16 v[36:37], v24 offset:36928
    ds_read_b64_tr_b16 v[38:39], v24 offset:37696
    s_waitcnt lgkmcnt(6)
    v_mfma_f32_32x32x16_bf16 v[64:79], v[56:59], a[44:47], v[64:79]
    ds_read_b64_tr_b16 v[40:41], v24 offset:39936
    ds_read_b64_tr_b16 v[42:43], v24 offset:40704
    s_waitcnt lgkmcnt(6)
    v_mfma_f32_32x32x16_bf16 v[80:95], v[60:63], a[44:47], v[80:95]
    ds_read_b64_tr_b16 v[44:45], v24 offset:40000
    ds_read_b64_tr_b16 v[46:47], v24 offset:40768
    s_waitcnt lgkmcnt(6)
    v_mfma_f32_32x32x16_bf16 v[64:79], v[32:35], a[48:51], v[64:79]
    ds_read_b64_tr_b16 v[48:49], v24 offset:43008
    ds_read_b64_tr_b16 v[50:51], v24 offset:43776
    s_waitcnt lgkmcnt(6)
    v_mfma_f32_32x32x16_bf16 v[80:95], v[36:39], a[48:51], v[80:95]
    ds_read_b64_tr_b16 v[52:53], v24 offset:43072
    ds_read_b64_tr_b16 v[54:55], v24 offset:43840
    s_waitcnt lgkmcnt(6)
    v_mfma_f32_32x32x16_bf16 v[64:79], v[40:43], a[52:55], v[64:79]
    ds_read_b64_tr_b16 v[56:57], v24 offset:46080
    ds_read_b64_tr_b16 v[58:59], v24 offset:46848
    s_waitcnt lgkmcnt(6)
    v_mfma_f32_32x32x16_bf16 v[80:95], v[44:47], a[52:55], v[80:95]
    s_barrier
    ds_read_b64_tr_b16 v[60:61], v24 offset:46144
    ds_read_b64_tr_b16 v[62:63], v24 offset:46912
    s_waitcnt lgkmcnt(6)
    v_mfma_f32_32x32x16_bf16 v[64:79], v[48:51], a[56:59], v[64:79]
    ds_read_b64_tr_b16 v[32:33], v25 offset:0
    ds_read_b64_tr_b16 v[34:35], v25 offset:768
    s_waitcnt lgkmcnt(6)
    v_mfma_f32_32x32x16_bf16 v[80:95], v[52:55], a[56:59], v[80:95]
    ds_read_b64_tr_b16 v[36:37], v25 offset:64
    ds_read_b64_tr_b16 v[38:39], v25 offset:832
    s_waitcnt lgkmcnt(6)
    v_mfma_f32_32x32x16_bf16 v[64:79], v[56:59], a[60:63], v[64:79]
    ds_read_b64_tr_b16 v[40:41], v25 offset:3072
    ds_read_b64_tr_b16 v[42:43], v25 offset:3840
    s_waitcnt lgkmcnt(6)
    v_mfma_f32_32x32x16_bf16 v[80:95], v[60:63], a[60:63], v[80:95]
    ds_read_b64_tr_b16 v[44:45], v25 offset:3136
    ds_read_b64_tr_b16 v[46:47], v25 offset:3904
    s_waitcnt lgkmcnt(6)
    v_mfma_f32_32x32x16_bf16 v[64:79], v[32:35], a[64:67], v[64:79]
    ds_read_b64_tr_b16 v[48:49], v25 offset:6144
    ds_read_b64_tr_b16 v[50:51], v25 offset:6912
    s_waitcnt lgkmcnt(6)
    v_mfma_f32_32x32x16_bf16 v[80:95], v[36:39], a[64:67], v[80:95]
    ds_read_b64_tr_b16 v[52:53], v25 offset:6208
    ds_read_b64_tr_b16 v[54:55], v25 offset:6976
    s_waitcnt lgkmcnt(6)
    v_mfma_f32_32x32x16_bf16 v[64:79], v[40:43], a[68:71], v[64:79]
    ds_read_b64_tr_b16 v[56:57], v25 offset:9216
    ds_read_b64_tr_b16 v[58:59], v25 offset:9984
    s_waitcnt lgkmcnt(6)
    v_mfma_f32_32x32x16_bf16 v[80:95], v[44:47], a[68:71], v[80:95]
    ds_read_b64_tr_b16 v[60:61], v25 offset:9280
    ds_read_b64_tr_b16 v[62:63], v25 offset:10048
    s_waitcnt lgkmcnt(6)
    v_mfma_f32_32x32x16_bf16 v[64:79], v[48:51], a[72:75], v[64:79]
    ds_read_b64_tr_b16 v[32:33], v25 offset:12288
    ds_read_b64_tr_b16 v[34:35], v25 offset:13056
    s_waitcnt lgkmcnt(6)
    v_mfma_f32_32x32x16_bf16 v[80:95], v[52:55], a[72:75], v[80:95]
    ds_read_b64_tr_b16 v[36:37], v25 offset:12352
    ds_read_b64_tr_b16 v[38:39], v25 offset:13120
    s_waitcnt lgkmcnt(6)
    v_mfma_f32_32x32x16_bf16 v[64:79], v[56:59], a[76:79], v[64:79]
    ds_read_b64_tr_b16 v[40:41], v25 offset:15360
    ds_read_b64_tr_b16 v[42:43], v25 offset:16128
    s_waitcnt lgkmcnt(6)
    v_mfma_f32_32x32x16_bf16 v[80:95], v[60:63], a[76:79], v[80:95]
    ds_read_b64_tr_b16 v[44:45], v25 offset:15424
    ds_read_b64_tr_b16 v[46:47], v25 offset:16192
    s_waitcnt lgkmcnt(6)
    v_mfma_f32_32x32x16_bf16 v[64:79], v[32:35], a[80:83], v[64:79]
    ds_read_b64_tr_b16 v[48:49], v25 offset:18432
    ds_read_b64_tr_b16 v[50:51], v25 offset:19200
    s_waitcnt lgkmcnt(6)
    v_mfma_f32_32x32x16_bf16 v[80:95], v[36:39], a[80:83], v[80:95]
    ds_read_b64_tr_b16 v[52:53], v25 offset:18496
    ds_read_b64_tr_b16 v[54:55], v25 offset:19264
    s_waitcnt lgkmcnt(6)
    v_mfma_f32_32x32x16_bf16 v[64:79], v[40:43], a[84:87], v[64:79]
    ds_read_b64_tr_b16 v[56:57], v25 offset:21504
    ds_read_b64_tr_b16 v[58:59], v25 offset:22272
    s_waitcnt lgkmcnt(6)
    v_mfma_f32_32x32x16_bf16 v[80:95], v[44:47], a[84:87], v[80:95]
    ds_read_b64_tr_b16 v[60:61], v25 offset:21568
    ds_read_b64_tr_b16 v[62:63], v25 offset:22336
    s_waitcnt lgkmcnt(6)
    v_mfma_f32_32x32x16_bf16 v[64:79], v[48:51], a[88:91], v[64:79]
    ds_read_b64_tr_b16 v[32:33], v25 offset:24576
    ds_read_b64_tr_b16 v[34:35], v25 offset:25344
    s_waitcnt lgkmcnt(6)
    v_mfma_f32_32x32x16_bf16 v[80:95], v[52:55], a[88:91], v[80:95]
    ds_read_b64_tr_b16 v[36:37], v25 offset:24640
    ds_read_b64_tr_b16 v[38:39], v25 offset:25408
    s_waitcnt lgkmcnt(6)
    v_mfma_f32_32x32x16_bf16 v[64:79], v[56:59], a[92:95], v[64:79]
    ds_read_b64_tr_b16 v[40:41], v25 offset:27648
    ds_read_b64_tr_b16 v[42:43], v25 offset:28416
    s_waitcnt lgkmcnt(6)
    v_mfma_f32_32x32x16_bf16 v[80:95], v[60:63], a[92:95], v[80:95]
    ds_read_b64_tr_b16 v[44:45], v25 offset:27712
    ds_read_b64_tr_b16 v[46:47], v25 offset:28480
    s_waitcnt lgkmcnt(6)
    v_mfma_f32_32x32x16_bf16 v[64:79], v[32:35], a[96:99], v[64:79]
    ds_read_b64_tr_b16 v[48:49], v25 offset:30720
    ds_read_b64_tr_b16 v[50:51], v25 offset:31488
    s_waitcnt lgkmcnt(6)
    v_mfma_f32_32x32x16_bf16 v[80:95], v[36:39], a[96:99], v[80:95]
    ds_read_b64_tr_b16 v[52:53], v25 offset:30784
    ds_read_b64_tr_b16 v[54:55], v25 offset:31552
    s_waitcnt lgkmcnt(6)
    v_mfma_f32_32x32x16_bf16 v[64:79], v[40:43], a[100:103], v[64:79]
    ds_read_b64_tr_b16 v[56:57], v25 offset:33792
    ds_read_b64_tr_b16 v[58:59], v25 offset:34560
    s_waitcnt lgkmcnt(6)
    v_mfma_f32_32x32x16_bf16 v[80:95], v[44:47], a[100:103], v[80:95]
    ds_read_b64_tr_b16 v[60:61], v25 offset:33856
    ds_read_b64_tr_b16 v[62:63], v25 offset:34624
    s_waitcnt lgkmcnt(6)
    v_mfma_f32_32x32x16_bf16 v[64:79], v[48:51], a[104:107], v[64:79]
    ds_read_b64_tr_b16 v[32:33], v25 offset:36864
    ds_read_b64_tr_b16 v[34:35], v25 offset:37632
    s_waitcnt lgkmcnt(6)
    v_mfma_f32_32x32x16_bf16 v[80:95], v[52:55], a[104:107], v[80:95]
    ds_read_b64_tr_b16 v[36:37], v25 offset:36928
    ds_read_b64_tr_b16 v[38:39], v25 offset:37696
    s_waitcnt lgkmcnt(6)
    v_mfma_f32_32x32x16_bf16 v[64:79], v[56:59], a[108:111], v[64:79]
    ds_read_b64_tr_b16 v[40:41], v25 offset:39936
    ds_read_b64_tr_b16 v[42:43], v25 offset:40704
    s_waitcnt lgkmcnt(6)
    v_mfma_f32_32x32x16_bf16 v[80:95], v[60:63], a[108:111], v[80:95]
    ds_read_b64_tr_b16 v[44:45], v25 offset:40000
    ds_read_b64_tr_b16 v[46:47], v25 offset:40768
    s_waitcnt lgkmcnt(6)
    v_mfma_f32_32x32x16_bf16 v[64:79], v[32:35], a[112:115], v[64:79]
    ds_read_b64_tr_b16 v[48:49], v25 offset:43008
    ds_read_b64_tr_b16 v[50:51], v25 offset:43776
    s_waitcnt lgkmcnt(6)
    v_mfma_f32_32x32x16_bf16 v[80:95], v[36:39], a[112:115], v[80:95]
    ds_read_b64_tr_b16 v[52:53], v25 offset:43072
    ds_read_b64_tr_b16 v[54:55], v25 offset:43840
    s_waitcnt lgkmcnt(6)
    v_mfma_f32_32x32x16_bf16 v[64:79], v[40:43], a[116:119], v[64:79]
    ds_read_b64_tr_b16 v[56:57], v25 offset:46080
    ds_read_b64_tr_b16 v[58:59], v25 offset:46848
    s_waitcnt lgkmcnt(6)
    v_mfma_f32_32x32x16_bf16 v[80:95], v[44:47], a[116:119], v[80:95]
    ds_read_b64_tr_b16 v[60:61], v25 offset:46144
    ds_read_b64_tr_b16 v[62:63], v25 offset:46912
    s_waitcnt lgkmcnt(6)
    v_mfma_f32_32x32x16_bf16 v[64:79], v[48:51], a[120:123], v[64:79]
    s_waitcnt lgkmcnt(4)
    v_mfma_f32_32x32x16_bf16 v[80:95], v[52:55], a[120:123], v[80:95]
    s_waitcnt lgkmcnt(2)
    v_mfma_f32_32x32x16_bf16 v[64:79], v[56:59], a[124:127], v[64:79]
    s_waitcnt lgkmcnt(0)
    v_mfma_f32_32x32x16_bf16 v[80:95], v[60:63], a[124:127], v[80:95]
    s_nop 9
    v_mul_f32 v32, 0xbfb8aa3b, v64
    v_exp_f32 v32, v32
    v_mul_f32 v33, v64, v72
    v_add_f32 v32, 1.0, v32
    v_rcp_f32 v32, v32
    s_nop 0
    v_mul_f32 v64, v33, v32
    v_mul_f32 v36, 0xbfb8aa3b, v65
    v_exp_f32 v36, v36
    v_mul_f32 v37, v65, v73
    v_add_f32 v36, 1.0, v36
    v_rcp_f32 v36, v36
    s_nop 0
    v_mul_f32 v65, v37, v36
    v_mul_f32 v40, 0xbfb8aa3b, v66
    v_exp_f32 v40, v40
    v_mul_f32 v41, v66, v74
    v_add_f32 v40, 1.0, v40
    v_rcp_f32 v40, v40
    s_nop 0
    v_mul_f32 v66, v41, v40
    v_mul_f32 v44, 0xbfb8aa3b, v67
    v_exp_f32 v44, v44
    v_mul_f32 v45, v67, v75
    v_add_f32 v44, 1.0, v44
    v_rcp_f32 v44, v44
    s_nop 0
    v_mul_f32 v67, v45, v44
    v_mul_f32 v32, 0xbfb8aa3b, v68
    v_exp_f32 v32, v32
    v_mul_f32 v33, v68, v76
    v_add_f32 v32, 1.0, v32
    v_rcp_f32 v32, v32
    s_nop 0
    v_mul_f32 v68, v33, v32
    v_mul_f32 v36, 0xbfb8aa3b, v69
    v_exp_f32 v36, v36
    v_mul_f32 v37, v69, v77
    v_add_f32 v36, 1.0, v36
    v_rcp_f32 v36, v36
    s_nop 0
    v_mul_f32 v69, v37, v36
    v_mul_f32 v40, 0xbfb8aa3b, v70
    v_exp_f32 v40, v40
    v_mul_f32 v41, v70, v78
    v_add_f32 v40, 1.0, v40
    v_rcp_f32 v40, v40
    s_nop 0
    v_mul_f32 v70, v41, v40
    v_mul_f32 v44, 0xbfb8aa3b, v71
    v_exp_f32 v44, v44
    v_mul_f32 v45, v71, v79
    v_add_f32 v44, 1.0, v44
    v_rcp_f32 v44, v44
    s_nop 0
    v_mul_f32 v71, v45, v44
    v_cvt_pk_bf16_f32 v64, v64, v65
    v_cvt_pk_bf16_f32 v65, v66, v67
    v_cvt_pk_bf16_f32 v66, v68, v69
    v_cvt_pk_bf16_f32 v67, v70, v71
    v_mul_f32 v32, 0xbfb8aa3b, v80
    v_exp_f32 v32, v32
    v_mul_f32 v33, v80, v88
    v_add_f32 v32, 1.0, v32
    v_rcp_f32 v32, v32
    s_nop 0
    v_mul_f32 v80, v33, v32
    v_mul_f32 v36, 0xbfb8aa3b, v81
    v_exp_f32 v36, v36
    v_mul_f32 v37, v81, v89
    v_add_f32 v36, 1.0, v36
    v_rcp_f32 v36, v36
    s_nop 0
    v_mul_f32 v81, v37, v36
    v_mul_f32 v40, 0xbfb8aa3b, v82
    v_exp_f32 v40, v40
    v_mul_f32 v41, v82, v90
    v_add_f32 v40, 1.0, v40
    v_rcp_f32 v40, v40
    s_nop 0
    v_mul_f32 v82, v41, v40
    v_mul_f32 v44, 0xbfb8aa3b, v83
    v_exp_f32 v44, v44
    v_mul_f32 v45, v83, v91
    v_add_f32 v44, 1.0, v44
    v_rcp_f32 v44, v44
    s_nop 0
    v_mul_f32 v83, v45, v44
    v_mul_f32 v32, 0xbfb8aa3b, v84
    v_exp_f32 v32, v32
    v_mul_f32 v33, v84, v92
    v_add_f32 v32, 1.0, v32
    v_rcp_f32 v32, v32
    s_nop 0
    v_mul_f32 v84, v33, v32
    v_mul_f32 v36, 0xbfb8aa3b, v85
    v_exp_f32 v36, v36
    v_mul_f32 v37, v85, v93
    v_add_f32 v36, 1.0, v36
    v_rcp_f32 v36, v36
    s_nop 0
    v_mul_f32 v85, v37, v36
    v_mul_f32 v40, 0xbfb8aa3b, v86
    v_exp_f32 v40, v40
    v_mul_f32 v41, v86, v94
    v_add_f32 v40, 1.0, v40
    v_rcp_f32 v40, v40
    s_nop 0
    v_mul_f32 v86, v41, v40
    v_mul_f32 v44, 0xbfb8aa3b, v87
    v_exp_f32 v44, v44
    v_mul_f32 v45, v87, v95
    v_add_f32 v44, 1.0, v44
    v_rcp_f32 v44, v44
    s_nop 0
    v_mul_f32 v87, v45, v44
    v_cvt_pk_bf16_f32 v80, v80, v81
    v_cvt_pk_bf16_f32 v81, v82, v83
    v_cvt_pk_bf16_f32 v82, v84, v85
    v_cvt_pk_bf16_f32 v83, v86, v87
    buffer_store_dwordx4 v[64:67], v2, s[28:31], s43 offen offset:0 sc1
    buffer_store_dwordx4 v[80:83], v2, s[28:31], s43 offen offset:1024 sc1
K2_gudB:
    v_accvgpr_write_b32 a64, v104
    v_accvgpr_write_b32 a65, v105
    v_accvgpr_write_b32 a66, v106
    v_accvgpr_write_b32 a67, v107
    v_accvgpr_write_b32 a68, v108
    v_accvgpr_write_b32 a69, v109
    v_accvgpr_write_b32 a70, v110
    v_accvgpr_write_b32 a71, v111
    v_accvgpr_write_b32 a72, v120
    v_accvgpr_write_b32 a73, v121
    v_accvgpr_write_b32 a74, v122
    v_accvgpr_write_b32 a75, v123
    v_accvgpr_write_b32 a76, v124
    v_accvgpr_write_b32 a77, v125
    v_accvgpr_write_b32 a78, v126
    v_accvgpr_write_b32 a79, v127
    v_accvgpr_write_b32 a80, v96
    v_accvgpr_write_b32 a81, v97
    v_accvgpr_write_b32 a82, v98
    v_accvgpr_write_b32 a83, v99
    v_accvgpr_write_b32 a84, v100
    v_accvgpr_write_b32 a85, v101
    v_accvgpr_write_b32 a86, v102
    v_accvgpr_write_b32 a87, v103
    v_accvgpr_write_b32 a88, v112
    v_accvgpr_write_b32 a89, v113
    v_accvgpr_write_b32 a90, v114
    v_accvgpr_write_b32 a91, v115
    v_accvgpr_write_b32 a92, v116
    v_accvgpr_write_b32 a93, v117
    v_accvgpr_write_b32 a94, v118
    v_accvgpr_write_b32 a95, v119
    v_mov_b32 v93, v2
    v_mov_b32 v99, v2
    v_and_b32 v3, 31, v1
    v_lshrrev_b32 v4, 5, v1
    v_lshlrev_b32 v4, 2, v4
    v_sub_u32 v3, v3, v4
    s_lshl_b32 s38, s64, 5
    v_add_u32 v3, s38, v3
    v_cvt_f32_i32 v3, v3
    v_add_f32 v3, 0.5, v3
    v_mul_f32 v94, 0x6c800000, v3
    v_mov_b32 v90, v93
    v_add_u32 v92, 49152, v93
    s_mov_b32 s45, s44
    s_add_u32 s46, s44, 81920
    s_mov_b32 s40, 0
    s_mov_b32 s41, 49152
    s_mov_b32 s47, 0x46800000
    s_mov_b32 s62, 0x80000000
    s_add_u32 s60, s60, 49152
    s_add_u32 s61, s61, 32768
    s_mov_b32 s58, 3
    s_mov_b32 s43, s60
    s_mov_b32 s44, s61
    s_and_b32 s48, s2, 7
    s_lshr_b32 s49, s2, 5
    s_lshr_b32 s50, s2, 3
    s_and_b32 s50, s50, 3
    s_lshl_b32 s38, s48, 2
    s_mul_i32 s39, s38, 3
    s_lshl_b32 s53, s38, 1
    s_add_u32 s53, s53, 22
    s_cmp_lt_u32 s38, 22
    s_cselect_b32 s51, s39, s53
    s_lshl_b32 s52, s50, 8
    s_mov_b32 s68, s14
    s_and_b32 s69, s15, 0xffff
    s_mov_b32 s70, 4194304
    s_mov_b32 s71, 0x20000
    s_mov_b32 s72, s22
    s_and_b32 s73, s23, 0xffff
    s_mov_b32 s74, 1409024
    s_mov_b32 s75, 0x20000
    v_lshrrev_b32 v12, 5, v1
    v_lshlrev_b32 v12, 2, v12
    v_bfe_u32 v13, v1, 2, 2
    v_add_u32 v12, v12, v13
    v_lshlrev_b32 v12, 8, v12
    v_bfe_u32 v4, v1, 4, 1
    v_lshlrev_b32 v4, 5, v4
    v_add_u32 v12, v12, v4
    v_and_b32 v4, 3, v1
    v_lshlrev_b32 v4, 3, v4
    v_add_u32 v12, v12, v4
    v_xor_b32 v4, 0, v13
    v_lshlrev_b32 v4, 6, v4
    v_add_u32 v4, v4, v12
    v_xor_b32 v5, 1, v13
    v_lshlrev_b32 v5, 6, v5
    v_add_u32 v5, v5, v12
    v_xor_b32 v6, 2, v13
    v_lshlrev_b32 v6, 6, v6
    v_add_u32 v6, v6, v12
    v_xor_b32 v7, 3, v13
    v_lshlrev_b32 v7, 6, v7
    v_add_u32 v7, v7, v12
    v_lshrrev_b32 v12, 4, v1
    v_bfe_u32 v13, v1, 2, 2
    v_xor_b32 v13, v13, v12
    v_lshlrev_b32 v13, 6, v13
    v_and_b32 v8, 3, v1
    v_lshlrev_b32 v8, 4, v8
    v_add_u32 v13, v13, v8
    v_mul_u32_u24 v12, 1024, v12
    v_add_u32 v8, v12, v13
    v_add_u32 v9, 3072, v8
ATT_B:
    s_setprio 2
    v_accvgpr_write_b32 a0, 0
    v_accvgpr_write_b32 a1, 0
    v_accvgpr_write_b32 a2, 0
    v_accvgpr_write_b32 a3, 0
    v_accvgpr_write_b32 a4, 0
    v_accvgpr_write_b32 a5, 0
    v_accvgpr_write_b32 a6, 0
    v_accvgpr_write_b32 a7, 0
    v_accvgpr_write_b32 a8, 0
    v_accvgpr_write_b32 a9, 0
    v_accvgpr_write_b32 a10, 0
    v_accvgpr_write_b32 a11, 0
    v_accvgpr_write_b32 a12, 0
    v_accvgpr_write_b32 a13, 0
    v_accvgpr_write_b32 a14, 0
    v_accvgpr_write_b32 a15, 0
    v_accvgpr_write_b32 a16, 0
    v_accvgpr_write_b32 a17, 0
    v_accvgpr_write_b32 a18, 0
    v_accvgpr_write_b32 a19, 0
    v_accvgpr_write_b32 a20, 0
    v_accvgpr_write_b32 a21, 0
    v_accvgpr_write_b32 a22, 0
    v_accvgpr_write_b32 a23, 0
    v_accvgpr_write_b32 a24, 0
    v_accvgpr_write_b32 a25, 0
    v_accvgpr_write_b32 a26, 0
    v_accvgpr_write_b32 a27, 0
    v_accvgpr_write_b32 a28, 0
    v_accvgpr_write_b32 a29, 0
    v_accvgpr_write_b32 a30, 0
    v_accvgpr_write_b32 a31, 0
    v_accvgpr_write_b32 a32, 0
    v_accvgpr_write_b32 a33, 0
    v_accvgpr_write_b32 a34, 0
    v_accvgpr_write_b32 a35, 0
    v_accvgpr_write_b32 a36, 0
    v_accvgpr_write_b32 a37, 0
    v_accvgpr_write_b32 a38, 0
    v_accvgpr_write_b32 a39, 0
    v_accvgpr_write_b32 a40, 0
    v_accvgpr_write_b32 a41, 0
    v_accvgpr_write_b32 a42, 0
    v_accvgpr_write_b32 a43, 0
    v_accvgpr_write_b32 a44, 0
    v_accvgpr_write_b32 a45, 0
    v_accvgpr_write_b32 a46, 0
    v_accvgpr_write_b32 a47, 0
    v_accvgpr_write_b32 a48, 0
    v_accvgpr_write_b32 a49, 0
    v_accvgpr_write_b32 a50, 0
    v_accvgpr_write_b32 a51, 0
    v_accvgpr_write_b32 a52, 0
    v_accvgpr_write_b32 a53, 0
    v_accvgpr_write_b32 a54, 0
    v_accvgpr_write_b32 a55, 0
    v_accvgpr_write_b32 a56, 0
    v_accvgpr_write_b32 a57, 0
    v_accvgpr_write_b32 a58, 0
    v_accvgpr_write_b32 a59, 0
    v_accvgpr_write_b32 a60, 0
    v_accvgpr_write_b32 a61, 0
    v_accvgpr_write_b32 a62, 0
    v_accvgpr_write_b32 a63, 0
    v_mov_b32 v48, 0
    v_mov_b32 v49, 0
    v_mov_b32 v50, 0
    v_mov_b32 v51, 0
    v_mov_b32 v52, 0
    v_mov_b32 v53, 0
    v_mov_b32 v54, 0
    v_mov_b32 v55, 0
    v_mov_b32 v56, 0
    v_mov_b32 v57, 0
    v_mov_b32 v58, 0
    v_mov_b32 v59, 0
    v_mov_b32 v60, 0
    v_mov_b32 v61, 0
    v_mov_b32 v62, 0
    v_mov_b32 v63, 0
    s_waitcnt vmcnt(0)
    s_barrier
    v_min_f32 v16, v94, v48
    v_add_f32 v17, 0xec800000, v94
    v_min_f32 v17, v17, v49
    v_add_f32 v18, 0xed000000, v94
    v_min_f32 v18, v18, v50
    v_add_f32 v19, 0xed400000, v94
    v_min_f32 v19, v19, v51
    v_add_f32 v20, 0xee000000, v94
    v_min_f32 v20, v20, v52
    v_add_f32 v21, 0xee100000, v94
    v_min_f32 v21, v21, v53
    v_add_f32 v22, 0xee200000, v94
    v_min_f32 v22, v22, v54
    v_add_f32 v23, 0xee300000, v94
    v_min_f32 v23, v23, v55
    v_add_f32 v24, 0xee800000, v94
    v_min_f32 v24, v24, v56
    v_add_f32 v25, 0xee880000, v94
    v_min_f32 v25, v25, v57
    v_add_f32 v26, 0xee900000, v94
    v_min_f32 v26, v26, v58
    v_add_f32 v27, 0xee980000, v94
    v_min_f32 v27, v27, v59
    v_add_f32 v28, 0xeec00000, v94
    v_min_f32 v28, v28, v60
    v_add_f32 v29, 0xeec80000, v94
    v_min_f32 v29, v29, v61
    v_add_f32 v30, 0xeed00000, v94
    v_min_f32 v30, v30, v62
    v_add_f32 v31, 0xeed80000, v94
    v_min_f32 v31, v31, v63
    v_add_f32 v94, 0xef000000, v94
    ds_read_b128 a[96:99], v90 offset:0
    ds_read_b128 a[100:103], v90 offset:1024
    ds_read_b128 a[104:107], v90 offset:2048
    ds_read_b128 a[108:111], v90 offset:3072
    ds_read_b128 a[112:115], v90 offset:4096
    ds_read_b128 a[116:119], v90 offset:5120
    ds_read_b128 a[120:123], v90 offset:6144
    ds_read_b128 a[124:127], v90 offset:7168
    s_waitcnt lgkmcnt(7)
    v_mfma_f32_32x32x16_bf16 v[16:31], a[96:99], a[64:67], v[16:31]
    s_waitcnt lgkmcnt(6)
    v_mfma_f32_32x32x16_bf16 v[16:31], a[100:103], a[68:71], v[16:31]
    s_waitcnt lgkmcnt(5)
    v_mfma_f32_32x32x16_bf16 v[16:31], a[104:107], a[72:75], v[16:31]
    s_waitcnt lgkmcnt(4)
    v_mfma_f32_32x32x16_bf16 v[16:31], a[108:111], a[76:79], v[16:31]
    s_waitcnt lgkmcnt(3)
    v_mfma_f32_32x32x16_bf16 v[16:31], a[112:115], a[80:83], v[16:31]
    s_waitcnt lgkmcnt(2)
    v_mfma_f32_32x32x16_bf16 v[16:31], a[116:119], a[84:87], v[16:31]
    s_waitcnt lgkmcnt(1)
    v_mfma_f32_32x32x16_bf16 v[16:31], a[120:123], a[88:91], v[16:31]
    s_waitcnt lgkmcnt(0)
    v_mfma_f32_32x32x16_bf16 v[16:31], a[124:127], a[92:95], v[16:31]
    ds_read_b128 a[96:99], v90 offset:8192
    ds_read_b128 a[100:103], v90 offset:9216
    ds_read_b128 a[104:107], v90 offset:10240
    ds_read_b128 a[108:111], v90 offset:11264
    ds_read_b128 a[112:115], v90 offset:12288
    ds_read_b128 a[116:119], v90 offset:13312
    ds_read_b128 a[120:123], v90 offset:14336
    ds_read_b128 a[124:127], v90 offset:15360
    s_nop 3
    v_max3_f32 v96, v16, v17, v18
    v_max3_f32 v96, v96, v19, v20
    v_max3_f32 v96, v96, v21, v22
    v_max3_f32 v96, v96, v23, v24
    v_max3_f32 v96, v96, v25, v26
    v_max3_f32 v96, v96, v27, v28
    v_max3_f32 v96, v96, v29, v30
    v_max_f32 v96, v96, v31
    v_mov_b32 v98, v96
    s_nop 1
    v_permlane32_swap_b32 v96, v98
    v_max_f32 v96, v96, v98
    v_sub_f32 v16, v16, v96
    v_sub_f32 v48, 0, v96
    v_sub_f32 v17, v17, v96
    v_sub_f32 v49, 0, v96
    v_sub_f32 v18, v18, v96
    v_sub_f32 v50, 0, v96
    v_sub_f32 v19, v19, v96
    v_sub_f32 v51, 0, v96
    v_sub_f32 v20, v20, v96
    v_sub_f32 v52, 0, v96
    v_sub_f32 v21, v21, v96
    v_sub_f32 v53, 0, v96
    v_sub_f32 v22, v22, v96
    v_sub_f32 v54, 0, v96
    v_sub_f32 v23, v23, v96
    v_sub_f32 v55, 0, v96
    v_sub_f32 v24, v24, v96
    v_sub_f32 v56, 0, v96
    v_sub_f32 v25, v25, v96
    v_sub_f32 v57, 0, v96
    v_sub_f32 v26, v26, v96
    v_sub_f32 v58, 0, v96
    v_sub_f32 v27, v27, v96
    v_sub_f32 v59, 0, v96
    v_sub_f32 v28, v28, v96
    v_sub_f32 v60, 0, v96
    v_sub_f32 v29, v29, v96
    v_sub_f32 v61, 0, v96
    v_sub_f32 v30, v30, v96
    v_sub_f32 v62, 0, v96
    v_sub_f32 v31, v31, v96
    v_sub_f32 v63, 0, v96
    v_min_f32 v32, v94, v48
    v_add_f32 v33, 0xec800000, v94
    v_min_f32 v33, v33, v49
    v_add_f32 v34, 0xed000000, v94
    v_min_f32 v34, v34, v50
    v_add_f32 v35, 0xed400000, v94
    v_min_f32 v35, v35, v51
    v_add_f32 v36, 0xee000000, v94
    v_min_f32 v36, v36, v52
    v_add_f32 v37, 0xee100000, v94
    v_min_f32 v37, v37, v53
    v_add_f32 v38, 0xee200000, v94
    v_min_f32 v38, v38, v54
    v_add_f32 v39, 0xee300000, v94
    v_min_f32 v39, v39, v55
    v_add_f32 v40, 0xee800000, v94
    v_min_f32 v40, v40, v56
    v_add_f32 v41, 0xee880000, v94
    v_min_f32 v41, v41, v57
    v_add_f32 v42, 0xee900000, v94
    v_min_f32 v42, v42, v58
    v_add_f32 v43, 0xee980000, v94
    v_min_f32 v43, v43, v59
    v_add_f32 v44, 0xeec00000, v94
    v_min_f32 v44, v44, v60
    v_add_f32 v45, 0xeec80000, v94
    v_min_f32 v45, v45, v61
    v_add_f32 v46, 0xeed00000, v94
    v_min_f32 v46, v46, v62
    v_add_f32 v47, 0xeed80000, v94
    v_min_f32 v47, v47, v63
    v_add_f32 v94, 0xef000000, v94
    s_waitcnt lgkmcnt(7)
    v_mfma_f32_32x32x16_bf16 v[32:47], a[96:99], a[64:67], v[32:47]
    s_waitcnt lgkmcnt(6)
    v_mfma_f32_32x32x16_bf16 v[32:47], a[100:103], a[68:71], v[32:47]
    s_waitcnt lgkmcnt(5)
    v_mfma_f32_32x32x16_bf16 v[32:47], a[104:107], a[72:75], v[32:47]
    s_waitcnt lgkmcnt(4)
    v_mfma_f32_32x32x16_bf16 v[32:47], a[108:111], a[76:79], v[32:47]
    s_waitcnt lgkmcnt(3)
    v_mfma_f32_32x32x16_bf16 v[32:47], a[112:115], a[80:83], v[32:47]
    s_waitcnt lgkmcnt(2)
    v_mfma_f32_32x32x16_bf16 v[32:47], a[116:119], a[84:87], v[32:47]
    s_waitcnt lgkmcnt(1)
    v_mfma_f32_32x32x16_bf16 v[32:47], a[120:123], a[88:91], v[32:47]
    s_waitcnt lgkmcnt(0)
    v_mfma_f32_32x32x16_bf16 v[32:47], a[124:127], a[92:95], v[32:47]
    s_add_u32 s40, s40, 16384
    s_cmp_eq_u32 s40, 49152
    s_cselect_b32 s40, 0, s40
    v_add_u32 v90, s40, v93
    s_barrier
    ds_read_b128 a[96:99], v90 offset:0
    ds_read_b128 a[100:103], v90 offset:1024
    ds_read_b128 a[104:107], v90 offset:2048
    ds_read_b128 a[108:111], v90 offset:3072
    ds_read_b128 a[112:115], v90 offset:4096
    ds_read_b128 a[116:119], v90 offset:5120
    v_exp_f32 v80, v16
    v_exp_f32 v81, v17
    s_nop 0
    v_add_f32 v88, v80, v81
    v_cvt_pk_bf16_f32 v64, v80, v81
    v_exp_f32 v80, v18
    v_exp_f32 v81, v19
    v_add_f32 v88, v88, v80
    v_add_f32 v88, v88, v81
    v_cvt_pk_bf16_f32 v65, v80, v81
    v_exp_f32 v80, v20
    v_exp_f32 v81, v21
    v_add_f32 v88, v88, v80
    v_add_f32 v88, v88, v81
    v_cvt_pk_bf16_f32 v66, v80, v81
    v_exp_f32 v80, v22
    v_exp_f32 v81, v23
    v_add_f32 v88, v88, v80
    v_add_f32 v88, v88, v81
    v_cvt_pk_bf16_f32 v67, v80, v81
    v_exp_f32 v80, v24
    v_exp_f32 v81, v25
    v_add_f32 v88, v88, v80
    v_add_f32 v88, v88, v81
    v_cvt_pk_bf16_f32 v68, v80, v81
    v_exp_f32 v80, v26
    v_exp_f32 v81, v27
    v_add_f32 v88, v88, v80
    v_add_f32 v88, v88, v81
    v_cvt_pk_bf16_f32 v69, v80, v81
    v_exp_f32 v80, v28
    v_exp_f32 v81, v29
    v_add_f32 v88, v88, v80
    v_add_f32 v88, v88, v81
    v_cvt_pk_bf16_f32 v70, v80, v81
    v_exp_f32 v80, v30
    v_exp_f32 v81, v31
    v_add_f32 v88, v88, v80
    v_add_f32 v88, v88, v81
    v_cvt_pk_bf16_f32 v71, v80, v81
    v_mov_b32 v89, v88
    v_exp_f32 v80, v32
    v_exp_f32 v81, v33
    v_exp_f32 v82, v34
    s_sub_i32 s42, s63, 3
    s_cmp_le_i32 s42, 0
    s_cbranch_scc1 B_masked_setup
B_loop:
    s_waitcnt lgkmcnt(5)
    v_mfma_f32_32x32x16_bf16 v[16:31], a[96:99], a[64:67], v[48:63]
    ds_read_b128 a[120:123], v90 offset:6144
    v_exp_f32 v83, v35
    v_add_f32 v88, v80, v81
    v_add_f32 v88, v88, v82
    v_cvt_pk_bf16_f32 v72, v80, v81
    s_waitcnt lgkmcnt(5)
    v_mfma_f32_32x32x16_bf16 v[16:31], a[100:103], a[68:71], v[16:31]
    ds_read_b128 a[124:127], v90 offset:7168
    v_exp_f32 v84, v36
    v_add_f32 v88, v88, v83
    v_cvt_pk_bf16_f32 v73, v82, v83
    s_waitcnt lgkmcnt(5)
    v_mfma_f32_32x32x16_bf16 v[16:31], a[104:107], a[72:75], v[16:31]
    ds_read_b128 a[96:99], v92 offset:0
    v_exp_f32 v85, v37
    v_add_f32 v88, v88, v84
    s_waitcnt lgkmcnt(5)
    v_mfma_f32_32x32x16_bf16 v[16:31], a[108:111], a[76:79], v[16:31]
    ds_read_b128 a[100:103], v92 offset:1024
    v_exp_f32 v86, v38
    v_add_f32 v88, v88, v85
    v_cvt_pk_bf16_f32 v74, v84, v85
    s_waitcnt lgkmcnt(5)
    v_mfma_f32_32x32x16_bf16 v[16:31], a[112:115], a[80:83], v[16:31]
    ds_read_b128 a[104:107], v92 offset:2048
    v_exp_f32 v87, v39
    v_add_f32 v88, v88, v86
    s_waitcnt lgkmcnt(5)
    v_mfma_f32_32x32x16_bf16 v[16:31], a[116:119], a[84:87], v[16:31]
    ds_read_b128 a[108:111], v92 offset:3072
    v_exp_f32 v80, v40
    v_add_f32 v88, v88, v87
    v_cvt_pk_bf16_f32 v75, v86, v87
    s_waitcnt lgkmcnt(5)
    v_mfma_f32_32x32x16_bf16 v[16:31], a[120:123], a[88:91], v[16:31]
    ds_read_b128 a[112:115], v92 offset:4096
    v_exp_f32 v81, v41
    v_add_f32 v88, v88, v80
    s_waitcnt lgkmcnt(5)
    v_mfma_f32_32x32x16_bf16 v[16:31], a[124:127], a[92:95], v[16:31]
    ds_read_b128 a[116:119], v92 offset:5120
    v_exp_f32 v82, v42
    v_add_f32 v88, v88, v81
    v_cvt_pk_bf16_f32 v76, v80, v81
    s_waitcnt lgkmcnt(5)
    v_mfma_f32_32x32x16_bf16 a[0:15], a[96:99], v[64:67], a[0:15]
    ds_read_b128 a[120:123], v92 offset:6144
    v_exp_f32 v83, v43
    v_add_f32 v88, v88, v82
    s_waitcnt lgkmcnt(5)
    v_mfma_f32_32x32x16_bf16 a[16:31], a[100:103], v[64:67], a[16:31]
    ds_read_b128 a[124:127], v92 offset:7168
    v_exp_f32 v84, v44
    v_add_f32 v88, v88, v83
    v_cvt_pk_bf16_f32 v77, v82, v83
    s_waitcnt lgkmcnt(5)
    v_mfma_f32_32x32x16_bf16 a[32:47], a[104:107], v[64:67], a[32:47]
    ds_read_b128 a[96:99], v90 offset:8192
    v_exp_f32 v85, v45
    v_add_f32 v88, v88, v84
    s_waitcnt lgkmcnt(5)
    v_mfma_f32_32x32x16_bf16 a[48:63], a[108:111], v[64:67], a[48:63]
    ds_read_b128 a[100:103], v90 offset:9216
    v_exp_f32 v86, v46
    v_add_f32 v88, v88, v85
    v_cvt_pk_bf16_f32 v78, v84, v85
    s_waitcnt lgkmcnt(5)
    v_mfma_f32_32x32x16_bf16 a[0:15], a[112:115], v[68:71], a[0:15]
    ds_read_b128 a[104:107], v90 offset:10240
    v_exp_f32 v87, v47
    v_add_f32 v88, v88, v86
    s_waitcnt lgkmcnt(5)
    v_mfma_f32_32x32x16_bf16 a[16:31], a[116:119], v[68:71], a[16:31]
    ds_read_b128 a[108:111], v90 offset:11264
    v_exp_f32 v80, v16
    v_add_f32 v88, v88, v87
    v_cvt_pk_bf16_f32 v79, v86, v87
    s_waitcnt lgkmcnt(5)
    v_mfma_f32_32x32x16_bf16 a[32:47], a[120:123], v[68:71], a[32:47]
    ds_read_b128 a[112:115], v90 offset:12288
    v_exp_f32 v81, v17
    v_cmp_lt_f32 vcc, s47, v88
    s_waitcnt lgkmcnt(5)
    v_mfma_f32_32x32x16_bf16 a[48:63], a[124:127], v[68:71], a[48:63]
    ds_read_b128 a[116:119], v90 offset:13312
    v_exp_f32 v82, v18
    s_cbranch_vccnz B_r0a
B_r0a_ret:
    v_add_f32 v89, v89, v88
    s_waitcnt lgkmcnt(5)
    v_mfma_f32_32x32x16_bf16 v[32:47], a[96:99], a[64:67], v[48:63]
    ds_read_b128 a[120:123], v90 offset:14336
    v_exp_f32 v83, v19
    v_add_f32 v88, v80, v81
    v_add_f32 v88, v88, v82
    v_cvt_pk_bf16_f32 v64, v80, v81
    s_waitcnt lgkmcnt(5)
    v_mfma_f32_32x32x16_bf16 v[32:47], a[100:103], a[68:71], v[32:47]
    ds_read_b128 a[124:127], v90 offset:15360
    v_exp_f32 v84, v20
    v_add_f32 v88, v88, v83
    v_cvt_pk_bf16_f32 v65, v82, v83
    s_waitcnt lgkmcnt(5)
    v_mfma_f32_32x32x16_bf16 v[32:47], a[104:107], a[72:75], v[32:47]
    ds_read_b128 a[96:99], v92 offset:8192
    v_exp_f32 v85, v21
    v_add_f32 v88, v88, v84
    s_waitcnt lgkmcnt(5)
    v_mfma_f32_32x32x16_bf16 v[32:47], a[108:111], a[76:79], v[32:47]
    ds_read_b128 a[100:103], v92 offset:9216
    v_exp_f32 v86, v22
    v_add_f32 v88, v88, v85
    v_cvt_pk_bf16_f32 v66, v84, v85
    s_add_u32 s40, s40, 16384
    s_cmp_eq_u32 s40, 49152
    s_cselect_b32 s40, 0, s40
    s_waitcnt lgkmcnt(5)
    v_mfma_f32_32x32x16_bf16 v[32:47], a[112:115], a[80:83], v[32:47]
    ds_read_b128 a[104:107], v92 offset:10240
    v_exp_f32 v87, v23
    v_add_f32 v88, v88, v86
    v_add_u32 v90, s40, v93
    s_waitcnt lgkmcnt(5)
    v_mfma_f32_32x32x16_bf16 v[32:47], a[116:119], a[84:87], v[32:47]
    ds_read_b128 a[108:111], v92 offset:11264
    v_exp_f32 v80, v24
    v_add_f32 v88, v88, v87
    v_cvt_pk_bf16_f32 v67, v86, v87
    s_waitcnt lgkmcnt(5)
    v_mfma_f32_32x32x16_bf16 v[32:47], a[120:123], a[88:91], v[32:47]
    ds_read_b128 a[112:115], v92 offset:12288
    v_exp_f32 v81, v25
    v_add_f32 v88, v88, v80
    s_waitcnt lgkmcnt(5)
    v_mfma_f32_32x32x16_bf16 v[32:47], a[124:127], a[92:95], v[32:47]
    ds_read_b128 a[116:119], v92 offset:13312
    v_exp_f32 v82, v26
    v_add_f32 v88, v88, v81
    v_cvt_pk_bf16_f32 v68, v80, v81
    s_waitcnt lgkmcnt(5)
    v_mfma_f32_32x32x16_bf16 a[0:15], a[96:99], v[72:75], a[0:15]
    ds_read_b128 a[120:123], v92 offset:14336
    v_exp_f32 v83, v27
    v_add_f32 v88, v88, v82
    s_waitcnt lgkmcnt(5)
    v_mfma_f32_32x32x16_bf16 a[16:31], a[100:103], v[72:75], a[16:31]
    ds_read_b128 a[124:127], v92 offset:15360
    v_exp_f32 v84, v28
    v_add_f32 v88, v88, v83
    v_cvt_pk_bf16_f32 v69, v82, v83
    s_waitcnt lgkmcnt(5)
    v_mfma_f32_32x32x16_bf16 a[32:47], a[104:107], v[72:75], a[32:47]
    s_barrier
    ds_read_b128 a[96:99], v90 offset:0
    v_exp_f32 v85, v29
    v_add_f32 v88, v88, v84
    s_waitcnt lgkmcnt(5)
    v_mfma_f32_32x32x16_bf16 a[48:63], a[108:111], v[72:75], a[48:63]
    ds_read_b128 a[100:103], v90 offset:1024
    v_exp_f32 v86, v30
    v_add_f32 v88, v88, v85
    v_cvt_pk_bf16_f32 v70, v84, v85
    s_add_u32 s41, s41, 16384
    s_cmp_eq_u32 s41, 114688
    s_cselect_b32 s41, 49152, s41
    s_waitcnt lgkmcnt(5)
    v_mfma_f32_32x32x16_bf16 a[0:15], a[112:115], v[76:79], a[0:15]
    ds_read_b128 a[104:107], v90 offset:2048
    v_exp_f32 v87, v31
    v_add_f32 v88, v88, v86
    v_add_u32 v92, s41, v93
    s_waitcnt lgkmcnt(5)
    v_mfma_f32_32x32x16_bf16 a[16:31], a[116:119], v[76:79], a[16:31]
    ds_read_b128 a[108:111], v90 offset:3072
    v_exp_f32 v80, v32
    v_add_f32 v88, v88, v87
    v_cvt_pk_bf16_f32 v71, v86, v87
    s_waitcnt lgkmcnt(5)
    v_mfma_f32_32x32x16_bf16 a[32:47], a[120:123], v[76:79], a[32:47]
    ds_read_b128 a[112:115], v90 offset:4096
    v_exp_f32 v81, v33
    v_cmp_lt_f32 vcc, s47, v88
    s_sub_u32 s42, s42, 1
    s_waitcnt lgkmcnt(5)
    v_mfma_f32_32x32x16_bf16 a[48:63], a[124:127], v[76:79], a[48:63]
    ds_read_b128 a[116:119], v90 offset:5120
    v_exp_f32 v82, v34
    s_cmp_lg_u32 s42, 0
    s_cbranch_vccnz B_r0b
B_r0b_ret:
    v_add_f32 v89, v89, v88
    s_cbranch_scc1 B_loop
B_masked_setup:
    s_sub_i32 s56, s63, 3
    s_max_i32 s56, s56, 0
    s_sub_i32 s42, s63, s56
    s_sub_i32 s42, s42, 1
    s_lshl_b32 s56, s56, 6
    v_cvt_f32_u32 v95, s56
    v_mul_f32 v95, 0x6c800000, v95
    v_sub_f32 v94, v94, v95
B_mloop:
    v_min_f32 v16, v94, v48
    v_add_f32 v17, 0xec800000, v94
    v_min_f32 v17, v17, v49
    v_add_f32 v18, 0xed000000, v94
    v_min_f32 v18, v18, v50
    v_add_f32 v19, 0xed400000, v94
    v_min_f32 v19, v19, v51
    v_add_f32 v20, 0xee000000, v94
    v_min_f32 v20, v20, v52
    v_add_f32 v21, 0xee100000, v94
    v_min_f32 v21, v21, v53
    v_add_f32 v22, 0xee200000, v94
    v_min_f32 v22, v22, v54
    v_add_f32 v23, 0xee300000, v94
    v_min_f32 v23, v23, v55
    v_add_f32 v24, 0xee800000, v94
    v_min_f32 v24, v24, v56
    v_add_f32 v25, 0xee880000, v94
    v_min_f32 v25, v25, v57
    v_add_f32 v26, 0xee900000, v94
    v_min_f32 v26, v26, v58
    v_add_f32 v27, 0xee980000, v94
    v_min_f32 v27, v27, v59
    v_add_f32 v28, 0xeec00000, v94
    v_min_f32 v28, v28, v60
    v_add_f32 v29, 0xeec80000, v94
    v_min_f32 v29, v29, v61
    v_add_f32 v30, 0xeed00000, v94
    v_min_f32 v30, v30, v62
    v_add_f32 v31, 0xeed80000, v94
    v_min_f32 v31, v31, v63
    v_add_f32 v94, 0xef000000, v94
    s_waitcnt lgkmcnt(5)
    v_mfma_f32_32x32x16_bf16 v[16:31], a[96:99], a[64:67], v[16:31]
    ds_read_b128 a[120:123], v90 offset:6144
    v_exp_f32 v83, v35
    v_add_f32 v88, v80, v81
    v_add_f32 v88, v88, v82
    v_cvt_pk_bf16_f32 v72, v80, v81
    s_waitcnt lgkmcnt(5)
    v_mfma_f32_32x32x16_bf16 v[16:31], a[100:103], a[68:71], v[16:31]
    ds_read_b128 a[124:127], v90 offset:7168
    v_exp_f32 v84, v36
    v_add_f32 v88, v88, v83
    v_cvt_pk_bf16_f32 v73, v82, v83
    s_waitcnt lgkmcnt(5)
    v_mfma_f32_32x32x16_bf16 v[16:31], a[104:107], a[72:75], v[16:31]
    ds_read_b128 a[96:99], v92 offset:0
    v_exp_f32 v85, v37
    v_add_f32 v88, v88, v84
    s_waitcnt lgkmcnt(5)
    v_mfma_f32_32x32x16_bf16 v[16:31], a[108:111], a[76:79], v[16:31]
    ds_read_b128 a[100:103], v92 offset:1024
    v_exp_f32 v86, v38
    v_add_f32 v88, v88, v85
    v_cvt_pk_bf16_f32 v74, v84, v85
    s_waitcnt lgkmcnt(5)
    v_mfma_f32_32x32x16_bf16 v[16:31], a[112:115], a[80:83], v[16:31]
    ds_read_b128 a[104:107], v92 offset:2048
    v_exp_f32 v87, v39
    v_add_f32 v88, v88, v86
    s_waitcnt lgkmcnt(5)
    v_mfma_f32_32x32x16_bf16 v[16:31], a[116:119], a[84:87], v[16:31]
    ds_read_b128 a[108:111], v92 offset:3072
    v_exp_f32 v80, v40
    v_add_f32 v88, v88, v87
    v_cvt_pk_bf16_f32 v75, v86, v87
    s_waitcnt lgkmcnt(5)
    v_mfma_f32_32x32x16_bf16 v[16:31], a[120:123], a[88:91], v[16:31]
    ds_read_b128 a[112:115], v92 offset:4096
    v_exp_f32 v81, v41
    v_add_f32 v88, v88, v80
    s_waitcnt lgkmcnt(5)
    v_mfma_f32_32x32x16_bf16 v[16:31], a[124:127], a[92:95], v[16:31]
    ds_read_b128 a[116:119], v92 offset:5120
    v_exp_f32 v82, v42
    v_add_f32 v88, v88, v81
    v_cvt_pk_bf16_f32 v76, v80, v81
    s_waitcnt lgkmcnt(5)
    v_mfma_f32_32x32x16_bf16 a[0:15], a[96:99], v[64:67], a[0:15]
    ds_read_b128 a[120:123], v92 offset:6144
    v_exp_f32 v83, v43
    v_add_f32 v88, v88, v82
    s_waitcnt lgkmcnt(5)
    v_mfma_f32_32x32x16_bf16 a[16:31], a[100:103], v[64:67], a[16:31]
    ds_read_b128 a[124:127], v92 offset:7168
    v_exp_f32 v84, v44
    v_add_f32 v88, v88, v83
    v_cvt_pk_bf16_f32 v77, v82, v83
    s_waitcnt lgkmcnt(5)
    v_mfma_f32_32x32x16_bf16 a[32:47], a[104:107], v[64:67], a[32:47]
    ds_read_b128 a[96:99], v90 offset:8192
    v_exp_f32 v85, v45
    v_add_f32 v88, v88, v84
    s_waitcnt lgkmcnt(5)
    v_mfma_f32_32x32x16_bf16 a[48:63], a[108:111], v[64:67], a[48:63]
    ds_read_b128 a[100:103], v90 offset:9216
    v_exp_f32 v86, v46
    v_add_f32 v88, v88, v85
    v_cvt_pk_bf16_f32 v78, v84, v85
    s_waitcnt lgkmcnt(5)
    v_mfma_f32_32x32x16_bf16 a[0:15], a[112:115], v[68:71], a[0:15]
    ds_read_b128 a[104:107], v90 offset:10240
    v_exp_f32 v87, v47
    v_add_f32 v88, v88, v86
    s_waitcnt lgkmcnt(5)
    v_mfma_f32_32x32x16_bf16 a[16:31], a[116:119], v[68:71], a[16:31]
    ds_read_b128 a[108:111], v90 offset:11264
    v_exp_f32 v80, v16
    v_add_f32 v88, v88, v87
    v_cvt_pk_bf16_f32 v79, v86, v87
    s_waitcnt lgkmcnt(5)
    v_mfma_f32_32x32x16_bf16 a[32:47], a[120:123], v[68:71], a[32:47]
    ds_read_b128 a[112:115], v90 offset:12288
    v_exp_f32 v81, v17
    v_cmp_lt_f32 vcc, s47, v88
    s_waitcnt lgkmcnt(5)
    v_mfma_f32_32x32x16_bf16 a[48:63], a[124:127], v[68:71], a[48:63]
    ds_read_b128 a[116:119], v90 offset:13312
    v_exp_f32 v82, v18
    s_cbranch_vccnz B_r1a
B_r1a_ret:
    v_add_f32 v89, v89, v88
    v_min_f32 v32, v94, v48
    v_add_f32 v33, 0xec800000, v94
    v_min_f32 v33, v33, v49
    v_add_f32 v34, 0xed000000, v94
    v_min_f32 v34, v34, v50
    v_add_f32 v35, 0xed400000, v94
    v_min_f32 v35, v35, v51
    v_add_f32 v36, 0xee000000, v94
    v_min_f32 v36, v36, v52
    v_add_f32 v37, 0xee100000, v94
    v_min_f32 v37, v37, v53
    v_add_f32 v38, 0xee200000, v94
    v_min_f32 v38, v38, v54
    v_add_f32 v39, 0xee300000, v94
    v_min_f32 v39, v39, v55
    v_add_f32 v40, 0xee800000, v94
    v_min_f32 v40, v40, v56
    v_add_f32 v41, 0xee880000, v94
    v_min_f32 v41, v41, v57
    v_add_f32 v42, 0xee900000, v94
    v_min_f32 v42, v42, v58
    v_add_f32 v43, 0xee980000, v94
    v_min_f32 v43, v43, v59
    v_add_f32 v44, 0xeec00000, v94
    v_min_f32 v44, v44, v60
    v_add_f32 v45, 0xeec80000, v94
    v_min_f32 v45, v45, v61
    v_add_f32 v46, 0xeed00000, v94
    v_min_f32 v46, v46, v62
    v_add_f32 v47, 0xeed80000, v94
    v_min_f32 v47, v47, v63
    v_add_f32 v94, 0xef000000, v94
    s_waitcnt lgkmcnt(5)
    v_mfma_f32_32x32x16_bf16 v[32:47], a[96:99], a[64:67], v[32:47]
    ds_read_b128 a[120:123], v90 offset:14336
    v_exp_f32 v83, v19
    v_add_f32 v88, v80, v81
    v_add_f32 v88, v88, v82
    v_cvt_pk_bf16_f32 v64, v80, v81
    s_waitcnt lgkmcnt(5)
    v_mfma_f32_32x32x16_bf16 v[32:47], a[100:103], a[68:71], v[32:47]
    ds_read_b128 a[124:127], v90 offset:15360
    v_exp_f32 v84, v20
    v_add_f32 v88, v88, v83
    v_cvt_pk_bf16_f32 v65, v82, v83
    s_waitcnt lgkmcnt(5)
    v_mfma_f32_32x32x16_bf16 v[32:47], a[104:107], a[72:75], v[32:47]
    ds_read_b128 a[96:99], v92 offset:8192
    v_exp_f32 v85, v21
    v_add_f32 v88, v88, v84
    s_waitcnt lgkmcnt(5)
    v_mfma_f32_32x32x16_bf16 v[32:47], a[108:111], a[76:79], v[32:47]
    ds_read_b128 a[100:103], v92 offset:9216
    v_exp_f32 v86, v22
    v_add_f32 v88, v88, v85
    v_cvt_pk_bf16_f32 v66, v84, v85
    s_add_u32 s40, s40, 16384
    s_cmp_eq_u32 s40, 49152
    s_cselect_b32 s40, 0, s40
    s_waitcnt lgkmcnt(5)
    v_mfma_f32_32x32x16_bf16 v[32:47], a[112:115], a[80:83], v[32:47]
    ds_read_b128 a[104:107], v92 offset:10240
    v_exp_f32 v87, v23
    v_add_f32 v88, v88, v86
    v_add_u32 v90, s40, v93
    s_waitcnt lgkmcnt(5)
    v_mfma_f32_32x32x16_bf16 v[32:47], a[116:119], a[84:87], v[32:47]
    ds_read_b128 a[108:111], v92 offset:11264
    v_exp_f32 v80, v24
    v_add_f32 v88, v88, v87
    v_cvt_pk_bf16_f32 v67, v86, v87
    s_waitcnt lgkmcnt(5)
    v_mfma_f32_32x32x16_bf16 v[32:47], a[120:123], a[88:91], v[32:47]
    ds_read_b128 a[112:115], v92 offset:12288
    v_exp_f32 v81, v25
    v_add_f32 v88, v88, v80
    s_waitcnt lgkmcnt(5)
    v_mfma_f32_32x32x16_bf16 v[32:47], a[124:127], a[92:95], v[32:47]
    ds_read_b128 a[116:119], v92 offset:13312
    v_exp_f32 v82, v26
    v_add_f32 v88, v88, v81
    v_cvt_pk_bf16_f32 v68, v80, v81
    s_waitcnt lgkmcnt(5)
    v_mfma_f32_32x32x16_bf16 a[0:15], a[96:99], v[72:75], a[0:15]
    ds_read_b128 a[120:123], v92 offset:14336
    v_exp_f32 v83, v27
    v_add_f32 v88, v88, v82
    s_waitcnt lgkmcnt(5)
    v_mfma_f32_32x32x16_bf16 a[16:31], a[100:103], v[72:75], a[16:31]
    ds_read_b128 a[124:127], v92 offset:15360
    v_exp_f32 v84, v28
    v_add_f32 v88, v88, v83
    v_cvt_pk_bf16_f32 v69, v82, v83
    s_waitcnt lgkmcnt(5)
    v_mfma_f32_32x32x16_bf16 a[32:47], a[104:107], v[72:75], a[32:47]
    s_barrier
    ds_read_b128 a[96:99], v90 offset:0
    v_exp_f32 v85, v29
    v_add_f32 v88, v88, v84
    s_waitcnt lgkmcnt(5)
    v_mfma_f32_32x32x16_bf16 a[48:63], a[108:111], v[72:75], a[48:63]
    ds_read_b128 a[100:103], v90 offset:1024
    v_exp_f32 v86, v30
    v_add_f32 v88, v88, v85
    v_cvt_pk_bf16_f32 v70, v84, v85
    s_add_u32 s41, s41, 16384
    s_cmp_eq_u32 s41, 114688
    s_cselect_b32 s41, 49152, s41
    s_waitcnt lgkmcnt(5)
    v_mfma_f32_32x32x16_bf16 a[0:15], a[112:115], v[76:79], a[0:15]
    ds_read_b128 a[104:107], v90 offset:2048
    v_exp_f32 v87, v31
    v_add_f32 v88, v88, v86
    v_add_u32 v92, s41, v93
    s_waitcnt lgkmcnt(5)
    v_mfma_f32_32x32x16_bf16 a[16:31], a[116:119], v[76:79], a[16:31]
    ds_read_b128 a[108:111], v90 offset:3072
    v_exp_f32 v80, v32
    v_add_f32 v88, v88, v87
    v_cvt_pk_bf16_f32 v71, v86, v87
    s_waitcnt lgkmcnt(5)
    v_mfma_f32_32x32x16_bf16 a[32:47], a[120:123], v[76:79], a[32:47]
    ds_read_b128 a[112:115], v90 offset:4096
    v_exp_f32 v81, v33
    v_cmp_lt_f32 vcc, s47, v88
    s_sub_u32 s42, s42, 1
    s_waitcnt lgkmcnt(5)
    v_mfma_f32_32x32x16_bf16 a[48:63], a[124:127], v[76:79], a[48:63]
    ds_read_b128 a[116:119], v90 offset:5120
    v_exp_f32 v82, v34
    s_cmp_lg_u32 s42, 0
    s_cbranch_vccnz B_r1b
B_r1b_ret:
    v_add_f32 v89, v89, v88
    s_cbranch_scc1 B_mloop
    v_exp_f32 v83, v35
    v_add_f32 v88, v80, v81
    v_add_f32 v88, v88, v82
    v_cvt_pk_bf16_f32 v72, v80, v81
    v_exp_f32 v84, v36
    v_add_f32 v88, v88, v83
    v_cvt_pk_bf16_f32 v73, v82, v83
    ds_read_b128 a[96:99], v92 offset:0
    v_exp_f32 v85, v37
    v_add_f32 v88, v88, v84
    ds_read_b128 a[100:103], v92 offset:1024
    v_exp_f32 v86, v38
    v_add_f32 v88, v88, v85
    v_cvt_pk_bf16_f32 v74, v84, v85
    ds_read_b128 a[104:107], v92 offset:2048
    v_exp_f32 v87, v39
    v_add_f32 v88, v88, v86
    ds_read_b128 a[108:111], v92 offset:3072
    v_exp_f32 v80, v40
    v_add_f32 v88, v88, v87
    v_cvt_pk_bf16_f32 v75, v86, v87
    ds_read_b128 a[112:115], v92 offset:4096
    v_exp_f32 v81, v41
    v_add_f32 v88, v88, v80
    ds_read_b128 a[116:119], v92 offset:5120
    v_exp_f32 v82, v42
    v_add_f32 v88, v88, v81
    v_cvt_pk_bf16_f32 v76, v80, v81
    s_waitcnt lgkmcnt(5)
    v_mfma_f32_32x32x16_bf16 a[0:15], a[96:99], v[64:67], a[0:15]
    ds_read_b128 a[120:123], v92 offset:6144
    v_exp_f32 v83, v43
    v_add_f32 v88, v88, v82
    s_waitcnt lgkmcnt(5)
    v_mfma_f32_32x32x16_bf16 a[16:31], a[100:103], v[64:67], a[16:31]
    ds_read_b128 a[124:127], v92 offset:7168
    v_exp_f32 v84, v44
    v_add_f32 v88, v88, v83
    v_cvt_pk_bf16_f32 v77, v82, v83
    s_waitcnt lgkmcnt(5)
    v_mfma_f32_32x32x16_bf16 a[32:47], a[104:107], v[64:67], a[32:47]
    v_exp_f32 v85, v45
    v_add_f32 v88, v88, v84
    s_waitcnt lgkmcnt(4)
    v_mfma_f32_32x32x16_bf16 a[48:63], a[108:111], v[64:67], a[48:63]
    v_exp_f32 v86, v46
    v_add_f32 v88, v88, v85
    v_cvt_pk_bf16_f32 v78, v84, v85
    s_waitcnt lgkmcnt(3)
    v_mfma_f32_32x32x16_bf16 a[0:15], a[112:115], v[68:71], a[0:15]
    v_exp_f32 v87, v47
    v_add_f32 v88, v88, v86
    s_waitcnt lgkmcnt(2)
    v_mfma_f32_32x32x16_bf16 a[16:31], a[116:119], v[68:71], a[16:31]
    v_add_f32 v88, v88, v87
    v_cvt_pk_bf16_f32 v79, v86, v87
    s_waitcnt lgkmcnt(1)
    v_mfma_f32_32x32x16_bf16 a[32:47], a[120:123], v[68:71], a[32:47]
    v_cmp_lt_f32 vcc, s47, v88
    s_waitcnt lgkmcnt(0)
    v_mfma_f32_32x32x16_bf16 a[48:63], a[124:127], v[68:71], a[48:63]
    s_cbranch_vccnz B_r2a
B_r2a_ret:
    v_add_f32 v89, v89, v88
    ds_read_b128 a[96:99], v92 offset:8192
    ds_read_b128 a[100:103], v92 offset:9216
    s_add_u32 s40, s40, 16384
    s_cmp_eq_u32 s40, 49152
    s_cselect_b32 s40, 0, s40
    ds_read_b128 a[104:107], v92 offset:10240
    v_add_u32 v90, s40, v93
    ds_read_b128 a[108:111], v92 offset:11264
    ds_read_b128 a[112:115], v92 offset:12288
    ds_read_b128 a[116:119], v92 offset:13312
    s_waitcnt lgkmcnt(5)
    v_mfma_f32_32x32x16_bf16 a[0:15], a[96:99], v[72:75], a[0:15]
    ds_read_b128 a[120:123], v92 offset:14336
    s_waitcnt lgkmcnt(5)
    v_mfma_f32_32x32x16_bf16 a[16:31], a[100:103], v[72:75], a[16:31]
    ds_read_b128 a[124:127], v92 offset:15360
    s_waitcnt lgkmcnt(5)
    v_mfma_f32_32x32x16_bf16 a[32:47], a[104:107], v[72:75], a[32:47]
    s_barrier
    s_waitcnt lgkmcnt(4)
    v_mfma_f32_32x32x16_bf16 a[48:63], a[108:111], v[72:75], a[48:63]
    s_add_u32 s41, s41, 16384
    s_cmp_eq_u32 s41, 114688
    s_cselect_b32 s41, 49152, s41
    s_waitcnt lgkmcnt(3)
    v_mfma_f32_32x32x16_bf16 a[0:15], a[112:115], v[76:79], a[0:15]
    v_add_u32 v92, s41, v93
    s_waitcnt lgkmcnt(2)
    v_mfma_f32_32x32x16_bf16 a[16:31], a[116:119], v[76:79], a[16:31]
    s_waitcnt lgkmcnt(1)
    v_mfma_f32_32x32x16_bf16 a[32:47], a[120:123], v[76:79], a[32:47]
    s_waitcnt lgkmcnt(0)
    v_mfma_f32_32x32x16_bf16 a[48:63], a[124:127], v[76:79], a[48:63]
    s_setprio 0
    s_cmp_eq_u32 s63, s59
    s_cbranch_scc1 B_noxb
    s_barrier
B_noxb:
    v_mov_b32 v96, v89
    v_mov_b32 v97, v89
    s_nop 1
    v_permlane32_swap_b32 v96, v97
    v_add_f32 v96, v96, v97
    v_rcp_f32 v96, v96
    v_accvgpr_read_b32 v48, a0
    v_accvgpr_read_b32 v49, a1
    v_accvgpr_read_b32 v50, a2
    v_accvgpr_read_b32 v51, a3
    v_accvgpr_read_b32 v52, a4
    v_accvgpr_read_b32 v53, a5
    v_accvgpr_read_b32 v54, a6
    v_accvgpr_read_b32 v55, a7
    v_mul_f32 v48, v48, v96
    v_mul_f32 v49, v49, v96
    v_mul_f32 v50, v50, v96
    v_mul_f32 v51, v51, v96
    v_mul_f32 v52, v52, v96
    v_mul_f32 v53, v53, v96
    v_mul_f32 v54, v54, v96
    v_mul_f32 v55, v55, v96
    v_cvt_pk_bf16_f32 v16, v48, v49
    v_cvt_pk_bf16_f32 v17, v50, v51
    v_cvt_pk_bf16_f32 v18, v52, v53
    v_cvt_pk_bf16_f32 v19, v54, v55
    v_accvgpr_read_b32 v48, a8
    v_accvgpr_read_b32 v49, a9
    v_accvgpr_read_b32 v50, a10
    v_accvgpr_read_b32 v51, a11
    v_accvgpr_read_b32 v52, a12
    v_accvgpr_read_b32 v53, a13
    v_accvgpr_read_b32 v54, a14
    v_accvgpr_read_b32 v55, a15
    v_mul_f32 v48, v48, v96
    v_mul_f32 v49, v49, v96
    v_mul_f32 v50, v50, v96
    v_mul_f32 v51, v51, v96
    v_mul_f32 v52, v52, v96
    v_mul_f32 v53, v53, v96
    v_mul_f32 v54, v54, v96
    v_mul_f32 v55, v55, v96
    v_cvt_pk_bf16_f32 v20, v48, v49
    v_cvt_pk_bf16_f32 v21, v50, v51
    v_cvt_pk_bf16_f32 v22, v52, v53
    v_cvt_pk_bf16_f32 v23, v54, v55
    v_accvgpr_read_b32 v48, a16
    v_accvgpr_read_b32 v49, a17
    v_accvgpr_read_b32 v50, a18
    v_accvgpr_read_b32 v51, a19
    v_accvgpr_read_b32 v52, a20
    v_accvgpr_read_b32 v53, a21
    v_accvgpr_read_b32 v54, a22
    v_accvgpr_read_b32 v55, a23
    v_mul_f32 v48, v48, v96
    v_mul_f32 v49, v49, v96
    v_mul_f32 v50, v50, v96
    v_mul_f32 v51, v51, v96
    v_mul_f32 v52, v52, v96
    v_mul_f32 v53, v53, v96
    v_mul_f32 v54, v54, v96
    v_mul_f32 v55, v55, v96
    v_cvt_pk_bf16_f32 v24, v48, v49
    v_cvt_pk_bf16_f32 v25, v50, v51
    v_cvt_pk_bf16_f32 v26, v52, v53
    v_cvt_pk_bf16_f32 v27, v54, v55
    v_accvgpr_read_b32 v48, a24
    v_accvgpr_read_b32 v49, a25
    v_accvgpr_read_b32 v50, a26
    v_accvgpr_read_b32 v51, a27
    v_accvgpr_read_b32 v52, a28
    v_accvgpr_read_b32 v53, a29
    v_accvgpr_read_b32 v54, a30
    v_accvgpr_read_b32 v55, a31
    v_mul_f32 v48, v48, v96
    v_mul_f32 v49, v49, v96
    v_mul_f32 v50, v50, v96
    v_mul_f32 v51, v51, v96
    v_mul_f32 v52, v52, v96
    v_mul_f32 v53, v53, v96
    v_mul_f32 v54, v54, v96
    v_mul_f32 v55, v55, v96
    v_cvt_pk_bf16_f32 v28, v48, v49
    v_cvt_pk_bf16_f32 v29, v50, v51
    v_cvt_pk_bf16_f32 v30, v52, v53
    v_cvt_pk_bf16_f32 v31, v54, v55
    v_accvgpr_read_b32 v48, a32
    v_accvgpr_read_b32 v49, a33
    v_accvgpr_read_b32 v50, a34
    v_accvgpr_read_b32 v51, a35
    v_accvgpr_read_b32 v52, a36
    v_accvgpr_read_b32 v53, a37
    v_accvgpr_read_b32 v54, a38
    v_accvgpr_read_b32 v55, a39
    v_mul_f32 v48, v48, v96
    v_mul_f32 v49, v49, v96
    v_mul_f32 v50, v50, v96
    v_mul_f32 v51, v51, v96
    v_mul_f32 v52, v52, v96
    v_mul_f32 v53, v53, v96
    v_mul_f32 v54, v54, v96
    v_mul_f32 v55, v55, v96
    v_cvt_pk_bf16_f32 v32, v48, v49
    v_cvt_pk_bf16_f32 v33, v50, v51
    v_cvt_pk_bf16_f32 v34, v52, v53
    v_cvt_pk_bf16_f32 v35, v54, v55
    v_accvgpr_read_b32 v48, a40
    v_accvgpr_read_b32 v49, a41
    v_accvgpr_read_b32 v50, a42
    v_accvgpr_read_b32 v51, a43
    v_accvgpr_read_b32 v52, a44
    v_accvgpr_read_b32 v53, a45
    v_accvgpr_read_b32 v54, a46
    v_accvgpr_read_b32 v55, a47
    v_mul_f32 v48, v48, v96
    v_mul_f32 v49, v49, v96
    v_mul_f32 v50, v50, v96
    v_mul_f32 v51, v51, v96
    v_mul_f32 v52, v52, v96
    v_mul_f32 v53, v53, v96
    v_mul_f32 v54, v54, v96
    v_mul_f32 v55, v55, v96
    v_cvt_pk_bf16_f32 v36, v48, v49
    v_cvt_pk_bf16_f32 v37, v50, v51
    v_cvt_pk_bf16_f32 v38, v52, v53
    v_cvt_pk_bf16_f32 v39, v54, v55
    v_accvgpr_read_b32 v48, a48
    v_accvgpr_read_b32 v49, a49
    v_accvgpr_read_b32 v50, a50
    v_accvgpr_read_b32 v51, a51
    v_accvgpr_read_b32 v52, a52
    v_accvgpr_read_b32 v53, a53
    v_accvgpr_read_b32 v54, a54
    v_accvgpr_read_b32 v55, a55
    v_mul_f32 v48, v48, v96
    v_mul_f32 v49, v49, v96
    v_mul_f32 v50, v50, v96
    v_mul_f32 v51, v51, v96
    v_mul_f32 v52, v52, v96
    v_mul_f32 v53, v53, v96
    v_mul_f32 v54, v54, v96
    v_mul_f32 v55, v55, v96
    v_cvt_pk_bf16_f32 v40, v48, v49
    v_cvt_pk_bf16_f32 v41, v50, v51
    v_cvt_pk_bf16_f32 v42, v52, v53
    v_cvt_pk_bf16_f32 v43, v54, v55
    v_accvgpr_read_b32 v48, a56
    v_accvgpr_read_b32 v49, a57
    v_accvgpr_read_b32 v50, a58
    v_accvgpr_read_b32 v51, a59
    v_accvgpr_read_b32 v52, a60
    v_accvgpr_read_b32 v53, a61
    v_accvgpr_read_b32 v54, a62
    v_accvgpr_read_b32 v55, a63
    v_mul_f32 v48, v48, v96
    v_mul_f32 v49, v49, v96
    v_mul_f32 v50, v50, v96
    v_mul_f32 v51, v51, v96
    v_mul_f32 v52, v52, v96
    v_mul_f32 v53, v53, v96
    v_mul_f32 v54, v54, v96
    v_mul_f32 v55, v55, v96
    v_cvt_pk_bf16_f32 v44, v48, v49
    v_cvt_pk_bf16_f32 v45, v50, v51
    v_cvt_pk_bf16_f32 v46, v52, v53
    v_cvt_pk_bf16_f32 v47, v54, v55
    s_add_u32 s56, s66, 4096
    buffer_store_dwordx4 v[16:19], v93, s[28:31], s66 offen offset:0 sc1
    buffer_store_dwordx4 v[20:23], v93, s[28:31], s66 offen offset:1024 sc1
    buffer_store_dwordx4 v[24:27], v93, s[28:31], s66 offen offset:2048 sc1
    buffer_store_dwordx4 v[28:31], v93, s[28:31], s66 offen offset:3072 sc1
    buffer_store_dwordx4 v[32:35], v93, s[28:31], s56 offen offset:0 sc1
    buffer_store_dwordx4 v[36:39], v93, s[28:31], s56 offen offset:1024 sc1
    buffer_store_dwordx4 v[40:43], v93, s[28:31], s56 offen offset:2048 sc1
    buffer_store_dwordx4 v[44:47], v93, s[28:31], s56 offen offset:3072 sc1
    s_branch K3_start
ATT_B_end:
B_r0a:
    v_max3_f32 v96, v32, v33, v34
    v_max3_f32 v96, v96, v35, v36
    v_max3_f32 v96, v96, v37, v38
    v_max3_f32 v96, v96, v39, v40
    v_max3_f32 v96, v96, v41, v42
    v_max3_f32 v96, v96, v43, v44
    v_max3_f32 v96, v96, v45, v46
    v_max_f32 v96, v96, v47
    v_mov_b32 v98, v96
    s_nop 1
    v_permlane32_swap_b32 v96, v98
    v_max_f32 v96, v96, v98
    v_max_f32 v96, 0, v96
    v_exp_f32 v97, -v96
    v_sub_f32 v32, v32, v96
    v_sub_f32 v16, v16, v96
    v_sub_f32 v48, v48, v96
    v_sub_f32 v33, v33, v96
    v_sub_f32 v17, v17, v96
    v_sub_f32 v49, v49, v96
    v_sub_f32 v34, v34, v96
    v_sub_f32 v18, v18, v96
    v_sub_f32 v50, v50, v96
    v_sub_f32 v35, v35, v96
    v_sub_f32 v19, v19, v96
    v_sub_f32 v51, v51, v96
    v_sub_f32 v36, v36, v96
    v_sub_f32 v20, v20, v96
    v_sub_f32 v52, v52, v96
    v_sub_f32 v37, v37, v96
    v_sub_f32 v21, v21, v96
    v_sub_f32 v53, v53, v96
    v_sub_f32 v38, v38, v96
    v_sub_f32 v22, v22, v96
    v_sub_f32 v54, v54, v96
    v_sub_f32 v39, v39, v96
    v_sub_f32 v23, v23, v96
    v_sub_f32 v55, v55, v96
    v_sub_f32 v40, v40, v96
    v_sub_f32 v24, v24, v96
    v_sub_f32 v56, v56, v96
    v_sub_f32 v41, v41, v96
    v_sub_f32 v25, v25, v96
    v_sub_f32 v57, v57, v96
    v_sub_f32 v42, v42, v96
    v_sub_f32 v26, v26, v96
    v_sub_f32 v58, v58, v96
    v_sub_f32 v43, v43, v96
    v_sub_f32 v27, v27, v96
    v_sub_f32 v59, v59, v96
    v_sub_f32 v44, v44, v96
    v_sub_f32 v28, v28, v96
    v_sub_f32 v60, v60, v96
    v_sub_f32 v45, v45, v96
    v_sub_f32 v29, v29, v96
    v_sub_f32 v61, v61, v96
    v_sub_f32 v46, v46, v96
    v_sub_f32 v30, v30, v96
    v_sub_f32 v62, v62, v96
    v_sub_f32 v47, v47, v96
    v_sub_f32 v31, v31, v96
    v_sub_f32 v63, v63, v96
    v_mul_f32 v89, v89, v97
    v_accvgpr_read_b32 v80, a0
    v_mul_f32 v80, v80, v97
    v_accvgpr_write_b32 a0, v80
    v_accvgpr_read_b32 v81, a1
    v_mul_f32 v81, v81, v97
    v_accvgpr_write_b32 a1, v81
    v_accvgpr_read_b32 v82, a2
    v_mul_f32 v82, v82, v97
    v_accvgpr_write_b32 a2, v82
    v_accvgpr_read_b32 v83, a3
    v_mul_f32 v83, v83, v97
    v_accvgpr_write_b32 a3, v83
    v_accvgpr_read_b32 v80, a4
    v_mul_f32 v80, v80, v97
    v_accvgpr_write_b32 a4, v80
    v_accvgpr_read_b32 v81, a5
    v_mul_f32 v81, v81, v97
    v_accvgpr_write_b32 a5, v81
    v_accvgpr_read_b32 v82, a6
    v_mul_f32 v82, v82, v97
    v_accvgpr_write_b32 a6, v82
    v_accvgpr_read_b32 v83, a7
    v_mul_f32 v83, v83, v97
    v_accvgpr_write_b32 a7, v83
    v_accvgpr_read_b32 v80, a8
    v_mul_f32 v80, v80, v97
    v_accvgpr_write_b32 a8, v80
    v_accvgpr_read_b32 v81, a9
    v_mul_f32 v81, v81, v97
    v_accvgpr_write_b32 a9, v81
    v_accvgpr_read_b32 v82, a10
    v_mul_f32 v82, v82, v97
    v_accvgpr_write_b32 a10, v82
    v_accvgpr_read_b32 v83, a11
    v_mul_f32 v83, v83, v97
    v_accvgpr_write_b32 a11, v83
    v_accvgpr_read_b32 v80, a12
    v_mul_f32 v80, v80, v97
    v_accvgpr_write_b32 a12, v80
    v_accvgpr_read_b32 v81, a13
    v_mul_f32 v81, v81, v97
    v_accvgpr_write_b32 a13, v81
    v_accvgpr_read_b32 v82, a14
    v_mul_f32 v82, v82, v97
    v_accvgpr_write_b32 a14, v82
    v_accvgpr_read_b32 v83, a15
    v_mul_f32 v83, v83, v97
    v_accvgpr_write_b32 a15, v83
    v_accvgpr_read_b32 v80, a16
    v_mul_f32 v80, v80, v97
    v_accvgpr_write_b32 a16, v80
    v_accvgpr_read_b32 v81, a17
    v_mul_f32 v81, v81, v97
    v_accvgpr_write_b32 a17, v81
    v_accvgpr_read_b32 v82, a18
    v_mul_f32 v82, v82, v97
    v_accvgpr_write_b32 a18, v82
    v_accvgpr_read_b32 v83, a19
    v_mul_f32 v83, v83, v97
    v_accvgpr_write_b32 a19, v83
    v_accvgpr_read_b32 v80, a20
    v_mul_f32 v80, v80, v97
    v_accvgpr_write_b32 a20, v80
    v_accvgpr_read_b32 v81, a21
    v_mul_f32 v81, v81, v97
    v_accvgpr_write_b32 a21, v81
    v_accvgpr_read_b32 v82, a22
    v_mul_f32 v82, v82, v97
    v_accvgpr_write_b32 a22, v82
    v_accvgpr_read_b32 v83, a23
    v_mul_f32 v83, v83, v97
    v_accvgpr_write_b32 a23, v83
    v_accvgpr_read_b32 v80, a24
    v_mul_f32 v80, v80, v97
    v_accvgpr_write_b32 a24, v80
    v_accvgpr_read_b32 v81, a25
    v_mul_f32 v81, v81, v97
    v_accvgpr_write_b32 a25, v81
    v_accvgpr_read_b32 v82, a26
    v_mul_f32 v82, v82, v97
    v_accvgpr_write_b32 a26, v82
    v_accvgpr_read_b32 v83, a27
    v_mul_f32 v83, v83, v97
    v_accvgpr_write_b32 a27, v83
    v_accvgpr_read_b32 v80, a28
    v_mul_f32 v80, v80, v97
    v_accvgpr_write_b32 a28, v80
    v_accvgpr_read_b32 v81, a29
    v_mul_f32 v81, v81, v97
    v_accvgpr_write_b32 a29, v81
    v_accvgpr_read_b32 v82, a30
    v_mul_f32 v82, v82, v97
    v_accvgpr_write_b32 a30, v82
    v_accvgpr_read_b32 v83, a31
    v_mul_f32 v83, v83, v97
    v_accvgpr_write_b32 a31, v83
    v_accvgpr_read_b32 v80, a32
    v_mul_f32 v80, v80, v97
    v_accvgpr_write_b32 a32, v80
    v_accvgpr_read_b32 v81, a33
    v_mul_f32 v81, v81, v97
    v_accvgpr_write_b32 a33, v81
    v_accvgpr_read_b32 v82, a34
    v_mul_f32 v82, v82, v97
    v_accvgpr_write_b32 a34, v82
    v_accvgpr_read_b32 v83, a35
    v_mul_f32 v83, v83, v97
    v_accvgpr_write_b32 a35, v83
    v_accvgpr_read_b32 v80, a36
    v_mul_f32 v80, v80, v97
    v_accvgpr_write_b32 a36, v80
    v_accvgpr_read_b32 v81, a37
    v_mul_f32 v81, v81, v97
    v_accvgpr_write_b32 a37, v81
    v_accvgpr_read_b32 v82, a38
    v_mul_f32 v82, v82, v97
    v_accvgpr_write_b32 a38, v82
    v_accvgpr_read_b32 v83, a39
    v_mul_f32 v83, v83, v97
    v_accvgpr_write_b32 a39, v83
    v_accvgpr_read_b32 v80, a40
    v_mul_f32 v80, v80, v97
    v_accvgpr_write_b32 a40, v80
    v_accvgpr_read_b32 v81, a41
    v_mul_f32 v81, v81, v97
    v_accvgpr_write_b32 a41, v81
    v_accvgpr_read_b32 v82, a42
    v_mul_f32 v82, v82, v97
    v_accvgpr_write_b32 a42, v82
    v_accvgpr_read_b32 v83, a43
    v_mul_f32 v83, v83, v97
    v_accvgpr_write_b32 a43, v83
    v_accvgpr_read_b32 v80, a44
    v_mul_f32 v80, v80, v97
    v_accvgpr_write_b32 a44, v80
    v_accvgpr_read_b32 v81, a45
    v_mul_f32 v81, v81, v97
    v_accvgpr_write_b32 a45, v81
    v_accvgpr_read_b32 v82, a46
    v_mul_f32 v82, v82, v97
    v_accvgpr_write_b32 a46, v82
    v_accvgpr_read_b32 v83, a47
    v_mul_f32 v83, v83, v97
    v_accvgpr_write_b32 a47, v83
    v_accvgpr_read_b32 v80, a48
    v_mul_f32 v80, v80, v97
    v_accvgpr_write_b32 a48, v80
    v_accvgpr_read_b32 v81, a49
    v_mul_f32 v81, v81, v97
    v_accvgpr_write_b32 a49, v81
    v_accvgpr_read_b32 v82, a50
    v_mul_f32 v82, v82, v97
    v_accvgpr_write_b32 a50, v82
    v_accvgpr_read_b32 v83, a51
    v_mul_f32 v83, v83, v97
    v_accvgpr_write_b32 a51, v83
    v_accvgpr_read_b32 v80, a52
    v_mul_f32 v80, v80, v97
    v_accvgpr_write_b32 a52, v80
    v_accvgpr_read_b32 v81, a53
    v_mul_f32 v81, v81, v97
    v_accvgpr_write_b32 a53, v81
    v_accvgpr_read_b32 v82, a54
    v_mul_f32 v82, v82, v97
    v_accvgpr_write_b32 a54, v82
    v_accvgpr_read_b32 v83, a55
    v_mul_f32 v83, v83, v97
    v_accvgpr_write_b32 a55, v83
    v_accvgpr_read_b32 v80, a56
    v_mul_f32 v80, v80, v97
    v_accvgpr_write_b32 a56, v80
    v_accvgpr_read_b32 v81, a57
    v_mul_f32 v81, v81, v97
    v_accvgpr_write_b32 a57, v81
    v_accvgpr_read_b32 v82, a58
    v_mul_f32 v82, v82, v97
    v_accvgpr_write_b32 a58, v82
    v_accvgpr_read_b32 v83, a59
    v_mul_f32 v83, v83, v97
    v_accvgpr_write_b32 a59, v83
    v_accvgpr_read_b32 v80, a60
    v_mul_f32 v80, v80, v97
    v_accvgpr_write_b32 a60, v80
    v_accvgpr_read_b32 v81, a61
    v_mul_f32 v81, v81, v97
    v_accvgpr_write_b32 a61, v81
    v_accvgpr_read_b32 v82, a62
    v_mul_f32 v82, v82, v97
    v_accvgpr_write_b32 a62, v82
    v_accvgpr_read_b32 v83, a63
    v_mul_f32 v83, v83, v97
    v_accvgpr_write_b32 a63, v83
    v_exp_f32 v80, v32
    v_exp_f32 v81, v33
    s_nop 0
    v_add_f32 v88, v80, v81
    v_cvt_pk_bf16_f32 v72, v80, v81
    v_exp_f32 v80, v34
    v_exp_f32 v81, v35
    v_add_f32 v88, v88, v80
    v_add_f32 v88, v88, v81
    v_cvt_pk_bf16_f32 v73, v80, v81
    v_exp_f32 v80, v36
    v_exp_f32 v81, v37
    v_add_f32 v88, v88, v80
    v_add_f32 v88, v88, v81
    v_cvt_pk_bf16_f32 v74, v80, v81
    v_exp_f32 v80, v38
    v_exp_f32 v81, v39
    v_add_f32 v88, v88, v80
    v_add_f32 v88, v88, v81
    v_cvt_pk_bf16_f32 v75, v80, v81
    v_exp_f32 v80, v40
    v_exp_f32 v81, v41
    v_add_f32 v88, v88, v80
    v_add_f32 v88, v88, v81
    v_cvt_pk_bf16_f32 v76, v80, v81
    v_exp_f32 v80, v42
    v_exp_f32 v81, v43
    v_add_f32 v88, v88, v80
    v_add_f32 v88, v88, v81
    v_cvt_pk_bf16_f32 v77, v80, v81
    v_exp_f32 v80, v44
    v_exp_f32 v81, v45
    v_add_f32 v88, v88, v80
    v_add_f32 v88, v88, v81
    v_cvt_pk_bf16_f32 v78, v80, v81
    v_exp_f32 v80, v46
    v_exp_f32 v81, v47
    v_add_f32 v88, v88, v80
    v_add_f32 v88, v88, v81
    v_cvt_pk_bf16_f32 v79, v80, v81
    v_exp_f32 v80, v16
    v_exp_f32 v81, v17
    v_exp_f32 v82, v18
    s_branch B_r0a_ret
B_r0b:
    v_max3_f32 v96, v16, v17, v18
    v_max3_f32 v96, v96, v19, v20
    v_max3_f32 v96, v96, v21, v22
    v_max3_f32 v96, v96, v23, v24
    v_max3_f32 v96, v96, v25, v26
    v_max3_f32 v96, v96, v27, v28
    v_max3_f32 v96, v96, v29, v30
    v_max_f32 v96, v96, v31
    v_mov_b32 v98, v96
    s_nop 1
    v_permlane32_swap_b32 v96, v98
    v_max_f32 v96, v96, v98
    v_max_f32 v96, 0, v96
    v_exp_f32 v97, -v96
    v_sub_f32 v16, v16, v96
    v_sub_f32 v32, v32, v96
    v_sub_f32 v48, v48, v96
    v_sub_f32 v17, v17, v96
    v_sub_f32 v33, v33, v96
    v_sub_f32 v49, v49, v96
    v_sub_f32 v18, v18, v96
    v_sub_f32 v34, v34, v96
    v_sub_f32 v50, v50, v96
    v_sub_f32 v19, v19, v96
    v_sub_f32 v35, v35, v96
    v_sub_f32 v51, v51, v96
    v_sub_f32 v20, v20, v96
    v_sub_f32 v36, v36, v96
    v_sub_f32 v52, v52, v96
    v_sub_f32 v21, v21, v96
    v_sub_f32 v37, v37, v96
    v_sub_f32 v53, v53, v96
    v_sub_f32 v22, v22, v96
    v_sub_f32 v38, v38, v96
    v_sub_f32 v54, v54, v96
    v_sub_f32 v23, v23, v96
    v_sub_f32 v39, v39, v96
    v_sub_f32 v55, v55, v96
    v_sub_f32 v24, v24, v96
    v_sub_f32 v40, v40, v96
    v_sub_f32 v56, v56, v96
    v_sub_f32 v25, v25, v96
    v_sub_f32 v41, v41, v96
    v_sub_f32 v57, v57, v96
    v_sub_f32 v26, v26, v96
    v_sub_f32 v42, v42, v96
    v_sub_f32 v58, v58, v96
    v_sub_f32 v27, v27, v96
    v_sub_f32 v43, v43, v96
    v_sub_f32 v59, v59, v96
    v_sub_f32 v28, v28, v96
    v_sub_f32 v44, v44, v96
    v_sub_f32 v60, v60, v96
    v_sub_f32 v29, v29, v96
    v_sub_f32 v45, v45, v96
    v_sub_f32 v61, v61, v96
    v_sub_f32 v30, v30, v96
    v_sub_f32 v46, v46, v96
    v_sub_f32 v62, v62, v96
    v_sub_f32 v31, v31, v96
    v_sub_f32 v47, v47, v96
    v_sub_f32 v63, v63, v96
    v_mul_f32 v89, v89, v97
    v_accvgpr_read_b32 v80, a0
    v_mul_f32 v80, v80, v97
    v_accvgpr_write_b32 a0, v80
    v_accvgpr_read_b32 v81, a1
    v_mul_f32 v81, v81, v97
    v_accvgpr_write_b32 a1, v81
    v_accvgpr_read_b32 v82, a2
    v_mul_f32 v82, v82, v97
    v_accvgpr_write_b32 a2, v82
    v_accvgpr_read_b32 v83, a3
    v_mul_f32 v83, v83, v97
    v_accvgpr_write_b32 a3, v83
    v_accvgpr_read_b32 v80, a4
    v_mul_f32 v80, v80, v97
    v_accvgpr_write_b32 a4, v80
    v_accvgpr_read_b32 v81, a5
    v_mul_f32 v81, v81, v97
    v_accvgpr_write_b32 a5, v81
    v_accvgpr_read_b32 v82, a6
    v_mul_f32 v82, v82, v97
    v_accvgpr_write_b32 a6, v82
    v_accvgpr_read_b32 v83, a7
    v_mul_f32 v83, v83, v97
    v_accvgpr_write_b32 a7, v83
    v_accvgpr_read_b32 v80, a8
    v_mul_f32 v80, v80, v97
    v_accvgpr_write_b32 a8, v80
    v_accvgpr_read_b32 v81, a9
    v_mul_f32 v81, v81, v97
    v_accvgpr_write_b32 a9, v81
    v_accvgpr_read_b32 v82, a10
    v_mul_f32 v82, v82, v97
    v_accvgpr_write_b32 a10, v82
    v_accvgpr_read_b32 v83, a11
    v_mul_f32 v83, v83, v97
    v_accvgpr_write_b32 a11, v83
    v_accvgpr_read_b32 v80, a12
    v_mul_f32 v80, v80, v97
    v_accvgpr_write_b32 a12, v80
    v_accvgpr_read_b32 v81, a13
    v_mul_f32 v81, v81, v97
    v_accvgpr_write_b32 a13, v81
    v_accvgpr_read_b32 v82, a14
    v_mul_f32 v82, v82, v97
    v_accvgpr_write_b32 a14, v82
    v_accvgpr_read_b32 v83, a15
    v_mul_f32 v83, v83, v97
    v_accvgpr_write_b32 a15, v83
    v_accvgpr_read_b32 v80, a16
    v_mul_f32 v80, v80, v97
    v_accvgpr_write_b32 a16, v80
    v_accvgpr_read_b32 v81, a17
    v_mul_f32 v81, v81, v97
    v_accvgpr_write_b32 a17, v81
    v_accvgpr_read_b32 v82, a18
    v_mul_f32 v82, v82, v97
    v_accvgpr_write_b32 a18, v82
    v_accvgpr_read_b32 v83, a19
    v_mul_f32 v83, v83, v97
    v_accvgpr_write_b32 a19, v83
    v_accvgpr_read_b32 v80, a20
    v_mul_f32 v80, v80, v97
    v_accvgpr_write_b32 a20, v80
    v_accvgpr_read_b32 v81, a21
    v_mul_f32 v81, v81, v97
    v_accvgpr_write_b32 a21, v81
    v_accvgpr_read_b32 v82, a22
    v_mul_f32 v82, v82, v97
    v_accvgpr_write_b32 a22, v82
    v_accvgpr_read_b32 v83, a23
    v_mul_f32 v83, v83, v97
    v_accvgpr_write_b32 a23, v83
    v_accvgpr_read_b32 v80, a24
    v_mul_f32 v80, v80, v97
    v_accvgpr_write_b32 a24, v80
    v_accvgpr_read_b32 v81, a25
    v_mul_f32 v81, v81, v97
    v_accvgpr_write_b32 a25, v81
    v_accvgpr_read_b32 v82, a26
    v_mul_f32 v82, v82, v97
    v_accvgpr_write_b32 a26, v82
    v_accvgpr_read_b32 v83, a27
    v_mul_f32 v83, v83, v97
    v_accvgpr_write_b32 a27, v83
    v_accvgpr_read_b32 v80, a28
    v_mul_f32 v80, v80, v97
    v_accvgpr_write_b32 a28, v80
    v_accvgpr_read_b32 v81, a29
    v_mul_f32 v81, v81, v97
    v_accvgpr_write_b32 a29, v81
    v_accvgpr_read_b32 v82, a30
    v_mul_f32 v82, v82, v97
    v_accvgpr_write_b32 a30, v82
    v_accvgpr_read_b32 v83, a31
    v_mul_f32 v83, v83, v97
    v_accvgpr_write_b32 a31, v83
    v_accvgpr_read_b32 v80, a32
    v_mul_f32 v80, v80, v97
    v_accvgpr_write_b32 a32, v80
    v_accvgpr_read_b32 v81, a33
    v_mul_f32 v81, v81, v97
    v_accvgpr_write_b32 a33, v81
    v_accvgpr_read_b32 v82, a34
    v_mul_f32 v82, v82, v97
    v_accvgpr_write_b32 a34, v82
    v_accvgpr_read_b32 v83, a35
    v_mul_f32 v83, v83, v97
    v_accvgpr_write_b32 a35, v83
    v_accvgpr_read_b32 v80, a36
    v_mul_f32 v80, v80, v97
    v_accvgpr_write_b32 a36, v80
    v_accvgpr_read_b32 v81, a37
    v_mul_f32 v81, v81, v97
    v_accvgpr_write_b32 a37, v81
    v_accvgpr_read_b32 v82, a38
    v_mul_f32 v82, v82, v97
    v_accvgpr_write_b32 a38, v82
    v_accvgpr_read_b32 v83, a39
    v_mul_f32 v83, v83, v97
    v_accvgpr_write_b32 a39, v83
    v_accvgpr_read_b32 v80, a40
    v_mul_f32 v80, v80, v97
    v_accvgpr_write_b32 a40, v80
    v_accvgpr_read_b32 v81, a41
    v_mul_f32 v81, v81, v97
    v_accvgpr_write_b32 a41, v81
    v_accvgpr_read_b32 v82, a42
    v_mul_f32 v82, v82, v97
    v_accvgpr_write_b32 a42, v82
    v_accvgpr_read_b32 v83, a43
    v_mul_f32 v83, v83, v97
    v_accvgpr_write_b32 a43, v83
    v_accvgpr_read_b32 v80, a44
    v_mul_f32 v80, v80, v97
    v_accvgpr_write_b32 a44, v80
    v_accvgpr_read_b32 v81, a45
    v_mul_f32 v81, v81, v97
    v_accvgpr_write_b32 a45, v81
    v_accvgpr_read_b32 v82, a46
    v_mul_f32 v82, v82, v97
    v_accvgpr_write_b32 a46, v82
    v_accvgpr_read_b32 v83, a47
    v_mul_f32 v83, v83, v97
    v_accvgpr_write_b32 a47, v83
    v_accvgpr_read_b32 v80, a48
    v_mul_f32 v80, v80, v97
    v_accvgpr_write_b32 a48, v80
    v_accvgpr_read_b32 v81, a49
    v_mul_f32 v81, v81, v97
    v_accvgpr_write_b32 a49, v81
    v_accvgpr_read_b32 v82, a50
    v_mul_f32 v82, v82, v97
    v_accvgpr_write_b32 a50, v82
    v_accvgpr_read_b32 v83, a51
    v_mul_f32 v83, v83, v97
    v_accvgpr_write_b32 a51, v83
    v_accvgpr_read_b32 v80, a52
    v_mul_f32 v80, v80, v97
    v_accvgpr_write_b32 a52, v80
    v_accvgpr_read_b32 v81, a53
    v_mul_f32 v81, v81, v97
    v_accvgpr_write_b32 a53, v81
    v_accvgpr_read_b32 v82, a54
    v_mul_f32 v82, v82, v97
    v_accvgpr_write_b32 a54, v82
    v_accvgpr_read_b32 v83, a55
    v_mul_f32 v83, v83, v97
    v_accvgpr_write_b32 a55, v83
    v_accvgpr_read_b32 v80, a56
    v_mul_f32 v80, v80, v97
    v_accvgpr_write_b32 a56, v80
    v_accvgpr_read_b32 v81, a57
    v_mul_f32 v81, v81, v97
    v_accvgpr_write_b32 a57, v81
    v_accvgpr_read_b32 v82, a58
    v_mul_f32 v82, v82, v97
    v_accvgpr_write_b32 a58, v82
    v_accvgpr_read_b32 v83, a59
    v_mul_f32 v83, v83, v97
    v_accvgpr_write_b32 a59, v83
    v_accvgpr_read_b32 v80, a60
    v_mul_f32 v80, v80, v97
    v_accvgpr_write_b32 a60, v80
    v_accvgpr_read_b32 v81, a61
    v_mul_f32 v81, v81, v97
    v_accvgpr_write_b32 a61, v81
    v_accvgpr_read_b32 v82, a62
    v_mul_f32 v82, v82, v97
    v_accvgpr_write_b32 a62, v82
    v_accvgpr_read_b32 v83, a63
    v_mul_f32 v83, v83, v97
    v_accvgpr_write_b32 a63, v83
    v_exp_f32 v80, v16
    v_exp_f32 v81, v17
    s_nop 0
    v_add_f32 v88, v80, v81
    v_cvt_pk_bf16_f32 v64, v80, v81
    v_exp_f32 v80, v18
    v_exp_f32 v81, v19
    v_add_f32 v88, v88, v80
    v_add_f32 v88, v88, v81
    v_cvt_pk_bf16_f32 v65, v80, v81
    v_exp_f32 v80, v20
    v_exp_f32 v81, v21
    v_add_f32 v88, v88, v80
    v_add_f32 v88, v88, v81
    v_cvt_pk_bf16_f32 v66, v80, v81
    v_exp_f32 v80, v22
    v_exp_f32 v81, v23
    v_add_f32 v88, v88, v80
    v_add_f32 v88, v88, v81
    v_cvt_pk_bf16_f32 v67, v80, v81
    v_exp_f32 v80, v24
    v_exp_f32 v81, v25
    v_add_f32 v88, v88, v80
    v_add_f32 v88, v88, v81
    v_cvt_pk_bf16_f32 v68, v80, v81
    v_exp_f32 v80, v26
    v_exp_f32 v81, v27
    v_add_f32 v88, v88, v80
    v_add_f32 v88, v88, v81
    v_cvt_pk_bf16_f32 v69, v80, v81
    v_exp_f32 v80, v28
    v_exp_f32 v81, v29
    v_add_f32 v88, v88, v80
    v_add_f32 v88, v88, v81
    v_cvt_pk_bf16_f32 v70, v80, v81
    v_exp_f32 v80, v30
    v_exp_f32 v81, v31
    v_add_f32 v88, v88, v80
    v_add_f32 v88, v88, v81
    v_cvt_pk_bf16_f32 v71, v80, v81
    v_exp_f32 v80, v32
    v_exp_f32 v81, v33
    v_exp_f32 v82, v34
    s_branch B_r0b_ret
B_r1a:
    v_max3_f32 v96, v32, v33, v34
    v_max3_f32 v96, v96, v35, v36
    v_max3_f32 v96, v96, v37, v38
    v_max3_f32 v96, v96, v39, v40
    v_max3_f32 v96, v96, v41, v42
    v_max3_f32 v96, v96, v43, v44
    v_max3_f32 v96, v96, v45, v46
    v_max_f32 v96, v96, v47
    v_mov_b32 v98, v96
    s_nop 1
    v_permlane32_swap_b32 v96, v98
    v_max_f32 v96, v96, v98
    v_max_f32 v96, 0, v96
    v_exp_f32 v97, -v96
    v_sub_f32 v32, v32, v96
    v_sub_f32 v16, v16, v96
    v_sub_f32 v48, v48, v96
    v_sub_f32 v33, v33, v96
    v_sub_f32 v17, v17, v96
    v_sub_f32 v49, v49, v96
    v_sub_f32 v34, v34, v96
    v_sub_f32 v18, v18, v96
    v_sub_f32 v50, v50, v96
    v_sub_f32 v35, v35, v96
    v_sub_f32 v19, v19, v96
    v_sub_f32 v51, v51, v96
    v_sub_f32 v36, v36, v96
    v_sub_f32 v20, v20, v96
    v_sub_f32 v52, v52, v96
    v_sub_f32 v37, v37, v96
    v_sub_f32 v21, v21, v96
    v_sub_f32 v53, v53, v96
    v_sub_f32 v38, v38, v96
    v_sub_f32 v22, v22, v96
    v_sub_f32 v54, v54, v96
    v_sub_f32 v39, v39, v96
    v_sub_f32 v23, v23, v96
    v_sub_f32 v55, v55, v96
    v_sub_f32 v40, v40, v96
    v_sub_f32 v24, v24, v96
    v_sub_f32 v56, v56, v96
    v_sub_f32 v41, v41, v96
    v_sub_f32 v25, v25, v96
    v_sub_f32 v57, v57, v96
    v_sub_f32 v42, v42, v96
    v_sub_f32 v26, v26, v96
    v_sub_f32 v58, v58, v96
    v_sub_f32 v43, v43, v96
    v_sub_f32 v27, v27, v96
    v_sub_f32 v59, v59, v96
    v_sub_f32 v44, v44, v96
    v_sub_f32 v28, v28, v96
    v_sub_f32 v60, v60, v96
    v_sub_f32 v45, v45, v96
    v_sub_f32 v29, v29, v96
    v_sub_f32 v61, v61, v96
    v_sub_f32 v46, v46, v96
    v_sub_f32 v30, v30, v96
    v_sub_f32 v62, v62, v96
    v_sub_f32 v47, v47, v96
    v_sub_f32 v31, v31, v96
    v_sub_f32 v63, v63, v96
    v_mul_f32 v89, v89, v97
    v_accvgpr_read_b32 v80, a0
    v_mul_f32 v80, v80, v97
    v_accvgpr_write_b32 a0, v80
    v_accvgpr_read_b32 v81, a1
    v_mul_f32 v81, v81, v97
    v_accvgpr_write_b32 a1, v81
    v_accvgpr_read_b32 v82, a2
    v_mul_f32 v82, v82, v97
    v_accvgpr_write_b32 a2, v82
    v_accvgpr_read_b32 v83, a3
    v_mul_f32 v83, v83, v97
    v_accvgpr_write_b32 a3, v83
    v_accvgpr_read_b32 v80, a4
    v_mul_f32 v80, v80, v97
    v_accvgpr_write_b32 a4, v80
    v_accvgpr_read_b32 v81, a5
    v_mul_f32 v81, v81, v97
    v_accvgpr_write_b32 a5, v81
    v_accvgpr_read_b32 v82, a6
    v_mul_f32 v82, v82, v97
    v_accvgpr_write_b32 a6, v82
    v_accvgpr_read_b32 v83, a7
    v_mul_f32 v83, v83, v97
    v_accvgpr_write_b32 a7, v83
    v_accvgpr_read_b32 v80, a8
    v_mul_f32 v80, v80, v97
    v_accvgpr_write_b32 a8, v80
    v_accvgpr_read_b32 v81, a9
    v_mul_f32 v81, v81, v97
    v_accvgpr_write_b32 a9, v81
    v_accvgpr_read_b32 v82, a10
    v_mul_f32 v82, v82, v97
    v_accvgpr_write_b32 a10, v82
    v_accvgpr_read_b32 v83, a11
    v_mul_f32 v83, v83, v97
    v_accvgpr_write_b32 a11, v83
    v_accvgpr_read_b32 v80, a12
    v_mul_f32 v80, v80, v97
    v_accvgpr_write_b32 a12, v80
    v_accvgpr_read_b32 v81, a13
    v_mul_f32 v81, v81, v97
    v_accvgpr_write_b32 a13, v81
    v_accvgpr_read_b32 v82, a14
    v_mul_f32 v82, v82, v97
    v_accvgpr_write_b32 a14, v82
    v_accvgpr_read_b32 v83, a15
    v_mul_f32 v83, v83, v97
    v_accvgpr_write_b32 a15, v83
    v_accvgpr_read_b32 v80, a16
    v_mul_f32 v80, v80, v97
    v_accvgpr_write_b32 a16, v80
    v_accvgpr_read_b32 v81, a17
    v_mul_f32 v81, v81, v97
    v_accvgpr_write_b32 a17, v81
    v_accvgpr_read_b32 v82, a18
    v_mul_f32 v82, v82, v97
    v_accvgpr_write_b32 a18, v82
    v_accvgpr_read_b32 v83, a19
    v_mul_f32 v83, v83, v97
    v_accvgpr_write_b32 a19, v83
    v_accvgpr_read_b32 v80, a20
    v_mul_f32 v80, v80, v97
    v_accvgpr_write_b32 a20, v80
    v_accvgpr_read_b32 v81, a21
    v_mul_f32 v81, v81, v97
    v_accvgpr_write_b32 a21, v81
    v_accvgpr_read_b32 v82, a22
    v_mul_f32 v82, v82, v97
    v_accvgpr_write_b32 a22, v82
    v_accvgpr_read_b32 v83, a23
    v_mul_f32 v83, v83, v97
    v_accvgpr_write_b32 a23, v83
    v_accvgpr_read_b32 v80, a24
    v_mul_f32 v80, v80, v97
    v_accvgpr_write_b32 a24, v80
    v_accvgpr_read_b32 v81, a25
    v_mul_f32 v81, v81, v97
    v_accvgpr_write_b32 a25, v81
    v_accvgpr_read_b32 v82, a26
    v_mul_f32 v82, v82, v97
    v_accvgpr_write_b32 a26, v82
    v_accvgpr_read_b32 v83, a27
    v_mul_f32 v83, v83, v97
    v_accvgpr_write_b32 a27, v83
    v_accvgpr_read_b32 v80, a28
    v_mul_f32 v80, v80, v97
    v_accvgpr_write_b32 a28, v80
    v_accvgpr_read_b32 v81, a29
    v_mul_f32 v81, v81, v97
    v_accvgpr_write_b32 a29, v81
    v_accvgpr_read_b32 v82, a30
    v_mul_f32 v82, v82, v97
    v_accvgpr_write_b32 a30, v82
    v_accvgpr_read_b32 v83, a31
    v_mul_f32 v83, v83, v97
    v_accvgpr_write_b32 a31, v83
    v_accvgpr_read_b32 v80, a32
    v_mul_f32 v80, v80, v97
    v_accvgpr_write_b32 a32, v80
    v_accvgpr_read_b32 v81, a33
    v_mul_f32 v81, v81, v97
    v_accvgpr_write_b32 a33, v81
    v_accvgpr_read_b32 v82, a34
    v_mul_f32 v82, v82, v97
    v_accvgpr_write_b32 a34, v82
    v_accvgpr_read_b32 v83, a35
    v_mul_f32 v83, v83, v97
    v_accvgpr_write_b32 a35, v83
    v_accvgpr_read_b32 v80, a36
    v_mul_f32 v80, v80, v97
    v_accvgpr_write_b32 a36, v80
    v_accvgpr_read_b32 v81, a37
    v_mul_f32 v81, v81, v97
    v_accvgpr_write_b32 a37, v81
    v_accvgpr_read_b32 v82, a38
    v_mul_f32 v82, v82, v97
    v_accvgpr_write_b32 a38, v82
    v_accvgpr_read_b32 v83, a39
    v_mul_f32 v83, v83, v97
    v_accvgpr_write_b32 a39, v83
    v_accvgpr_read_b32 v80, a40
    v_mul_f32 v80, v80, v97
    v_accvgpr_write_b32 a40, v80
    v_accvgpr_read_b32 v81, a41
    v_mul_f32 v81, v81, v97
    v_accvgpr_write_b32 a41, v81
    v_accvgpr_read_b32 v82, a42
    v_mul_f32 v82, v82, v97
    v_accvgpr_write_b32 a42, v82
    v_accvgpr_read_b32 v83, a43
    v_mul_f32 v83, v83, v97
    v_accvgpr_write_b32 a43, v83
    v_accvgpr_read_b32 v80, a44
    v_mul_f32 v80, v80, v97
    v_accvgpr_write_b32 a44, v80
    v_accvgpr_read_b32 v81, a45
    v_mul_f32 v81, v81, v97
    v_accvgpr_write_b32 a45, v81
    v_accvgpr_read_b32 v82, a46
    v_mul_f32 v82, v82, v97
    v_accvgpr_write_b32 a46, v82
    v_accvgpr_read_b32 v83, a47
    v_mul_f32 v83, v83, v97
    v_accvgpr_write_b32 a47, v83
    v_accvgpr_read_b32 v80, a48
    v_mul_f32 v80, v80, v97
    v_accvgpr_write_b32 a48, v80
    v_accvgpr_read_b32 v81, a49
    v_mul_f32 v81, v81, v97
    v_accvgpr_write_b32 a49, v81
    v_accvgpr_read_b32 v82, a50
    v_mul_f32 v82, v82, v97
    v_accvgpr_write_b32 a50, v82
    v_accvgpr_read_b32 v83, a51
    v_mul_f32 v83, v83, v97
    v_accvgpr_write_b32 a51, v83
    v_accvgpr_read_b32 v80, a52
    v_mul_f32 v80, v80, v97
    v_accvgpr_write_b32 a52, v80
    v_accvgpr_read_b32 v81, a53
    v_mul_f32 v81, v81, v97
    v_accvgpr_write_b32 a53, v81
    v_accvgpr_read_b32 v82, a54
    v_mul_f32 v82, v82, v97
    v_accvgpr_write_b32 a54, v82
    v_accvgpr_read_b32 v83, a55
    v_mul_f32 v83, v83, v97
    v_accvgpr_write_b32 a55, v83
    v_accvgpr_read_b32 v80, a56
    v_mul_f32 v80, v80, v97
    v_accvgpr_write_b32 a56, v80
    v_accvgpr_read_b32 v81, a57
    v_mul_f32 v81, v81, v97
    v_accvgpr_write_b32 a57, v81
    v_accvgpr_read_b32 v82, a58
    v_mul_f32 v82, v82, v97
    v_accvgpr_write_b32 a58, v82
    v_accvgpr_read_b32 v83, a59
    v_mul_f32 v83, v83, v97
    v_accvgpr_write_b32 a59, v83
    v_accvgpr_read_b32 v80, a60
    v_mul_f32 v80, v80, v97
    v_accvgpr_write_b32 a60, v80
    v_accvgpr_read_b32 v81, a61
    v_mul_f32 v81, v81, v97
    v_accvgpr_write_b32 a61, v81
    v_accvgpr_read_b32 v82, a62
    v_mul_f32 v82, v82, v97
    v_accvgpr_write_b32 a62, v82
    v_accvgpr_read_b32 v83, a63
    v_mul_f32 v83, v83, v97
    v_accvgpr_write_b32 a63, v83
    v_exp_f32 v80, v32
    v_exp_f32 v81, v33
    s_nop 0
    v_add_f32 v88, v80, v81
    v_cvt_pk_bf16_f32 v72, v80, v81
    v_exp_f32 v80, v34
    v_exp_f32 v81, v35
    v_add_f32 v88, v88, v80
    v_add_f32 v88, v88, v81
    v_cvt_pk_bf16_f32 v73, v80, v81
    v_exp_f32 v80, v36
    v_exp_f32 v81, v37
    v_add_f32 v88, v88, v80
    v_add_f32 v88, v88, v81
    v_cvt_pk_bf16_f32 v74, v80, v81
    v_exp_f32 v80, v38
    v_exp_f32 v81, v39
    v_add_f32 v88, v88, v80
    v_add_f32 v88, v88, v81
    v_cvt_pk_bf16_f32 v75, v80, v81
    v_exp_f32 v80, v40
    v_exp_f32 v81, v41
    v_add_f32 v88, v88, v80
    v_add_f32 v88, v88, v81
    v_cvt_pk_bf16_f32 v76, v80, v81
    v_exp_f32 v80, v42
    v_exp_f32 v81, v43
    v_add_f32 v88, v88, v80
    v_add_f32 v88, v88, v81
    v_cvt_pk_bf16_f32 v77, v80, v81
    v_exp_f32 v80, v44
    v_exp_f32 v81, v45
    v_add_f32 v88, v88, v80
    v_add_f32 v88, v88, v81
    v_cvt_pk_bf16_f32 v78, v80, v81
    v_exp_f32 v80, v46
    v_exp_f32 v81, v47
    v_add_f32 v88, v88, v80
    v_add_f32 v88, v88, v81
    v_cvt_pk_bf16_f32 v79, v80, v81
    v_exp_f32 v80, v16
    v_exp_f32 v81, v17
    v_exp_f32 v82, v18
    s_branch B_r1a_ret
B_r1b:
    v_max3_f32 v96, v16, v17, v18
    v_max3_f32 v96, v96, v19, v20
    v_max3_f32 v96, v96, v21, v22
    v_max3_f32 v96, v96, v23, v24
    v_max3_f32 v96, v96, v25, v26
    v_max3_f32 v96, v96, v27, v28
    v_max3_f32 v96, v96, v29, v30
    v_max_f32 v96, v96, v31
    v_mov_b32 v98, v96
    s_nop 1
    v_permlane32_swap_b32 v96, v98
    v_max_f32 v96, v96, v98
    v_max_f32 v96, 0, v96
    v_exp_f32 v97, -v96
    v_sub_f32 v16, v16, v96
    v_sub_f32 v32, v32, v96
    v_sub_f32 v48, v48, v96
    v_sub_f32 v17, v17, v96
    v_sub_f32 v33, v33, v96
    v_sub_f32 v49, v49, v96
    v_sub_f32 v18, v18, v96
    v_sub_f32 v34, v34, v96
    v_sub_f32 v50, v50, v96
    v_sub_f32 v19, v19, v96
    v_sub_f32 v35, v35, v96
    v_sub_f32 v51, v51, v96
    v_sub_f32 v20, v20, v96
    v_sub_f32 v36, v36, v96
    v_sub_f32 v52, v52, v96
    v_sub_f32 v21, v21, v96
    v_sub_f32 v37, v37, v96
    v_sub_f32 v53, v53, v96
    v_sub_f32 v22, v22, v96
    v_sub_f32 v38, v38, v96
    v_sub_f32 v54, v54, v96
    v_sub_f32 v23, v23, v96
    v_sub_f32 v39, v39, v96
    v_sub_f32 v55, v55, v96
    v_sub_f32 v24, v24, v96
    v_sub_f32 v40, v40, v96
    v_sub_f32 v56, v56, v96
    v_sub_f32 v25, v25, v96
    v_sub_f32 v41, v41, v96
    v_sub_f32 v57, v57, v96
    v_sub_f32 v26, v26, v96
    v_sub_f32 v42, v42, v96
    v_sub_f32 v58, v58, v96
    v_sub_f32 v27, v27, v96
    v_sub_f32 v43, v43, v96
    v_sub_f32 v59, v59, v96
    v_sub_f32 v28, v28, v96
    v_sub_f32 v44, v44, v96
    v_sub_f32 v60, v60, v96
    v_sub_f32 v29, v29, v96
    v_sub_f32 v45, v45, v96
    v_sub_f32 v61, v61, v96
    v_sub_f32 v30, v30, v96
    v_sub_f32 v46, v46, v96
    v_sub_f32 v62, v62, v96
    v_sub_f32 v31, v31, v96
    v_sub_f32 v47, v47, v96
    v_sub_f32 v63, v63, v96
    v_mul_f32 v89, v89, v97
    v_accvgpr_read_b32 v80, a0
    v_mul_f32 v80, v80, v97
    v_accvgpr_write_b32 a0, v80
    v_accvgpr_read_b32 v81, a1
    v_mul_f32 v81, v81, v97
    v_accvgpr_write_b32 a1, v81
    v_accvgpr_read_b32 v82, a2
    v_mul_f32 v82, v82, v97
    v_accvgpr_write_b32 a2, v82
    v_accvgpr_read_b32 v83, a3
    v_mul_f32 v83, v83, v97
    v_accvgpr_write_b32 a3, v83
    v_accvgpr_read_b32 v80, a4
    v_mul_f32 v80, v80, v97
    v_accvgpr_write_b32 a4, v80
    v_accvgpr_read_b32 v81, a5
    v_mul_f32 v81, v81, v97
    v_accvgpr_write_b32 a5, v81
    v_accvgpr_read_b32 v82, a6
    v_mul_f32 v82, v82, v97
    v_accvgpr_write_b32 a6, v82
    v_accvgpr_read_b32 v83, a7
    v_mul_f32 v83, v83, v97
    v_accvgpr_write_b32 a7, v83
    v_accvgpr_read_b32 v80, a8
    v_mul_f32 v80, v80, v97
    v_accvgpr_write_b32 a8, v80
    v_accvgpr_read_b32 v81, a9
    v_mul_f32 v81, v81, v97
    v_accvgpr_write_b32 a9, v81
    v_accvgpr_read_b32 v82, a10
    v_mul_f32 v82, v82, v97
    v_accvgpr_write_b32 a10, v82
    v_accvgpr_read_b32 v83, a11
    v_mul_f32 v83, v83, v97
    v_accvgpr_write_b32 a11, v83
    v_accvgpr_read_b32 v80, a12
    v_mul_f32 v80, v80, v97
    v_accvgpr_write_b32 a12, v80
    v_accvgpr_read_b32 v81, a13
    v_mul_f32 v81, v81, v97
    v_accvgpr_write_b32 a13, v81
    v_accvgpr_read_b32 v82, a14
    v_mul_f32 v82, v82, v97
    v_accvgpr_write_b32 a14, v82
    v_accvgpr_read_b32 v83, a15
    v_mul_f32 v83, v83, v97
    v_accvgpr_write_b32 a15, v83
    v_accvgpr_read_b32 v80, a16
    v_mul_f32 v80, v80, v97
    v_accvgpr_write_b32 a16, v80
    v_accvgpr_read_b32 v81, a17
    v_mul_f32 v81, v81, v97
    v_accvgpr_write_b32 a17, v81
    v_accvgpr_read_b32 v82, a18
    v_mul_f32 v82, v82, v97
    v_accvgpr_write_b32 a18, v82
    v_accvgpr_read_b32 v83, a19
    v_mul_f32 v83, v83, v97
    v_accvgpr_write_b32 a19, v83
    v_accvgpr_read_b32 v80, a20
    v_mul_f32 v80, v80, v97
    v_accvgpr_write_b32 a20, v80
    v_accvgpr_read_b32 v81, a21
    v_mul_f32 v81, v81, v97
    v_accvgpr_write_b32 a21, v81
    v_accvgpr_read_b32 v82, a22
    v_mul_f32 v82, v82, v97
    v_accvgpr_write_b32 a22, v82
    v_accvgpr_read_b32 v83, a23
    v_mul_f32 v83, v83, v97
    v_accvgpr_write_b32 a23, v83
    v_accvgpr_read_b32 v80, a24
    v_mul_f32 v80, v80, v97
    v_accvgpr_write_b32 a24, v80
    v_accvgpr_read_b32 v81, a25
    v_mul_f32 v81, v81, v97
    v_accvgpr_write_b32 a25, v81
    v_accvgpr_read_b32 v82, a26
    v_mul_f32 v82, v82, v97
    v_accvgpr_write_b32 a26, v82
    v_accvgpr_read_b32 v83, a27
    v_mul_f32 v83, v83, v97
    v_accvgpr_write_b32 a27, v83
    v_accvgpr_read_b32 v80, a28
    v_mul_f32 v80, v80, v97
    v_accvgpr_write_b32 a28, v80
    v_accvgpr_read_b32 v81, a29
    v_mul_f32 v81, v81, v97
    v_accvgpr_write_b32 a29, v81
    v_accvgpr_read_b32 v82, a30
    v_mul_f32 v82, v82, v97
    v_accvgpr_write_b32 a30, v82
    v_accvgpr_read_b32 v83, a31
    v_mul_f32 v83, v83, v97
    v_accvgpr_write_b32 a31, v83
    v_accvgpr_read_b32 v80, a32
    v_mul_f32 v80, v80, v97
    v_accvgpr_write_b32 a32, v80
    v_accvgpr_read_b32 v81, a33
    v_mul_f32 v81, v81, v97
    v_accvgpr_write_b32 a33, v81
    v_accvgpr_read_b32 v82, a34
    v_mul_f32 v82, v82, v97
    v_accvgpr_write_b32 a34, v82
    v_accvgpr_read_b32 v83, a35
    v_mul_f32 v83, v83, v97
    v_accvgpr_write_b32 a35, v83
    v_accvgpr_read_b32 v80, a36
    v_mul_f32 v80, v80, v97
    v_accvgpr_write_b32 a36, v80
    v_accvgpr_read_b32 v81, a37
    v_mul_f32 v81, v81, v97
    v_accvgpr_write_b32 a37, v81
    v_accvgpr_read_b32 v82, a38
    v_mul_f32 v82, v82, v97
    v_accvgpr_write_b32 a38, v82
    v_accvgpr_read_b32 v83, a39
    v_mul_f32 v83, v83, v97
    v_accvgpr_write_b32 a39, v83
    v_accvgpr_read_b32 v80, a40
    v_mul_f32 v80, v80, v97
    v_accvgpr_write_b32 a40, v80
    v_accvgpr_read_b32 v81, a41
    v_mul_f32 v81, v81, v97
    v_accvgpr_write_b32 a41, v81
    v_accvgpr_read_b32 v82, a42
    v_mul_f32 v82, v82, v97
    v_accvgpr_write_b32 a42, v82
    v_accvgpr_read_b32 v83, a43
    v_mul_f32 v83, v83, v97
    v_accvgpr_write_b32 a43, v83
    v_accvgpr_read_b32 v80, a44
    v_mul_f32 v80, v80, v97
    v_accvgpr_write_b32 a44, v80
    v_accvgpr_read_b32 v81, a45
    v_mul_f32 v81, v81, v97
    v_accvgpr_write_b32 a45, v81
    v_accvgpr_read_b32 v82, a46
    v_mul_f32 v82, v82, v97
    v_accvgpr_write_b32 a46, v82
    v_accvgpr_read_b32 v83, a47
    v_mul_f32 v83, v83, v97
    v_accvgpr_write_b32 a47, v83
    v_accvgpr_read_b32 v80, a48
    v_mul_f32 v80, v80, v97
    v_accvgpr_write_b32 a48, v80
    v_accvgpr_read_b32 v81, a49
    v_mul_f32 v81, v81, v97
    v_accvgpr_write_b32 a49, v81
    v_accvgpr_read_b32 v82, a50
    v_mul_f32 v82, v82, v97
    v_accvgpr_write_b32 a50, v82
    v_accvgpr_read_b32 v83, a51
    v_mul_f32 v83, v83, v97
    v_accvgpr_write_b32 a51, v83
    v_accvgpr_read_b32 v80, a52
    v_mul_f32 v80, v80, v97
    v_accvgpr_write_b32 a52, v80
    v_accvgpr_read_b32 v81, a53
    v_mul_f32 v81, v81, v97
    v_accvgpr_write_b32 a53, v81
    v_accvgpr_read_b32 v82, a54
    v_mul_f32 v82, v82, v97
    v_accvgpr_write_b32 a54, v82
    v_accvgpr_read_b32 v83, a55
    v_mul_f32 v83, v83, v97
    v_accvgpr_write_b32 a55, v83
    v_accvgpr_read_b32 v80, a56
    v_mul_f32 v80, v80, v97
    v_accvgpr_write_b32 a56, v80
    v_accvgpr_read_b32 v81, a57
    v_mul_f32 v81, v81, v97
    v_accvgpr_write_b32 a57, v81
    v_accvgpr_read_b32 v82, a58
    v_mul_f32 v82, v82, v97
    v_accvgpr_write_b32 a58, v82
    v_accvgpr_read_b32 v83, a59
    v_mul_f32 v83, v83, v97
    v_accvgpr_write_b32 a59, v83
    v_accvgpr_read_b32 v80, a60
    v_mul_f32 v80, v80, v97
    v_accvgpr_write_b32 a60, v80
    v_accvgpr_read_b32 v81, a61
    v_mul_f32 v81, v81, v97
    v_accvgpr_write_b32 a61, v81
    v_accvgpr_read_b32 v82, a62
    v_mul_f32 v82, v82, v97
    v_accvgpr_write_b32 a62, v82
    v_accvgpr_read_b32 v83, a63
    v_mul_f32 v83, v83, v97
    v_accvgpr_write_b32 a63, v83
    v_exp_f32 v80, v16
    v_exp_f32 v81, v17
    s_nop 0
    v_add_f32 v88, v80, v81
    v_cvt_pk_bf16_f32 v64, v80, v81
    v_exp_f32 v80, v18
    v_exp_f32 v81, v19
    v_add_f32 v88, v88, v80
    v_add_f32 v88, v88, v81
    v_cvt_pk_bf16_f32 v65, v80, v81
    v_exp_f32 v80, v20
    v_exp_f32 v81, v21
    v_add_f32 v88, v88, v80
    v_add_f32 v88, v88, v81
    v_cvt_pk_bf16_f32 v66, v80, v81
    v_exp_f32 v80, v22
    v_exp_f32 v81, v23
    v_add_f32 v88, v88, v80
    v_add_f32 v88, v88, v81
    v_cvt_pk_bf16_f32 v67, v80, v81
    v_exp_f32 v80, v24
    v_exp_f32 v81, v25
    v_add_f32 v88, v88, v80
    v_add_f32 v88, v88, v81
    v_cvt_pk_bf16_f32 v68, v80, v81
    v_exp_f32 v80, v26
    v_exp_f32 v81, v27
    v_add_f32 v88, v88, v80
    v_add_f32 v88, v88, v81
    v_cvt_pk_bf16_f32 v69, v80, v81
    v_exp_f32 v80, v28
    v_exp_f32 v81, v29
    v_add_f32 v88, v88, v80
    v_add_f32 v88, v88, v81
    v_cvt_pk_bf16_f32 v70, v80, v81
    v_exp_f32 v80, v30
    v_exp_f32 v81, v31
    v_add_f32 v88, v88, v80
    v_add_f32 v88, v88, v81
    v_cvt_pk_bf16_f32 v71, v80, v81
    v_exp_f32 v80, v32
    v_exp_f32 v81, v33
    v_exp_f32 v82, v34
    s_branch B_r1b_ret
B_r2a:
    v_max3_f32 v96, v32, v33, v34
    v_max3_f32 v96, v96, v35, v36
    v_max3_f32 v96, v96, v37, v38
    v_max3_f32 v96, v96, v39, v40
    v_max3_f32 v96, v96, v41, v42
    v_max3_f32 v96, v96, v43, v44
    v_max3_f32 v96, v96, v45, v46
    v_max_f32 v96, v96, v47
    v_mov_b32 v98, v96
    s_nop 1
    v_permlane32_swap_b32 v96, v98
    v_max_f32 v96, v96, v98
    v_max_f32 v96, 0, v96
    v_exp_f32 v97, -v96
    v_sub_f32 v32, v32, v96
    v_sub_f32 v16, v16, v96
    v_sub_f32 v48, v48, v96
    v_sub_f32 v33, v33, v96
    v_sub_f32 v17, v17, v96
    v_sub_f32 v49, v49, v96
    v_sub_f32 v34, v34, v96
    v_sub_f32 v18, v18, v96
    v_sub_f32 v50, v50, v96
    v_sub_f32 v35, v35, v96
    v_sub_f32 v19, v19, v96
    v_sub_f32 v51, v51, v96
    v_sub_f32 v36, v36, v96
    v_sub_f32 v20, v20, v96
    v_sub_f32 v52, v52, v96
    v_sub_f32 v37, v37, v96
    v_sub_f32 v21, v21, v96
    v_sub_f32 v53, v53, v96
    v_sub_f32 v38, v38, v96
    v_sub_f32 v22, v22, v96
    v_sub_f32 v54, v54, v96
    v_sub_f32 v39, v39, v96
    v_sub_f32 v23, v23, v96
    v_sub_f32 v55, v55, v96
    v_sub_f32 v40, v40, v96
    v_sub_f32 v24, v24, v96
    v_sub_f32 v56, v56, v96
    v_sub_f32 v41, v41, v96
    v_sub_f32 v25, v25, v96
    v_sub_f32 v57, v57, v96
    v_sub_f32 v42, v42, v96
    v_sub_f32 v26, v26, v96
    v_sub_f32 v58, v58, v96
    v_sub_f32 v43, v43, v96
    v_sub_f32 v27, v27, v96
    v_sub_f32 v59, v59, v96
    v_sub_f32 v44, v44, v96
    v_sub_f32 v28, v28, v96
    v_sub_f32 v60, v60, v96
    v_sub_f32 v45, v45, v96
    v_sub_f32 v29, v29, v96
    v_sub_f32 v61, v61, v96
    v_sub_f32 v46, v46, v96
    v_sub_f32 v30, v30, v96
    v_sub_f32 v62, v62, v96
    v_sub_f32 v47, v47, v96
    v_sub_f32 v31, v31, v96
    v_sub_f32 v63, v63, v96
    v_mul_f32 v89, v89, v97
    v_accvgpr_read_b32 v80, a0
    v_mul_f32 v80, v80, v97
    v_accvgpr_write_b32 a0, v80
    v_accvgpr_read_b32 v81, a1
    v_mul_f32 v81, v81, v97
    v_accvgpr_write_b32 a1, v81
    v_accvgpr_read_b32 v82, a2
    v_mul_f32 v82, v82, v97
    v_accvgpr_write_b32 a2, v82
    v_accvgpr_read_b32 v83, a3
    v_mul_f32 v83, v83, v97
    v_accvgpr_write_b32 a3, v83
    v_accvgpr_read_b32 v80, a4
    v_mul_f32 v80, v80, v97
    v_accvgpr_write_b32 a4, v80
    v_accvgpr_read_b32 v81, a5
    v_mul_f32 v81, v81, v97
    v_accvgpr_write_b32 a5, v81
    v_accvgpr_read_b32 v82, a6
    v_mul_f32 v82, v82, v97
    v_accvgpr_write_b32 a6, v82
    v_accvgpr_read_b32 v83, a7
    v_mul_f32 v83, v83, v97
    v_accvgpr_write_b32 a7, v83
    v_accvgpr_read_b32 v80, a8
    v_mul_f32 v80, v80, v97
    v_accvgpr_write_b32 a8, v80
    v_accvgpr_read_b32 v81, a9
    v_mul_f32 v81, v81, v97
    v_accvgpr_write_b32 a9, v81
    v_accvgpr_read_b32 v82, a10
    v_mul_f32 v82, v82, v97
    v_accvgpr_write_b32 a10, v82
    v_accvgpr_read_b32 v83, a11
    v_mul_f32 v83, v83, v97
    v_accvgpr_write_b32 a11, v83
    v_accvgpr_read_b32 v80, a12
    v_mul_f32 v80, v80, v97
    v_accvgpr_write_b32 a12, v80
    v_accvgpr_read_b32 v81, a13
    v_mul_f32 v81, v81, v97
    v_accvgpr_write_b32 a13, v81
    v_accvgpr_read_b32 v82, a14
    v_mul_f32 v82, v82, v97
    v_accvgpr_write_b32 a14, v82
    v_accvgpr_read_b32 v83, a15
    v_mul_f32 v83, v83, v97
    v_accvgpr_write_b32 a15, v83
    v_accvgpr_read_b32 v80, a16
    v_mul_f32 v80, v80, v97
    v_accvgpr_write_b32 a16, v80
    v_accvgpr_read_b32 v81, a17
    v_mul_f32 v81, v81, v97
    v_accvgpr_write_b32 a17, v81
    v_accvgpr_read_b32 v82, a18
    v_mul_f32 v82, v82, v97
    v_accvgpr_write_b32 a18, v82
    v_accvgpr_read_b32 v83, a19
    v_mul_f32 v83, v83, v97
    v_accvgpr_write_b32 a19, v83
    v_accvgpr_read_b32 v80, a20
    v_mul_f32 v80, v80, v97
    v_accvgpr_write_b32 a20, v80
    v_accvgpr_read_b32 v81, a21
    v_mul_f32 v81, v81, v97
    v_accvgpr_write_b32 a21, v81
    v_accvgpr_read_b32 v82, a22
    v_mul_f32 v82, v82, v97
    v_accvgpr_write_b32 a22, v82
    v_accvgpr_read_b32 v83, a23
    v_mul_f32 v83, v83, v97
    v_accvgpr_write_b32 a23, v83
    v_accvgpr_read_b32 v80, a24
    v_mul_f32 v80, v80, v97
    v_accvgpr_write_b32 a24, v80
    v_accvgpr_read_b32 v81, a25
    v_mul_f32 v81, v81, v97
    v_accvgpr_write_b32 a25, v81
    v_accvgpr_read_b32 v82, a26
    v_mul_f32 v82, v82, v97
    v_accvgpr_write_b32 a26, v82
    v_accvgpr_read_b32 v83, a27
    v_mul_f32 v83, v83, v97
    v_accvgpr_write_b32 a27, v83
    v_accvgpr_read_b32 v80, a28
    v_mul_f32 v80, v80, v97
    v_accvgpr_write_b32 a28, v80
    v_accvgpr_read_b32 v81, a29
    v_mul_f32 v81, v81, v97
    v_accvgpr_write_b32 a29, v81
    v_accvgpr_read_b32 v82, a30
    v_mul_f32 v82, v82, v97
    v_accvgpr_write_b32 a30, v82
    v_accvgpr_read_b32 v83, a31
    v_mul_f32 v83, v83, v97
    v_accvgpr_write_b32 a31, v83
    v_accvgpr_read_b32 v80, a32
    v_mul_f32 v80, v80, v97
    v_accvgpr_write_b32 a32, v80
    v_accvgpr_read_b32 v81, a33
    v_mul_f32 v81, v81, v97
    v_accvgpr_write_b32 a33, v81
    v_accvgpr_read_b32 v82, a34
    v_mul_f32 v82, v82, v97
    v_accvgpr_write_b32 a34, v82
    v_accvgpr_read_b32 v83, a35
    v_mul_f32 v83, v83, v97
    v_accvgpr_write_b32 a35, v83
    v_accvgpr_read_b32 v80, a36
    v_mul_f32 v80, v80, v97
    v_accvgpr_write_b32 a36, v80
    v_accvgpr_read_b32 v81, a37
    v_mul_f32 v81, v81, v97
    v_accvgpr_write_b32 a37, v81
    v_accvgpr_read_b32 v82, a38
    v_mul_f32 v82, v82, v97
    v_accvgpr_write_b32 a38, v82
    v_accvgpr_read_b32 v83, a39
    v_mul_f32 v83, v83, v97
    v_accvgpr_write_b32 a39, v83
    v_accvgpr_read_b32 v80, a40
    v_mul_f32 v80, v80, v97
    v_accvgpr_write_b32 a40, v80
    v_accvgpr_read_b32 v81, a41
    v_mul_f32 v81, v81, v97
    v_accvgpr_write_b32 a41, v81
    v_accvgpr_read_b32 v82, a42
    v_mul_f32 v82, v82, v97
    v_accvgpr_write_b32 a42, v82
    v_accvgpr_read_b32 v83, a43
    v_mul_f32 v83, v83, v97
    v_accvgpr_write_b32 a43, v83
    v_accvgpr_read_b32 v80, a44
    v_mul_f32 v80, v80, v97
    v_accvgpr_write_b32 a44, v80
    v_accvgpr_read_b32 v81, a45
    v_mul_f32 v81, v81, v97
    v_accvgpr_write_b32 a45, v81
    v_accvgpr_read_b32 v82, a46
    v_mul_f32 v82, v82, v97
    v_accvgpr_write_b32 a46, v82
    v_accvgpr_read_b32 v83, a47
    v_mul_f32 v83, v83, v97
    v_accvgpr_write_b32 a47, v83
    v_accvgpr_read_b32 v80, a48
    v_mul_f32 v80, v80, v97
    v_accvgpr_write_b32 a48, v80
    v_accvgpr_read_b32 v81, a49
    v_mul_f32 v81, v81, v97
    v_accvgpr_write_b32 a49, v81
    v_accvgpr_read_b32 v82, a50
    v_mul_f32 v82, v82, v97
    v_accvgpr_write_b32 a50, v82
    v_accvgpr_read_b32 v83, a51
    v_mul_f32 v83, v83, v97
    v_accvgpr_write_b32 a51, v83
    v_accvgpr_read_b32 v80, a52
    v_mul_f32 v80, v80, v97
    v_accvgpr_write_b32 a52, v80
    v_accvgpr_read_b32 v81, a53
    v_mul_f32 v81, v81, v97
    v_accvgpr_write_b32 a53, v81
    v_accvgpr_read_b32 v82, a54
    v_mul_f32 v82, v82, v97
    v_accvgpr_write_b32 a54, v82
    v_accvgpr_read_b32 v83, a55
    v_mul_f32 v83, v83, v97
    v_accvgpr_write_b32 a55, v83
    v_accvgpr_read_b32 v80, a56
    v_mul_f32 v80, v80, v97
    v_accvgpr_write_b32 a56, v80
    v_accvgpr_read_b32 v81, a57
    v_mul_f32 v81, v81, v97
    v_accvgpr_write_b32 a57, v81
    v_accvgpr_read_b32 v82, a58
    v_mul_f32 v82, v82, v97
    v_accvgpr_write_b32 a58, v82
    v_accvgpr_read_b32 v83, a59
    v_mul_f32 v83, v83, v97
    v_accvgpr_write_b32 a59, v83
    v_accvgpr_read_b32 v80, a60
    v_mul_f32 v80, v80, v97
    v_accvgpr_write_b32 a60, v80
    v_accvgpr_read_b32 v81, a61
    v_mul_f32 v81, v81, v97
    v_accvgpr_write_b32 a61, v81
    v_accvgpr_read_b32 v82, a62
    v_mul_f32 v82, v82, v97
    v_accvgpr_write_b32 a62, v82
    v_accvgpr_read_b32 v83, a63
    v_mul_f32 v83, v83, v97
    v_accvgpr_write_b32 a63, v83
    v_exp_f32 v80, v32
    v_exp_f32 v81, v33
    s_nop 0
    v_add_f32 v88, v80, v81
    v_cvt_pk_bf16_f32 v72, v80, v81
    v_exp_f32 v80, v34
    v_exp_f32 v81, v35
    v_add_f32 v88, v88, v80
    v_add_f32 v88, v88, v81
    v_cvt_pk_bf16_f32 v73, v80, v81
    v_exp_f32 v80, v36
    v_exp_f32 v81, v37
    v_add_f32 v88, v88, v80
    v_add_f32 v88, v88, v81
    v_cvt_pk_bf16_f32 v74, v80, v81
    v_exp_f32 v80, v38
    v_exp_f32 v81, v39
    v_add_f32 v88, v88, v80
    v_add_f32 v88, v88, v81
    v_cvt_pk_bf16_f32 v75, v80, v81
    v_exp_f32 v80, v40
    v_exp_f32 v81, v41
    v_add_f32 v88, v88, v80
    v_add_f32 v88, v88, v81
    v_cvt_pk_bf16_f32 v76, v80, v81
    v_exp_f32 v80, v42
    v_exp_f32 v81, v43
    v_add_f32 v88, v88, v80
    v_add_f32 v88, v88, v81
    v_cvt_pk_bf16_f32 v77, v80, v81
    v_exp_f32 v80, v44
    v_exp_f32 v81, v45
    v_add_f32 v88, v88, v80
    v_add_f32 v88, v88, v81
    v_cvt_pk_bf16_f32 v78, v80, v81
    v_exp_f32 v80, v46
    v_exp_f32 v81, v47
    v_add_f32 v88, v88, v80
    v_add_f32 v88, v88, v81
    v_cvt_pk_bf16_f32 v79, v80, v81
    v_exp_f32 v80, v16
    v_exp_f32 v81, v17
    v_exp_f32 v82, v18
    s_branch B_r2a_ret
K3_start:
    s_waitcnt vmcnt(0)
    s_barrier
    s_cmp_lg_u32 s3, 0
    s_cbranch_scc1 ON46
    s_sub_u32 s55, 15, s37
    s_lshr_b32 s55, s55, 1
    s_lshl_b32 s38, s48, 3
    s_add_u32 s55, s55, s38
    s_lshl_b32 s55, s55, 7
    s_add_u32 s55, s55, 83890176
    v_mbcnt_lo_u32_b32 v16, -1, 0
    v_mbcnt_hi_u32_b32 v16, -1, v16
    v_cmp_eq_u32 vcc, 0, v16
    v_mov_b32 v17, 0x7fffff00
    s_nop 0
    v_cndmask_b32 v16, v17, v16, vcc
    v_mov_b32 v17, 1
    buffer_atomic_add v17, v16, s[28:31], s55 offen sc1
ON46:
    s_lshl_b32 s38, s48, 3
    s_add_u32 s44, s49, s38
    s_lshl_b32 s44, s44, 7
    s_add_u32 s44, s44, 83890176
    s_lshl_b32 s38, s49, 3
    s_add_u32 s64, s38, s3
    s_mul_i32 s38, s64, 342
    s_lshl_b32 s39, s48, 5
    s_add_u32 s39, s39, s38
    s_lshl_b32 s53, s39, 10
    s_add_u32 s53, s53, 41943040
    s_add_u32 s39, s38, s51
    s_add_u32 s39, s39, 256
    s_lshl_b32 s55, s39, 10
    s_add_u32 s55, s55, 41943040
    s_lshl_b32 s54, s3, 11
    s_add_u32 s38, s55, 0
    buffer_load_dwordx4 a[0:3], v2, s[28:31], s38 offen offset:0 sc1
    s_add_u32 s38, s55, 0
    buffer_load_dwordx4 a[4:7], v2, s[28:31], s38 offen offset:1024 sc1
    s_add_u32 s38, s55, 0
    buffer_load_dwordx4 a[8:11], v2, s[28:31], s38 offen offset:2048 sc1
    s_add_u32 s38, s55, 0
    buffer_load_dwordx4 a[12:15], v2, s[28:31], s38 offen offset:3072 sc1
    s_add_u32 s38, s55, 4096
    buffer_load_dwordx4 a[16:19], v2, s[28:31], s38 offen offset:0 sc1
    s_add_u32 s38, s55, 4096
    buffer_load_dwordx4 a[20:23], v2, s[28:31], s38 offen offset:1024 sc1
    s_add_u32 s38, s55, 4096
    buffer_load_dwordx4 a[24:27], v2, s[28:31], s38 offen offset:2048 sc1
    s_add_u32 s38, s55, 4096
    buffer_load_dwordx4 a[28:31], v2, s[28:31], s38 offen offset:3072 sc1
    s_add_u32 s38, s55, 8192
    s_cmp_lt_u32 s48, 6
    s_cselect_b32 s38, s38, s62
    buffer_load_dwordx4 a[32:35], v2, s[28:31], s38 offen offset:0 sc1
    s_add_u32 s38, s55, 8192
    s_cmp_lt_u32 s48, 6
    s_cselect_b32 s38, s38, s62
    buffer_load_dwordx4 a[36:39], v2, s[28:31], s38 offen offset:1024 sc1
    s_add_u32 s38, s55, 8192
    s_cmp_lt_u32 s48, 5
    s_cselect_b32 s38, s38, s62
    buffer_load_dwordx4 a[40:43], v2, s[28:31], s38 offen offset:2048 sc1
    s_add_u32 s38, s55, 8192
    s_cmp_lt_u32 s48, 5
    s_cselect_b32 s38, s38, s62
    buffer_load_dwordx4 a[44:47], v2, s[28:31], s38 offen offset:3072 sc1
    v_add_u32 v4, 98304, v4
    v_add_u32 v5, 98304, v5
    v_add_u32 v6, 98304, v6
    v_add_u32 v7, 98304, v7
    s_cmp_ge_u32 s3, 4
    s_cbranch_scc1 K3_B
    s_cmp_lg_u32 s3, 0
    s_cbranch_scc1 ON47
    v_mov_b32 v17, 0
    buffer_load_dword v16, v17, s[28:31], s44 offen sc1
ON47:
    ds_read_b64_tr_b16 v[32:33], v4 offset:16384
    ds_read_b64_tr_b16 v[34:35], v4 offset:18432
    ds_read_b64_tr_b16 v[36:37], v5 offset:16384
    ds_read_b64_tr_b16 v[38:39], v5 offset:18432
    ds_read_b64_tr_b16 v[40:41], v6 offset:16384
    ds_read_b64_tr_b16 v[42:43], v6 offset:18432
    ds_read_b64_tr_b16 v[44:45], v7 offset:16384
    ds_read_b64_tr_b16 v[46:47], v7 offset:18432
    s_waitcnt vmcnt(11) lgkmcnt(6)
    v_mfma_f32_32x32x16_bf16 v[64:79], v[32:35], a[0:3], 0
    ds_read_b64_tr_b16 v[48:49], v4 offset:20480
    ds_read_b64_tr_b16 v[50:51], v4 offset:22528
    s_waitcnt lgkmcnt(6)
    v_mfma_f32_32x32x16_bf16 v[80:95], v[36:39], a[0:3], 0
    ds_read_b64_tr_b16 v[52:53], v5 offset:20480
    ds_read_b64_tr_b16 v[54:55], v5 offset:22528
    s_waitcnt lgkmcnt(6)
    v_mfma_f32_32x32x16_bf16 v[96:111], v[40:43], a[0:3], 0
    ds_read_b64_tr_b16 v[56:57], v6 offset:20480
    ds_read_b64_tr_b16 v[58:59], v6 offset:22528
    s_waitcnt lgkmcnt(6)
    v_mfma_f32_32x32x16_bf16 v[112:127], v[44:47], a[0:3], 0
    ds_read_b64_tr_b16 v[60:61], v7 offset:20480
    ds_read_b64_tr_b16 v[62:63], v7 offset:22528
    s_waitcnt vmcnt(10) lgkmcnt(6)
    v_mfma_f32_32x32x16_bf16 v[64:79], v[48:51], a[4:7], v[64:79]
    ds_read_b64_tr_b16 v[32:33], v4 offset:24576
    ds_read_b64_tr_b16 v[34:35], v4 offset:26624
    s_waitcnt lgkmcnt(6)
    v_mfma_f32_32x32x16_bf16 v[80:95], v[52:55], a[4:7], v[80:95]
    ds_read_b64_tr_b16 v[36:37], v5 offset:24576
    ds_read_b64_tr_b16 v[38:39], v5 offset:26624
    s_waitcnt lgkmcnt(6)
    v_mfma_f32_32x32x16_bf16 v[96:111], v[56:59], a[4:7], v[96:111]
    ds_read_b64_tr_b16 v[40:41], v6 offset:24576
    ds_read_b64_tr_b16 v[42:43], v6 offset:26624
    s_waitcnt lgkmcnt(6)
    v_mfma_f32_32x32x16_bf16 v[112:127], v[60:63], a[4:7], v[112:127]
    ds_read_b64_tr_b16 v[44:45], v7 offset:24576
    ds_read_b64_tr_b16 v[46:47], v7 offset:26624
    s_waitcnt vmcnt(9) lgkmcnt(6)
    v_mfma_f32_32x32x16_bf16 v[64:79], v[32:35], a[8:11], v[64:79]
    ds_read_b64_tr_b16 v[48:49], v4 offset:28672
    ds_read_b64_tr_b16 v[50:51], v4 offset:30720
    s_waitcnt lgkmcnt(6)
    v_mfma_f32_32x32x16_bf16 v[80:95], v[36:39], a[8:11], v[80:95]
    ds_read_b64_tr_b16 v[52:53], v5 offset:28672
    ds_read_b64_tr_b16 v[54:55], v5 offset:30720
    s_waitcnt lgkmcnt(6)
    v_mfma_f32_32x32x16_bf16 v[96:111], v[40:43], a[8:11], v[96:111]
    ds_read_b64_tr_b16 v[56:57], v6 offset:28672
    ds_read_b64_tr_b16 v[58:59], v6 offset:30720
    s_waitcnt lgkmcnt(6)
    v_mfma_f32_32x32x16_bf16 v[112:127], v[44:47], a[8:11], v[112:127]
    s_cmp_lg_u32 s3, 0
    s_cbranch_scc1 ON48
    s_waitcnt vmcnt(0)
    v_readfirstlane_b32 s38, v16
    s_cmp_ge_u32 s38, 8
    s_cbranch_scc1 SY6_ok
    s_mov_b32 s95, 0
    v_mov_b32 v17, 0
SP7:
    buffer_load_dword v16, v17, s[28:31], s44 offen sc1
    s_waitcnt vmcnt(0)
    v_readfirstlane_b32 s38, v16
    s_cmp_ge_u32 s38, 8
    s_cbranch_scc1 SP7_d
    s_add_u32 s95, s95, 1
    s_cmp_lt_u32 s95, 262144
    s_cbranch_scc1 SP7
SP7_d:
SY6_ok:
ON48:
    s_barrier
    ds_read_b64_tr_b16 v[60:61], v7 offset:28672
    ds_read_b64_tr_b16 v[62:63], v7 offset:30720
    s_waitcnt vmcnt(8) lgkmcnt(6)
    v_mfma_f32_32x32x16_bf16 v[64:79], v[48:51], a[12:15], v[64:79]
    ds_read_b64_tr_b16 v[32:33], v4 offset:32768
    ds_read_b64_tr_b16 v[34:35], v4 offset:34816
    s_add_u32 m0, s54, 98304
    s_lshl_b32 s39, s54, 2
    s_add_u32 s39, s39, s52
    s_lshl_b32 s38, s48, 19
    s_add_u32 s38, s38, 0
    s_add_u32 s38, s38, s39
    buffer_load_dwordx4 v8, s[68:71], s38 offen offset:0 lds
    s_waitcnt lgkmcnt(6)
    v_mfma_f32_32x32x16_bf16 v[80:95], v[52:55], a[12:15], v[80:95]
    ds_read_b64_tr_b16 v[36:37], v5 offset:32768
    ds_read_b64_tr_b16 v[38:39], v5 offset:34816
    s_waitcnt lgkmcnt(6)
    v_mfma_f32_32x32x16_bf16 v[96:111], v[56:59], a[12:15], v[96:111]
    ds_read_b64_tr_b16 v[40:41], v6 offset:32768
    ds_read_b64_tr_b16 v[42:43], v6 offset:34816
    s_add_u32 m0, s54, 98304
    s_lshl_b32 s39, s54, 2
    s_add_u32 s39, s39, s52
    s_lshl_b32 s38, s48, 19
    s_add_u32 s38, s38, 0
    s_add_u32 s38, s38, s39
    buffer_load_dwordx4 v9, s[68:71], s38 offen offset:1024 lds
    s_waitcnt lgkmcnt(6)
    v_mfma_f32_32x32x16_bf16 v[112:127], v[60:63], a[12:15], v[112:127]
    ds_read_b64_tr_b16 v[44:45], v7 offset:32768
    ds_read_b64_tr_b16 v[46:47], v7 offset:34816
    s_waitcnt vmcnt(9) lgkmcnt(6)
    v_mfma_f32_32x32x16_bf16 v[64:79], v[32:35], a[16:19], v[64:79]
    ds_read_b64_tr_b16 v[48:49], v4 offset:36864
    ds_read_b64_tr_b16 v[50:51], v4 offset:38912
    s_add_u32 s38, s53, 0
    buffer_load_dwordx4 a[48:51], v2, s[28:31], s38 offen offset:0 sc1
    s_waitcnt lgkmcnt(6)
    v_mfma_f32_32x32x16_bf16 v[80:95], v[36:39], a[16:19], v[80:95]
    ds_read_b64_tr_b16 v[52:53], v5 offset:36864
    ds_read_b64_tr_b16 v[54:55], v5 offset:38912
    s_waitcnt lgkmcnt(6)
    v_mfma_f32_32x32x16_bf16 v[96:111], v[40:43], a[16:19], v[96:111]
    ds_read_b64_tr_b16 v[56:57], v6 offset:36864
    ds_read_b64_tr_b16 v[58:59], v6 offset:38912
    s_add_u32 s38, s53, 0
    buffer_load_dwordx4 a[52:55], v2, s[28:31], s38 offen offset:1024 sc1
    s_waitcnt lgkmcnt(6)
    v_mfma_f32_32x32x16_bf16 v[112:127], v[44:47], a[16:19], v[112:127]
    ds_read_b64_tr_b16 v[60:61], v7 offset:36864
    ds_read_b64_tr_b16 v[62:63], v7 offset:38912
    s_waitcnt vmcnt(10) lgkmcnt(6)
    v_mfma_f32_32x32x16_bf16 v[64:79], v[48:51], a[20:23], v[64:79]
    ds_read_b64_tr_b16 v[32:33], v4 offset:40960
    ds_read_b64_tr_b16 v[34:35], v4 offset:43008
    s_add_u32 s38, s53, 0
    buffer_load_dwordx4 a[56:59], v2, s[28:31], s38 offen offset:2048 sc1
    s_waitcnt lgkmcnt(6)
    v_mfma_f32_32x32x16_bf16 v[80:95], v[52:55], a[20:23], v[80:95]
    ds_read_b64_tr_b16 v[36:37], v5 offset:40960
    ds_read_b64_tr_b16 v[38:39], v5 offset:43008
    s_waitcnt lgkmcnt(6)
    v_mfma_f32_32x32x16_bf16 v[96:111], v[56:59], a[20:23], v[96:111]
    ds_read_b64_tr_b16 v[40:41], v6 offset:40960
    ds_read_b64_tr_b16 v[42:43], v6 offset:43008
    s_add_u32 s38, s53, 0
    buffer_load_dwordx4 a[60:63], v2, s[28:31], s38 offen offset:3072 sc1
    s_waitcnt lgkmcnt(6)
    v_mfma_f32_32x32x16_bf16 v[112:127], v[60:63], a[20:23], v[112:127]
    ds_read_b64_tr_b16 v[44:45], v7 offset:40960
    ds_read_b64_tr_b16 v[46:47], v7 offset:43008
    s_waitcnt vmcnt(11) lgkmcnt(6)
    v_mfma_f32_32x32x16_bf16 v[64:79], v[32:35], a[24:27], v[64:79]
    ds_read_b64_tr_b16 v[48:49], v4 offset:45056
    ds_read_b64_tr_b16 v[50:51], v4 offset:47104
    s_waitcnt lgkmcnt(6)
    v_mfma_f32_32x32x16_bf16 v[80:95], v[36:39], a[24:27], v[80:95]
    ds_read_b64_tr_b16 v[52:53], v5 offset:45056
    ds_read_b64_tr_b16 v[54:55], v5 offset:47104
    s_waitcnt lgkmcnt(6)
    v_mfma_f32_32x32x16_bf16 v[96:111], v[40:43], a[24:27], v[96:111]
    ds_read_b64_tr_b16 v[56:57], v6 offset:45056
    ds_read_b64_tr_b16 v[58:59], v6 offset:47104
    s_waitcnt lgkmcnt(6)
    v_mfma_f32_32x32x16_bf16 v[112:127], v[44:47], a[24:27], v[112:127]
    s_barrier
    ds_read_b64_tr_b16 v[60:61], v7 offset:45056
    ds_read_b64_tr_b16 v[62:63], v7 offset:47104
    s_waitcnt vmcnt(10) lgkmcnt(6)
    v_mfma_f32_32x32x16_bf16 v[64:79], v[48:51], a[28:31], v[64:79]
    ds_read_b64_tr_b16 v[32:33], v4 offset:49152
    ds_read_b64_tr_b16 v[34:35], v4 offset:51200
    s_add_u32 m0, s54, 114688
    s_lshl_b32 s39, s54, 2
    s_add_u32 s39, s39, s52
    s_lshl_b32 s38, s48, 19
    s_add_u32 s38, s38, 65536
    s_add_u32 s38, s38, s39
    buffer_load_dwordx4 v8, s[68:71], s38 offen offset:0 lds
    s_waitcnt lgkmcnt(6)
    v_mfma_f32_32x32x16_bf16 v[80:95], v[52:55], a[28:31], v[80:95]
    ds_read_b64_tr_b16 v[36:37], v5 offset:49152
    ds_read_b64_tr_b16 v[38:39], v5 offset:51200
    s_waitcnt lgkmcnt(6)
    v_mfma_f32_32x32x16_bf16 v[96:111], v[56:59], a[28:31], v[96:111]
    ds_read_b64_tr_b16 v[40:41], v6 offset:49152
    ds_read_b64_tr_b16 v[42:43], v6 offset:51200
    s_add_u32 m0, s54, 114688
    s_lshl_b32 s39, s54, 2
    s_add_u32 s39, s39, s52
    s_lshl_b32 s38, s48, 19
    s_add_u32 s38, s38, 65536
    s_add_u32 s38, s38, s39
    buffer_load_dwordx4 v9, s[68:71], s38 offen offset:1024 lds
    s_waitcnt lgkmcnt(6)
    v_mfma_f32_32x32x16_bf16 v[112:127], v[60:63], a[28:31], v[112:127]
    ds_read_b64_tr_b16 v[44:45], v7 offset:49152
    ds_read_b64_tr_b16 v[46:47], v7 offset:51200
    s_waitcnt vmcnt(11) lgkmcnt(6)
    v_mfma_f32_32x32x16_bf16 v[64:79], v[32:35], a[32:35], v[64:79]
    ds_read_b64_tr_b16 v[48:49], v4 offset:53248
    ds_read_b64_tr_b16 v[50:51], v4 offset:55296
    s_add_u32 s38, s53, 4096
    buffer_load_dwordx4 a[0:3], v2, s[28:31], s38 offen offset:0 sc1
    s_waitcnt lgkmcnt(6)
    v_mfma_f32_32x32x16_bf16 v[80:95], v[36:39], a[32:35], v[80:95]
    ds_read_b64_tr_b16 v[52:53], v5 offset:53248
    ds_read_b64_tr_b16 v[54:55], v5 offset:55296
    s_waitcnt lgkmcnt(6)
    v_mfma_f32_32x32x16_bf16 v[96:111], v[40:43], a[32:35], v[96:111]
    ds_read_b64_tr_b16 v[56:57], v6 offset:53248
    ds_read_b64_tr_b16 v[58:59], v6 offset:55296
    s_add_u32 s38, s53, 4096
    buffer_load_dwordx4 a[4:7], v2, s[28:31], s38 offen offset:1024 sc1
    s_waitcnt lgkmcnt(6)
    v_mfma_f32_32x32x16_bf16 v[112:127], v[44:47], a[32:35], v[112:127]
    ds_read_b64_tr_b16 v[60:61], v7 offset:53248
    ds_read_b64_tr_b16 v[62:63], v7 offset:55296
    s_waitcnt vmcnt(12) lgkmcnt(6)
    v_mfma_f32_32x32x16_bf16 v[64:79], v[48:51], a[36:39], v[64:79]
    ds_read_b64_tr_b16 v[32:33], v4 offset:57344
    ds_read_b64_tr_b16 v[34:35], v4 offset:59392
    s_add_u32 s38, s53, 4096
    buffer_load_dwordx4 a[8:11], v2, s[28:31], s38 offen offset:2048 sc1
    s_waitcnt lgkmcnt(6)
    v_mfma_f32_32x32x16_bf16 v[80:95], v[52:55], a[36:39], v[80:95]
    ds_read_b64_tr_b16 v[36:37], v5 offset:57344
    ds_read_b64_tr_b16 v[38:39], v5 offset:59392
    s_waitcnt lgkmcnt(6)
    v_mfma_f32_32x32x16_bf16 v[96:111], v[56:59], a[36:39], v[96:111]
    ds_read_b64_tr_b16 v[40:41], v6 offset:57344
    ds_read_b64_tr_b16 v[42:43], v6 offset:59392
    s_add_u32 s38, s53, 4096
    buffer_load_dwordx4 a[12:15], v2, s[28:31], s38 offen offset:3072 sc1
    s_waitcnt lgkmcnt(6)
    v_mfma_f32_32x32x16_bf16 v[112:127], v[60:63], a[36:39], v[112:127]
    ds_read_b64_tr_b16 v[44:45], v7 offset:57344
    ds_read_b64_tr_b16 v[46:47], v7 offset:59392
    s_waitcnt vmcnt(13) lgkmcnt(6)
    v_mfma_f32_32x32x16_bf16 v[64:79], v[32:35], a[40:43], v[64:79]
    ds_read_b64_tr_b16 v[48:49], v4 offset:61440
    ds_read_b64_tr_b16 v[50:51], v4 offset:63488
    s_waitcnt lgkmcnt(6)
    v_mfma_f32_32x32x16_bf16 v[80:95], v[36:39], a[40:43], v[80:95]
    ds_read_b64_tr_b16 v[52:53], v5 offset:61440
    ds_read_b64_tr_b16 v[54:55], v5 offset:63488
    s_waitcnt lgkmcnt(6)
    v_mfma_f32_32x32x16_bf16 v[96:111], v[40:43], a[40:43], v[96:111]
    ds_read_b64_tr_b16 v[56:57], v6 offset:61440
    ds_read_b64_tr_b16 v[58:59], v6 offset:63488
    s_waitcnt lgkmcnt(6)
    v_mfma_f32_32x32x16_bf16 v[112:127], v[44:47], a[40:43], v[112:127]
    s_waitcnt vmcnt(10)
    s_barrier
    ds_read_b64_tr_b16 v[60:61], v7 offset:61440
    ds_read_b64_tr_b16 v[62:63], v7 offset:63488
    s_waitcnt lgkmcnt(6)
    v_mfma_f32_32x32x16_bf16 v[64:79], v[48:51], a[44:47], v[64:79]
    ds_read_b64_tr_b16 v[32:33], v4 offset:0
    ds_read_b64_tr_b16 v[34:35], v4 offset:2048
    s_add_u32 m0, s54, 131072
    s_lshl_b32 s39, s54, 2
    s_add_u32 s39, s39, s52
    s_lshl_b32 s38, s48, 19
    s_add_u32 s38, s38, 131072
    s_add_u32 s38, s38, s39
    buffer_load_dwordx4 v8, s[68:71], s38 offen offset:0 lds
    s_waitcnt lgkmcnt(6)
    v_mfma_f32_32x32x16_bf16 v[80:95], v[52:55], a[44:47], v[80:95]
    ds_read_b64_tr_b16 v[36:37], v5 offset:0
    ds_read_b64_tr_b16 v[38:39], v5 offset:2048
    s_waitcnt lgkmcnt(6)
    v_mfma_f32_32x32x16_bf16 v[96:111], v[56:59], a[44:47], v[96:111]
    ds_read_b64_tr_b16 v[40:41], v6 offset:0
    ds_read_b64_tr_b16 v[42:43], v6 offset:2048
    s_add_u32 m0, s54, 131072
    s_lshl_b32 s39, s54, 2
    s_add_u32 s39, s39, s52
    s_lshl_b32 s38, s48, 19
    s_add_u32 s38, s38, 131072
    s_add_u32 s38, s38, s39
    buffer_load_dwordx4 v9, s[68:71], s38 offen offset:1024 lds
    s_waitcnt lgkmcnt(6)
    v_mfma_f32_32x32x16_bf16 v[112:127], v[60:63], a[44:47], v[112:127]
    ds_read_b64_tr_b16 v[44:45], v7 offset:0
    ds_read_b64_tr_b16 v[46:47], v7 offset:2048
    s_waitcnt vmcnt(11) lgkmcnt(6)
    v_mfma_f32_32x32x16_bf16 v[64:79], v[32:35], a[48:51], v[64:79]
    ds_read_b64_tr_b16 v[48:49], v4 offset:4096
    ds_read_b64_tr_b16 v[50:51], v4 offset:6144
    s_add_u32 s38, s53, 8192
    buffer_load_dwordx4 a[16:19], v2, s[28:31], s38 offen offset:0 sc1
    s_waitcnt lgkmcnt(6)
    v_mfma_f32_32x32x16_bf16 v[80:95], v[36:39], a[48:51], v[80:95]
    ds_read_b64_tr_b16 v[52:53], v5 offset:4096
    ds_read_b64_tr_b16 v[54:55], v5 offset:6144
    s_waitcnt lgkmcnt(6)
    v_mfma_f32_32x32x16_bf16 v[96:111], v[40:43], a[48:51], v[96:111]
    ds_read_b64_tr_b16 v[56:57], v6 offset:4096
    ds_read_b64_tr_b16 v[58:59], v6 offset:6144
    s_add_u32 s38, s53, 8192
    buffer_load_dwordx4 a[20:23], v2, s[28:31], s38 offen offset:1024 sc1
    s_waitcnt lgkmcnt(6)
    v_mfma_f32_32x32x16_bf16 v[112:127], v[44:47], a[48:51], v[112:127]
    ds_read_b64_tr_b16 v[60:61], v7 offset:4096
    ds_read_b64_tr_b16 v[62:63], v7 offset:6144
    s_waitcnt vmcnt(12) lgkmcnt(6)
    v_mfma_f32_32x32x16_bf16 v[64:79], v[48:51], a[52:55], v[64:79]
    ds_read_b64_tr_b16 v[32:33], v4 offset:8192
    ds_read_b64_tr_b16 v[34:35], v4 offset:10240
    s_add_u32 s38, s53, 8192
    buffer_load_dwordx4 a[24:27], v2, s[28:31], s38 offen offset:2048 sc1
    s_waitcnt lgkmcnt(6)
    v_mfma_f32_32x32x16_bf16 v[80:95], v[52:55], a[52:55], v[80:95]
    ds_read_b64_tr_b16 v[36:37], v5 offset:8192
    ds_read_b64_tr_b16 v[38:39], v5 offset:10240
    s_waitcnt lgkmcnt(6)
    v_mfma_f32_32x32x16_bf16 v[96:111], v[56:59], a[52:55], v[96:111]
    ds_read_b64_tr_b16 v[40:41], v6 offset:8192
    ds_read_b64_tr_b16 v[42:43], v6 offset:10240
    s_add_u32 s38, s53, 8192
    buffer_load_dwordx4 a[28:31], v2, s[28:31], s38 offen offset:3072 sc1
    s_waitcnt lgkmcnt(6)
    v_mfma_f32_32x32x16_bf16 v[112:127], v[60:63], a[52:55], v[112:127]
    ds_read_b64_tr_b16 v[44:45], v7 offset:8192
    ds_read_b64_tr_b16 v[46:47], v7 offset:10240
    s_waitcnt vmcnt(13) lgkmcnt(6)
    v_mfma_f32_32x32x16_bf16 v[64:79], v[32:35], a[56:59], v[64:79]
    ds_read_b64_tr_b16 v[48:49], v4 offset:12288
    ds_read_b64_tr_b16 v[50:51], v4 offset:14336
    s_waitcnt lgkmcnt(6)
    v_mfma_f32_32x32x16_bf16 v[80:95], v[36:39], a[56:59], v[80:95]
    ds_read_b64_tr_b16 v[52:53], v5 offset:12288
    ds_read_b64_tr_b16 v[54:55], v5 offset:14336
    s_waitcnt lgkmcnt(6)
    v_mfma_f32_32x32x16_bf16 v[96:111], v[40:43], a[56:59], v[96:111]
    ds_read_b64_tr_b16 v[56:57], v6 offset:12288
    ds_read_b64_tr_b16 v[58:59], v6 offset:14336
    s_waitcnt lgkmcnt(6)
    v_mfma_f32_32x32x16_bf16 v[112:127], v[44:47], a[56:59], v[112:127]
    s_waitcnt vmcnt(10)
    s_barrier
    ds_read_b64_tr_b16 v[60:61], v7 offset:12288
    ds_read_b64_tr_b16 v[62:63], v7 offset:14336
    s_waitcnt lgkmcnt(6)
    v_mfma_f32_32x32x16_bf16 v[64:79], v[48:51], a[60:63], v[64:79]
    ds_read_b64_tr_b16 v[32:33], v4 offset:16384
    ds_read_b64_tr_b16 v[34:35], v4 offset:18432
    s_add_u32 m0, s54, 147456
    s_lshl_b32 s39, s54, 2
    s_add_u32 s39, s39, s52
    s_lshl_b32 s38, s48, 19
    s_add_u32 s38, s38, 196608
    s_add_u32 s38, s38, s39
    buffer_load_dwordx4 v8, s[68:71], s38 offen offset:0 lds
    s_waitcnt lgkmcnt(6)
    v_mfma_f32_32x32x16_bf16 v[80:95], v[52:55], a[60:63], v[80:95]
    ds_read_b64_tr_b16 v[36:37], v5 offset:16384
    ds_read_b64_tr_b16 v[38:39], v5 offset:18432
    s_waitcnt lgkmcnt(6)
    v_mfma_f32_32x32x16_bf16 v[96:111], v[56:59], a[60:63], v[96:111]
    ds_read_b64_tr_b16 v[40:41], v6 offset:16384
    ds_read_b64_tr_b16 v[42:43], v6 offset:18432
    s_add_u32 m0, s54, 147456
    s_lshl_b32 s39, s54, 2
    s_add_u32 s39, s39, s52
    s_lshl_b32 s38, s48, 19
    s_add_u32 s38, s38, 196608
    s_add_u32 s38, s38, s39
    buffer_load_dwordx4 v9, s[68:71], s38 offen offset:1024 lds
    s_waitcnt lgkmcnt(6)
    v_mfma_f32_32x32x16_bf16 v[112:127], v[60:63], a[60:63], v[112:127]
    ds_read_b64_tr_b16 v[44:45], v7 offset:16384
    ds_read_b64_tr_b16 v[46:47], v7 offset:18432
    s_waitcnt vmcnt(11) lgkmcnt(6)
    v_mfma_f32_32x32x16_bf16 v[64:79], v[32:35], a[0:3], v[64:79]
    ds_read_b64_tr_b16 v[48:49], v4 offset:20480
    ds_read_b64_tr_b16 v[50:51], v4 offset:22528
    s_add_u32 s38, s53, 12288
    buffer_load_dwordx4 a[32:35], v2, s[28:31], s38 offen offset:0 sc1
    s_waitcnt lgkmcnt(6)
    v_mfma_f32_32x32x16_bf16 v[80:95], v[36:39], a[0:3], v[80:95]
    ds_read_b64_tr_b16 v[52:53], v5 offset:20480
    ds_read_b64_tr_b16 v[54:55], v5 offset:22528
    s_waitcnt lgkmcnt(6)
    v_mfma_f32_32x32x16_bf16 v[96:111], v[40:43], a[0:3], v[96:111]
    ds_read_b64_tr_b16 v[56:57], v6 offset:20480
    ds_read_b64_tr_b16 v[58:59], v6 offset:22528
    s_add_u32 s38, s53, 12288
    buffer_load_dwordx4 a[36:39], v2, s[28:31], s38 offen offset:1024 sc1
    s_waitcnt lgkmcnt(6)
    v_mfma_f32_32x32x16_bf16 v[112:127], v[44:47], a[0:3], v[112:127]
    ds_read_b64_tr_b16 v[60:61], v7 offset:20480
    ds_read_b64_tr_b16 v[62:63], v7 offset:22528
    s_waitcnt vmcnt(12) lgkmcnt(6)
    v_mfma_f32_32x32x16_bf16 v[64:79], v[48:51], a[4:7], v[64:79]
    ds_read_b64_tr_b16 v[32:33], v4 offset:24576
    ds_read_b64_tr_b16 v[34:35], v4 offset:26624
    s_add_u32 s38, s53, 12288
    buffer_load_dwordx4 a[40:43], v2, s[28:31], s38 offen offset:2048 sc1
    s_waitcnt lgkmcnt(6)
    v_mfma_f32_32x32x16_bf16 v[80:95], v[52:55], a[4:7], v[80:95]
    ds_read_b64_tr_b16 v[36:37], v5 offset:24576
    ds_read_b64_tr_b16 v[38:39], v5 offset:26624
    s_waitcnt lgkmcnt(6)
    v_mfma_f32_32x32x16_bf16 v[96:111], v[56:59], a[4:7], v[96:111]
    ds_read_b64_tr_b16 v[40:41], v6 offset:24576
    ds_read_b64_tr_b16 v[42:43], v6 offset:26624
    s_add_u32 s38, s53, 12288
    buffer_load_dwordx4 a[44:47], v2, s[28:31], s38 offen offset:3072 sc1
    s_waitcnt lgkmcnt(6)
    v_mfma_f32_32x32x16_bf16 v[112:127], v[60:63], a[4:7], v[112:127]
    ds_read_b64_tr_b16 v[44:45], v7 offset:24576
    ds_read_b64_tr_b16 v[46:47], v7 offset:26624
    s_waitcnt vmcnt(13) lgkmcnt(6)
    v_mfma_f32_32x32x16_bf16 v[64:79], v[32:35], a[8:11], v[64:79]
    ds_read_b64_tr_b16 v[48:49], v4 offset:28672
    ds_read_b64_tr_b16 v[50:51], v4 offset:30720
    s_waitcnt lgkmcnt(6)
    v_mfma_f32_32x32x16_bf16 v[80:95], v[36:39], a[8:11], v[80:95]
    ds_read_b64_tr_b16 v[52:53], v5 offset:28672
    ds_read_b64_tr_b16 v[54:55], v5 offset:30720
    s_waitcnt lgkmcnt(6)
    v_mfma_f32_32x32x16_bf16 v[96:111], v[40:43], a[8:11], v[96:111]
    ds_read_b64_tr_b16 v[56:57], v6 offset:28672
    ds_read_b64_tr_b16 v[58:59], v6 offset:30720
    s_waitcnt lgkmcnt(6)
    v_mfma_f32_32x32x16_bf16 v[112:127], v[44:47], a[8:11], v[112:127]
    s_waitcnt vmcnt(10)
    s_barrier
    ds_read_b64_tr_b16 v[60:61], v7 offset:28672
    ds_read_b64_tr_b16 v[62:63], v7 offset:30720
    s_waitcnt lgkmcnt(6)
    v_mfma_f32_32x32x16_bf16 v[64:79], v[48:51], a[12:15], v[64:79]
    ds_read_b64_tr_b16 v[32:33], v4 offset:32768
    ds_read_b64_tr_b16 v[34:35], v4 offset:34816
    s_add_u32 m0, s54, 98304
    s_lshl_b32 s39, s54, 2
    s_add_u32 s39, s39, s52
    s_lshl_b32 s38, s48, 19
    s_add_u32 s38, s38, 262144
    s_add_u32 s38, s38, s39
    buffer_load_dwordx4 v8, s[68:71], s38 offen offset:0 lds
    s_waitcnt lgkmcnt(6)
    v_mfma_f32_32x32x16_bf16 v[80:95], v[52:55], a[12:15], v[80:95]
    ds_read_b64_tr_b16 v[36:37], v5 offset:32768
    ds_read_b64_tr_b16 v[38:39], v5 offset:34816
    s_waitcnt lgkmcnt(6)
    v_mfma_f32_32x32x16_bf16 v[96:111], v[56:59], a[12:15], v[96:111]
    ds_read_b64_tr_b16 v[40:41], v6 offset:32768
    ds_read_b64_tr_b16 v[42:43], v6 offset:34816
    s_add_u32 m0, s54, 98304
    s_lshl_b32 s39, s54, 2
    s_add_u32 s39, s39, s52
    s_lshl_b32 s38, s48, 19
    s_add_u32 s38, s38, 262144
    s_add_u32 s38, s38, s39
    buffer_load_dwordx4 v9, s[68:71], s38 offen offset:1024 lds
    s_waitcnt lgkmcnt(6)
    v_mfma_f32_32x32x16_bf16 v[112:127], v[60:63], a[12:15], v[112:127]
    ds_read_b64_tr_b16 v[44:45], v7 offset:32768
    ds_read_b64_tr_b16 v[46:47], v7 offset:34816
    s_waitcnt vmcnt(11) lgkmcnt(6)
    v_mfma_f32_32x32x16_bf16 v[64:79], v[32:35], a[16:19], v[64:79]
    ds_read_b64_tr_b16 v[48:49], v4 offset:36864
    ds_read_b64_tr_b16 v[50:51], v4 offset:38912
    s_add_u32 s38, s53, 16384
    buffer_load_dwordx4 a[48:51], v2, s[28:31], s38 offen offset:0 sc1
    s_waitcnt lgkmcnt(6)
    v_mfma_f32_32x32x16_bf16 v[80:95], v[36:39], a[16:19], v[80:95]
    ds_read_b64_tr_b16 v[52:53], v5 offset:36864
    ds_read_b64_tr_b16 v[54:55], v5 offset:38912
    s_waitcnt lgkmcnt(6)
    v_mfma_f32_32x32x16_bf16 v[96:111], v[40:43], a[16:19], v[96:111]
    ds_read_b64_tr_b16 v[56:57], v6 offset:36864
    ds_read_b64_tr_b16 v[58:59], v6 offset:38912
    s_add_u32 s38, s53, 16384
    buffer_load_dwordx4 a[52:55], v2, s[28:31], s38 offen offset:1024 sc1
    s_waitcnt lgkmcnt(6)
    v_mfma_f32_32x32x16_bf16 v[112:127], v[44:47], a[16:19], v[112:127]
    ds_read_b64_tr_b16 v[60:61], v7 offset:36864
    ds_read_b64_tr_b16 v[62:63], v7 offset:38912
    s_waitcnt vmcnt(12) lgkmcnt(6)
    v_mfma_f32_32x32x16_bf16 v[64:79], v[48:51], a[20:23], v[64:79]
    ds_read_b64_tr_b16 v[32:33], v4 offset:40960
    ds_read_b64_tr_b16 v[34:35], v4 offset:43008
    s_add_u32 s38, s53, 16384
    buffer_load_dwordx4 a[56:59], v2, s[28:31], s38 offen offset:2048 sc1
    s_waitcnt lgkmcnt(6)
    v_mfma_f32_32x32x16_bf16 v[80:95], v[52:55], a[20:23], v[80:95]
    ds_read_b64_tr_b16 v[36:37], v5 offset:40960
    ds_read_b64_tr_b16 v[38:39], v5 offset:43008
    s_waitcnt lgkmcnt(6)
    v_mfma_f32_32x32x16_bf16 v[96:111], v[56:59], a[20:23], v[96:111]
    ds_read_b64_tr_b16 v[40:41], v6 offset:40960
    ds_read_b64_tr_b16 v[42:43], v6 offset:43008
    s_add_u32 s38, s53, 16384
    buffer_load_dwordx4 a[60:63], v2, s[28:31], s38 offen offset:3072 sc1
    s_waitcnt lgkmcnt(6)
    v_mfma_f32_32x32x16_bf16 v[112:127], v[60:63], a[20:23], v[112:127]
    ds_read_b64_tr_b16 v[44:45], v7 offset:40960
    ds_read_b64_tr_b16 v[46:47], v7 offset:43008
    s_waitcnt vmcnt(13) lgkmcnt(6)
    v_mfma_f32_32x32x16_bf16 v[64:79], v[32:35], a[24:27], v[64:79]
    ds_read_b64_tr_b16 v[48:49], v4 offset:45056
    ds_read_b64_tr_b16 v[50:51], v4 offset:47104
    s_waitcnt lgkmcnt(6)
    v_mfma_f32_32x32x16_bf16 v[80:95], v[36:39], a[24:27], v[80:95]
    ds_read_b64_tr_b16 v[52:53], v5 offset:45056
    ds_read_b64_tr_b16 v[54:55], v5 offset:47104
    s_waitcnt lgkmcnt(6)
    v_mfma_f32_32x32x16_bf16 v[96:111], v[40:43], a[24:27], v[96:111]
    ds_read_b64_tr_b16 v[56:57], v6 offset:45056
    ds_read_b64_tr_b16 v[58:59], v6 offset:47104
    s_waitcnt lgkmcnt(6)
    v_mfma_f32_32x32x16_bf16 v[112:127], v[44:47], a[24:27], v[112:127]
    s_waitcnt vmcnt(10)
    s_barrier
    ds_read_b64_tr_b16 v[60:61], v7 offset:45056
    ds_read_b64_tr_b16 v[62:63], v7 offset:47104
    s_waitcnt lgkmcnt(6)
    v_mfma_f32_32x32x16_bf16 v[64:79], v[48:51], a[28:31], v[64:79]
    ds_read_b64_tr_b16 v[32:33], v4 offset:49152
    ds_read_b64_tr_b16 v[34:35], v4 offset:51200
    s_add_u32 m0, s54, 114688
    s_lshl_b32 s39, s54, 2
    s_add_u32 s39, s39, s52
    s_lshl_b32 s38, s48, 19
    s_add_u32 s38, s38, 327680
    s_add_u32 s38, s38, s39
    buffer_load_dwordx4 v8, s[68:71], s38 offen offset:0 lds
    s_waitcnt lgkmcnt(6)
    v_mfma_f32_32x32x16_bf16 v[80:95], v[52:55], a[28:31], v[80:95]
    ds_read_b64_tr_b16 v[36:37], v5 offset:49152
    ds_read_b64_tr_b16 v[38:39], v5 offset:51200
    s_waitcnt lgkmcnt(6)
    v_mfma_f32_32x32x16_bf16 v[96:111], v[56:59], a[28:31], v[96:111]
    ds_read_b64_tr_b16 v[40:41], v6 offset:49152
    ds_read_b64_tr_b16 v[42:43], v6 offset:51200
    s_add_u32 m0, s54, 114688
    s_lshl_b32 s39, s54, 2
    s_add_u32 s39, s39, s52
    s_lshl_b32 s38, s48, 19
    s_add_u32 s38, s38, 327680
    s_add_u32 s38, s38, s39
    buffer_load_dwordx4 v9, s[68:71], s38 offen offset:1024 lds
    s_waitcnt lgkmcnt(6)
    v_mfma_f32_32x32x16_bf16 v[112:127], v[60:63], a[28:31], v[112:127]
    ds_read_b64_tr_b16 v[44:45], v7 offset:49152
    ds_read_b64_tr_b16 v[46:47], v7 offset:51200
    s_waitcnt vmcnt(11) lgkmcnt(6)
    v_mfma_f32_32x32x16_bf16 v[64:79], v[32:35], a[32:35], v[64:79]
    ds_read_b64_tr_b16 v[48:49], v4 offset:53248
    ds_read_b64_tr_b16 v[50:51], v4 offset:55296
    s_add_u32 s38, s53, 20480
    buffer_load_dwordx4 a[0:3], v2, s[28:31], s38 offen offset:0 sc1
    s_waitcnt lgkmcnt(6)
    v_mfma_f32_32x32x16_bf16 v[80:95], v[36:39], a[32:35], v[80:95]
    ds_read_b64_tr_b16 v[52:53], v5 offset:53248
    ds_read_b64_tr_b16 v[54:55], v5 offset:55296
    s_waitcnt lgkmcnt(6)
    v_mfma_f32_32x32x16_bf16 v[96:111], v[40:43], a[32:35], v[96:111]
    ds_read_b64_tr_b16 v[56:57], v6 offset:53248
    ds_read_b64_tr_b16 v[58:59], v6 offset:55296
    s_add_u32 s38, s53, 20480
    buffer_load_dwordx4 a[4:7], v2, s[28:31], s38 offen offset:1024 sc1
    s_waitcnt lgkmcnt(6)
    v_mfma_f32_32x32x16_bf16 v[112:127], v[44:47], a[32:35], v[112:127]
    ds_read_b64_tr_b16 v[60:61], v7 offset:53248
    ds_read_b64_tr_b16 v[62:63], v7 offset:55296
    s_waitcnt vmcnt(12) lgkmcnt(6)
    v_mfma_f32_32x32x16_bf16 v[64:79], v[48:51], a[36:39], v[64:79]
    ds_read_b64_tr_b16 v[32:33], v4 offset:57344
    ds_read_b64_tr_b16 v[34:35], v4 offset:59392
    s_add_u32 s38, s53, 20480
    buffer_load_dwordx4 a[8:11], v2, s[28:31], s38 offen offset:2048 sc1
    s_waitcnt lgkmcnt(6)
    v_mfma_f32_32x32x16_bf16 v[80:95], v[52:55], a[36:39], v[80:95]
    ds_read_b64_tr_b16 v[36:37], v5 offset:57344
    ds_read_b64_tr_b16 v[38:39], v5 offset:59392
    s_waitcnt lgkmcnt(6)
    v_mfma_f32_32x32x16_bf16 v[96:111], v[56:59], a[36:39], v[96:111]
    ds_read_b64_tr_b16 v[40:41], v6 offset:57344
    ds_read_b64_tr_b16 v[42:43], v6 offset:59392
    s_add_u32 s38, s53, 20480
    buffer_load_dwordx4 a[12:15], v2, s[28:31], s38 offen offset:3072 sc1
    s_waitcnt lgkmcnt(6)
    v_mfma_f32_32x32x16_bf16 v[112:127], v[60:63], a[36:39], v[112:127]
    ds_read_b64_tr_b16 v[44:45], v7 offset:57344
    ds_read_b64_tr_b16 v[46:47], v7 offset:59392
    s_waitcnt vmcnt(13) lgkmcnt(6)
    v_mfma_f32_32x32x16_bf16 v[64:79], v[32:35], a[40:43], v[64:79]
    ds_read_b64_tr_b16 v[48:49], v4 offset:61440
    ds_read_b64_tr_b16 v[50:51], v4 offset:63488
    s_waitcnt lgkmcnt(6)
    v_mfma_f32_32x32x16_bf16 v[80:95], v[36:39], a[40:43], v[80:95]
    ds_read_b64_tr_b16 v[52:53], v5 offset:61440
    ds_read_b64_tr_b16 v[54:55], v5 offset:63488
    s_waitcnt lgkmcnt(6)
    v_mfma_f32_32x32x16_bf16 v[96:111], v[40:43], a[40:43], v[96:111]
    ds_read_b64_tr_b16 v[56:57], v6 offset:61440
    ds_read_b64_tr_b16 v[58:59], v6 offset:63488
    s_waitcnt lgkmcnt(6)
    v_mfma_f32_32x32x16_bf16 v[112:127], v[44:47], a[40:43], v[112:127]
    s_waitcnt vmcnt(10)
    s_barrier
    ds_read_b64_tr_b16 v[60:61], v7 offset:61440
    ds_read_b64_tr_b16 v[62:63], v7 offset:63488
    s_waitcnt lgkmcnt(6)
    v_mfma_f32_32x32x16_bf16 v[64:79], v[48:51], a[44:47], v[64:79]
    ds_read_b64_tr_b16 v[32:33], v4 offset:0
    ds_read_b64_tr_b16 v[34:35], v4 offset:2048
    s_add_u32 m0, s54, 131072
    s_lshl_b32 s39, s54, 2
    s_add_u32 s39, s39, s52
    s_lshl_b32 s38, s48, 19
    s_add_u32 s38, s38, 393216
    s_add_u32 s38, s38, s39
    buffer_load_dwordx4 v8, s[68:71], s38 offen offset:0 lds
    s_waitcnt lgkmcnt(6)
    v_mfma_f32_32x32x16_bf16 v[80:95], v[52:55], a[44:47], v[80:95]
    ds_read_b64_tr_b16 v[36:37], v5 offset:0
    ds_read_b64_tr_b16 v[38:39], v5 offset:2048
    s_waitcnt lgkmcnt(6)
    v_mfma_f32_32x32x16_bf16 v[96:111], v[56:59], a[44:47], v[96:111]
    ds_read_b64_tr_b16 v[40:41], v6 offset:0
    ds_read_b64_tr_b16 v[42:43], v6 offset:2048
    s_add_u32 m0, s54, 131072
    s_lshl_b32 s39, s54, 2
    s_add_u32 s39, s39, s52
    s_lshl_b32 s38, s48, 19
    s_add_u32 s38, s38, 393216
    s_add_u32 s38, s38, s39
    buffer_load_dwordx4 v9, s[68:71], s38 offen offset:1024 lds
    s_waitcnt lgkmcnt(6)
    v_mfma_f32_32x32x16_bf16 v[112:127], v[60:63], a[44:47], v[112:127]
    ds_read_b64_tr_b16 v[44:45], v7 offset:0
    ds_read_b64_tr_b16 v[46:47], v7 offset:2048
    s_waitcnt vmcnt(11) lgkmcnt(6)
    v_mfma_f32_32x32x16_bf16 v[64:79], v[32:35], a[48:51], v[64:79]
    ds_read_b64_tr_b16 v[48:49], v4 offset:4096
    ds_read_b64_tr_b16 v[50:51], v4 offset:6144
    s_add_u32 s38, s53, 24576
    buffer_load_dwordx4 a[16:19], v2, s[28:31], s38 offen offset:0 sc1
    s_waitcnt lgkmcnt(6)
    v_mfma_f32_32x32x16_bf16 v[80:95], v[36:39], a[48:51], v[80:95]
    ds_read_b64_tr_b16 v[52:53], v5 offset:4096
    ds_read_b64_tr_b16 v[54:55], v5 offset:6144
    s_waitcnt lgkmcnt(6)
    v_mfma_f32_32x32x16_bf16 v[96:111], v[40:43], a[48:51], v[96:111]
    ds_read_b64_tr_b16 v[56:57], v6 offset:4096
    ds_read_b64_tr_b16 v[58:59], v6 offset:6144
    s_add_u32 s38, s53, 24576
    buffer_load_dwordx4 a[20:23], v2, s[28:31], s38 offen offset:1024 sc1
    s_waitcnt lgkmcnt(6)
    v_mfma_f32_32x32x16_bf16 v[112:127], v[44:47], a[48:51], v[112:127]
    ds_read_b64_tr_b16 v[60:61], v7 offset:4096
    ds_read_b64_tr_b16 v[62:63], v7 offset:6144
    s_waitcnt vmcnt(12) lgkmcnt(6)
    v_mfma_f32_32x32x16_bf16 v[64:79], v[48:51], a[52:55], v[64:79]
    ds_read_b64_tr_b16 v[32:33], v4 offset:8192
    ds_read_b64_tr_b16 v[34:35], v4 offset:10240
    s_add_u32 s38, s53, 24576
    buffer_load_dwordx4 a[24:27], v2, s[28:31], s38 offen offset:2048 sc1
    s_waitcnt lgkmcnt(6)
    v_mfma_f32_32x32x16_bf16 v[80:95], v[52:55], a[52:55], v[80:95]
    ds_read_b64_tr_b16 v[36:37], v5 offset:8192
    ds_read_b64_tr_b16 v[38:39], v5 offset:10240
    s_waitcnt lgkmcnt(6)
    v_mfma_f32_32x32x16_bf16 v[96:111], v[56:59], a[52:55], v[96:111]
    ds_read_b64_tr_b16 v[40:41], v6 offset:8192
    ds_read_b64_tr_b16 v[42:43], v6 offset:10240
    s_add_u32 s38, s53, 24576
    buffer_load_dwordx4 a[28:31], v2, s[28:31], s38 offen offset:3072 sc1
    s_waitcnt lgkmcnt(6)
    v_mfma_f32_32x32x16_bf16 v[112:127], v[60:63], a[52:55], v[112:127]
    ds_read_b64_tr_b16 v[44:45], v7 offset:8192
    ds_read_b64_tr_b16 v[46:47], v7 offset:10240
    s_waitcnt vmcnt(13) lgkmcnt(6)
    v_mfma_f32_32x32x16_bf16 v[64:79], v[32:35], a[56:59], v[64:79]
    ds_read_b64_tr_b16 v[48:49], v4 offset:12288
    ds_read_b64_tr_b16 v[50:51], v4 offset:14336
    s_waitcnt lgkmcnt(6)
    v_mfma_f32_32x32x16_bf16 v[80:95], v[36:39], a[56:59], v[80:95]
    ds_read_b64_tr_b16 v[52:53], v5 offset:12288
    ds_read_b64_tr_b16 v[54:55], v5 offset:14336
    s_waitcnt lgkmcnt(6)
    v_mfma_f32_32x32x16_bf16 v[96:111], v[40:43], a[56:59], v[96:111]
    ds_read_b64_tr_b16 v[56:57], v6 offset:12288
    ds_read_b64_tr_b16 v[58:59], v6 offset:14336
    s_waitcnt lgkmcnt(6)
    v_mfma_f32_32x32x16_bf16 v[112:127], v[44:47], a[56:59], v[112:127]
    s_waitcnt vmcnt(10)
    s_barrier
    ds_read_b64_tr_b16 v[60:61], v7 offset:12288
    ds_read_b64_tr_b16 v[62:63], v7 offset:14336
    s_waitcnt lgkmcnt(6)
    v_mfma_f32_32x32x16_bf16 v[64:79], v[48:51], a[60:63], v[64:79]
    ds_read_b64_tr_b16 v[32:33], v4 offset:16384
    ds_read_b64_tr_b16 v[34:35], v4 offset:18432
    s_add_u32 m0, s54, 147456
    s_lshl_b32 s39, s54, 2
    s_add_u32 s39, s39, s52
    s_lshl_b32 s38, s48, 19
    s_add_u32 s38, s38, 458752
    s_add_u32 s38, s38, s39
    buffer_load_dwordx4 v8, s[68:71], s38 offen offset:0 lds
    s_waitcnt lgkmcnt(6)
    v_mfma_f32_32x32x16_bf16 v[80:95], v[52:55], a[60:63], v[80:95]
    ds_read_b64_tr_b16 v[36:37], v5 offset:16384
    ds_read_b64_tr_b16 v[38:39], v5 offset:18432
    s_waitcnt lgkmcnt(6)
    v_mfma_f32_32x32x16_bf16 v[96:111], v[56:59], a[60:63], v[96:111]
    ds_read_b64_tr_b16 v[40:41], v6 offset:16384
    ds_read_b64_tr_b16 v[42:43], v6 offset:18432
    s_add_u32 m0, s54, 147456
    s_lshl_b32 s39, s54, 2
    s_add_u32 s39, s39, s52
    s_lshl_b32 s38, s48, 19
    s_add_u32 s38, s38, 458752
    s_add_u32 s38, s38, s39
    buffer_load_dwordx4 v9, s[68:71], s38 offen offset:1024 lds
    s_waitcnt lgkmcnt(6)
    v_mfma_f32_32x32x16_bf16 v[112:127], v[60:63], a[60:63], v[112:127]
    ds_read_b64_tr_b16 v[44:45], v7 offset:16384
    ds_read_b64_tr_b16 v[46:47], v7 offset:18432
    s_waitcnt vmcnt(11) lgkmcnt(6)
    v_mfma_f32_32x32x16_bf16 v[64:79], v[32:35], a[0:3], v[64:79]
    ds_read_b64_tr_b16 v[48:49], v4 offset:20480
    ds_read_b64_tr_b16 v[50:51], v4 offset:22528
    s_add_u32 s38, s53, 28672
    buffer_load_dwordx4 a[32:35], v2, s[28:31], s38 offen offset:0 sc1
    s_waitcnt lgkmcnt(6)
    v_mfma_f32_32x32x16_bf16 v[80:95], v[36:39], a[0:3], v[80:95]
    ds_read_b64_tr_b16 v[52:53], v5 offset:20480
    ds_read_b64_tr_b16 v[54:55], v5 offset:22528
    s_waitcnt lgkmcnt(6)
    v_mfma_f32_32x32x16_bf16 v[96:111], v[40:43], a[0:3], v[96:111]
    ds_read_b64_tr_b16 v[56:57], v6 offset:20480
    ds_read_b64_tr_b16 v[58:59], v6 offset:22528
    s_add_u32 s38, s53, 28672
    buffer_load_dwordx4 a[36:39], v2, s[28:31], s38 offen offset:1024 sc1
    s_waitcnt lgkmcnt(6)
    v_mfma_f32_32x32x16_bf16 v[112:127], v[44:47], a[0:3], v[112:127]
    ds_read_b64_tr_b16 v[60:61], v7 offset:20480
    ds_read_b64_tr_b16 v[62:63], v7 offset:22528
    s_waitcnt vmcnt(12) lgkmcnt(6)
    v_mfma_f32_32x32x16_bf16 v[64:79], v[48:51], a[4:7], v[64:79]
    ds_read_b64_tr_b16 v[32:33], v4 offset:24576
    ds_read_b64_tr_b16 v[34:35], v4 offset:26624
    s_add_u32 s38, s53, 28672
    buffer_load_dwordx4 a[40:43], v2, s[28:31], s38 offen offset:2048 sc1
    s_waitcnt lgkmcnt(6)
    v_mfma_f32_32x32x16_bf16 v[80:95], v[52:55], a[4:7], v[80:95]
    ds_read_b64_tr_b16 v[36:37], v5 offset:24576
    ds_read_b64_tr_b16 v[38:39], v5 offset:26624
    s_waitcnt lgkmcnt(6)
    v_mfma_f32_32x32x16_bf16 v[96:111], v[56:59], a[4:7], v[96:111]
    ds_read_b64_tr_b16 v[40:41], v6 offset:24576
    ds_read_b64_tr_b16 v[42:43], v6 offset:26624
    s_add_u32 s38, s53, 28672
    buffer_load_dwordx4 a[44:47], v2, s[28:31], s38 offen offset:3072 sc1
    s_waitcnt lgkmcnt(6)
    v_mfma_f32_32x32x16_bf16 v[112:127], v[60:63], a[4:7], v[112:127]
    ds_read_b64_tr_b16 v[44:45], v7 offset:24576
    ds_read_b64_tr_b16 v[46:47], v7 offset:26624
    s_waitcnt vmcnt(13) lgkmcnt(6)
    v_mfma_f32_32x32x16_bf16 v[64:79], v[32:35], a[8:11], v[64:79]
    ds_read_b64_tr_b16 v[48:49], v4 offset:28672
    ds_read_b64_tr_b16 v[50:51], v4 offset:30720
    s_waitcnt lgkmcnt(6)
    v_mfma_f32_32x32x16_bf16 v[80:95], v[36:39], a[8:11], v[80:95]
    ds_read_b64_tr_b16 v[52:53], v5 offset:28672
    ds_read_b64_tr_b16 v[54:55], v5 offset:30720
    s_waitcnt lgkmcnt(6)
    v_mfma_f32_32x32x16_bf16 v[96:111], v[40:43], a[8:11], v[96:111]
    ds_read_b64_tr_b16 v[56:57], v6 offset:28672
    ds_read_b64_tr_b16 v[58:59], v6 offset:30720
    s_waitcnt lgkmcnt(6)
    v_mfma_f32_32x32x16_bf16 v[112:127], v[44:47], a[8:11], v[112:127]
    s_waitcnt vmcnt(10)
    s_barrier
    ds_read_b64_tr_b16 v[60:61], v7 offset:28672
    ds_read_b64_tr_b16 v[62:63], v7 offset:30720
    s_waitcnt lgkmcnt(6)
    v_mfma_f32_32x32x16_bf16 v[64:79], v[48:51], a[12:15], v[64:79]
    ds_read_b64_tr_b16 v[32:33], v4 offset:32768
    ds_read_b64_tr_b16 v[34:35], v4 offset:34816
    s_waitcnt lgkmcnt(6)
    v_mfma_f32_32x32x16_bf16 v[80:95], v[52:55], a[12:15], v[80:95]
    ds_read_b64_tr_b16 v[36:37], v5 offset:32768
    ds_read_b64_tr_b16 v[38:39], v5 offset:34816
    s_waitcnt lgkmcnt(6)
    v_mfma_f32_32x32x16_bf16 v[96:111], v[56:59], a[12:15], v[96:111]
    ds_read_b64_tr_b16 v[40:41], v6 offset:32768
    ds_read_b64_tr_b16 v[42:43], v6 offset:34816
    s_waitcnt lgkmcnt(6)
    v_mfma_f32_32x32x16_bf16 v[112:127], v[60:63], a[12:15], v[112:127]
    ds_read_b64_tr_b16 v[44:45], v7 offset:32768
    ds_read_b64_tr_b16 v[46:47], v7 offset:34816
    s_waitcnt vmcnt(9) lgkmcnt(6)
    v_mfma_f32_32x32x16_bf16 v[64:79], v[32:35], a[16:19], v[64:79]
    ds_read_b64_tr_b16 v[48:49], v4 offset:36864
    ds_read_b64_tr_b16 v[50:51], v4 offset:38912
    s_waitcnt lgkmcnt(6)
    v_mfma_f32_32x32x16_bf16 v[80:95], v[36:39], a[16:19], v[80:95]
    ds_read_b64_tr_b16 v[52:53], v5 offset:36864
    ds_read_b64_tr_b16 v[54:55], v5 offset:38912
    s_waitcnt lgkmcnt(6)
    v_mfma_f32_32x32x16_bf16 v[96:111], v[40:43], a[16:19], v[96:111]
    ds_read_b64_tr_b16 v[56:57], v6 offset:36864
    ds_read_b64_tr_b16 v[58:59], v6 offset:38912
    s_waitcnt lgkmcnt(6)
    v_mfma_f32_32x32x16_bf16 v[112:127], v[44:47], a[16:19], v[112:127]
    ds_read_b64_tr_b16 v[60:61], v7 offset:36864
    ds_read_b64_tr_b16 v[62:63], v7 offset:38912
    s_waitcnt vmcnt(8) lgkmcnt(6)
    v_mfma_f32_32x32x16_bf16 v[64:79], v[48:51], a[20:23], v[64:79]
    ds_read_b64_tr_b16 v[32:33], v4 offset:40960
    ds_read_b64_tr_b16 v[34:35], v4 offset:43008
    s_waitcnt lgkmcnt(6)
    v_mfma_f32_32x32x16_bf16 v[80:95], v[52:55], a[20:23], v[80:95]
    ds_read_b64_tr_b16 v[36:37], v5 offset:40960
    ds_read_b64_tr_b16 v[38:39], v5 offset:43008
    s_waitcnt lgkmcnt(6)
    v_mfma_f32_32x32x16_bf16 v[96:111], v[56:59], a[20:23], v[96:111]
    ds_read_b64_tr_b16 v[40:41], v6 offset:40960
    ds_read_b64_tr_b16 v[42:43], v6 offset:43008
    s_waitcnt lgkmcnt(6)
    v_mfma_f32_32x32x16_bf16 v[112:127], v[60:63], a[20:23], v[112:127]
    ds_read_b64_tr_b16 v[44:45], v7 offset:40960
    ds_read_b64_tr_b16 v[46:47], v7 offset:43008
    s_waitcnt vmcnt(7) lgkmcnt(6)
    v_mfma_f32_32x32x16_bf16 v[64:79], v[32:35], a[24:27], v[64:79]
    ds_read_b64_tr_b16 v[48:49], v4 offset:45056
    ds_read_b64_tr_b16 v[50:51], v4 offset:47104
    s_waitcnt lgkmcnt(6)
    v_mfma_f32_32x32x16_bf16 v[80:95], v[36:39], a[24:27], v[80:95]
    ds_read_b64_tr_b16 v[52:53], v5 offset:45056
    ds_read_b64_tr_b16 v[54:55], v5 offset:47104
    s_waitcnt lgkmcnt(6)
    v_mfma_f32_32x32x16_bf16 v[96:111], v[40:43], a[24:27], v[96:111]
    ds_read_b64_tr_b16 v[56:57], v6 offset:45056
    ds_read_b64_tr_b16 v[58:59], v6 offset:47104
    s_waitcnt lgkmcnt(6)
    v_mfma_f32_32x32x16_bf16 v[112:127], v[44:47], a[24:27], v[112:127]
    s_waitcnt vmcnt(4)
    s_barrier
    ds_read_b64_tr_b16 v[60:61], v7 offset:45056
    ds_read_b64_tr_b16 v[62:63], v7 offset:47104
    s_waitcnt lgkmcnt(6)
    v_mfma_f32_32x32x16_bf16 v[64:79], v[48:51], a[28:31], v[64:79]
    ds_read_b64_tr_b16 v[32:33], v4 offset:49152
    ds_read_b64_tr_b16 v[34:35], v4 offset:51200
    s_waitcnt lgkmcnt(6)
    v_mfma_f32_32x32x16_bf16 v[80:95], v[52:55], a[28:31], v[80:95]
    ds_read_b64_tr_b16 v[36:37], v4 offset:53248
    ds_read_b64_tr_b16 v[38:39], v4 offset:55296
    s_waitcnt lgkmcnt(6)
    v_mfma_f32_32x32x16_bf16 v[96:111], v[56:59], a[28:31], v[96:111]
    ds_read_b64_tr_b16 v[40:41], v4 offset:57344
    ds_read_b64_tr_b16 v[42:43], v4 offset:59392
    s_waitcnt lgkmcnt(6)
    v_mfma_f32_32x32x16_bf16 v[112:127], v[60:63], a[28:31], v[112:127]
    ds_read_b64_tr_b16 v[44:45], v4 offset:61440
    ds_read_b64_tr_b16 v[46:47], v4 offset:63488
    s_waitcnt vmcnt(3) lgkmcnt(6)
    v_mfma_f32_32x32x16_bf16 v[64:79], v[32:35], a[32:35], v[64:79]
    ds_read_b64_tr_b16 v[48:49], v5 offset:49152
    ds_read_b64_tr_b16 v[50:51], v5 offset:51200
    s_lshl_b32 s38, s48, 6
    s_add_u32 s38, s38, s64
    s_lshl_b32 s38, s38, 4
    s_lshl_b32 s39, s50, 2
    s_add_u32 s38, s38, s39
    s_lshl_b32 s38, s38, 11
    s_add_u32 s46, s38, 67108864
    s_waitcnt vmcnt(2) lgkmcnt(6)
    v_mfma_f32_32x32x16_bf16 v[64:79], v[36:39], a[36:39], v[64:79]
    ds_read_b64_tr_b16 v[52:53], v5 offset:53248
    ds_read_b64_tr_b16 v[54:55], v5 offset:55296
    s_waitcnt vmcnt(1) lgkmcnt(6)
    v_mfma_f32_32x32x16_bf16 v[64:79], v[40:43], a[40:43], v[64:79]
    ds_read_b64_tr_b16 v[56:57], v5 offset:57344
    ds_read_b64_tr_b16 v[58:59], v5 offset:59392
    s_waitcnt vmcnt(0) lgkmcnt(6)
    v_mfma_f32_32x32x16_bf16 v[64:79], v[44:47], a[44:47], v[64:79]
    ds_read_b64_tr_b16 v[60:61], v5 offset:61440
    ds_read_b64_tr_b16 v[62:63], v5 offset:63488
    s_waitcnt lgkmcnt(6)
    v_mfma_f32_32x32x16_bf16 v[80:95], v[48:51], a[32:35], v[80:95]
    ds_read_b64_tr_b16 v[32:33], v6 offset:49152
    ds_read_b64_tr_b16 v[34:35], v6 offset:51200
    s_waitcnt lgkmcnt(6)
    v_mfma_f32_32x32x16_bf16 v[80:95], v[52:55], a[36:39], v[80:95]
    ds_read_b64_tr_b16 v[36:37], v6 offset:53248
    ds_read_b64_tr_b16 v[38:39], v6 offset:55296
    s_nop 1
    v_cvt_pk_bf16_f32 v64, v64, v65
    v_cvt_pk_bf16_f32 v65, v66, v67
    v_cvt_pk_bf16_f32 v66, v68, v69
    v_cvt_pk_bf16_f32 v67, v70, v71
    buffer_store_dwordx4 v[64:67], v2, s[28:31], s46 offen offset:0 sc1
    s_waitcnt lgkmcnt(6)
    v_mfma_f32_32x32x16_bf16 v[80:95], v[56:59], a[40:43], v[80:95]
    ds_read_b64_tr_b16 v[40:41], v6 offset:57344
    ds_read_b64_tr_b16 v[42:43], v6 offset:59392
    v_cvt_pk_bf16_f32 v68, v72, v73
    v_cvt_pk_bf16_f32 v69, v74, v75
    v_cvt_pk_bf16_f32 v70, v76, v77
    v_cvt_pk_bf16_f32 v71, v78, v79
    buffer_store_dwordx4 v[68:71], v2, s[28:31], s46 offen offset:1024 sc1
    s_waitcnt lgkmcnt(6)
    v_mfma_f32_32x32x16_bf16 v[80:95], v[60:63], a[44:47], v[80:95]
    ds_read_b64_tr_b16 v[44:45], v6 offset:61440
    ds_read_b64_tr_b16 v[46:47], v6 offset:63488
    s_waitcnt lgkmcnt(6)
    v_mfma_f32_32x32x16_bf16 v[96:111], v[32:35], a[32:35], v[96:111]
    ds_read_b64_tr_b16 v[48:49], v7 offset:49152
    ds_read_b64_tr_b16 v[50:51], v7 offset:51200
    s_waitcnt lgkmcnt(6)
    v_mfma_f32_32x32x16_bf16 v[96:111], v[36:39], a[36:39], v[96:111]
    ds_read_b64_tr_b16 v[52:53], v7 offset:53248
    ds_read_b64_tr_b16 v[54:55], v7 offset:55296
    s_nop 1
    v_cvt_pk_bf16_f32 v80, v80, v81
    v_cvt_pk_bf16_f32 v81, v82, v83
    v_cvt_pk_bf16_f32 v82, v84, v85
    v_cvt_pk_bf16_f32 v83, v86, v87
    buffer_store_dwordx4 v[80:83], v2, s[28:31], s46 offen offset:2048 sc1
    s_waitcnt lgkmcnt(6)
    v_mfma_f32_32x32x16_bf16 v[96:111], v[40:43], a[40:43], v[96:111]
    ds_read_b64_tr_b16 v[56:57], v7 offset:57344
    ds_read_b64_tr_b16 v[58:59], v7 offset:59392
    v_cvt_pk_bf16_f32 v84, v88, v89
    v_cvt_pk_bf16_f32 v85, v90, v91
    v_cvt_pk_bf16_f32 v86, v92, v93
    v_cvt_pk_bf16_f32 v87, v94, v95
    buffer_store_dwordx4 v[84:87], v2, s[28:31], s46 offen offset:3072 sc1
    s_waitcnt lgkmcnt(6)
    v_mfma_f32_32x32x16_bf16 v[96:111], v[44:47], a[44:47], v[96:111]
    ds_read_b64_tr_b16 v[60:61], v7 offset:61440
    ds_read_b64_tr_b16 v[62:63], v7 offset:63488
    s_waitcnt lgkmcnt(6)
    v_mfma_f32_32x32x16_bf16 v[112:127], v[48:51], a[32:35], v[112:127]
    s_waitcnt lgkmcnt(4)
    v_mfma_f32_32x32x16_bf16 v[112:127], v[52:55], a[36:39], v[112:127]
    s_nop 5
    v_cvt_pk_bf16_f32 v96, v96, v97
    v_cvt_pk_bf16_f32 v97, v98, v99
    v_cvt_pk_bf16_f32 v98, v100, v101
    s_nop 2
    v_cvt_pk_bf16_f32 v99, v102, v103
    s_add_u32 s46, s46, 4096
    buffer_store_dwordx4 v[96:99], v2, s[28:31], s46 offen offset:0 sc1
    s_waitcnt lgkmcnt(2)
    v_mfma_f32_32x32x16_bf16 v[112:127], v[56:59], a[40:43], v[112:127]
    v_cvt_pk_bf16_f32 v100, v104, v105
    v_cvt_pk_bf16_f32 v101, v106, v107
    v_cvt_pk_bf16_f32 v102, v108, v109
    v_cvt_pk_bf16_f32 v103, v110, v111
    buffer_store_dwordx4 v[100:103], v2, s[28:31], s46 offen offset:1024 sc1
    s_waitcnt lgkmcnt(0)
    v_mfma_f32_32x32x16_bf16 v[112:127], v[60:63], a[44:47], v[112:127]
    s_nop 11
    v_cvt_pk_bf16_f32 v112, v112, v113
    v_cvt_pk_bf16_f32 v113, v114, v115
    v_cvt_pk_bf16_f32 v114, v116, v117
    v_cvt_pk_bf16_f32 v115, v118, v119
    buffer_store_dwordx4 v[112:115], v2, s[28:31], s46 offen offset:2048 sc1
    v_cvt_pk_bf16_f32 v116, v120, v121
    v_cvt_pk_bf16_f32 v117, v122, v123
    v_cvt_pk_bf16_f32 v118, v124, v125
    v_cvt_pk_bf16_f32 v119, v126, v127
    s_nop 2
    buffer_store_dwordx4 v[116:119], v2, s[28:31], s46 offen offset:3072 sc1
    s_branch K3_epi
K3_B:
    ds_read_b64_tr_b16 v[32:33], v4 offset:16384
    ds_read_b64_tr_b16 v[34:35], v4 offset:18432
    ds_read_b64_tr_b16 v[36:37], v5 offset:16384
    ds_read_b64_tr_b16 v[38:39], v5 offset:18432
    ds_read_b64_tr_b16 v[40:41], v6 offset:16384
    ds_read_b64_tr_b16 v[42:43], v6 offset:18432
    ds_read_b64_tr_b16 v[44:45], v7 offset:16384
    ds_read_b64_tr_b16 v[46:47], v7 offset:18432
    s_waitcnt vmcnt(11) lgkmcnt(6)
    v_mfma_f32_32x32x16_bf16 v[64:79], v[32:35], a[0:3], 0
    ds_read_b64_tr_b16 v[48:49], v4 offset:20480
    ds_read_b64_tr_b16 v[50:51], v4 offset:22528
    s_waitcnt lgkmcnt(6)
    v_mfma_f32_32x32x16_bf16 v[80:95], v[36:39], a[0:3], 0
    ds_read_b64_tr_b16 v[52:53], v5 offset:20480
    ds_read_b64_tr_b16 v[54:55], v5 offset:22528
    s_waitcnt lgkmcnt(6)
    v_mfma_f32_32x32x16_bf16 v[96:111], v[40:43], a[0:3], 0
    ds_read_b64_tr_b16 v[56:57], v6 offset:20480
    ds_read_b64_tr_b16 v[58:59], v6 offset:22528
    s_waitcnt lgkmcnt(6)
    v_mfma_f32_32x32x16_bf16 v[112:127], v[44:47], a[0:3], 0
    ds_read_b64_tr_b16 v[60:61], v7 offset:20480
    ds_read_b64_tr_b16 v[62:63], v7 offset:22528
    s_waitcnt vmcnt(10) lgkmcnt(6)
    v_mfma_f32_32x32x16_bf16 v[64:79], v[48:51], a[4:7], v[64:79]
    ds_read_b64_tr_b16 v[32:33], v4 offset:24576
    ds_read_b64_tr_b16 v[34:35], v4 offset:26624
    s_waitcnt lgkmcnt(6)
    v_mfma_f32_32x32x16_bf16 v[80:95], v[52:55], a[4:7], v[80:95]
    ds_read_b64_tr_b16 v[36:37], v5 offset:24576
    ds_read_b64_tr_b16 v[38:39], v5 offset:26624
    s_waitcnt lgkmcnt(6)
    v_mfma_f32_32x32x16_bf16 v[96:111], v[56:59], a[4:7], v[96:111]
    ds_read_b64_tr_b16 v[40:41], v6 offset:24576
    ds_read_b64_tr_b16 v[42:43], v6 offset:26624
    s_waitcnt lgkmcnt(6)
    v_mfma_f32_32x32x16_bf16 v[112:127], v[60:63], a[4:7], v[112:127]
    ds_read_b64_tr_b16 v[44:45], v7 offset:24576
    ds_read_b64_tr_b16 v[46:47], v7 offset:26624
    s_waitcnt vmcnt(9) lgkmcnt(6)
    v_mfma_f32_32x32x16_bf16 v[64:79], v[32:35], a[8:11], v[64:79]
    ds_read_b64_tr_b16 v[48:49], v4 offset:28672
    ds_read_b64_tr_b16 v[50:51], v4 offset:30720
    s_waitcnt lgkmcnt(6)
    v_mfma_f32_32x32x16_bf16 v[80:95], v[36:39], a[8:11], v[80:95]
    ds_read_b64_tr_b16 v[52:53], v5 offset:28672
    ds_read_b64_tr_b16 v[54:55], v5 offset:30720
    s_waitcnt lgkmcnt(6)
    v_mfma_f32_32x32x16_bf16 v[96:111], v[40:43], a[8:11], v[96:111]
    ds_read_b64_tr_b16 v[56:57], v6 offset:28672
    ds_read_b64_tr_b16 v[58:59], v6 offset:30720
    s_waitcnt lgkmcnt(6)
    v_mfma_f32_32x32x16_bf16 v[112:127], v[44:47], a[8:11], v[112:127]
    s_barrier
    ds_read_b64_tr_b16 v[60:61], v7 offset:28672
    ds_read_b64_tr_b16 v[62:63], v7 offset:30720
    s_waitcnt vmcnt(8) lgkmcnt(6)
    v_mfma_f32_32x32x16_bf16 v[64:79], v[48:51], a[12:15], v[64:79]
    ds_read_b64_tr_b16 v[32:33], v4 offset:32768
    ds_read_b64_tr_b16 v[34:35], v4 offset:34816
    s_waitcnt lgkmcnt(6)
    v_mfma_f32_32x32x16_bf16 v[80:95], v[52:55], a[12:15], v[80:95]
    ds_read_b64_tr_b16 v[36:37], v5 offset:32768
    ds_read_b64_tr_b16 v[38:39], v5 offset:34816
    s_waitcnt lgkmcnt(6)
    v_mfma_f32_32x32x16_bf16 v[96:111], v[56:59], a[12:15], v[96:111]
    ds_read_b64_tr_b16 v[40:41], v6 offset:32768
    ds_read_b64_tr_b16 v[42:43], v6 offset:34816
    s_waitcnt lgkmcnt(6)
    v_mfma_f32_32x32x16_bf16 v[112:127], v[60:63], a[12:15], v[112:127]
    ds_read_b64_tr_b16 v[44:45], v7 offset:32768
    ds_read_b64_tr_b16 v[46:47], v7 offset:34816
    s_waitcnt vmcnt(7) lgkmcnt(6)
    v_mfma_f32_32x32x16_bf16 v[64:79], v[32:35], a[16:19], v[64:79]
    ds_read_b64_tr_b16 v[48:49], v4 offset:36864
    ds_read_b64_tr_b16 v[50:51], v4 offset:38912
    s_waitcnt lgkmcnt(6)
    v_mfma_f32_32x32x16_bf16 v[80:95], v[36:39], a[16:19], v[80:95]
    ds_read_b64_tr_b16 v[52:53], v5 offset:36864
    ds_read_b64_tr_b16 v[54:55], v5 offset:38912
    s_add_u32 m0, s54, 98304
    s_lshl_b32 s39, s54, 2
    s_add_u32 s39, s39, s52
    s_lshl_b32 s38, s48, 19
    s_add_u32 s38, s38, 0
    s_add_u32 s38, s38, s39
    buffer_load_dwordx4 v8, s[68:71], s38 offen offset:0 lds
    s_waitcnt lgkmcnt(6)
    v_mfma_f32_32x32x16_bf16 v[96:111], v[40:43], a[16:19], v[96:111]
    ds_read_b64_tr_b16 v[56:57], v6 offset:36864
    ds_read_b64_tr_b16 v[58:59], v6 offset:38912
    s_waitcnt lgkmcnt(6)
    v_mfma_f32_32x32x16_bf16 v[112:127], v[44:47], a[16:19], v[112:127]
    ds_read_b64_tr_b16 v[60:61], v7 offset:36864
    ds_read_b64_tr_b16 v[62:63], v7 offset:38912
    s_add_u32 m0, s54, 98304
    s_lshl_b32 s39, s54, 2
    s_add_u32 s39, s39, s52
    s_lshl_b32 s38, s48, 19
    s_add_u32 s38, s38, 0
    s_add_u32 s38, s38, s39
    buffer_load_dwordx4 v9, s[68:71], s38 offen offset:1024 lds
    s_waitcnt vmcnt(8) lgkmcnt(6)
    v_mfma_f32_32x32x16_bf16 v[64:79], v[48:51], a[20:23], v[64:79]
    ds_read_b64_tr_b16 v[32:33], v4 offset:40960
    ds_read_b64_tr_b16 v[34:35], v4 offset:43008
    s_waitcnt lgkmcnt(6)
    v_mfma_f32_32x32x16_bf16 v[80:95], v[52:55], a[20:23], v[80:95]
    ds_read_b64_tr_b16 v[36:37], v5 offset:40960
    ds_read_b64_tr_b16 v[38:39], v5 offset:43008
    s_add_u32 s38, s53, 0
    buffer_load_dwordx4 a[48:51], v2, s[28:31], s38 offen offset:0 sc1
    s_waitcnt lgkmcnt(6)
    v_mfma_f32_32x32x16_bf16 v[96:111], v[56:59], a[20:23], v[96:111]
    ds_read_b64_tr_b16 v[40:41], v6 offset:40960
    ds_read_b64_tr_b16 v[42:43], v6 offset:43008
    s_waitcnt lgkmcnt(6)
    v_mfma_f32_32x32x16_bf16 v[112:127], v[60:63], a[20:23], v[112:127]
    ds_read_b64_tr_b16 v[44:45], v7 offset:40960
    ds_read_b64_tr_b16 v[46:47], v7 offset:43008
    s_add_u32 s38, s53, 0
    buffer_load_dwordx4 a[52:55], v2, s[28:31], s38 offen offset:1024 sc1
    s_waitcnt vmcnt(9) lgkmcnt(6)
    v_mfma_f32_32x32x16_bf16 v[64:79], v[32:35], a[24:27], v[64:79]
    ds_read_b64_tr_b16 v[48:49], v4 offset:45056
    ds_read_b64_tr_b16 v[50:51], v4 offset:47104
    s_waitcnt lgkmcnt(6)
    v_mfma_f32_32x32x16_bf16 v[80:95], v[36:39], a[24:27], v[80:95]
    ds_read_b64_tr_b16 v[52:53], v5 offset:45056
    ds_read_b64_tr_b16 v[54:55], v5 offset:47104
    s_add_u32 s38, s53, 0
    buffer_load_dwordx4 a[56:59], v2, s[28:31], s38 offen offset:2048 sc1
    s_waitcnt lgkmcnt(6)
    v_mfma_f32_32x32x16_bf16 v[96:111], v[40:43], a[24:27], v[96:111]
    ds_read_b64_tr_b16 v[56:57], v6 offset:45056
    ds_read_b64_tr_b16 v[58:59], v6 offset:47104
    s_waitcnt lgkmcnt(6)
    v_mfma_f32_32x32x16_bf16 v[112:127], v[44:47], a[24:27], v[112:127]
    s_barrier
    ds_read_b64_tr_b16 v[60:61], v7 offset:45056
    ds_read_b64_tr_b16 v[62:63], v7 offset:47104
    s_add_u32 s38, s53, 0
    buffer_load_dwordx4 a[60:63], v2, s[28:31], s38 offen offset:3072 sc1
    s_waitcnt vmcnt(10) lgkmcnt(6)
    v_mfma_f32_32x32x16_bf16 v[64:79], v[48:51], a[28:31], v[64:79]
    ds_read_b64_tr_b16 v[32:33], v4 offset:49152
    ds_read_b64_tr_b16 v[34:35], v4 offset:51200
    s_waitcnt lgkmcnt(6)
    v_mfma_f32_32x32x16_bf16 v[80:95], v[52:55], a[28:31], v[80:95]
    ds_read_b64_tr_b16 v[36:37], v5 offset:49152
    ds_read_b64_tr_b16 v[38:39], v5 offset:51200
    s_waitcnt lgkmcnt(6)
    v_mfma_f32_32x32x16_bf16 v[96:111], v[56:59], a[28:31], v[96:111]
    ds_read_b64_tr_b16 v[40:41], v6 offset:49152
    ds_read_b64_tr_b16 v[42:43], v6 offset:51200
    s_waitcnt lgkmcnt(6)
    v_mfma_f32_32x32x16_bf16 v[112:127], v[60:63], a[28:31], v[112:127]
    ds_read_b64_tr_b16 v[44:45], v7 offset:49152
    ds_read_b64_tr_b16 v[46:47], v7 offset:51200
    s_waitcnt vmcnt(9) lgkmcnt(6)
    v_mfma_f32_32x32x16_bf16 v[64:79], v[32:35], a[32:35], v[64:79]
    ds_read_b64_tr_b16 v[48:49], v4 offset:53248
    ds_read_b64_tr_b16 v[50:51], v4 offset:55296
    s_waitcnt lgkmcnt(6)
    v_mfma_f32_32x32x16_bf16 v[80:95], v[36:39], a[32:35], v[80:95]
    ds_read_b64_tr_b16 v[52:53], v5 offset:53248
    ds_read_b64_tr_b16 v[54:55], v5 offset:55296
    s_add_u32 m0, s54, 114688
    s_lshl_b32 s39, s54, 2
    s_add_u32 s39, s39, s52
    s_lshl_b32 s38, s48, 19
    s_add_u32 s38, s38, 65536
    s_add_u32 s38, s38, s39
    buffer_load_dwordx4 v8, s[68:71], s38 offen offset:0 lds
    s_waitcnt lgkmcnt(6)
    v_mfma_f32_32x32x16_bf16 v[96:111], v[40:43], a[32:35], v[96:111]
    ds_read_b64_tr_b16 v[56:57], v6 offset:53248
    ds_read_b64_tr_b16 v[58:59], v6 offset:55296
    s_waitcnt lgkmcnt(6)
    v_mfma_f32_32x32x16_bf16 v[112:127], v[44:47], a[32:35], v[112:127]
    ds_read_b64_tr_b16 v[60:61], v7 offset:53248
    ds_read_b64_tr_b16 v[62:63], v7 offset:55296
    s_add_u32 m0, s54, 114688
    s_lshl_b32 s39, s54, 2
    s_add_u32 s39, s39, s52
    s_lshl_b32 s38, s48, 19
    s_add_u32 s38, s38, 65536
    s_add_u32 s38, s38, s39
    buffer_load_dwordx4 v9, s[68:71], s38 offen offset:1024 lds
    s_waitcnt vmcnt(10) lgkmcnt(6)
    v_mfma_f32_32x32x16_bf16 v[64:79], v[48:51], a[36:39], v[64:79]
    ds_read_b64_tr_b16 v[32:33], v4 offset:57344
    ds_read_b64_tr_b16 v[34:35], v4 offset:59392
    s_waitcnt lgkmcnt(6)
    v_mfma_f32_32x32x16_bf16 v[80:95], v[52:55], a[36:39], v[80:95]
    ds_read_b64_tr_b16 v[36:37], v5 offset:57344
    ds_read_b64_tr_b16 v[38:39], v5 offset:59392
    s_add_u32 s38, s53, 4096
    buffer_load_dwordx4 a[0:3], v2, s[28:31], s38 offen offset:0 sc1
    s_waitcnt lgkmcnt(6)
    v_mfma_f32_32x32x16_bf16 v[96:111], v[56:59], a[36:39], v[96:111]
    ds_read_b64_tr_b16 v[40:41], v6 offset:57344
    ds_read_b64_tr_b16 v[42:43], v6 offset:59392
    s_waitcnt lgkmcnt(6)
    v_mfma_f32_32x32x16_bf16 v[112:127], v[60:63], a[36:39], v[112:127]
    ds_read_b64_tr_b16 v[44:45], v7 offset:57344
    ds_read_b64_tr_b16 v[46:47], v7 offset:59392
    s_add_u32 s38, s53, 4096
    buffer_load_dwordx4 a[4:7], v2, s[28:31], s38 offen offset:1024 sc1
    s_waitcnt vmcnt(11) lgkmcnt(6)
    v_mfma_f32_32x32x16_bf16 v[64:79], v[32:35], a[40:43], v[64:79]
    ds_read_b64_tr_b16 v[48:49], v4 offset:61440
    ds_read_b64_tr_b16 v[50:51], v4 offset:63488
    s_waitcnt lgkmcnt(6)
    v_mfma_f32_32x32x16_bf16 v[80:95], v[36:39], a[40:43], v[80:95]
    ds_read_b64_tr_b16 v[52:53], v5 offset:61440
    ds_read_b64_tr_b16 v[54:55], v5 offset:63488
    s_add_u32 s38, s53, 4096
    buffer_load_dwordx4 a[8:11], v2, s[28:31], s38 offen offset:2048 sc1
    s_waitcnt lgkmcnt(6)
    v_mfma_f32_32x32x16_bf16 v[96:111], v[40:43], a[40:43], v[96:111]
    ds_read_b64_tr_b16 v[56:57], v6 offset:61440
    ds_read_b64_tr_b16 v[58:59], v6 offset:63488
    s_waitcnt lgkmcnt(6)
    v_mfma_f32_32x32x16_bf16 v[112:127], v[44:47], a[40:43], v[112:127]
    s_waitcnt vmcnt(9)
    s_barrier
    ds_read_b64_tr_b16 v[60:61], v7 offset:61440
    ds_read_b64_tr_b16 v[62:63], v7 offset:63488
    s_add_u32 s38, s53, 4096
    buffer_load_dwordx4 a[12:15], v2, s[28:31], s38 offen offset:3072 sc1
    s_waitcnt lgkmcnt(6)
    v_mfma_f32_32x32x16_bf16 v[64:79], v[48:51], a[44:47], v[64:79]
    ds_read_b64_tr_b16 v[32:33], v4 offset:0
    ds_read_b64_tr_b16 v[34:35], v4 offset:2048
    s_waitcnt lgkmcnt(6)
    v_mfma_f32_32x32x16_bf16 v[80:95], v[52:55], a[44:47], v[80:95]
    ds_read_b64_tr_b16 v[36:37], v5 offset:0
    ds_read_b64_tr_b16 v[38:39], v5 offset:2048
    s_waitcnt lgkmcnt(6)
    v_mfma_f32_32x32x16_bf16 v[96:111], v[56:59], a[44:47], v[96:111]
    ds_read_b64_tr_b16 v[40:41], v6 offset:0
    ds_read_b64_tr_b16 v[42:43], v6 offset:2048
    s_waitcnt lgkmcnt(6)
    v_mfma_f32_32x32x16_bf16 v[112:127], v[60:63], a[44:47], v[112:127]
    ds_read_b64_tr_b16 v[44:45], v7 offset:0
    ds_read_b64_tr_b16 v[46:47], v7 offset:2048
    s_waitcnt vmcnt(9) lgkmcnt(6)
    v_mfma_f32_32x32x16_bf16 v[64:79], v[32:35], a[48:51], v[64:79]
    ds_read_b64_tr_b16 v[48:49], v4 offset:4096
    ds_read_b64_tr_b16 v[50:51], v4 offset:6144
    s_waitcnt lgkmcnt(6)
    v_mfma_f32_32x32x16_bf16 v[80:95], v[36:39], a[48:51], v[80:95]
    ds_read_b64_tr_b16 v[52:53], v5 offset:4096
    ds_read_b64_tr_b16 v[54:55], v5 offset:6144
    s_add_u32 m0, s54, 131072
    s_lshl_b32 s39, s54, 2
    s_add_u32 s39, s39, s52
    s_lshl_b32 s38, s48, 19
    s_add_u32 s38, s38, 131072
    s_add_u32 s38, s38, s39
    buffer_load_dwordx4 v8, s[68:71], s38 offen offset:0 lds
    s_waitcnt lgkmcnt(6)
    v_mfma_f32_32x32x16_bf16 v[96:111], v[40:43], a[48:51], v[96:111]
    ds_read_b64_tr_b16 v[56:57], v6 offset:4096
    ds_read_b64_tr_b16 v[58:59], v6 offset:6144
    s_waitcnt lgkmcnt(6)
    v_mfma_f32_32x32x16_bf16 v[112:127], v[44:47], a[48:51], v[112:127]
    ds_read_b64_tr_b16 v[60:61], v7 offset:4096
    ds_read_b64_tr_b16 v[62:63], v7 offset:6144
    s_add_u32 m0, s54, 131072
    s_lshl_b32 s39, s54, 2
    s_add_u32 s39, s39, s52
    s_lshl_b32 s38, s48, 19
    s_add_u32 s38, s38, 131072
    s_add_u32 s38, s38, s39
    buffer_load_dwordx4 v9, s[68:71], s38 offen offset:1024 lds
    s_waitcnt vmcnt(10) lgkmcnt(6)
    v_mfma_f32_32x32x16_bf16 v[64:79], v[48:51], a[52:55], v[64:79]
    ds_read_b64_tr_b16 v[32:33], v4 offset:8192
    ds_read_b64_tr_b16 v[34:35], v4 offset:10240
    s_waitcnt lgkmcnt(6)
    v_mfma_f32_32x32x16_bf16 v[80:95], v[52:55], a[52:55], v[80:95]
    ds_read_b64_tr_b16 v[36:37], v5 offset:8192
    ds_read_b64_tr_b16 v[38:39], v5 offset:10240
    s_add_u32 s38, s53, 8192
    buffer_load_dwordx4 a[16:19], v2, s[28:31], s38 offen offset:0 sc1
    s_waitcnt lgkmcnt(6)
    v_mfma_f32_32x32x16_bf16 v[96:111], v[56:59], a[52:55], v[96:111]
    ds_read_b64_tr_b16 v[40:41], v6 offset:8192
    ds_read_b64_tr_b16 v[42:43], v6 offset:10240
    s_waitcnt lgkmcnt(6)
    v_mfma_f32_32x32x16_bf16 v[112:127], v[60:63], a[52:55], v[112:127]
    ds_read_b64_tr_b16 v[44:45], v7 offset:8192
    ds_read_b64_tr_b16 v[46:47], v7 offset:10240
    s_add_u32 s38, s53, 8192
    buffer_load_dwordx4 a[20:23], v2, s[28:31], s38 offen offset:1024 sc1
    s_waitcnt vmcnt(11) lgkmcnt(6)
    v_mfma_f32_32x32x16_bf16 v[64:79], v[32:35], a[56:59], v[64:79]
    ds_read_b64_tr_b16 v[48:49], v4 offset:12288
    ds_read_b64_tr_b16 v[50:51], v4 offset:14336
    s_waitcnt lgkmcnt(6)
    v_mfma_f32_32x32x16_bf16 v[80:95], v[36:39], a[56:59], v[80:95]
    ds_read_b64_tr_b16 v[52:53], v5 offset:12288
    ds_read_b64_tr_b16 v[54:55], v5 offset:14336
    s_add_u32 s38, s53, 8192
    buffer_load_dwordx4 a[24:27], v2, s[28:31], s38 offen offset:2048 sc1
    s_waitcnt lgkmcnt(6)
    v_mfma_f32_32x32x16_bf16 v[96:111], v[40:43], a[56:59], v[96:111]
    ds_read_b64_tr_b16 v[56:57], v6 offset:12288
    ds_read_b64_tr_b16 v[58:59], v6 offset:14336
    s_waitcnt lgkmcnt(6)
    v_mfma_f32_32x32x16_bf16 v[112:127], v[44:47], a[56:59], v[112:127]
    s_waitcnt vmcnt(9)
    s_barrier
    ds_read_b64_tr_b16 v[60:61], v7 offset:12288
    ds_read_b64_tr_b16 v[62:63], v7 offset:14336
    s_add_u32 s38, s53, 8192
    buffer_load_dwordx4 a[28:31], v2, s[28:31], s38 offen offset:3072 sc1
    s_waitcnt lgkmcnt(6)
    v_mfma_f32_32x32x16_bf16 v[64:79], v[48:51], a[60:63], v[64:79]
    ds_read_b64_tr_b16 v[32:33], v4 offset:16384
    ds_read_b64_tr_b16 v[34:35], v4 offset:18432
    s_waitcnt lgkmcnt(6)
    v_mfma_f32_32x32x16_bf16 v[80:95], v[52:55], a[60:63], v[80:95]
    ds_read_b64_tr_b16 v[36:37], v5 offset:16384
    ds_read_b64_tr_b16 v[38:39], v5 offset:18432
    s_waitcnt lgkmcnt(6)
    v_mfma_f32_32x32x16_bf16 v[96:111], v[56:59], a[60:63], v[96:111]
    ds_read_b64_tr_b16 v[40:41], v6 offset:16384
    ds_read_b64_tr_b16 v[42:43], v6 offset:18432
    s_waitcnt lgkmcnt(6)
    v_mfma_f32_32x32x16_bf16 v[112:127], v[60:63], a[60:63], v[112:127]
    ds_read_b64_tr_b16 v[44:45], v7 offset:16384
    ds_read_b64_tr_b16 v[46:47], v7 offset:18432
    s_waitcnt vmcnt(9) lgkmcnt(6)
    v_mfma_f32_32x32x16_bf16 v[64:79], v[32:35], a[0:3], v[64:79]
    ds_read_b64_tr_b16 v[48:49], v4 offset:20480
    ds_read_b64_tr_b16 v[50:51], v4 offset:22528
    s_waitcnt lgkmcnt(6)
    v_mfma_f32_32x32x16_bf16 v[80:95], v[36:39], a[0:3], v[80:95]
    ds_read_b64_tr_b16 v[52:53], v5 offset:20480
    ds_read_b64_tr_b16 v[54:55], v5 offset:22528
    s_add_u32 m0, s54, 147456
    s_lshl_b32 s39, s54, 2
    s_add_u32 s39, s39, s52
    s_lshl_b32 s38, s48, 19
    s_add_u32 s38, s38, 196608
    s_add_u32 s38, s38, s39
    buffer_load_dwordx4 v8, s[68:71], s38 offen offset:0 lds
    s_waitcnt lgkmcnt(6)
    v_mfma_f32_32x32x16_bf16 v[96:111], v[40:43], a[0:3], v[96:111]
    ds_read_b64_tr_b16 v[56:57], v6 offset:20480
    ds_read_b64_tr_b16 v[58:59], v6 offset:22528
    s_waitcnt lgkmcnt(6)
    v_mfma_f32_32x32x16_bf16 v[112:127], v[44:47], a[0:3], v[112:127]
    ds_read_b64_tr_b16 v[60:61], v7 offset:20480
    ds_read_b64_tr_b16 v[62:63], v7 offset:22528
    s_add_u32 m0, s54, 147456
    s_lshl_b32 s39, s54, 2
    s_add_u32 s39, s39, s52
    s_lshl_b32 s38, s48, 19
    s_add_u32 s38, s38, 196608
    s_add_u32 s38, s38, s39
    buffer_load_dwordx4 v9, s[68:71], s38 offen offset:1024 lds
    s_waitcnt vmcnt(10) lgkmcnt(6)
    v_mfma_f32_32x32x16_bf16 v[64:79], v[48:51], a[4:7], v[64:79]
    ds_read_b64_tr_b16 v[32:33], v4 offset:24576
    ds_read_b64_tr_b16 v[34:35], v4 offset:26624
    s_waitcnt lgkmcnt(6)
    v_mfma_f32_32x32x16_bf16 v[80:95], v[52:55], a[4:7], v[80:95]
    ds_read_b64_tr_b16 v[36:37], v5 offset:24576
    ds_read_b64_tr_b16 v[38:39], v5 offset:26624
    s_add_u32 s38, s53, 12288
    buffer_load_dwordx4 a[32:35], v2, s[28:31], s38 offen offset:0 sc1
    s_waitcnt lgkmcnt(6)
    v_mfma_f32_32x32x16_bf16 v[96:111], v[56:59], a[4:7], v[96:111]
    ds_read_b64_tr_b16 v[40:41], v6 offset:24576
    ds_read_b64_tr_b16 v[42:43], v6 offset:26624
    s_waitcnt lgkmcnt(6)
    v_mfma_f32_32x32x16_bf16 v[112:127], v[60:63], a[4:7], v[112:127]
    ds_read_b64_tr_b16 v[44:45], v7 offset:24576
    ds_read_b64_tr_b16 v[46:47], v7 offset:26624
    s_add_u32 s38, s53, 12288
    buffer_load_dwordx4 a[36:39], v2, s[28:31], s38 offen offset:1024 sc1
    s_waitcnt vmcnt(11) lgkmcnt(6)
    v_mfma_f32_32x32x16_bf16 v[64:79], v[32:35], a[8:11], v[64:79]
    ds_read_b64_tr_b16 v[48:49], v4 offset:28672
    ds_read_b64_tr_b16 v[50:51], v4 offset:30720
    s_waitcnt lgkmcnt(6)
    v_mfma_f32_32x32x16_bf16 v[80:95], v[36:39], a[8:11], v[80:95]
    ds_read_b64_tr_b16 v[52:53], v5 offset:28672
    ds_read_b64_tr_b16 v[54:55], v5 offset:30720
    s_add_u32 s38, s53, 12288
    buffer_load_dwordx4 a[40:43], v2, s[28:31], s38 offen offset:2048 sc1
    s_waitcnt lgkmcnt(6)
    v_mfma_f32_32x32x16_bf16 v[96:111], v[40:43], a[8:11], v[96:111]
    ds_read_b64_tr_b16 v[56:57], v6 offset:28672
    ds_read_b64_tr_b16 v[58:59], v6 offset:30720
    s_waitcnt lgkmcnt(6)
    v_mfma_f32_32x32x16_bf16 v[112:127], v[44:47], a[8:11], v[112:127]
    s_waitcnt vmcnt(9)
    s_barrier
    ds_read_b64_tr_b16 v[60:61], v7 offset:28672
    ds_read_b64_tr_b16 v[62:63], v7 offset:30720
    s_add_u32 s38, s53, 12288
    buffer_load_dwordx4 a[44:47], v2, s[28:31], s38 offen offset:3072 sc1
    s_waitcnt lgkmcnt(6)
    v_mfma_f32_32x32x16_bf16 v[64:79], v[48:51], a[12:15], v[64:79]
    ds_read_b64_tr_b16 v[32:33], v4 offset:32768
    ds_read_b64_tr_b16 v[34:35], v4 offset:34816
    s_waitcnt lgkmcnt(6)
    v_mfma_f32_32x32x16_bf16 v[80:95], v[52:55], a[12:15], v[80:95]
    ds_read_b64_tr_b16 v[36:37], v5 offset:32768
    ds_read_b64_tr_b16 v[38:39], v5 offset:34816
    s_waitcnt lgkmcnt(6)
    v_mfma_f32_32x32x16_bf16 v[96:111], v[56:59], a[12:15], v[96:111]
    ds_read_b64_tr_b16 v[40:41], v6 offset:32768
    ds_read_b64_tr_b16 v[42:43], v6 offset:34816
    s_waitcnt lgkmcnt(6)
    v_mfma_f32_32x32x16_bf16 v[112:127], v[60:63], a[12:15], v[112:127]
    ds_read_b64_tr_b16 v[44:45], v7 offset:32768
    ds_read_b64_tr_b16 v[46:47], v7 offset:34816
    s_waitcnt vmcnt(9) lgkmcnt(6)
    v_mfma_f32_32x32x16_bf16 v[64:79], v[32:35], a[16:19], v[64:79]
    ds_read_b64_tr_b16 v[48:49], v4 offset:36864
    ds_read_b64_tr_b16 v[50:51], v4 offset:38912
    s_waitcnt lgkmcnt(6)
    v_mfma_f32_32x32x16_bf16 v[80:95], v[36:39], a[16:19], v[80:95]
    ds_read_b64_tr_b16 v[52:53], v5 offset:36864
    ds_read_b64_tr_b16 v[54:55], v5 offset:38912
    s_add_u32 m0, s54, 98304
    s_lshl_b32 s39, s54, 2
    s_add_u32 s39, s39, s52
    s_lshl_b32 s38, s48, 19
    s_add_u32 s38, s38, 262144
    s_add_u32 s38, s38, s39
    buffer_load_dwordx4 v8, s[68:71], s38 offen offset:0 lds
    s_waitcnt lgkmcnt(6)
    v_mfma_f32_32x32x16_bf16 v[96:111], v[40:43], a[16:19], v[96:111]
    ds_read_b64_tr_b16 v[56:57], v6 offset:36864
    ds_read_b64_tr_b16 v[58:59], v6 offset:38912
    s_waitcnt lgkmcnt(6)
    v_mfma_f32_32x32x16_bf16 v[112:127], v[44:47], a[16:19], v[112:127]
    ds_read_b64_tr_b16 v[60:61], v7 offset:36864
    ds_read_b64_tr_b16 v[62:63], v7 offset:38912
    s_add_u32 m0, s54, 98304
    s_lshl_b32 s39, s54, 2
    s_add_u32 s39, s39, s52
    s_lshl_b32 s38, s48, 19
    s_add_u32 s38, s38, 262144
    s_add_u32 s38, s38, s39
    buffer_load_dwordx4 v9, s[68:71], s38 offen offset:1024 lds
    s_waitcnt vmcnt(10) lgkmcnt(6)
    v_mfma_f32_32x32x16_bf16 v[64:79], v[48:51], a[20:23], v[64:79]
    ds_read_b64_tr_b16 v[32:33], v4 offset:40960
    ds_read_b64_tr_b16 v[34:35], v4 offset:43008
    s_waitcnt lgkmcnt(6)
    v_mfma_f32_32x32x16_bf16 v[80:95], v[52:55], a[20:23], v[80:95]
    ds_read_b64_tr_b16 v[36:37], v5 offset:40960
    ds_read_b64_tr_b16 v[38:39], v5 offset:43008
    s_add_u32 s38, s53, 16384
    buffer_load_dwordx4 a[48:51], v2, s[28:31], s38 offen offset:0 sc1
    s_waitcnt lgkmcnt(6)
    v_mfma_f32_32x32x16_bf16 v[96:111], v[56:59], a[20:23], v[96:111]
    ds_read_b64_tr_b16 v[40:41], v6 offset:40960
    ds_read_b64_tr_b16 v[42:43], v6 offset:43008
    s_waitcnt lgkmcnt(6)
    v_mfma_f32_32x32x16_bf16 v[112:127], v[60:63], a[20:23], v[112:127]
    ds_read_b64_tr_b16 v[44:45], v7 offset:40960
    ds_read_b64_tr_b16 v[46:47], v7 offset:43008
    s_add_u32 s38, s53, 16384
    buffer_load_dwordx4 a[52:55], v2, s[28:31], s38 offen offset:1024 sc1
    s_waitcnt vmcnt(11) lgkmcnt(6)
    v_mfma_f32_32x32x16_bf16 v[64:79], v[32:35], a[24:27], v[64:79]
    ds_read_b64_tr_b16 v[48:49], v4 offset:45056
    ds_read_b64_tr_b16 v[50:51], v4 offset:47104
    s_waitcnt lgkmcnt(6)
    v_mfma_f32_32x32x16_bf16 v[80:95], v[36:39], a[24:27], v[80:95]
    ds_read_b64_tr_b16 v[52:53], v5 offset:45056
    ds_read_b64_tr_b16 v[54:55], v5 offset:47104
    s_add_u32 s38, s53, 16384
    buffer_load_dwordx4 a[56:59], v2, s[28:31], s38 offen offset:2048 sc1
    s_waitcnt lgkmcnt(6)
    v_mfma_f32_32x32x16_bf16 v[96:111], v[40:43], a[24:27], v[96:111]
    ds_read_b64_tr_b16 v[56:57], v6 offset:45056
    ds_read_b64_tr_b16 v[58:59], v6 offset:47104
    s_waitcnt lgkmcnt(6)
    v_mfma_f32_32x32x16_bf16 v[112:127], v[44:47], a[24:27], v[112:127]
    s_waitcnt vmcnt(9)
    s_barrier
    ds_read_b64_tr_b16 v[60:61], v7 offset:45056
    ds_read_b64_tr_b16 v[62:63], v7 offset:47104
    s_add_u32 s38, s53, 16384
    buffer_load_dwordx4 a[60:63], v2, s[28:31], s38 offen offset:3072 sc1
    s_waitcnt lgkmcnt(6)
    v_mfma_f32_32x32x16_bf16 v[64:79], v[48:51], a[28:31], v[64:79]
    ds_read_b64_tr_b16 v[32:33], v4 offset:49152
    ds_read_b64_tr_b16 v[34:35], v4 offset:51200
    s_waitcnt lgkmcnt(6)
    v_mfma_f32_32x32x16_bf16 v[80:95], v[52:55], a[28:31], v[80:95]
    ds_read_b64_tr_b16 v[36:37], v5 offset:49152
    ds_read_b64_tr_b16 v[38:39], v5 offset:51200
    s_waitcnt lgkmcnt(6)
    v_mfma_f32_32x32x16_bf16 v[96:111], v[56:59], a[28:31], v[96:111]
    ds_read_b64_tr_b16 v[40:41], v6 offset:49152
    ds_read_b64_tr_b16 v[42:43], v6 offset:51200
    s_waitcnt lgkmcnt(6)
    v_mfma_f32_32x32x16_bf16 v[112:127], v[60:63], a[28:31], v[112:127]
    ds_read_b64_tr_b16 v[44:45], v7 offset:49152
    ds_read_b64_tr_b16 v[46:47], v7 offset:51200
    s_waitcnt vmcnt(9) lgkmcnt(6)
    v_mfma_f32_32x32x16_bf16 v[64:79], v[32:35], a[32:35], v[64:79]
    ds_read_b64_tr_b16 v[48:49], v4 offset:53248
    ds_read_b64_tr_b16 v[50:51], v4 offset:55296
    s_waitcnt lgkmcnt(6)
    v_mfma_f32_32x32x16_bf16 v[80:95], v[36:39], a[32:35], v[80:95]
    ds_read_b64_tr_b16 v[52:53], v5 offset:53248
    ds_read_b64_tr_b16 v[54:55], v5 offset:55296
    s_add_u32 m0, s54, 114688
    s_lshl_b32 s39, s54, 2
    s_add_u32 s39, s39, s52
    s_lshl_b32 s38, s48, 19
    s_add_u32 s38, s38, 327680
    s_add_u32 s38, s38, s39
    buffer_load_dwordx4 v8, s[68:71], s38 offen offset:0 lds
    s_waitcnt lgkmcnt(6)
    v_mfma_f32_32x32x16_bf16 v[96:111], v[40:43], a[32:35], v[96:111]
    ds_read_b64_tr_b16 v[56:57], v6 offset:53248
    ds_read_b64_tr_b16 v[58:59], v6 offset:55296
    s_waitcnt lgkmcnt(6)
    v_mfma_f32_32x32x16_bf16 v[112:127], v[44:47], a[32:35], v[112:127]
    ds_read_b64_tr_b16 v[60:61], v7 offset:53248
    ds_read_b64_tr_b16 v[62:63], v7 offset:55296
    s_add_u32 m0, s54, 114688
    s_lshl_b32 s39, s54, 2
    s_add_u32 s39, s39, s52
    s_lshl_b32 s38, s48, 19
    s_add_u32 s38, s38, 327680
    s_add_u32 s38, s38, s39
    buffer_load_dwordx4 v9, s[68:71], s38 offen offset:1024 lds
    s_waitcnt vmcnt(10) lgkmcnt(6)
    v_mfma_f32_32x32x16_bf16 v[64:79], v[48:51], a[36:39], v[64:79]
    ds_read_b64_tr_b16 v[32:33], v4 offset:57344
    ds_read_b64_tr_b16 v[34:35], v4 offset:59392
    s_waitcnt lgkmcnt(6)
    v_mfma_f32_32x32x16_bf16 v[80:95], v[52:55], a[36:39], v[80:95]
    ds_read_b64_tr_b16 v[36:37], v5 offset:57344
    ds_read_b64_tr_b16 v[38:39], v5 offset:59392
    s_add_u32 s38, s53, 20480
    buffer_load_dwordx4 a[0:3], v2, s[28:31], s38 offen offset:0 sc1
    s_waitcnt lgkmcnt(6)
    v_mfma_f32_32x32x16_bf16 v[96:111], v[56:59], a[36:39], v[96:111]
    ds_read_b64_tr_b16 v[40:41], v6 offset:57344
    ds_read_b64_tr_b16 v[42:43], v6 offset:59392
    s_waitcnt lgkmcnt(6)
    v_mfma_f32_32x32x16_bf16 v[112:127], v[60:63], a[36:39], v[112:127]
    ds_read_b64_tr_b16 v[44:45], v7 offset:57344
    ds_read_b64_tr_b16 v[46:47], v7 offset:59392
    s_add_u32 s38, s53, 20480
    buffer_load_dwordx4 a[4:7], v2, s[28:31], s38 offen offset:1024 sc1
    s_waitcnt vmcnt(11) lgkmcnt(6)
    v_mfma_f32_32x32x16_bf16 v[64:79], v[32:35], a[40:43], v[64:79]
    ds_read_b64_tr_b16 v[48:49], v4 offset:61440
    ds_read_b64_tr_b16 v[50:51], v4 offset:63488
    s_waitcnt lgkmcnt(6)
    v_mfma_f32_32x32x16_bf16 v[80:95], v[36:39], a[40:43], v[80:95]
    ds_read_b64_tr_b16 v[52:53], v5 offset:61440
    ds_read_b64_tr_b16 v[54:55], v5 offset:63488
    s_add_u32 s38, s53, 20480
    buffer_load_dwordx4 a[8:11], v2, s[28:31], s38 offen offset:2048 sc1
    s_waitcnt lgkmcnt(6)
    v_mfma_f32_32x32x16_bf16 v[96:111], v[40:43], a[40:43], v[96:111]
    ds_read_b64_tr_b16 v[56:57], v6 offset:61440
    ds_read_b64_tr_b16 v[58:59], v6 offset:63488
    s_waitcnt lgkmcnt(6)
    v_mfma_f32_32x32x16_bf16 v[112:127], v[44:47], a[40:43], v[112:127]
    s_waitcnt vmcnt(9)
    s_barrier
    ds_read_b64_tr_b16 v[60:61], v7 offset:61440
    ds_read_b64_tr_b16 v[62:63], v7 offset:63488
    s_add_u32 s38, s53, 20480
    buffer_load_dwordx4 a[12:15], v2, s[28:31], s38 offen offset:3072 sc1
    s_waitcnt lgkmcnt(6)
    v_mfma_f32_32x32x16_bf16 v[64:79], v[48:51], a[44:47], v[64:79]
    ds_read_b64_tr_b16 v[32:33], v4 offset:0
    ds_read_b64_tr_b16 v[34:35], v4 offset:2048
    s_waitcnt lgkmcnt(6)
    v_mfma_f32_32x32x16_bf16 v[80:95], v[52:55], a[44:47], v[80:95]
    ds_read_b64_tr_b16 v[36:37], v5 offset:0
    ds_read_b64_tr_b16 v[38:39], v5 offset:2048
    s_waitcnt lgkmcnt(6)
    v_mfma_f32_32x32x16_bf16 v[96:111], v[56:59], a[44:47], v[96:111]
    ds_read_b64_tr_b16 v[40:41], v6 offset:0
    ds_read_b64_tr_b16 v[42:43], v6 offset:2048
    s_waitcnt lgkmcnt(6)
    v_mfma_f32_32x32x16_bf16 v[112:127], v[60:63], a[44:47], v[112:127]
    ds_read_b64_tr_b16 v[44:45], v7 offset:0
    ds_read_b64_tr_b16 v[46:47], v7 offset:2048
    s_waitcnt vmcnt(9) lgkmcnt(6)
    v_mfma_f32_32x32x16_bf16 v[64:79], v[32:35], a[48:51], v[64:79]
    ds_read_b64_tr_b16 v[48:49], v4 offset:4096
    ds_read_b64_tr_b16 v[50:51], v4 offset:6144
    s_waitcnt lgkmcnt(6)
    v_mfma_f32_32x32x16_bf16 v[80:95], v[36:39], a[48:51], v[80:95]
    ds_read_b64_tr_b16 v[52:53], v5 offset:4096
    ds_read_b64_tr_b16 v[54:55], v5 offset:6144
    s_add_u32 m0, s54, 131072
    s_lshl_b32 s39, s54, 2
    s_add_u32 s39, s39, s52
    s_lshl_b32 s38, s48, 19
    s_add_u32 s38, s38, 393216
    s_add_u32 s38, s38, s39
    buffer_load_dwordx4 v8, s[68:71], s38 offen offset:0 lds
    s_waitcnt lgkmcnt(6)
    v_mfma_f32_32x32x16_bf16 v[96:111], v[40:43], a[48:51], v[96:111]
    ds_read_b64_tr_b16 v[56:57], v6 offset:4096
    ds_read_b64_tr_b16 v[58:59], v6 offset:6144
    s_waitcnt lgkmcnt(6)
    v_mfma_f32_32x32x16_bf16 v[112:127], v[44:47], a[48:51], v[112:127]
    ds_read_b64_tr_b16 v[60:61], v7 offset:4096
    ds_read_b64_tr_b16 v[62:63], v7 offset:6144
    s_add_u32 m0, s54, 131072
    s_lshl_b32 s39, s54, 2
    s_add_u32 s39, s39, s52
    s_lshl_b32 s38, s48, 19
    s_add_u32 s38, s38, 393216
    s_add_u32 s38, s38, s39
    buffer_load_dwordx4 v9, s[68:71], s38 offen offset:1024 lds
    s_waitcnt vmcnt(10) lgkmcnt(6)
    v_mfma_f32_32x32x16_bf16 v[64:79], v[48:51], a[52:55], v[64:79]
    ds_read_b64_tr_b16 v[32:33], v4 offset:8192
    ds_read_b64_tr_b16 v[34:35], v4 offset:10240
    s_waitcnt lgkmcnt(6)
    v_mfma_f32_32x32x16_bf16 v[80:95], v[52:55], a[52:55], v[80:95]
    ds_read_b64_tr_b16 v[36:37], v5 offset:8192
    ds_read_b64_tr_b16 v[38:39], v5 offset:10240
    s_add_u32 s38, s53, 24576
    buffer_load_dwordx4 a[16:19], v2, s[28:31], s38 offen offset:0 sc1
    s_waitcnt lgkmcnt(6)
    v_mfma_f32_32x32x16_bf16 v[96:111], v[56:59], a[52:55], v[96:111]
    ds_read_b64_tr_b16 v[40:41], v6 offset:8192
    ds_read_b64_tr_b16 v[42:43], v6 offset:10240
    s_waitcnt lgkmcnt(6)
    v_mfma_f32_32x32x16_bf16 v[112:127], v[60:63], a[52:55], v[112:127]
    ds_read_b64_tr_b16 v[44:45], v7 offset:8192
    ds_read_b64_tr_b16 v[46:47], v7 offset:10240
    s_add_u32 s38, s53, 24576
    buffer_load_dwordx4 a[20:23], v2, s[28:31], s38 offen offset:1024 sc1
    s_waitcnt vmcnt(11) lgkmcnt(6)
    v_mfma_f32_32x32x16_bf16 v[64:79], v[32:35], a[56:59], v[64:79]
    ds_read_b64_tr_b16 v[48:49], v4 offset:12288
    ds_read_b64_tr_b16 v[50:51], v4 offset:14336
    s_waitcnt lgkmcnt(6)
    v_mfma_f32_32x32x16_bf16 v[80:95], v[36:39], a[56:59], v[80:95]
    ds_read_b64_tr_b16 v[52:53], v5 offset:12288
    ds_read_b64_tr_b16 v[54:55], v5 offset:14336
    s_add_u32 s38, s53, 24576
    buffer_load_dwordx4 a[24:27], v2, s[28:31], s38 offen offset:2048 sc1
    s_waitcnt lgkmcnt(6)
    v_mfma_f32_32x32x16_bf16 v[96:111], v[40:43], a[56:59], v[96:111]
    ds_read_b64_tr_b16 v[56:57], v6 offset:12288
    ds_read_b64_tr_b16 v[58:59], v6 offset:14336
    s_waitcnt lgkmcnt(6)
    v_mfma_f32_32x32x16_bf16 v[112:127], v[44:47], a[56:59], v[112:127]
    s_waitcnt vmcnt(9)
    s_barrier
    ds_read_b64_tr_b16 v[60:61], v7 offset:12288
    ds_read_b64_tr_b16 v[62:63], v7 offset:14336
    s_add_u32 s38, s53, 24576
    buffer_load_dwordx4 a[28:31], v2, s[28:31], s38 offen offset:3072 sc1
    s_waitcnt lgkmcnt(6)
    v_mfma_f32_32x32x16_bf16 v[64:79], v[48:51], a[60:63], v[64:79]
    ds_read_b64_tr_b16 v[32:33], v4 offset:16384
    ds_read_b64_tr_b16 v[34:35], v4 offset:18432
    s_waitcnt lgkmcnt(6)
    v_mfma_f32_32x32x16_bf16 v[80:95], v[52:55], a[60:63], v[80:95]
    ds_read_b64_tr_b16 v[36:37], v5 offset:16384
    ds_read_b64_tr_b16 v[38:39], v5 offset:18432
    s_waitcnt lgkmcnt(6)
    v_mfma_f32_32x32x16_bf16 v[96:111], v[56:59], a[60:63], v[96:111]
    ds_read_b64_tr_b16 v[40:41], v6 offset:16384
    ds_read_b64_tr_b16 v[42:43], v6 offset:18432
    s_waitcnt lgkmcnt(6)
    v_mfma_f32_32x32x16_bf16 v[112:127], v[60:63], a[60:63], v[112:127]
    ds_read_b64_tr_b16 v[44:45], v7 offset:16384
    ds_read_b64_tr_b16 v[46:47], v7 offset:18432
    s_waitcnt vmcnt(9) lgkmcnt(6)
    v_mfma_f32_32x32x16_bf16 v[64:79], v[32:35], a[0:3], v[64:79]
    ds_read_b64_tr_b16 v[48:49], v4 offset:20480
    ds_read_b64_tr_b16 v[50:51], v4 offset:22528
    s_waitcnt lgkmcnt(6)
    v_mfma_f32_32x32x16_bf16 v[80:95], v[36:39], a[0:3], v[80:95]
    ds_read_b64_tr_b16 v[52:53], v5 offset:20480
    ds_read_b64_tr_b16 v[54:55], v5 offset:22528
    s_add_u32 m0, s54, 147456
    s_lshl_b32 s39, s54, 2
    s_add_u32 s39, s39, s52
    s_lshl_b32 s38, s48, 19
    s_add_u32 s38, s38, 458752
    s_add_u32 s38, s38, s39
    buffer_load_dwordx4 v8, s[68:71], s38 offen offset:0 lds
    s_waitcnt lgkmcnt(6)
    v_mfma_f32_32x32x16_bf16 v[96:111], v[40:43], a[0:3], v[96:111]
    ds_read_b64_tr_b16 v[56:57], v6 offset:20480
    ds_read_b64_tr_b16 v[58:59], v6 offset:22528
    s_waitcnt lgkmcnt(6)
    v_mfma_f32_32x32x16_bf16 v[112:127], v[44:47], a[0:3], v[112:127]
    ds_read_b64_tr_b16 v[60:61], v7 offset:20480
    ds_read_b64_tr_b16 v[62:63], v7 offset:22528
    s_add_u32 m0, s54, 147456
    s_lshl_b32 s39, s54, 2
    s_add_u32 s39, s39, s52
    s_lshl_b32 s38, s48, 19
    s_add_u32 s38, s38, 458752
    s_add_u32 s38, s38, s39
    buffer_load_dwordx4 v9, s[68:71], s38 offen offset:1024 lds
    s_waitcnt vmcnt(10) lgkmcnt(6)
    v_mfma_f32_32x32x16_bf16 v[64:79], v[48:51], a[4:7], v[64:79]
    ds_read_b64_tr_b16 v[32:33], v4 offset:24576
    ds_read_b64_tr_b16 v[34:35], v4 offset:26624
    s_waitcnt lgkmcnt(6)
    v_mfma_f32_32x32x16_bf16 v[80:95], v[52:55], a[4:7], v[80:95]
    ds_read_b64_tr_b16 v[36:37], v5 offset:24576
    ds_read_b64_tr_b16 v[38:39], v5 offset:26624
    s_add_u32 s38, s53, 28672
    buffer_load_dwordx4 a[32:35], v2, s[28:31], s38 offen offset:0 sc1
    s_waitcnt lgkmcnt(6)
    v_mfma_f32_32x32x16_bf16 v[96:111], v[56:59], a[4:7], v[96:111]
    ds_read_b64_tr_b16 v[40:41], v6 offset:24576
    ds_read_b64_tr_b16 v[42:43], v6 offset:26624
    s_waitcnt lgkmcnt(6)
    v_mfma_f32_32x32x16_bf16 v[112:127], v[60:63], a[4:7], v[112:127]
    ds_read_b64_tr_b16 v[44:45], v7 offset:24576
    ds_read_b64_tr_b16 v[46:47], v7 offset:26624
    s_add_u32 s38, s53, 28672
    buffer_load_dwordx4 a[36:39], v2, s[28:31], s38 offen offset:1024 sc1
    s_waitcnt vmcnt(11) lgkmcnt(6)
    v_mfma_f32_32x32x16_bf16 v[64:79], v[32:35], a[8:11], v[64:79]
    ds_read_b64_tr_b16 v[48:49], v4 offset:28672
    ds_read_b64_tr_b16 v[50:51], v4 offset:30720
    s_waitcnt lgkmcnt(6)
    v_mfma_f32_32x32x16_bf16 v[80:95], v[36:39], a[8:11], v[80:95]
    ds_read_b64_tr_b16 v[52:53], v5 offset:28672
    ds_read_b64_tr_b16 v[54:55], v5 offset:30720
    s_add_u32 s38, s53, 28672
    buffer_load_dwordx4 a[40:43], v2, s[28:31], s38 offen offset:2048 sc1
    s_waitcnt lgkmcnt(6)
    v_mfma_f32_32x32x16_bf16 v[96:111], v[40:43], a[8:11], v[96:111]
    ds_read_b64_tr_b16 v[56:57], v6 offset:28672
    ds_read_b64_tr_b16 v[58:59], v6 offset:30720
    s_waitcnt lgkmcnt(6)
    v_mfma_f32_32x32x16_bf16 v[112:127], v[44:47], a[8:11], v[112:127]
    s_waitcnt vmcnt(9)
    s_barrier
    ds_read_b64_tr_b16 v[60:61], v7 offset:28672
    ds_read_b64_tr_b16 v[62:63], v7 offset:30720
    s_add_u32 s38, s53, 28672
    buffer_load_dwordx4 a[44:47], v2, s[28:31], s38 offen offset:3072 sc1
    s_waitcnt lgkmcnt(6)
    v_mfma_f32_32x32x16_bf16 v[64:79], v[48:51], a[12:15], v[64:79]
    ds_read_b64_tr_b16 v[32:33], v4 offset:32768
    ds_read_b64_tr_b16 v[34:35], v4 offset:34816
    s_waitcnt lgkmcnt(6)
    v_mfma_f32_32x32x16_bf16 v[80:95], v[52:55], a[12:15], v[80:95]
    ds_read_b64_tr_b16 v[36:37], v5 offset:32768
    ds_read_b64_tr_b16 v[38:39], v5 offset:34816
    s_waitcnt lgkmcnt(6)
    v_mfma_f32_32x32x16_bf16 v[96:111], v[56:59], a[12:15], v[96:111]
    ds_read_b64_tr_b16 v[40:41], v6 offset:32768
    ds_read_b64_tr_b16 v[42:43], v6 offset:34816
    s_waitcnt lgkmcnt(6)
    v_mfma_f32_32x32x16_bf16 v[112:127], v[60:63], a[12:15], v[112:127]
    ds_read_b64_tr_b16 v[44:45], v7 offset:32768
    ds_read_b64_tr_b16 v[46:47], v7 offset:34816
    s_waitcnt vmcnt(9) lgkmcnt(6)
    v_mfma_f32_32x32x16_bf16 v[64:79], v[32:35], a[16:19], v[64:79]
    ds_read_b64_tr_b16 v[48:49], v4 offset:36864
    ds_read_b64_tr_b16 v[50:51], v4 offset:38912
    s_waitcnt lgkmcnt(6)
    v_mfma_f32_32x32x16_bf16 v[80:95], v[36:39], a[16:19], v[80:95]
    ds_read_b64_tr_b16 v[52:53], v5 offset:36864
    ds_read_b64_tr_b16 v[54:55], v5 offset:38912
    s_waitcnt lgkmcnt(6)
    v_mfma_f32_32x32x16_bf16 v[96:111], v[40:43], a[16:19], v[96:111]
    ds_read_b64_tr_b16 v[56:57], v6 offset:36864
    ds_read_b64_tr_b16 v[58:59], v6 offset:38912
    s_waitcnt lgkmcnt(6)
    v_mfma_f32_32x32x16_bf16 v[112:127], v[44:47], a[16:19], v[112:127]
    ds_read_b64_tr_b16 v[60:61], v7 offset:36864
    ds_read_b64_tr_b16 v[62:63], v7 offset:38912
    s_waitcnt vmcnt(8) lgkmcnt(6)
    v_mfma_f32_32x32x16_bf16 v[64:79], v[48:51], a[20:23], v[64:79]
    ds_read_b64_tr_b16 v[32:33], v4 offset:40960
    ds_read_b64_tr_b16 v[34:35], v4 offset:43008
    s_waitcnt lgkmcnt(6)
    v_mfma_f32_32x32x16_bf16 v[80:95], v[52:55], a[20:23], v[80:95]
    ds_read_b64_tr_b16 v[36:37], v5 offset:40960
    ds_read_b64_tr_b16 v[38:39], v5 offset:43008
    s_waitcnt lgkmcnt(6)
    v_mfma_f32_32x32x16_bf16 v[96:111], v[56:59], a[20:23], v[96:111]
    ds_read_b64_tr_b16 v[40:41], v6 offset:40960
    ds_read_b64_tr_b16 v[42:43], v6 offset:43008
    s_waitcnt lgkmcnt(6)
    v_mfma_f32_32x32x16_bf16 v[112:127], v[60:63], a[20:23], v[112:127]
    ds_read_b64_tr_b16 v[44:45], v7 offset:40960
    ds_read_b64_tr_b16 v[46:47], v7 offset:43008
    s_waitcnt vmcnt(7) lgkmcnt(6)
    v_mfma_f32_32x32x16_bf16 v[64:79], v[32:35], a[24:27], v[64:79]
    ds_read_b64_tr_b16 v[48:49], v4 offset:45056
    ds_read_b64_tr_b16 v[50:51], v4 offset:47104
    s_waitcnt lgkmcnt(6)
    v_mfma_f32_32x32x16_bf16 v[80:95], v[36:39], a[24:27], v[80:95]
    ds_read_b64_tr_b16 v[52:53], v5 offset:45056
    ds_read_b64_tr_b16 v[54:55], v5 offset:47104
    s_waitcnt lgkmcnt(6)
    v_mfma_f32_32x32x16_bf16 v[96:111], v[40:43], a[24:27], v[96:111]
    ds_read_b64_tr_b16 v[56:57], v6 offset:45056
    ds_read_b64_tr_b16 v[58:59], v6 offset:47104
    s_waitcnt lgkmcnt(6)
    v_mfma_f32_32x32x16_bf16 v[112:127], v[44:47], a[24:27], v[112:127]
    s_waitcnt vmcnt(4)
    s_barrier
    ds_read_b64_tr_b16 v[60:61], v7 offset:45056
    ds_read_b64_tr_b16 v[62:63], v7 offset:47104
    s_waitcnt lgkmcnt(6)
    v_mfma_f32_32x32x16_bf16 v[64:79], v[48:51], a[28:31], v[64:79]
    ds_read_b64_tr_b16 v[32:33], v4 offset:49152
    ds_read_b64_tr_b16 v[34:35], v4 offset:51200
    s_waitcnt lgkmcnt(6)
    v_mfma_f32_32x32x16_bf16 v[80:95], v[52:55], a[28:31], v[80:95]
    ds_read_b64_tr_b16 v[36:37], v4 offset:53248
    ds_read_b64_tr_b16 v[38:39], v4 offset:55296
    s_waitcnt lgkmcnt(6)
    v_mfma_f32_32x32x16_bf16 v[96:111], v[56:59], a[28:31], v[96:111]
    ds_read_b64_tr_b16 v[40:41], v4 offset:57344
    ds_read_b64_tr_b16 v[42:43], v4 offset:59392
    s_waitcnt lgkmcnt(6)
    v_mfma_f32_32x32x16_bf16 v[112:127], v[60:63], a[28:31], v[112:127]
    ds_read_b64_tr_b16 v[44:45], v4 offset:61440
    ds_read_b64_tr_b16 v[46:47], v4 offset:63488
    s_waitcnt vmcnt(3) lgkmcnt(6)
    v_mfma_f32_32x32x16_bf16 v[64:79], v[32:35], a[32:35], v[64:79]
    ds_read_b64_tr_b16 v[48:49], v5 offset:49152
    ds_read_b64_tr_b16 v[50:51], v5 offset:51200
    s_lshl_b32 s38, s48, 6
    s_add_u32 s38, s38, s64
    s_lshl_b32 s38, s38, 4
    s_lshl_b32 s39, s50, 2
    s_add_u32 s38, s38, s39
    s_lshl_b32 s38, s38, 11
    s_add_u32 s46, s38, 67108864
    s_waitcnt vmcnt(2) lgkmcnt(6)
    v_mfma_f32_32x32x16_bf16 v[64:79], v[36:39], a[36:39], v[64:79]
    ds_read_b64_tr_b16 v[52:53], v5 offset:53248
    ds_read_b64_tr_b16 v[54:55], v5 offset:55296
    s_waitcnt vmcnt(1) lgkmcnt(6)
    v_mfma_f32_32x32x16_bf16 v[64:79], v[40:43], a[40:43], v[64:79]
    ds_read_b64_tr_b16 v[56:57], v5 offset:57344
    ds_read_b64_tr_b16 v[58:59], v5 offset:59392
    s_waitcnt vmcnt(0) lgkmcnt(6)
    v_mfma_f32_32x32x16_bf16 v[64:79], v[44:47], a[44:47], v[64:79]
    ds_read_b64_tr_b16 v[60:61], v5 offset:61440
    ds_read_b64_tr_b16 v[62:63], v5 offset:63488
    s_waitcnt lgkmcnt(6)
    v_mfma_f32_32x32x16_bf16 v[80:95], v[48:51], a[32:35], v[80:95]
    ds_read_b64_tr_b16 v[32:33], v6 offset:49152
    ds_read_b64_tr_b16 v[34:35], v6 offset:51200
    s_waitcnt lgkmcnt(6)
    v_mfma_f32_32x32x16_bf16 v[80:95], v[52:55], a[36:39], v[80:95]
    ds_read_b64_tr_b16 v[36:37], v6 offset:53248
    ds_read_b64_tr_b16 v[38:39], v6 offset:55296
    s_nop 1
    v_cvt_pk_bf16_f32 v64, v64, v65
    v_cvt_pk_bf16_f32 v65, v66, v67
    v_cvt_pk_bf16_f32 v66, v68, v69
    v_cvt_pk_bf16_f32 v67, v70, v71
    buffer_store_dwordx4 v[64:67], v2, s[28:31], s46 offen offset:0 sc1
    s_waitcnt lgkmcnt(6)
    v_mfma_f32_32x32x16_bf16 v[80:95], v[56:59], a[40:43], v[80:95]
    ds_read_b64_tr_b16 v[40:41], v6 offset:57344
    ds_read_b64_tr_b16 v[42:43], v6 offset:59392
    v_cvt_pk_bf16_f32 v68, v72, v73
    v_cvt_pk_bf16_f32 v69, v74, v75
    v_cvt_pk_bf16_f32 v70, v76, v77
    v_cvt_pk_bf16_f32 v71, v78, v79
    buffer_store_dwordx4 v[68:71], v2, s[28:31], s46 offen offset:1024 sc1
    s_waitcnt lgkmcnt(6)
    v_mfma_f32_32x32x16_bf16 v[80:95], v[60:63], a[44:47], v[80:95]
    ds_read_b64_tr_b16 v[44:45], v6 offset:61440
    ds_read_b64_tr_b16 v[46:47], v6 offset:63488
    s_waitcnt lgkmcnt(6)
    v_mfma_f32_32x32x16_bf16 v[96:111], v[32:35], a[32:35], v[96:111]
    ds_read_b64_tr_b16 v[48:49], v7 offset:49152
    ds_read_b64_tr_b16 v[50:51], v7 offset:51200
    s_waitcnt lgkmcnt(6)
    v_mfma_f32_32x32x16_bf16 v[96:111], v[36:39], a[36:39], v[96:111]
    ds_read_b64_tr_b16 v[52:53], v7 offset:53248
    ds_read_b64_tr_b16 v[54:55], v7 offset:55296
    s_nop 1
    v_cvt_pk_bf16_f32 v80, v80, v81
    v_cvt_pk_bf16_f32 v81, v82, v83
    v_cvt_pk_bf16_f32 v82, v84, v85
    v_cvt_pk_bf16_f32 v83, v86, v87
    buffer_store_dwordx4 v[80:83], v2, s[28:31], s46 offen offset:2048 sc1
    s_waitcnt lgkmcnt(6)
    v_mfma_f32_32x32x16_bf16 v[96:111], v[40:43], a[40:43], v[96:111]
    ds_read_b64_tr_b16 v[56:57], v7 offset:57344
    ds_read_b64_tr_b16 v[58:59], v7 offset:59392
    v_cvt_pk_bf16_f32 v84, v88, v89
    v_cvt_pk_bf16_f32 v85, v90, v91
    v_cvt_pk_bf16_f32 v86, v92, v93
    v_cvt_pk_bf16_f32 v87, v94, v95
    buffer_store_dwordx4 v[84:87], v2, s[28:31], s46 offen offset:3072 sc1
    s_waitcnt lgkmcnt(6)
    v_mfma_f32_32x32x16_bf16 v[96:111], v[44:47], a[44:47], v[96:111]
    ds_read_b64_tr_b16 v[60:61], v7 offset:61440
    ds_read_b64_tr_b16 v[62:63], v7 offset:63488
    s_waitcnt lgkmcnt(6)
    v_mfma_f32_32x32x16_bf16 v[112:127], v[48:51], a[32:35], v[112:127]
    s_waitcnt lgkmcnt(4)
    v_mfma_f32_32x32x16_bf16 v[112:127], v[52:55], a[36:39], v[112:127]
    s_nop 5
    v_cvt_pk_bf16_f32 v96, v96, v97
    v_cvt_pk_bf16_f32 v97, v98, v99
    v_cvt_pk_bf16_f32 v98, v100, v101
    s_nop 2
    v_cvt_pk_bf16_f32 v99, v102, v103
    s_add_u32 s46, s46, 4096
    buffer_store_dwordx4 v[96:99], v2, s[28:31], s46 offen offset:0 sc1
    s_waitcnt lgkmcnt(2)
    v_mfma_f32_32x32x16_bf16 v[112:127], v[56:59], a[40:43], v[112:127]
    v_cvt_pk_bf16_f32 v100, v104, v105
    v_cvt_pk_bf16_f32 v101, v106, v107
    v_cvt_pk_bf16_f32 v102, v108, v109
    v_cvt_pk_bf16_f32 v103, v110, v111
    buffer_store_dwordx4 v[100:103], v2, s[28:31], s46 offen offset:1024 sc1
    s_waitcnt lgkmcnt(0)
    v_mfma_f32_32x32x16_bf16 v[112:127], v[60:63], a[44:47], v[112:127]
    s_nop 11
    v_cvt_pk_bf16_f32 v112, v112, v113
    v_cvt_pk_bf16_f32 v113, v114, v115
    v_cvt_pk_bf16_f32 v114, v116, v117
    v_cvt_pk_bf16_f32 v115, v118, v119
    buffer_store_dwordx4 v[112:115], v2, s[28:31], s46 offen offset:2048 sc1
    v_cvt_pk_bf16_f32 v116, v120, v121
    v_cvt_pk_bf16_f32 v117, v122, v123
    v_cvt_pk_bf16_f32 v118, v124, v125
    v_cvt_pk_bf16_f32 v119, v126, v127
    s_nop 2
    buffer_store_dwordx4 v[116:119], v2, s[28:31], s46 offen offset:3072 sc1
    s_branch K3_epi
K3_epi:
    s_mov_b32 s53, s48
    s_mov_b32 s54, s49
    s_mov_b32 s55, s50
    s_mov_b32 s48, s4
    s_and_b32 s49, s5, 0xffff
    s_mov_b32 s50, 2097152
    s_mov_b32 s51, 0x20000
    s_mov_b32 s72, s24
    s_and_b32 s73, s25, 0xffff
    s_mov_b32 s74, 2097152
    s_mov_b32 s75, 0x20000
    s_lshl_b32 s38, s54, 3
    s_add_u32 s40, s38, s53
    s_lshl_b32 s38, s55, 2
    s_and_b32 s39, s3, 3
    s_add_u32 s41, s38, s39
    s_lshr_b32 s42, s3, 2
    s_lshl_b32 s38, s40, 15
    s_lshl_b32 s39, s41, 6
    s_add_u32 s43, s38, s39
    s_lshl_b32 s39, s42, 5
    s_add_u32 s43, s43, s39
    v_and_b32 v3, 31, v1
    v_lshlrev_b32 v3, 10, v3
    v_lshrrev_b32 v16, 5, v1
    v_lshlrev_b32 v16, 3, v16
    v_add_u32 v3, v3, v16
    buffer_load_dwordx2 v[8:9], v3, s[48:51], s43 offen offset:0
    buffer_load_dwordx2 v[10:11], v3, s[48:51], s43 offen offset:16
    s_waitcnt vmcnt(0)
    s_barrier
    s_cmp_lg_u32 s3, 0
    s_cbranch_scc1 ON49
    s_lshl_b32 s38, s54, 2
    s_add_u32 s38, s38, s55
    s_lshl_b32 s44, s38, 7
    s_add_u32 s44, s44, 83898368
    v_mbcnt_lo_u32_b32 v16, -1, 0
    v_mbcnt_hi_u32_b32 v16, -1, v16
    v_cmp_eq_u32 vcc, 0, v16
    v_mov_b32 v17, 0x7fffff00
    s_nop 0
    v_cndmask_b32 v16, v17, v16, vcc
    v_mov_b32 v17, 1
    buffer_atomic_add v17, v16, s[28:31], s44 offen sc1
    s_mov_b32 s95, 0
    v_mov_b32 v17, 0
SP8:
    buffer_load_dword v16, v17, s[28:31], s44 offen sc1
    s_waitcnt vmcnt(0)
    v_readfirstlane_b32 s38, v16
    s_cmp_ge_u32 s38, 8
    s_cbranch_scc1 SP8_d
    s_add_u32 s95, s95, 1
    s_cmp_lt_u32 s95, 262144
    s_cbranch_scc1 SP8
SP8_d:
ON49:
    s_barrier
    s_lshl_b32 s38, s40, 4
    s_add_u32 s38, s38, s41
    s_lshl_b32 s38, s38, 11
    s_lshl_b32 s39, s42, 10
    s_add_u32 s38, s38, s39
    s_add_u32 s38, s38, 67108864
    buffer_load_dwordx4 v[16:19], v2, s[28:31], s38 offen sc1
    s_add_u32 s38, s38, 2097152
    buffer_load_dwordx4 v[20:23], v2, s[28:31], s38 offen sc1
    s_add_u32 s38, s38, 2097152
    buffer_load_dwordx4 v[24:27], v2, s[28:31], s38 offen sc1
    s_add_u32 s38, s38, 2097152
    buffer_load_dwordx4 v[28:31], v2, s[28:31], s38 offen sc1
    s_add_u32 s38, s38, 2097152
    buffer_load_dwordx4 v[32:35], v2, s[28:31], s38 offen sc1
    s_add_u32 s38, s38, 2097152
    buffer_load_dwordx4 v[36:39], v2, s[28:31], s38 offen sc1
    s_add_u32 s38, s38, 2097152
    buffer_load_dwordx4 v[40:43], v2, s[28:31], s38 offen sc1
    s_add_u32 s38, s38, 2097152
    buffer_load_dwordx4 v[44:47], v2, s[28:31], s38 offen sc1
    v_lshlrev_b32 v64, 16, v8
    v_and_b32 v65, 0xffff0000, v8
    v_lshlrev_b32 v66, 16, v9
    v_and_b32 v67, 0xffff0000, v9
    v_lshlrev_b32 v68, 16, v10
    v_and_b32 v69, 0xffff0000, v10
    v_lshlrev_b32 v70, 16, v11
    v_and_b32 v71, 0xffff0000, v11
    s_waitcnt vmcnt(7)
    v_lshlrev_b32 v5, 16, v16
    v_and_b32 v6, 0xffff0000, v16
    v_add_f32 v64, v64, v5
    v_add_f32 v65, v65, v6
    v_lshlrev_b32 v5, 16, v17
    v_and_b32 v6, 0xffff0000, v17
    v_add_f32 v66, v66, v5
    v_add_f32 v67, v67, v6
    v_lshlrev_b32 v5, 16, v18
    v_and_b32 v6, 0xffff0000, v18
    v_add_f32 v68, v68, v5
    v_add_f32 v69, v69, v6
    v_lshlrev_b32 v5, 16, v19
    v_and_b32 v6, 0xffff0000, v19
    v_add_f32 v70, v70, v5
    v_add_f32 v71, v71, v6
    s_waitcnt vmcnt(6)
    v_lshlrev_b32 v5, 16, v20
    v_and_b32 v6, 0xffff0000, v20
    v_add_f32 v64, v64, v5
    v_add_f32 v65, v65, v6
    v_lshlrev_b32 v5, 16, v21
    v_and_b32 v6, 0xffff0000, v21
    v_add_f32 v66, v66, v5
    v_add_f32 v67, v67, v6
    v_lshlrev_b32 v5, 16, v22
    v_and_b32 v6, 0xffff0000, v22
    v_add_f32 v68, v68, v5
    v_add_f32 v69, v69, v6
    v_lshlrev_b32 v5, 16, v23
    v_and_b32 v6, 0xffff0000, v23
    v_add_f32 v70, v70, v5
    v_add_f32 v71, v71, v6
    s_waitcnt vmcnt(5)
    v_lshlrev_b32 v5, 16, v24
    v_and_b32 v6, 0xffff0000, v24
    v_add_f32 v64, v64, v5
    v_add_f32 v65, v65, v6
    v_lshlrev_b32 v5, 16, v25
    v_and_b32 v6, 0xffff0000, v25
    v_add_f32 v66, v66, v5
    v_add_f32 v67, v67, v6
    v_lshlrev_b32 v5, 16, v26
    v_and_b32 v6, 0xffff0000, v26
    v_add_f32 v68, v68, v5
    v_add_f32 v69, v69, v6
    v_lshlrev_b32 v5, 16, v27
    v_and_b32 v6, 0xffff0000, v27
    v_add_f32 v70, v70, v5
    v_add_f32 v71, v71, v6
    s_waitcnt vmcnt(4)
    v_lshlrev_b32 v5, 16, v28
    v_and_b32 v6, 0xffff0000, v28
    v_add_f32 v64, v64, v5
    v_add_f32 v65, v65, v6
    v_lshlrev_b32 v5, 16, v29
    v_and_b32 v6, 0xffff0000, v29
    v_add_f32 v66, v66, v5
    v_add_f32 v67, v67, v6
    v_lshlrev_b32 v5, 16, v30
    v_and_b32 v6, 0xffff0000, v30
    v_add_f32 v68, v68, v5
    v_add_f32 v69, v69, v6
    v_lshlrev_b32 v5, 16, v31
    v_and_b32 v6, 0xffff0000, v31
    v_add_f32 v70, v70, v5
    v_add_f32 v71, v71, v6
    s_waitcnt vmcnt(3)
    v_lshlrev_b32 v5, 16, v32
    v_and_b32 v6, 0xffff0000, v32
    v_add_f32 v64, v64, v5
    v_add_f32 v65, v65, v6
    v_lshlrev_b32 v5, 16, v33
    v_and_b32 v6, 0xffff0000, v33
    v_add_f32 v66, v66, v5
    v_add_f32 v67, v67, v6
    v_lshlrev_b32 v5, 16, v34
    v_and_b32 v6, 0xffff0000, v34
    v_add_f32 v68, v68, v5
    v_add_f32 v69, v69, v6
    v_lshlrev_b32 v5, 16, v35
    v_and_b32 v6, 0xffff0000, v35
    v_add_f32 v70, v70, v5
    v_add_f32 v71, v71, v6
    s_waitcnt vmcnt(2)
    v_lshlrev_b32 v5, 16, v36
    v_and_b32 v6, 0xffff0000, v36
    v_add_f32 v64, v64, v5
    v_add_f32 v65, v65, v6
    v_lshlrev_b32 v5, 16, v37
    v_and_b32 v6, 0xffff0000, v37
    v_add_f32 v66, v66, v5
    v_add_f32 v67, v67, v6
    v_lshlrev_b32 v5, 16, v38
    v_and_b32 v6, 0xffff0000, v38
    v_add_f32 v68, v68, v5
    v_add_f32 v69, v69, v6
    v_lshlrev_b32 v5, 16, v39
    v_and_b32 v6, 0xffff0000, v39
    v_add_f32 v70, v70, v5
    v_add_f32 v71, v71, v6
    s_waitcnt vmcnt(1)
    v_lshlrev_b32 v5, 16, v40
    v_and_b32 v6, 0xffff0000, v40
    v_add_f32 v64, v64, v5
    v_add_f32 v65, v65, v6
    v_lshlrev_b32 v5, 16, v41
    v_and_b32 v6, 0xffff0000, v41
    v_add_f32 v66, v66, v5
    v_add_f32 v67, v67, v6
    v_lshlrev_b32 v5, 16, v42
    v_and_b32 v6, 0xffff0000, v42
    v_add_f32 v68, v68, v5
    v_add_f32 v69, v69, v6
    v_lshlrev_b32 v5, 16, v43
    v_and_b32 v6, 0xffff0000, v43
    v_add_f32 v70, v70, v5
    v_add_f32 v71, v71, v6
    s_waitcnt vmcnt(0)
    v_lshlrev_b32 v5, 16, v44
    v_and_b32 v6, 0xffff0000, v44
    v_add_f32 v64, v64, v5
    v_add_f32 v65, v65, v6
    v_lshlrev_b32 v5, 16, v45
    v_and_b32 v6, 0xffff0000, v45
    v_add_f32 v66, v66, v5
    v_add_f32 v67, v67, v6
    v_lshlrev_b32 v5, 16, v46
    v_and_b32 v6, 0xffff0000, v46
    v_add_f32 v68, v68, v5
    v_add_f32 v69, v69, v6
    v_lshlrev_b32 v5, 16, v47
    v_and_b32 v6, 0xffff0000, v47
    v_add_f32 v70, v70, v5
    v_add_f32 v71, v71, v6
    v_cvt_pk_bf16_f32 v8, v64, v65
    v_cvt_pk_bf16_f32 v9, v66, v67
    v_cvt_pk_bf16_f32 v10, v68, v69
    v_cvt_pk_bf16_f32 v11, v70, v71
    buffer_store_dwordx2 v[8:9], v3, s[72:75], s43 offen offset:0
    buffer_store_dwordx2 v[10:11], v3, s[72:75], s43 offen offset:16
K_end:
    s_endpgm
K_code_end:
.section .rodata,"a"
.p2align 6
.amdhsa_kernel parallel_sum__compressed_kv_cla__swiglu_ffn__prompt_kernel
  .amdhsa_next_free_vgpr 256
  .amdhsa_next_free_sgpr 102
  .amdhsa_accum_offset 128
  .amdhsa_group_segment_fixed_size 0
  .amdhsa_kernarg_size 104
  .amdhsa_user_sgpr_count 2
  .amdhsa_user_sgpr_kernarg_segment_ptr 1
  .amdhsa_system_sgpr_workgroup_id_x 1
  .amdhsa_float_denorm_mode_32 3
.end_amdhsa_kernel
.text
```
